```python
import torch

def _softmax(x, axis=-1):
    return torch.softmax(x, dim=axis)

def _gelu(x):
    return torch.nn.functional.gelu(x, approximate='tanh')

def _silu(x):
    return torch.nn.functional.silu(x)

def _sigmoid(x):
    return torch.sigmoid(x)

def _layernorm(x, axis=-1, eps=1e-05):
    m = x.mean(dim=axis, keepdim=True)
    v = x.var(dim=axis, keepdim=True, unbiased=False)
    return (x - m) / torch.sqrt(v + eps)

def _scatter_add(tgt, idx, src, axis=0):
    return tgt.clone().index_add_(axis, idx, src)

def _segment_sum(src, seg, n):
    out = torch.zeros((n,) + src.shape[1:], dtype=src.dtype)
    return out.index_add_(0, seg, src)

def _pad(x, pw):
    flat = tuple((v for pair in reversed(pw) for v in pair))
    return torch.nn.functional.pad(x, flat)
kernel_name = 'adaLN_cond__sliding_block_cached__glu_gated_glu__prompt'

def setup_inputs():

    _w = lambda a: (lambda t: t.to(torch.bfloat16) if t.is_floating_point() else t)(torch.as_tensor(a))

    def _A_setup():
        B, Sq, D = (1, 2048, 576)
        Hq, Hkv, Sk, Dh = (32, 16, 2048, 128)
        assert Hq % Hkv == 0, (Hq, Hkv)
        return {'x': _w((lambda *s: torch.randn(*s, dtype=torch.bfloat16) * 0.05)(B, Sq, D)), 'k_cache': _w((lambda *s: torch.randn(*s, dtype=torch.bfloat16) * 3.2)(B, Hkv, Sk, Dh)), 'v_cache': _w((lambda *s: torch.randn(*s, dtype=torch.bfloat16) * 0.4)(B, Hkv, Sk, Dh)), 'wq': _w((lambda *s: torch.randn(*s, dtype=torch.bfloat16) * 3.2)(D, Hq * Dh) * D ** (-0.5)), 'wo': _w((lambda *s: torch.randn(*s, dtype=torch.bfloat16) * 0.4)(Hq * Dh, D) * (Hq * Dh) ** (-0.5))}
    _A_in = _A_setup()

    def _B_setup():
        B, S, D, F = (1, 2048, 576, 4608)
        return {'x': _w((lambda *s: torch.randn(*s, dtype=torch.bfloat16) * 0.05)(B, S, D)), 'w_gate': _w((lambda *s: torch.randn(*s, dtype=torch.bfloat16) * 0.05)(D, F)), 'w_up': _w((lambda *s: torch.randn(*s, dtype=torch.bfloat16) * 0.05)(D, F)), 'w_down': _w((lambda *s: torch.randn(*s, dtype=torch.bfloat16) * 0.05)(F, D))}
    _B_in = _B_setup()
    return {'A_x': _A_in['x'], 'A_k_cache': _A_in['k_cache'], 'A_v_cache': _A_in['v_cache'], 'A_wq': _A_in['wq'], 'A_wo': _A_in['wo'], 'B_x': _B_in['x'], 'B_w_gate': _B_in['w_gate'], 'B_w_up': _B_in['w_up'], 'B_w_down': _B_in['w_down'], 'c': _w((lambda *s: torch.randn(*s, dtype=torch.bfloat16) * 0.1)(1, 576) * 8.0), 'w_mod': _w((lambda *s: torch.randn(*s, dtype=torch.bfloat16) * 0.1)(576, 6 * 576) * 576 ** (-0.5) * 8.0)}

def reference(A_x, A_k_cache, A_v_cache, A_wq, A_wo, B_x, B_w_gate, B_w_up, B_w_down, c, w_mod):

    def _A_ref(x, k_cache, v_cache, wq, wo):
        B, Sq, D = x.shape
        Hq, Dh = (32, 128)
        Hkv, Sk = (k_cache.shape[1], k_cache.shape[2])
        W = min(4096, max(256, Sk // 4))
        rep = Hq // Hkv
        q = (lambda x, *d: x.permute(*d))((x @ wq).reshape(B, Sq, Hq, Dh), 0, 2, 1, 3)
        k = (lambda x, n, axis: torch.repeat_interleave(x, n, dim=axis))(k_cache[:, :, Sk - W:, :], rep, axis=1)
        v = (lambda x, n, axis: torch.repeat_interleave(x, n, dim=axis))(v_cache[:, :, Sk - W:, :], rep, axis=1)
        scores = torch.einsum('bhqd,bhkd->bhqk', q, k) * Dh ** (-0.5)
        p = _softmax(scores, axis=-1)
        o = torch.einsum('bhqk,bhkd->bhqd', p, v)
        return (lambda x, *d: x.permute(*d))(o, 0, 2, 1, 3).reshape(B, Sq, Hq * Dh) @ wo

    def _B_ref(x, w_gate, w_up, w_down):
        g = torch.einsum('bsd,df->bsf', x, w_gate)
        u = torch.einsum('bsd,df->bsf', x, w_up)
        h = _sigmoid(g) * u
        return torch.einsum('bsf,fd->bsd', h, w_down)
    x = A_x
    mod = (_silu(c) @ w_mod).reshape(c.shape[0], 6, 1, -1)
    sa, ca, ga, sb, cb, gb = (mod[:, 0].clone(), mod[:, 1].clone(), mod[:, 2].clone(), mod[:, 3].clone(), mod[:, 4].clone(), mod[:, 5].clone())
    h = _layernorm(x, axis=-1) * (1 + ca) + sa
    x = x + ga * _A_ref(h, A_k_cache, A_v_cache, A_wq, A_wo)
    h = _layernorm(x, axis=-1) * (1 + cb) + sb
    x = x + gb * _B_ref(h, B_w_gate, B_w_up, B_w_down)
    return x
```

```asm
; @launch grid=(256,1,1) block=(256,1,1) lds=163840
.amdgcn_target "amdgcn-amd-amdhsa--gfx950"
.text
.globl adaLN_cond__sliding_block_cached__glu_gated_glu__prompt_kernel
.p2align 8
.type adaLN_cond__sliding_block_cached__glu_gated_glu__prompt_kernel,@function
adaLN_cond__sliding_block_cached__glu_gated_glu__prompt_kernel:
s_getpc_b64 s[8:9]
s_cmp_ge_u32 s2, 256
s_cbranch_scc1 END
s_load_dwordx2 s[36:37], s[0:1], 104
s_load_dwordx2 s[92:93], s[0:1], 72
s_load_dwordx2 s[96:97], s[0:1], 80
s_load_dwordx2 s[16:17], s[0:1], 0
s_load_dwordx2 s[28:29], s[0:1], 24
s_load_dwordx2 s[20:21], s[0:1], 8
s_load_dwordx2 s[24:25], s[0:1], 16
s_load_dwordx2 s[32:33], s[0:1], 32
s_load_dwordx2 s[72:73], s[0:1], 48
s_load_dwordx2 s[76:77], s[0:1], 56
s_load_dwordx2 s[80:81], s[0:1], 64
s_load_dwordx2 s[84:85], s[0:1], 88
s_mov_b32 s38, 268435456
s_mov_b32 s39, 0x20000
s_mov_b32 s94, 1152
s_mov_b32 s95, 0x20000
s_mov_b32 s98, 3981312
s_mov_b32 s99, 0x20000
s_mov_b32 s18, 2359296
s_mov_b32 s19, 0x20000
s_mov_b32 s30, 4718592
s_mov_b32 s31, 0x20000
s_mov_b32 s22, 8388608
s_mov_b32 s23, 0x20000
s_mov_b32 s26, 8388608
s_mov_b32 s27, 0x20000
s_mov_b32 s34, 4718592
s_mov_b32 s35, 0x20000
s_mov_b32 s74, 5308416
s_mov_b32 s75, 0x20000
s_mov_b32 s78, 5308416
s_mov_b32 s79, 0x20000
s_mov_b32 s82, 5308416
s_mov_b32 s83, 0x20000
s_mov_b32 s86, 2359296
s_mov_b32 s87, 0x20000
s_mov_b32 s10, CODE_END-adaLN_cond__sliding_block_cached__glu_gated_glu__prompt_kernel-4
s_mov_b32 s11, 0x20000
v_and_b32 v1, 63, v0
v_lshrrev_b32 v2, 6, v0
s_nop 0
v_readfirstlane_b32 s40, v2
v_lshlrev_b32 v224, 4, v1
s_lshr_b32 s41, s2, 3
s_and_b32 s42, s2, 7
s_lshr_b32 s45, s2, 5
s_lshl_b32 s45, s45, 3
s_and_b32 s46, s2, 7
s_add_u32 s45, s45, s46
s_lshl_b32 s45, s45, 2
s_bfe_u32 s46, s2, 0x20003
s_add_u32 s15, s45, s46
s_lshl_b32 s45, s15, 5
s_cmp_lt_u32 s15, 216
s_cselect_b32 s45, s45, 2146435072
v_and_b32 v2, 0xfe, v0
v_and_b32 v5, 1, v0
v_lshrrev_b32 v6, 3, v1
v_and_b32 v7, 7, v1
v_mul_u32_u24 v4, 1152, v6
v_lshl_add_u32 v4, v7, 4, v4
s_lshl_b32 s46, s41, 2
s_add_u32 s46, s46, s40
s_lshl_b32 s46, s46, 1
s_xor_b32 s46, s46, s42
s_andn2_b32 s46, s46, 1
s_mul_i32 s60, s46, 9216
s_add_u32 s61, s60, 9216
s_and_b32 s47, s15, 3
s_mul_i32 s47, s47, 288
v_add_u32 v2, s47, v2
v_lshlrev_b32 v3, 4, v5
v_mov_b32 v8, 3456
v_lshrrev_b32 v9, 7, v0
v_add_u32 v36, 0, v2
v_subrev_u32 v10, 1152, v36
v_min_u32 v36, v36, v10
v_mad_u32_u24 v44, v36, v8, v3
v_add_u32 v37, 256, v2
v_subrev_u32 v10, 1152, v37
v_min_u32 v37, v37, v10
v_mad_u32_u24 v45, v37, v8, v3
v_add_u32 v38, 512, v2
v_subrev_u32 v10, 1152, v38
v_min_u32 v38, v38, v10
v_mad_u32_u24 v46, v38, v8, v3
v_add_u32 v39, 768, v2
v_subrev_u32 v10, 1152, v39
v_min_u32 v39, v39, v10
v_mad_u32_u24 v47, v39, v8, v3
v_add_u32 v40, 1024, v2
v_subrev_u32 v10, 1152, v40
v_min_u32 v40, v40, v10
v_lshl_add_u32 v40, v9, 11, v40
v_mad_u32_u24 v48, v40, v8, v3
s_waitcnt lgkmcnt(0)
buffer_load_dword v10, off, s[36:39], 0
buffer_load_ushort v11, v36, s[92:95], 0 offen
buffer_load_ushort v12, v37, s[92:95], 0 offen
buffer_load_ushort v13, v38, s[92:95], 0 offen
buffer_load_ushort v14, v39, s[92:95], 0 offen
buffer_load_ushort v15, v40, s[92:95], 0 offen
buffer_load_dwordx4 v[16:19], v44, s[96:99], s45 offen nt
buffer_load_dwordx4 v[20:23], v45, s[96:99], s45 offen nt
buffer_load_dwordx4 v[24:27], v46, s[96:99], s45 offen nt
buffer_load_dwordx4 v[28:31], v47, s[96:99], s45 offen nt
buffer_load_dwordx4 v[32:35], v48, s[96:99], s45 offen nt
buffer_load_dwordx4 v[150:153], v4, s[16:19], s60 offen offset:0
buffer_load_dwordx4 v[154:157], v4, s[16:19], s60 offen offset:128
buffer_load_dwordx4 v[158:161], v4, s[16:19], s60 offen offset:256
buffer_load_dwordx4 v[162:165], v4, s[16:19], s60 offen offset:384
buffer_load_dwordx4 v[166:169], v4, s[16:19], s60 offen offset:512
buffer_load_dwordx4 v[170:173], v4, s[16:19], s60 offen offset:640
buffer_load_dwordx4 v[174:177], v4, s[16:19], s60 offen offset:768
buffer_load_dwordx4 v[178:181], v4, s[16:19], s60 offen offset:896
buffer_load_dwordx4 v[182:185], v4, s[16:19], s60 offen offset:1024
v_lshlrev_b32 v247, 12, v0
v_min_u32 v8, 143, v0
v_and_b32 v9, 7, v8
v_lshrrev_b32 v8, 3, v8
v_lshlrev_b32 v9, 7, v9
v_lshl_add_u32 v223, v8, 13, v9
s_lshr_b32 s45, s2, 3
s_mul_i32 s45, s45, 147456
s_lshl_b32 s46, s42, 10
s_add_u32 s62, s45, s46
s_lshl_b32 s45, s40, 8
s_add_u32 s58, s46, s45
s_mul_i32 s43, s40, 20480
s_add_u32 s43, s43, 73728
s_mov_b32 s100, 0x3f803f80
s_movk_i32 s101, 0x3f80
s_mov_b32 s65, 0x3f800000
s_and_b32 s12, s2, 7
s_mul_i32 s12, s12, 20480
s_add_u32 s12, s12, 4096
s_add_u32 s13, s12, 4608
s_add_u32 s14, s12, 9216
v_xor_b32 v8, v6, v7
v_lshlrev_b32 v8, 4, v8
v_lshl_add_u32 v8, v7, 10, v8
s_and_b32 s47, s42, 1
s_lshl_b32 s47, s47, 7
s_add_u32 s47, s47, s45
v_add_u32 v250, s47, v8
v_lshlrev_b32 v8, 5, v7
v_add_u32 v251, 155648, v8
v_min_u32 v8, 143, v0
v_lshlrev_b32 v252, 4, v8
v_lshrrev_b32 v9, 3, v8
v_lshlrev_b32 v9, 6, v9
v_and_b32 v36, 3, v8
v_lshl_add_u32 v9, v36, 4, v9
v_bfe_u32 v36, v8, 2, 1
v_lshl_add_u32 v9, v36, 3, v9
v_add_u32 v253, 155648, v9
v_min_u32 v8, 39, v0
v_lshlrev_b32 v8, 6, v8
v_add_u32 v254, 13828, v8
v_or_b32 v8, s2, v0
v_min_u32 v8, 1, v8
v_lshlrev_b32 v255, 30, v8
v_lshrrev_b32 v36, 4, v1
v_and_b32 v37, 15, v1
v_xor_b32 v8, v36, v37
v_lshlrev_b32 v8, 4, v8
v_lshl_add_u32 v238, v36, 10, v8
v_xor_b32 v239, 64, v238
v_add_u32 v240, 65536, v238
v_add_u32 v241, 65536, v239
v_bfe_u32 v8, v1, 1, 2
v_lshlrev_b32 v8, 1, v8
v_xor_b32 v8, v8, v36
v_lshlrev_b32 v8, 4, v8
v_lshl_add_u32 v8, v37, 7, v8
s_lshr_b32 s46, s40, 1
s_lshl_b32 s47, s46, 13
v_add_u32 v244, s47, v8
v_xor_b32 v245, 64, v244
s_add_u32 s56, s47, 32768
s_lshl_b32 s50, s40, 12
s_lshl_b32 s47, s42, 1
s_add_u32 s47, s47, s46
s_lshl_b32 s47, s47, 19
s_and_b32 s48, s40, 1
s_lshl_b32 s48, s48, 7
s_add_u32 s47, s47, s48
s_add_u32 s55, s47, 393216
s_add_u32 s52, s55, 122880
s_mov_b32 s53, -1
s_mov_b32 s54, 0xc2200000
s_mul_i32 s59, s42, 589824
s_lshr_b32 s45, s45, 1
s_add_u32 s59, s59, s45
v_bfe_u32 v8, v1, 2, 2
v_bfe_u32 v9, v1, 3, 2
v_lshlrev_b32 v9, 5, v9
v_lshl_add_u32 v9, v8, 7, v9
v_and_b32 v8, 3, v1
v_lshl_add_u32 v8, v8, 3, v9
v_lshl_add_u32 v225, v36, 9, v8
v_lshl_add_u32 v9, v5, 4, v9
v_bfe_u32 v8, v1, 1, 1
v_lshl_add_u32 v9, v8, 3, v9
v_lshl_add_u32 v9, v36, 10, v9
s_lshl_b32 s46, s46, 6
v_xor_b32 v242, s46, v225
v_xor_b32 v243, 32, v242
s_lshl_b32 s46, s40, 13
v_add_u32 v246, s46, v224
v_add_u32 v226, s43, v9
v_xor_b32 v227, 32, v226
v_xor_b32 v228, 64, v226
v_xor_b32 v229, 96, v226
v_lshrrev_b32 v8, 7, v224
v_mul_u32_u24 v8, 8192, v8
v_bfe_u32 v9, v224, 8, 1
v_lshlrev_b32 v9, 5, v9
v_xor_b32 v9, v9, v224
v_and_b32 v9, 0x70, v9
v_add_u32 v230, v8, v9
v_xor_b32 v231, 64, v230
v_add_u32 v231, 64512, v231
v_add_u32 v232, 129024, v230
v_add_u32 v233, 129024, v231
v_lshrrev_b32 v8, 7, v224
v_mul_u32_u24 v8, 256, v8
v_bfe_u32 v9, v224, 8, 2
v_lshlrev_b32 v9, 5, v9
v_xor_b32 v9, v9, v224
v_and_b32 v9, 0x70, v9
v_add_u32 v234, v8, v9
v_add_u32 v235, 1024, v234
v_add_u32 v236, 2048, v234
v_add_u32 v237, 2048, v235
v_and_b32 v8, 0xc0, v0
v_lshl_add_u32 v8, v5, 5, v8
v_bfe_u32 v9, v0, 4, 1
v_lshl_add_u32 v8, v9, 3, v8
v_bfe_u32 v9, v0, 5, 1
v_lshl_add_u32 v8, v9, 2, v8
v_add_u32 v8, 160768, v8
v_lshlrev_b32 v7, 3, v7
v_add_u32 v9, 160768, v7
v_mul_u32_u24 v6, 20480, v6
v_add_u32 v7, v7, v6
v_lshrrev_b32 v6, 6, v0
v_lshl_add_u32 v7, v6, 29, v7
v_min_u32 v222, 127, v0
s_andn2_b32 s47, 1, s41
s_lshl_b32 s47, s47, 30
v_lshl_add_u32 v222, v222, 7, s47
s_lshl_b32 s15, s15, 6
s_add_u32 s15, s15, 4096
s_waitcnt vmcnt(19)
v_readfirstlane_b32 s3, v10
s_nop 1
s_add_u32 s3, s3, 0x9E3779B9
s_waitcnt vmcnt(18)
v_lshlrev_b32 v11, 16, v11
s_waitcnt vmcnt(17)
v_lshlrev_b32 v12, 16, v12
s_waitcnt vmcnt(16)
v_lshlrev_b32 v13, 16, v13
s_waitcnt vmcnt(15)
v_lshlrev_b32 v14, 16, v14
s_waitcnt vmcnt(14)
v_lshlrev_b32 v15, 16, v15
v_mul_f32 v36, 0xbfb8aa3b, v11
v_mul_f32 v37, 0xbfb8aa3b, v12
v_mul_f32 v38, 0xbfb8aa3b, v13
v_mul_f32 v39, 0xbfb8aa3b, v14
v_mul_f32 v40, 0xbfb8aa3b, v15
v_exp_f32 v36, v36
v_exp_f32 v37, v37
v_exp_f32 v38, v38
v_exp_f32 v39, v39
v_exp_f32 v40, v40
v_add_f32 v36, 1.0, v36
v_add_f32 v37, 1.0, v37
v_add_f32 v38, 1.0, v38
v_add_f32 v39, 1.0, v39
v_add_f32 v40, 1.0, v40
v_rcp_f32 v36, v36
v_rcp_f32 v37, v37
v_rcp_f32 v38, v38
v_rcp_f32 v39, v39
v_rcp_f32 v40, v40
v_mul_f32 v36, v36, v11
v_mul_f32 v37, v37, v12
v_mul_f32 v38, v38, v13
v_mul_f32 v39, v39, v14
v_mul_f32 v40, v40, v15
v_cvt_pk_bf16_f32 v11, v36, 0
v_cvt_pk_bf16_f32 v12, v37, 0
v_cvt_pk_bf16_f32 v13, v38, 0
v_cvt_pk_bf16_f32 v14, v39, 0
v_cvt_pk_bf16_f32 v15, v40, 0
v_lshlrev_b32 v36, 16, v11
v_lshlrev_b32 v37, 16, v12
v_lshlrev_b32 v38, 16, v13
v_lshlrev_b32 v39, 16, v14
v_lshlrev_b32 v40, 16, v15
s_waitcnt vmcnt(13)
v_dot2_f32_bf16 v44, v16, v11, 0
v_dot2_f32_bf16 v45, v16, v36, 0
v_dot2_f32_bf16 v46, v17, v11, 0
v_dot2_f32_bf16 v47, v17, v36, 0
v_dot2_f32_bf16 v48, v18, v11, 0
v_dot2_f32_bf16 v49, v18, v36, 0
v_dot2_f32_bf16 v50, v19, v11, 0
v_dot2_f32_bf16 v51, v19, v36, 0
s_waitcnt vmcnt(12)
v_dot2_f32_bf16 v44, v20, v12, v44
v_dot2_f32_bf16 v45, v20, v37, v45
v_dot2_f32_bf16 v46, v21, v12, v46
v_dot2_f32_bf16 v47, v21, v37, v47
v_dot2_f32_bf16 v48, v22, v12, v48
v_dot2_f32_bf16 v49, v22, v37, v49
v_dot2_f32_bf16 v50, v23, v12, v50
v_dot2_f32_bf16 v51, v23, v37, v51
s_waitcnt vmcnt(11)
v_dot2_f32_bf16 v44, v24, v13, v44
v_dot2_f32_bf16 v45, v24, v38, v45
v_dot2_f32_bf16 v46, v25, v13, v46
v_dot2_f32_bf16 v47, v25, v38, v47
v_dot2_f32_bf16 v48, v26, v13, v48
v_dot2_f32_bf16 v49, v26, v38, v49
v_dot2_f32_bf16 v50, v27, v13, v50
v_dot2_f32_bf16 v51, v27, v38, v51
s_waitcnt vmcnt(10)
v_dot2_f32_bf16 v44, v28, v14, v44
v_dot2_f32_bf16 v45, v28, v39, v45
v_dot2_f32_bf16 v46, v29, v14, v46
v_dot2_f32_bf16 v47, v29, v39, v47
v_dot2_f32_bf16 v48, v30, v14, v48
v_dot2_f32_bf16 v49, v30, v39, v49
v_dot2_f32_bf16 v50, v31, v14, v50
v_dot2_f32_bf16 v51, v31, v39, v51
s_waitcnt vmcnt(9)
v_dot2_f32_bf16 v44, v32, v15, v44
v_dot2_f32_bf16 v45, v32, v40, v45
v_dot2_f32_bf16 v46, v33, v15, v46
v_dot2_f32_bf16 v47, v33, v40, v47
v_dot2_f32_bf16 v48, v34, v15, v48
v_dot2_f32_bf16 v49, v34, v40, v49
v_dot2_f32_bf16 v50, v35, v15, v50
v_dot2_f32_bf16 v51, v35, v40, v51
v_permlane32_swap_b32 v44, v45
v_permlane32_swap_b32 v46, v47
v_permlane32_swap_b32 v48, v49
v_permlane32_swap_b32 v50, v51
v_add_f32 v44, v44, v45
v_add_f32 v46, v46, v47
v_add_f32 v48, v48, v49
v_add_f32 v50, v50, v51
v_permlane16_swap_b32 v44, v46
s_nop 0
v_permlane16_swap_b32 v48, v50
v_add_f32 v44, v44, v46
v_add_f32 v48, v48, v50
s_nop 0
v_add_f32_dpp v44, v44, v44 quad_perm:[2,3,0,1] row_mask:0xf bank_mask:0xf
v_add_f32_dpp v48, v48, v48 quad_perm:[2,3,0,1] row_mask:0xf bank_mask:0xf
s_nop 0
v_add_f32_dpp v44, v44, v44 row_ror:4 row_mask:0xf bank_mask:0xf
v_add_f32_dpp v48, v48, v48 row_ror:4 row_mask:0xf bank_mask:0xf
s_nop 0
v_add_f32_dpp v44, v44, v44 row_ror:8 row_mask:0xf bank_mask:0xf
v_add_f32_dpp v48, v48, v48 row_ror:8 row_mask:0xf bank_mask:0xf
ds_write_b32 v8, v44
ds_write_b32 v8, v48 offset:16
s_waitcnt lgkmcnt(0)
s_barrier
ds_read2_b64 v[16:19], v9 offset1:8
ds_read2_b64 v[20:23], v9 offset0:16 offset1:24
s_waitcnt lgkmcnt(1)
v_pk_add_f32 v[16:17], v[16:17], v[18:19]
s_waitcnt lgkmcnt(0)
v_pk_add_f32 v[20:21], v[20:21], v[22:23]
v_pk_add_f32 v[16:17], v[16:17], v[20:21]
v_cvt_pk_bf16_f32 v16, v16, v17
v_mov_b32 v17, s3
buffer_store_dwordx2 v[16:17], v7, s[36:39], s15 offen sc1
buffer_load_dwordx4 v[186:189], v4, s[16:19], s61 offen offset:0
buffer_load_dwordx4 v[190:193], v4, s[16:19], s61 offen offset:128
buffer_load_dwordx4 v[194:197], v4, s[16:19], s61 offen offset:256
buffer_load_dwordx4 v[198:201], v4, s[16:19], s61 offen offset:384
buffer_load_dwordx4 v[202:205], v4, s[16:19], s61 offen offset:512
buffer_load_dwordx4 v[206:209], v4, s[16:19], s61 offen offset:640
buffer_load_dwordx4 v[210:213], v4, s[16:19], s61 offen offset:768
buffer_load_dwordx4 v[214:217], v4, s[16:19], s61 offen offset:896
buffer_load_dwordx4 v[218:221], v4, s[16:19], s61 offen offset:1024
s_lshr_b32 s45, s2, 3
s_lshl_b32 s45, s45, 7
buffer_load_dword v249, v247, s[8:11], s45 offen
s_waitcnt vmcnt(19)
v_dot2_f32_bf16 v144, v150, s100, 0
v_dot2_f32_bf16 v145, v151, s100, 0
v_dot2_f32_bf16 v146, v152, s100, 0
v_dot2_f32_bf16 v147, v153, s100, 0
s_waitcnt vmcnt(18)
v_dot2_f32_bf16 v144, v154, s100, v144
v_dot2_f32_bf16 v145, v155, s100, v145
v_dot2_f32_bf16 v146, v156, s100, v146
v_dot2_f32_bf16 v147, v157, s100, v147
s_waitcnt vmcnt(17)
v_dot2_f32_bf16 v144, v158, s100, v144
v_dot2_f32_bf16 v145, v159, s100, v145
v_dot2_f32_bf16 v146, v160, s100, v146
v_dot2_f32_bf16 v147, v161, s100, v147
s_waitcnt vmcnt(16)
v_dot2_f32_bf16 v144, v162, s100, v144
v_dot2_f32_bf16 v145, v163, s100, v145
v_dot2_f32_bf16 v146, v164, s100, v146
v_dot2_f32_bf16 v147, v165, s100, v147
s_waitcnt vmcnt(15)
v_dot2_f32_bf16 v144, v166, s100, v144
v_dot2_f32_bf16 v145, v167, s100, v145
v_dot2_f32_bf16 v146, v168, s100, v146
v_dot2_f32_bf16 v147, v169, s100, v147
s_waitcnt vmcnt(14)
v_dot2_f32_bf16 v144, v170, s100, v144
v_dot2_f32_bf16 v145, v171, s100, v145
v_dot2_f32_bf16 v146, v172, s100, v146
v_dot2_f32_bf16 v147, v173, s100, v147
s_waitcnt vmcnt(13)
v_dot2_f32_bf16 v144, v174, s100, v144
v_dot2_f32_bf16 v145, v175, s100, v145
v_dot2_f32_bf16 v146, v176, s100, v146
v_dot2_f32_bf16 v147, v177, s100, v147
s_waitcnt vmcnt(12)
v_dot2_f32_bf16 v144, v178, s100, v144
v_dot2_f32_bf16 v145, v179, s100, v145
v_dot2_f32_bf16 v146, v180, s100, v146
v_dot2_f32_bf16 v147, v181, s100, v147
s_waitcnt vmcnt(11)
v_dot2_f32_bf16 v144, v182, s100, v144
v_dot2_f32_bf16 v145, v183, s100, v145
v_dot2_f32_bf16 v146, v184, s100, v146
v_dot2_f32_bf16 v147, v185, s100, v147
s_nop 2
v_pk_add_f32 v[144:145], v[144:145], v[146:147]
v_add_f32 v148, v144, v145
s_nop 1
v_add_f32_dpp v148, v148, v148 quad_perm:[1,0,3,2] row_mask:0xf bank_mask:0xf
s_nop 1
v_add_f32_dpp v148, v148, v148 quad_perm:[2,3,0,1] row_mask:0xf bank_mask:0xf
s_nop 1
v_add_f32_dpp v148, v148, v148 row_half_mirror row_mask:0xf bank_mask:0xf
v_mul_f32 v148, 0xbae38e39, v148
v_dot2_f32_bf16 v0, v150, s101, v148
v_dot2_f32_bf16 v1, v150, s65, v148
v_dot2_f32_bf16 v2, v151, s101, v148
v_dot2_f32_bf16 v3, v151, s65, v148
v_dot2_f32_bf16 v4, v152, s101, v148
v_dot2_f32_bf16 v5, v152, s65, v148
v_dot2_f32_bf16 v6, v153, s101, v148
v_dot2_f32_bf16 v7, v153, s65, v148
v_dot2_f32_bf16 v8, v154, s101, v148
v_dot2_f32_bf16 v9, v154, s65, v148
v_dot2_f32_bf16 v10, v155, s101, v148
v_dot2_f32_bf16 v11, v155, s65, v148
v_dot2_f32_bf16 v12, v156, s101, v148
v_dot2_f32_bf16 v13, v156, s65, v148
v_dot2_f32_bf16 v14, v157, s101, v148
v_dot2_f32_bf16 v15, v157, s65, v148
v_dot2_f32_bf16 v16, v158, s101, v148
v_dot2_f32_bf16 v17, v158, s65, v148
v_dot2_f32_bf16 v18, v159, s101, v148
v_dot2_f32_bf16 v19, v159, s65, v148
v_dot2_f32_bf16 v20, v160, s101, v148
v_dot2_f32_bf16 v21, v160, s65, v148
v_dot2_f32_bf16 v22, v161, s101, v148
v_dot2_f32_bf16 v23, v161, s65, v148
v_dot2_f32_bf16 v24, v162, s101, v148
v_dot2_f32_bf16 v25, v162, s65, v148
v_dot2_f32_bf16 v26, v163, s101, v148
v_dot2_f32_bf16 v27, v163, s65, v148
v_dot2_f32_bf16 v28, v164, s101, v148
v_dot2_f32_bf16 v29, v164, s65, v148
v_dot2_f32_bf16 v30, v165, s101, v148
v_dot2_f32_bf16 v31, v165, s65, v148
v_dot2_f32_bf16 v32, v166, s101, v148
v_dot2_f32_bf16 v33, v166, s65, v148
v_dot2_f32_bf16 v34, v167, s101, v148
v_dot2_f32_bf16 v35, v167, s65, v148
v_dot2_f32_bf16 v36, v168, s101, v148
v_dot2_f32_bf16 v37, v168, s65, v148
v_dot2_f32_bf16 v38, v169, s101, v148
v_dot2_f32_bf16 v39, v169, s65, v148
v_dot2_f32_bf16 v40, v170, s101, v148
v_dot2_f32_bf16 v41, v170, s65, v148
v_dot2_f32_bf16 v42, v171, s101, v148
v_dot2_f32_bf16 v43, v171, s65, v148
v_dot2_f32_bf16 v44, v172, s101, v148
v_dot2_f32_bf16 v45, v172, s65, v148
v_dot2_f32_bf16 v46, v173, s101, v148
v_dot2_f32_bf16 v47, v173, s65, v148
v_dot2_f32_bf16 v48, v174, s101, v148
v_dot2_f32_bf16 v49, v174, s65, v148
v_dot2_f32_bf16 v50, v175, s101, v148
v_dot2_f32_bf16 v51, v175, s65, v148
v_dot2_f32_bf16 v52, v176, s101, v148
v_dot2_f32_bf16 v53, v176, s65, v148
v_dot2_f32_bf16 v54, v177, s101, v148
v_dot2_f32_bf16 v55, v177, s65, v148
v_dot2_f32_bf16 v56, v178, s101, v148
v_dot2_f32_bf16 v57, v178, s65, v148
v_dot2_f32_bf16 v58, v179, s101, v148
v_dot2_f32_bf16 v59, v179, s65, v148
v_dot2_f32_bf16 v60, v180, s101, v148
v_dot2_f32_bf16 v61, v180, s65, v148
v_dot2_f32_bf16 v62, v181, s101, v148
v_dot2_f32_bf16 v63, v181, s65, v148
v_dot2_f32_bf16 v64, v182, s101, v148
v_dot2_f32_bf16 v65, v182, s65, v148
v_dot2_f32_bf16 v66, v183, s101, v148
v_dot2_f32_bf16 v67, v183, s65, v148
v_dot2_f32_bf16 v68, v184, s101, v148
v_dot2_f32_bf16 v69, v184, s65, v148
v_dot2_f32_bf16 v70, v185, s101, v148
v_dot2_f32_bf16 v71, v185, s65, v148
buffer_load_dword v249, v223, s[28:31], s62 offen
v_pk_fma_f32 v[144:145], v[0:1], v[0:1], 0
v_pk_fma_f32 v[144:145], v[2:3], v[2:3], v[144:145]
v_pk_fma_f32 v[144:145], v[4:5], v[4:5], v[144:145]
v_pk_fma_f32 v[144:145], v[6:7], v[6:7], v[144:145]
v_pk_fma_f32 v[144:145], v[8:9], v[8:9], v[144:145]
v_pk_fma_f32 v[144:145], v[10:11], v[10:11], v[144:145]
v_pk_fma_f32 v[144:145], v[12:13], v[12:13], v[144:145]
v_pk_fma_f32 v[144:145], v[14:15], v[14:15], v[144:145]
v_pk_fma_f32 v[144:145], v[16:17], v[16:17], v[144:145]
v_pk_fma_f32 v[144:145], v[18:19], v[18:19], v[144:145]
v_pk_fma_f32 v[144:145], v[20:21], v[20:21], v[144:145]
v_pk_fma_f32 v[144:145], v[22:23], v[22:23], v[144:145]
v_pk_fma_f32 v[144:145], v[24:25], v[24:25], v[144:145]
v_pk_fma_f32 v[144:145], v[26:27], v[26:27], v[144:145]
v_pk_fma_f32 v[144:145], v[28:29], v[28:29], v[144:145]
v_pk_fma_f32 v[144:145], v[30:31], v[30:31], v[144:145]
v_pk_fma_f32 v[144:145], v[32:33], v[32:33], v[144:145]
v_pk_fma_f32 v[144:145], v[34:35], v[34:35], v[144:145]
v_pk_fma_f32 v[144:145], v[36:37], v[36:37], v[144:145]
v_pk_fma_f32 v[144:145], v[38:39], v[38:39], v[144:145]
v_pk_fma_f32 v[144:145], v[40:41], v[40:41], v[144:145]
v_pk_fma_f32 v[144:145], v[42:43], v[42:43], v[144:145]
v_pk_fma_f32 v[144:145], v[44:45], v[44:45], v[144:145]
v_pk_fma_f32 v[144:145], v[46:47], v[46:47], v[144:145]
v_pk_fma_f32 v[144:145], v[48:49], v[48:49], v[144:145]
v_pk_fma_f32 v[144:145], v[50:51], v[50:51], v[144:145]
v_pk_fma_f32 v[144:145], v[52:53], v[52:53], v[144:145]
v_pk_fma_f32 v[144:145], v[54:55], v[54:55], v[144:145]
v_pk_fma_f32 v[144:145], v[56:57], v[56:57], v[144:145]
v_pk_fma_f32 v[144:145], v[58:59], v[58:59], v[144:145]
v_pk_fma_f32 v[144:145], v[60:61], v[60:61], v[144:145]
v_pk_fma_f32 v[144:145], v[62:63], v[62:63], v[144:145]
v_pk_fma_f32 v[144:145], v[64:65], v[64:65], v[144:145]
v_pk_fma_f32 v[144:145], v[66:67], v[66:67], v[144:145]
v_pk_fma_f32 v[144:145], v[68:69], v[68:69], v[144:145]
v_pk_fma_f32 v[144:145], v[70:71], v[70:71], v[144:145]
v_add_f32 v148, v144, v145
s_nop 1
v_add_f32_dpp v148, v148, v148 quad_perm:[1,0,3,2] row_mask:0xf bank_mask:0xf
s_nop 1
v_add_f32_dpp v148, v148, v148 quad_perm:[2,3,0,1] row_mask:0xf bank_mask:0xf
s_nop 1
v_add_f32_dpp v148, v148, v148 row_half_mirror row_mask:0xf bank_mask:0xf
v_mov_b32 v149, 0x3727c5ac
v_fmac_f32 v149, 0x3ae38e39, v148
v_rsq_f32 v148, v149
s_nop 0
v_pk_mul_f32 v[0:1], v[0:1], v[148:149] op_sel_hi:[1,0]
v_pk_mul_f32 v[2:3], v[2:3], v[148:149] op_sel_hi:[1,0]
v_pk_mul_f32 v[4:5], v[4:5], v[148:149] op_sel_hi:[1,0]
v_pk_mul_f32 v[6:7], v[6:7], v[148:149] op_sel_hi:[1,0]
v_pk_mul_f32 v[8:9], v[8:9], v[148:149] op_sel_hi:[1,0]
v_pk_mul_f32 v[10:11], v[10:11], v[148:149] op_sel_hi:[1,0]
v_pk_mul_f32 v[12:13], v[12:13], v[148:149] op_sel_hi:[1,0]
v_pk_mul_f32 v[14:15], v[14:15], v[148:149] op_sel_hi:[1,0]
v_pk_mul_f32 v[16:17], v[16:17], v[148:149] op_sel_hi:[1,0]
v_pk_mul_f32 v[18:19], v[18:19], v[148:149] op_sel_hi:[1,0]
v_pk_mul_f32 v[20:21], v[20:21], v[148:149] op_sel_hi:[1,0]
v_pk_mul_f32 v[22:23], v[22:23], v[148:149] op_sel_hi:[1,0]
v_pk_mul_f32 v[24:25], v[24:25], v[148:149] op_sel_hi:[1,0]
v_pk_mul_f32 v[26:27], v[26:27], v[148:149] op_sel_hi:[1,0]
v_pk_mul_f32 v[28:29], v[28:29], v[148:149] op_sel_hi:[1,0]
v_pk_mul_f32 v[30:31], v[30:31], v[148:149] op_sel_hi:[1,0]
v_pk_mul_f32 v[32:33], v[32:33], v[148:149] op_sel_hi:[1,0]
v_pk_mul_f32 v[34:35], v[34:35], v[148:149] op_sel_hi:[1,0]
v_pk_mul_f32 v[36:37], v[36:37], v[148:149] op_sel_hi:[1,0]
v_pk_mul_f32 v[38:39], v[38:39], v[148:149] op_sel_hi:[1,0]
v_pk_mul_f32 v[40:41], v[40:41], v[148:149] op_sel_hi:[1,0]
v_pk_mul_f32 v[42:43], v[42:43], v[148:149] op_sel_hi:[1,0]
v_pk_mul_f32 v[44:45], v[44:45], v[148:149] op_sel_hi:[1,0]
v_pk_mul_f32 v[46:47], v[46:47], v[148:149] op_sel_hi:[1,0]
v_pk_mul_f32 v[48:49], v[48:49], v[148:149] op_sel_hi:[1,0]
v_pk_mul_f32 v[50:51], v[50:51], v[148:149] op_sel_hi:[1,0]
v_pk_mul_f32 v[52:53], v[52:53], v[148:149] op_sel_hi:[1,0]
v_pk_mul_f32 v[54:55], v[54:55], v[148:149] op_sel_hi:[1,0]
v_pk_mul_f32 v[56:57], v[56:57], v[148:149] op_sel_hi:[1,0]
v_pk_mul_f32 v[58:59], v[58:59], v[148:149] op_sel_hi:[1,0]
v_pk_mul_f32 v[60:61], v[60:61], v[148:149] op_sel_hi:[1,0]
v_pk_mul_f32 v[62:63], v[62:63], v[148:149] op_sel_hi:[1,0]
v_pk_mul_f32 v[64:65], v[64:65], v[148:149] op_sel_hi:[1,0]
v_pk_mul_f32 v[66:67], v[66:67], v[148:149] op_sel_hi:[1,0]
v_pk_mul_f32 v[68:69], v[68:69], v[148:149] op_sel_hi:[1,0]
v_pk_mul_f32 v[70:71], v[70:71], v[148:149] op_sel_hi:[1,0]
s_waitcnt vmcnt(10)
v_dot2_f32_bf16 v144, v186, s100, 0
v_dot2_f32_bf16 v145, v187, s100, 0
v_dot2_f32_bf16 v146, v188, s100, 0
v_dot2_f32_bf16 v147, v189, s100, 0
s_waitcnt vmcnt(9)
v_dot2_f32_bf16 v144, v190, s100, v144
v_dot2_f32_bf16 v145, v191, s100, v145
v_dot2_f32_bf16 v146, v192, s100, v146
v_dot2_f32_bf16 v147, v193, s100, v147
s_waitcnt vmcnt(8)
v_dot2_f32_bf16 v144, v194, s100, v144
v_dot2_f32_bf16 v145, v195, s100, v145
v_dot2_f32_bf16 v146, v196, s100, v146
v_dot2_f32_bf16 v147, v197, s100, v147
s_waitcnt vmcnt(7)
v_dot2_f32_bf16 v144, v198, s100, v144
v_dot2_f32_bf16 v145, v199, s100, v145
v_dot2_f32_bf16 v146, v200, s100, v146
v_dot2_f32_bf16 v147, v201, s100, v147
s_waitcnt vmcnt(6)
v_dot2_f32_bf16 v144, v202, s100, v144
v_dot2_f32_bf16 v145, v203, s100, v145
v_dot2_f32_bf16 v146, v204, s100, v146
v_dot2_f32_bf16 v147, v205, s100, v147
s_waitcnt vmcnt(5)
v_dot2_f32_bf16 v144, v206, s100, v144
v_dot2_f32_bf16 v145, v207, s100, v145
v_dot2_f32_bf16 v146, v208, s100, v146
v_dot2_f32_bf16 v147, v209, s100, v147
s_waitcnt vmcnt(4)
v_dot2_f32_bf16 v144, v210, s100, v144
v_dot2_f32_bf16 v145, v211, s100, v145
v_dot2_f32_bf16 v146, v212, s100, v146
v_dot2_f32_bf16 v147, v213, s100, v147
s_waitcnt vmcnt(3)
v_dot2_f32_bf16 v144, v214, s100, v144
v_dot2_f32_bf16 v145, v215, s100, v145
v_dot2_f32_bf16 v146, v216, s100, v146
v_dot2_f32_bf16 v147, v217, s100, v147
s_waitcnt vmcnt(2)
v_dot2_f32_bf16 v144, v218, s100, v144
v_dot2_f32_bf16 v145, v219, s100, v145
v_dot2_f32_bf16 v146, v220, s100, v146
v_dot2_f32_bf16 v147, v221, s100, v147
s_nop 2
v_pk_add_f32 v[144:145], v[144:145], v[146:147]
v_add_f32 v148, v144, v145
s_nop 1
v_add_f32_dpp v148, v148, v148 quad_perm:[1,0,3,2] row_mask:0xf bank_mask:0xf
s_nop 1
v_add_f32_dpp v148, v148, v148 quad_perm:[2,3,0,1] row_mask:0xf bank_mask:0xf
s_nop 1
v_add_f32_dpp v148, v148, v148 row_half_mirror row_mask:0xf bank_mask:0xf
v_mul_f32 v148, 0xbae38e39, v148
v_dot2_f32_bf16 v72, v186, s101, v148
v_dot2_f32_bf16 v73, v186, s65, v148
v_dot2_f32_bf16 v74, v187, s101, v148
v_dot2_f32_bf16 v75, v187, s65, v148
v_dot2_f32_bf16 v76, v188, s101, v148
v_dot2_f32_bf16 v77, v188, s65, v148
v_dot2_f32_bf16 v78, v189, s101, v148
v_dot2_f32_bf16 v79, v189, s65, v148
v_dot2_f32_bf16 v80, v190, s101, v148
v_dot2_f32_bf16 v81, v190, s65, v148
v_dot2_f32_bf16 v82, v191, s101, v148
v_dot2_f32_bf16 v83, v191, s65, v148
v_dot2_f32_bf16 v84, v192, s101, v148
v_dot2_f32_bf16 v85, v192, s65, v148
v_dot2_f32_bf16 v86, v193, s101, v148
v_dot2_f32_bf16 v87, v193, s65, v148
v_dot2_f32_bf16 v88, v194, s101, v148
v_dot2_f32_bf16 v89, v194, s65, v148
v_dot2_f32_bf16 v90, v195, s101, v148
v_dot2_f32_bf16 v91, v195, s65, v148
v_dot2_f32_bf16 v92, v196, s101, v148
v_dot2_f32_bf16 v93, v196, s65, v148
v_dot2_f32_bf16 v94, v197, s101, v148
v_dot2_f32_bf16 v95, v197, s65, v148
v_dot2_f32_bf16 v96, v198, s101, v148
v_dot2_f32_bf16 v97, v198, s65, v148
v_dot2_f32_bf16 v98, v199, s101, v148
v_dot2_f32_bf16 v99, v199, s65, v148
v_dot2_f32_bf16 v100, v200, s101, v148
v_dot2_f32_bf16 v101, v200, s65, v148
v_dot2_f32_bf16 v102, v201, s101, v148
v_dot2_f32_bf16 v103, v201, s65, v148
v_dot2_f32_bf16 v104, v202, s101, v148
v_dot2_f32_bf16 v105, v202, s65, v148
v_dot2_f32_bf16 v106, v203, s101, v148
v_dot2_f32_bf16 v107, v203, s65, v148
v_dot2_f32_bf16 v108, v204, s101, v148
v_dot2_f32_bf16 v109, v204, s65, v148
v_dot2_f32_bf16 v110, v205, s101, v148
v_dot2_f32_bf16 v111, v205, s65, v148
v_dot2_f32_bf16 v112, v206, s101, v148
v_dot2_f32_bf16 v113, v206, s65, v148
v_dot2_f32_bf16 v114, v207, s101, v148
v_dot2_f32_bf16 v115, v207, s65, v148
v_dot2_f32_bf16 v116, v208, s101, v148
v_dot2_f32_bf16 v117, v208, s65, v148
v_dot2_f32_bf16 v118, v209, s101, v148
v_dot2_f32_bf16 v119, v209, s65, v148
v_dot2_f32_bf16 v120, v210, s101, v148
v_dot2_f32_bf16 v121, v210, s65, v148
v_dot2_f32_bf16 v122, v211, s101, v148
v_dot2_f32_bf16 v123, v211, s65, v148
v_dot2_f32_bf16 v124, v212, s101, v148
v_dot2_f32_bf16 v125, v212, s65, v148
v_dot2_f32_bf16 v126, v213, s101, v148
v_dot2_f32_bf16 v127, v213, s65, v148
v_dot2_f32_bf16 v128, v214, s101, v148
v_dot2_f32_bf16 v129, v214, s65, v148
v_dot2_f32_bf16 v130, v215, s101, v148
v_dot2_f32_bf16 v131, v215, s65, v148
v_dot2_f32_bf16 v132, v216, s101, v148
v_dot2_f32_bf16 v133, v216, s65, v148
v_dot2_f32_bf16 v134, v217, s101, v148
v_dot2_f32_bf16 v135, v217, s65, v148
v_dot2_f32_bf16 v136, v218, s101, v148
v_dot2_f32_bf16 v137, v218, s65, v148
v_dot2_f32_bf16 v138, v219, s101, v148
v_dot2_f32_bf16 v139, v219, s65, v148
v_dot2_f32_bf16 v140, v220, s101, v148
v_dot2_f32_bf16 v141, v220, s65, v148
v_dot2_f32_bf16 v142, v221, s101, v148
v_dot2_f32_bf16 v143, v221, s65, v148
buffer_load_dwordx4 v[150:153], v252, s[36:39], s12 offen sc1
buffer_load_dwordx4 v[154:157], v252, s[36:39], s12 offen offset:2304 sc1
s_add_u32 m0, s43, 0
s_add_u32 s44, s58, 0
buffer_load_dwordx4 v230, s[28:31], s44 offen offset:0 lds
buffer_load_dwordx4 v231, s[28:31], s44 offen offset:1024 lds
buffer_load_dwordx4 v232, s[28:31], s44 offen offset:2048 lds
buffer_load_dwordx4 v233, s[28:31], s44 offen offset:3072 lds
s_add_u32 m0, s43, 4096
s_add_u32 s44, s58, 262144
buffer_load_dwordx4 v230, s[28:31], s44 offen offset:0 lds
buffer_load_dwordx4 v231, s[28:31], s44 offen offset:1024 lds
buffer_load_dwordx4 v232, s[28:31], s44 offen offset:2048 lds
buffer_load_dwordx4 v233, s[28:31], s44 offen offset:3072 lds
v_pk_fma_f32 v[144:145], v[72:73], v[72:73], 0
v_pk_fma_f32 v[144:145], v[74:75], v[74:75], v[144:145]
v_pk_fma_f32 v[144:145], v[76:77], v[76:77], v[144:145]
v_pk_fma_f32 v[144:145], v[78:79], v[78:79], v[144:145]
v_pk_fma_f32 v[144:145], v[80:81], v[80:81], v[144:145]
v_pk_fma_f32 v[144:145], v[82:83], v[82:83], v[144:145]
v_pk_fma_f32 v[144:145], v[84:85], v[84:85], v[144:145]
v_pk_fma_f32 v[144:145], v[86:87], v[86:87], v[144:145]
v_pk_fma_f32 v[144:145], v[88:89], v[88:89], v[144:145]
v_pk_fma_f32 v[144:145], v[90:91], v[90:91], v[144:145]
v_pk_fma_f32 v[144:145], v[92:93], v[92:93], v[144:145]
v_pk_fma_f32 v[144:145], v[94:95], v[94:95], v[144:145]
v_pk_fma_f32 v[144:145], v[96:97], v[96:97], v[144:145]
v_pk_fma_f32 v[144:145], v[98:99], v[98:99], v[144:145]
v_pk_fma_f32 v[144:145], v[100:101], v[100:101], v[144:145]
v_pk_fma_f32 v[144:145], v[102:103], v[102:103], v[144:145]
v_pk_fma_f32 v[144:145], v[104:105], v[104:105], v[144:145]
v_pk_fma_f32 v[144:145], v[106:107], v[106:107], v[144:145]
v_pk_fma_f32 v[144:145], v[108:109], v[108:109], v[144:145]
v_pk_fma_f32 v[144:145], v[110:111], v[110:111], v[144:145]
v_pk_fma_f32 v[144:145], v[112:113], v[112:113], v[144:145]
v_pk_fma_f32 v[144:145], v[114:115], v[114:115], v[144:145]
v_pk_fma_f32 v[144:145], v[116:117], v[116:117], v[144:145]
v_pk_fma_f32 v[144:145], v[118:119], v[118:119], v[144:145]
v_pk_fma_f32 v[144:145], v[120:121], v[120:121], v[144:145]
v_pk_fma_f32 v[144:145], v[122:123], v[122:123], v[144:145]
v_pk_fma_f32 v[144:145], v[124:125], v[124:125], v[144:145]
v_pk_fma_f32 v[144:145], v[126:127], v[126:127], v[144:145]
v_pk_fma_f32 v[144:145], v[128:129], v[128:129], v[144:145]
v_pk_fma_f32 v[144:145], v[130:131], v[130:131], v[144:145]
v_pk_fma_f32 v[144:145], v[132:133], v[132:133], v[144:145]
v_pk_fma_f32 v[144:145], v[134:135], v[134:135], v[144:145]
v_pk_fma_f32 v[144:145], v[136:137], v[136:137], v[144:145]
v_pk_fma_f32 v[144:145], v[138:139], v[138:139], v[144:145]
v_pk_fma_f32 v[144:145], v[140:141], v[140:141], v[144:145]
v_pk_fma_f32 v[144:145], v[142:143], v[142:143], v[144:145]
v_add_f32 v148, v144, v145
s_nop 1
v_add_f32_dpp v148, v148, v148 quad_perm:[1,0,3,2] row_mask:0xf bank_mask:0xf
s_nop 1
v_add_f32_dpp v148, v148, v148 quad_perm:[2,3,0,1] row_mask:0xf bank_mask:0xf
s_nop 1
v_add_f32_dpp v148, v148, v148 row_half_mirror row_mask:0xf bank_mask:0xf
v_mov_b32 v149, 0x3727c5ac
v_fmac_f32 v149, 0x3ae38e39, v148
v_rsq_f32 v148, v149
s_nop 0
v_pk_mul_f32 v[72:73], v[72:73], v[148:149] op_sel_hi:[1,0]
v_pk_mul_f32 v[74:75], v[74:75], v[148:149] op_sel_hi:[1,0]
v_pk_mul_f32 v[76:77], v[76:77], v[148:149] op_sel_hi:[1,0]
v_pk_mul_f32 v[78:79], v[78:79], v[148:149] op_sel_hi:[1,0]
v_pk_mul_f32 v[80:81], v[80:81], v[148:149] op_sel_hi:[1,0]
v_pk_mul_f32 v[82:83], v[82:83], v[148:149] op_sel_hi:[1,0]
v_pk_mul_f32 v[84:85], v[84:85], v[148:149] op_sel_hi:[1,0]
v_pk_mul_f32 v[86:87], v[86:87], v[148:149] op_sel_hi:[1,0]
v_pk_mul_f32 v[88:89], v[88:89], v[148:149] op_sel_hi:[1,0]
v_pk_mul_f32 v[90:91], v[90:91], v[148:149] op_sel_hi:[1,0]
v_pk_mul_f32 v[92:93], v[92:93], v[148:149] op_sel_hi:[1,0]
v_pk_mul_f32 v[94:95], v[94:95], v[148:149] op_sel_hi:[1,0]
v_pk_mul_f32 v[96:97], v[96:97], v[148:149] op_sel_hi:[1,0]
v_pk_mul_f32 v[98:99], v[98:99], v[148:149] op_sel_hi:[1,0]
v_pk_mul_f32 v[100:101], v[100:101], v[148:149] op_sel_hi:[1,0]
v_pk_mul_f32 v[102:103], v[102:103], v[148:149] op_sel_hi:[1,0]
v_pk_mul_f32 v[104:105], v[104:105], v[148:149] op_sel_hi:[1,0]
v_pk_mul_f32 v[106:107], v[106:107], v[148:149] op_sel_hi:[1,0]
v_pk_mul_f32 v[108:109], v[108:109], v[148:149] op_sel_hi:[1,0]
v_pk_mul_f32 v[110:111], v[110:111], v[148:149] op_sel_hi:[1,0]
v_pk_mul_f32 v[112:113], v[112:113], v[148:149] op_sel_hi:[1,0]
v_pk_mul_f32 v[114:115], v[114:115], v[148:149] op_sel_hi:[1,0]
v_pk_mul_f32 v[116:117], v[116:117], v[148:149] op_sel_hi:[1,0]
v_pk_mul_f32 v[118:119], v[118:119], v[148:149] op_sel_hi:[1,0]
v_pk_mul_f32 v[120:121], v[120:121], v[148:149] op_sel_hi:[1,0]
v_pk_mul_f32 v[122:123], v[122:123], v[148:149] op_sel_hi:[1,0]
v_pk_mul_f32 v[124:125], v[124:125], v[148:149] op_sel_hi:[1,0]
v_pk_mul_f32 v[126:127], v[126:127], v[148:149] op_sel_hi:[1,0]
v_pk_mul_f32 v[128:129], v[128:129], v[148:149] op_sel_hi:[1,0]
v_pk_mul_f32 v[130:131], v[130:131], v[148:149] op_sel_hi:[1,0]
v_pk_mul_f32 v[132:133], v[132:133], v[148:149] op_sel_hi:[1,0]
v_pk_mul_f32 v[134:135], v[134:135], v[148:149] op_sel_hi:[1,0]
v_pk_mul_f32 v[136:137], v[136:137], v[148:149] op_sel_hi:[1,0]
v_pk_mul_f32 v[138:139], v[138:139], v[148:149] op_sel_hi:[1,0]
v_pk_mul_f32 v[140:141], v[140:141], v[148:149] op_sel_hi:[1,0]
v_pk_mul_f32 v[142:143], v[142:143], v[148:149] op_sel_hi:[1,0]
s_waitcnt vmcnt(9)
v_xor_b32 v158, s3, v151
v_xor_b32 v159, s3, v153
v_or_b32 v158, v158, v159
s_waitcnt vmcnt(8)
v_xor_b32 v159, s3, v155
v_or_b32 v158, v158, v159
v_xor_b32 v159, s3, v157
v_or_b32 v158, v158, v159
v_cmp_ne_u32 vcc, 0, v158
s_mov_b32 s45, 0x3e0293ee
v_add_u32 v223, 155648, v252
s_nop 2
s_cbranch_vccnz P1_RETRY
P1_OK:
v_lshlrev_b32 v160, 16, v150
v_and_b32 v161, 0xffff0000, v150
v_lshlrev_b32 v162, 16, v152
v_and_b32 v163, 0xffff0000, v152
v_lshlrev_b32 v164, 16, v154
v_and_b32 v165, 0xffff0000, v154
v_lshlrev_b32 v166, 16, v156
v_and_b32 v167, 0xffff0000, v156
v_mul_f32 v160, s45, v160
v_fma_f32 v164, v164, s45, s45
v_mul_f32 v161, s45, v161
v_fma_f32 v165, v165, s45, s45
v_mul_f32 v162, s45, v162
v_fma_f32 v166, v166, s45, s45
v_mul_f32 v163, s45, v163
v_fma_f32 v167, v167, s45, s45
ds_write_b128 v223, v[160:163] offset:2304
ds_write_b128 v223, v[164:167]
v_xor_b32 v223, 128, v250
s_waitcnt lgkmcnt(0)
s_barrier
ds_read_b128 v[144:147], v251 offset:0
ds_read_b128 v[148:151], v251 offset:16
ds_read_b128 v[152:155], v251 offset:2304
ds_read_b128 v[156:159], v251 offset:2320
ds_read_b128 v[160:163], v251 offset:256
ds_read_b128 v[164:167], v251 offset:272
ds_read_b128 v[168:171], v251 offset:2560
ds_read_b128 v[172:175], v251 offset:2576
ds_read_b128 v[176:179], v251 offset:512
ds_read_b128 v[180:183], v251 offset:528
ds_read_b128 v[184:187], v251 offset:2816
ds_read_b128 v[188:191], v251 offset:2832
s_lshr_b32 s47, s2, 7
s_lshl_b32 s48, s42, 1
s_add_u32 s47, s47, s48
s_lshl_b32 s47, s47, 19
s_bfe_u32 s48, s2, 196612
s_lshl_b32 s48, s48, 14
s_add_u32 s47, s47, s48
s_add_u32 s47, s47, 393216
buffer_load_dword v249, v222, s[20:23], s47 offen
ds_read_b128 v[192:195], v251 offset:768
ds_read_b128 v[196:199], v251 offset:784
ds_read_b128 v[200:203], v251 offset:3072
ds_read_b128 v[204:207], v251 offset:3088
s_waitcnt lgkmcnt(13)
v_pk_fma_f32 v[0:1], v[0:1], v[144:145], v[152:153]
v_pk_fma_f32 v[2:3], v[2:3], v[146:147], v[154:155]
s_waitcnt lgkmcnt(12)
v_pk_fma_f32 v[4:5], v[4:5], v[148:149], v[156:157]
v_pk_fma_f32 v[6:7], v[6:7], v[150:151], v[158:159]
v_cvt_pk_bf16_f32 v0, v0, v1
buffer_load_dword v249, v222, s[24:27], s47 offen
v_cvt_pk_bf16_f32 v1, v2, v3
v_cvt_pk_bf16_f32 v2, v4, v5
v_cvt_pk_bf16_f32 v3, v6, v7
ds_write_b128 v250, v[0:3] offset:0
v_pk_fma_f32 v[72:73], v[72:73], v[144:145], v[152:153]
v_pk_fma_f32 v[74:75], v[74:75], v[146:147], v[154:155]
v_pk_fma_f32 v[76:77], v[76:77], v[148:149], v[156:157]
v_pk_fma_f32 v[78:79], v[78:79], v[150:151], v[158:159]
v_cvt_pk_bf16_f32 v72, v72, v73
s_add_u32 m0, s43, 8192
s_add_u32 s44, s58, 524288
buffer_load_dwordx4 v230, s[28:31], s44 offen offset:0 lds
v_cvt_pk_bf16_f32 v73, v74, v75
v_cvt_pk_bf16_f32 v74, v76, v77
v_cvt_pk_bf16_f32 v75, v78, v79
ds_write_b128 v223, v[72:75] offset:0
ds_read_b128 v[144:147], v251 offset:1024
ds_read_b128 v[148:151], v251 offset:1040
ds_read_b128 v[152:155], v251 offset:3328
ds_read_b128 v[156:159], v251 offset:3344
s_waitcnt lgkmcnt(15)
v_pk_fma_f32 v[8:9], v[8:9], v[160:161], v[168:169]
buffer_load_dwordx4 v231, s[28:31], s44 offen offset:1024 lds
v_pk_fma_f32 v[10:11], v[10:11], v[162:163], v[170:171]
s_waitcnt lgkmcnt(14)
v_pk_fma_f32 v[12:13], v[12:13], v[164:165], v[172:173]
v_pk_fma_f32 v[14:15], v[14:15], v[166:167], v[174:175]
v_cvt_pk_bf16_f32 v8, v8, v9
v_cvt_pk_bf16_f32 v9, v10, v11
v_cvt_pk_bf16_f32 v10, v12, v13
v_cvt_pk_bf16_f32 v11, v14, v15
ds_write_b128 v250, v[8:11] offset:8192
v_pk_fma_f32 v[80:81], v[80:81], v[160:161], v[168:169]
buffer_load_dwordx4 v232, s[28:31], s44 offen offset:2048 lds
v_pk_fma_f32 v[82:83], v[82:83], v[162:163], v[170:171]
v_pk_fma_f32 v[84:85], v[84:85], v[164:165], v[172:173]
v_pk_fma_f32 v[86:87], v[86:87], v[166:167], v[174:175]
v_cvt_pk_bf16_f32 v80, v80, v81
v_cvt_pk_bf16_f32 v81, v82, v83
v_cvt_pk_bf16_f32 v82, v84, v85
v_cvt_pk_bf16_f32 v83, v86, v87
ds_write_b128 v223, v[80:83] offset:8192
ds_read_b128 v[160:163], v251 offset:1280
buffer_load_dwordx4 v233, s[28:31], s44 offen offset:3072 lds
ds_read_b128 v[164:167], v251 offset:1296
ds_read_b128 v[168:171], v251 offset:3584
ds_read_b128 v[172:175], v251 offset:3600
s_waitcnt lgkmcnt(15)
v_pk_fma_f32 v[16:17], v[16:17], v[176:177], v[184:185]
v_pk_fma_f32 v[18:19], v[18:19], v[178:179], v[186:187]
v_pk_fma_f32 v[20:21], v[20:21], v[180:181], v[188:189]
v_pk_fma_f32 v[22:23], v[22:23], v[182:183], v[190:191]
v_cvt_pk_bf16_f32 v16, v16, v17
v_cvt_pk_bf16_f32 v17, v18, v19
s_add_u32 m0, s43, 12288
s_add_u32 s44, s58, 786432
buffer_load_dwordx4 v230, s[28:31], s44 offen offset:0 lds
v_cvt_pk_bf16_f32 v18, v20, v21
v_cvt_pk_bf16_f32 v19, v22, v23
ds_write_b128 v250, v[16:19] offset:16384
v_pk_fma_f32 v[88:89], v[88:89], v[176:177], v[184:185]
v_pk_fma_f32 v[90:91], v[90:91], v[178:179], v[186:187]
v_pk_fma_f32 v[92:93], v[92:93], v[180:181], v[188:189]
v_pk_fma_f32 v[94:95], v[94:95], v[182:183], v[190:191]
v_cvt_pk_bf16_f32 v88, v88, v89
v_cvt_pk_bf16_f32 v89, v90, v91
buffer_load_dwordx4 v231, s[28:31], s44 offen offset:1024 lds
v_cvt_pk_bf16_f32 v90, v92, v93
v_cvt_pk_bf16_f32 v91, v94, v95
ds_write_b128 v223, v[88:91] offset:16384
ds_read_b128 v[176:179], v251 offset:1536
ds_read_b128 v[180:183], v251 offset:1552
ds_read_b128 v[184:187], v251 offset:3840
ds_read_b128 v[188:191], v251 offset:3856
s_waitcnt lgkmcnt(15)
v_pk_fma_f32 v[24:25], v[24:25], v[192:193], v[200:201]
v_pk_fma_f32 v[26:27], v[26:27], v[194:195], v[202:203]
buffer_load_dwordx4 v232, s[28:31], s44 offen offset:2048 lds
v_pk_fma_f32 v[28:29], v[28:29], v[196:197], v[204:205]
v_pk_fma_f32 v[30:31], v[30:31], v[198:199], v[206:207]
v_cvt_pk_bf16_f32 v24, v24, v25
v_cvt_pk_bf16_f32 v25, v26, v27
v_cvt_pk_bf16_f32 v26, v28, v29
v_cvt_pk_bf16_f32 v27, v30, v31
ds_write_b128 v250, v[24:27] offset:24576
v_pk_fma_f32 v[96:97], v[96:97], v[192:193], v[200:201]
v_pk_fma_f32 v[98:99], v[98:99], v[194:195], v[202:203]
buffer_load_dwordx4 v233, s[28:31], s44 offen offset:3072 lds
v_pk_fma_f32 v[100:101], v[100:101], v[196:197], v[204:205]
v_pk_fma_f32 v[102:103], v[102:103], v[198:199], v[206:207]
v_cvt_pk_bf16_f32 v96, v96, v97
v_cvt_pk_bf16_f32 v97, v98, v99
v_cvt_pk_bf16_f32 v98, v100, v101
v_cvt_pk_bf16_f32 v99, v102, v103
ds_write_b128 v223, v[96:99] offset:24576
ds_read_b128 v[192:195], v251 offset:1792
ds_read_b128 v[196:199], v251 offset:1808
s_xor_b32 s47, s42, 1
s_lshl_b32 s48, s41, 3
s_add_u32 s47, s47, s48
s_mul_i32 s47, s47, 4352
s_add_u32 s47, s47, 67108864
v_min_u32 v221, 144, v224
v_and_b32 v220, 16, v221
v_lshlrev_b32 v221, 4, v221
v_lshlrev_b32 v220, 3, v220
v_sub_u32 v221, v221, v220
buffer_load_dword v249, v221, s[36:39], s47 offen
ds_read_b128 v[200:203], v251 offset:4096
ds_read_b128 v[204:207], v251 offset:4112
s_waitcnt lgkmcnt(15)
v_pk_fma_f32 v[32:33], v[32:33], v[144:145], v[152:153]
v_pk_fma_f32 v[34:35], v[34:35], v[146:147], v[154:155]
v_pk_fma_f32 v[36:37], v[36:37], v[148:149], v[156:157]
v_pk_fma_f32 v[38:39], v[38:39], v[150:151], v[158:159]
v_cvt_pk_bf16_f32 v32, v32, v33
v_cvt_pk_bf16_f32 v33, v34, v35
v_cvt_pk_bf16_f32 v34, v36, v37
v_cvt_pk_bf16_f32 v35, v38, v39
ds_write_b128 v250, v[32:35] offset:32768
v_pk_fma_f32 v[104:105], v[104:105], v[144:145], v[152:153]
v_pk_fma_f32 v[106:107], v[106:107], v[146:147], v[154:155]
v_pk_fma_f32 v[108:109], v[108:109], v[148:149], v[156:157]
v_pk_fma_f32 v[110:111], v[110:111], v[150:151], v[158:159]
v_cvt_pk_bf16_f32 v104, v104, v105
v_cvt_pk_bf16_f32 v105, v106, v107
v_cvt_pk_bf16_f32 v106, v108, v109
v_cvt_pk_bf16_f32 v107, v110, v111
ds_write_b128 v223, v[104:107] offset:32768
ds_read_b128 v[144:147], v251 offset:2048
ds_read_b128 v[148:151], v251 offset:2064
ds_read_b128 v[152:155], v251 offset:4352
ds_read_b128 v[156:159], v251 offset:4368
s_waitcnt lgkmcnt(15)
v_pk_fma_f32 v[40:41], v[40:41], v[160:161], v[168:169]
v_pk_fma_f32 v[42:43], v[42:43], v[162:163], v[170:171]
v_pk_fma_f32 v[44:45], v[44:45], v[164:165], v[172:173]
v_pk_fma_f32 v[46:47], v[46:47], v[166:167], v[174:175]
v_cvt_pk_bf16_f32 v40, v40, v41
v_cvt_pk_bf16_f32 v41, v42, v43
v_cvt_pk_bf16_f32 v42, v44, v45
v_cvt_pk_bf16_f32 v43, v46, v47
ds_write_b128 v250, v[40:43] offset:40960
v_pk_fma_f32 v[112:113], v[112:113], v[160:161], v[168:169]
v_pk_fma_f32 v[114:115], v[114:115], v[162:163], v[170:171]
v_pk_fma_f32 v[116:117], v[116:117], v[164:165], v[172:173]
v_pk_fma_f32 v[118:119], v[118:119], v[166:167], v[174:175]
v_cvt_pk_bf16_f32 v112, v112, v113
v_cvt_pk_bf16_f32 v113, v114, v115
v_cvt_pk_bf16_f32 v114, v116, v117
v_cvt_pk_bf16_f32 v115, v118, v119
ds_write_b128 v223, v[112:115] offset:40960
s_waitcnt lgkmcnt(15)
v_pk_fma_f32 v[48:49], v[48:49], v[176:177], v[184:185]
v_pk_fma_f32 v[50:51], v[50:51], v[178:179], v[186:187]
s_waitcnt lgkmcnt(14)
v_pk_fma_f32 v[52:53], v[52:53], v[180:181], v[188:189]
v_pk_fma_f32 v[54:55], v[54:55], v[182:183], v[190:191]
v_cvt_pk_bf16_f32 v48, v48, v49
v_cvt_pk_bf16_f32 v49, v50, v51
v_cvt_pk_bf16_f32 v50, v52, v53
v_cvt_pk_bf16_f32 v51, v54, v55
ds_write_b128 v250, v[48:51] offset:49152
v_pk_fma_f32 v[120:121], v[120:121], v[176:177], v[184:185]
v_pk_fma_f32 v[122:123], v[122:123], v[178:179], v[186:187]
v_pk_fma_f32 v[124:125], v[124:125], v[180:181], v[188:189]
v_pk_fma_f32 v[126:127], v[126:127], v[182:183], v[190:191]
v_cvt_pk_bf16_f32 v120, v120, v121
v_cvt_pk_bf16_f32 v121, v122, v123
v_cvt_pk_bf16_f32 v122, v124, v125
v_cvt_pk_bf16_f32 v123, v126, v127
ds_write_b128 v223, v[120:123] offset:49152
s_waitcnt lgkmcnt(11)
v_pk_fma_f32 v[56:57], v[56:57], v[192:193], v[200:201]
v_pk_fma_f32 v[58:59], v[58:59], v[194:195], v[202:203]
s_waitcnt lgkmcnt(10)
v_pk_fma_f32 v[60:61], v[60:61], v[196:197], v[204:205]
v_pk_fma_f32 v[62:63], v[62:63], v[198:199], v[206:207]
v_cvt_pk_bf16_f32 v56, v56, v57
v_cvt_pk_bf16_f32 v57, v58, v59
v_cvt_pk_bf16_f32 v58, v60, v61
v_cvt_pk_bf16_f32 v59, v62, v63
ds_write_b128 v250, v[56:59] offset:57344
v_pk_fma_f32 v[128:129], v[128:129], v[192:193], v[200:201]
v_pk_fma_f32 v[130:131], v[130:131], v[194:195], v[202:203]
v_pk_fma_f32 v[132:133], v[132:133], v[196:197], v[204:205]
v_pk_fma_f32 v[134:135], v[134:135], v[198:199], v[206:207]
v_cvt_pk_bf16_f32 v128, v128, v129
v_cvt_pk_bf16_f32 v129, v130, v131
v_cvt_pk_bf16_f32 v130, v132, v133
v_cvt_pk_bf16_f32 v131, v134, v135
ds_write_b128 v223, v[128:131] offset:57344
v_add_u32 v250, 65536, v250
v_add_u32 v223, 65536, v223
s_waitcnt lgkmcnt(7)
v_pk_fma_f32 v[64:65], v[64:65], v[144:145], v[152:153]
v_pk_fma_f32 v[66:67], v[66:67], v[146:147], v[154:155]
s_waitcnt lgkmcnt(6)
v_pk_fma_f32 v[68:69], v[68:69], v[148:149], v[156:157]
v_pk_fma_f32 v[70:71], v[70:71], v[150:151], v[158:159]
v_cvt_pk_bf16_f32 v64, v64, v65
v_cvt_pk_bf16_f32 v65, v66, v67
v_cvt_pk_bf16_f32 v66, v68, v69
v_cvt_pk_bf16_f32 v67, v70, v71
ds_write_b128 v250, v[64:67] offset:0
v_pk_fma_f32 v[136:137], v[136:137], v[144:145], v[152:153]
v_pk_fma_f32 v[138:139], v[138:139], v[146:147], v[154:155]
v_pk_fma_f32 v[140:141], v[140:141], v[148:149], v[156:157]
v_pk_fma_f32 v[142:143], v[142:143], v[150:151], v[158:159]
v_cvt_pk_bf16_f32 v136, v136, v137
v_cvt_pk_bf16_f32 v137, v138, v139
v_cvt_pk_bf16_f32 v138, v140, v141
v_cvt_pk_bf16_f32 v139, v142, v143
ds_write_b128 v223, v[136:139] offset:0
s_waitcnt lgkmcnt(0)
s_barrier
s_waitcnt vmcnt(15)
ds_read_b64_tr_b16 v[160:161], v226 offset:0
ds_read_b64_tr_b16 v[162:163], v226 offset:512
ds_read_b64_tr_b16 v[164:165], v227 offset:0
ds_read_b64_tr_b16 v[166:167], v227 offset:512
ds_read_b64_tr_b16 v[168:169], v228 offset:0
ds_read_b64_tr_b16 v[170:171], v228 offset:512
ds_read_b64_tr_b16 v[172:173], v229 offset:0
ds_read_b64_tr_b16 v[174:175], v229 offset:512
ds_read_b128 a[0:3], v238 offset:0
ds_read_b128 a[4:7], v238 offset:256
ds_read_b128 a[8:11], v238 offset:512
ds_read_b128 a[12:15], v238 offset:768
s_waitcnt vmcnt(11) lgkmcnt(0)
v_mfma_f32_16x16x32_bf16 v[0:3], v[160:163], a[0:3], 0
s_add_u32 m0, s43, 16384
ds_read_b128 a[16:19], v239 offset:4096
v_mfma_f32_16x16x32_bf16 v[8:11], v[160:163], a[4:7], 0
ds_read_b64_tr_b16 v[176:177], v226 offset:4096
s_add_u32 s44, s58, 1048576
v_mfma_f32_16x16x32_bf16 v[16:19], v[160:163], a[8:11], 0
ds_read_b128 a[20:23], v239 offset:4352
v_mfma_f32_16x16x32_bf16 v[24:27], v[160:163], a[12:15], 0
ds_read_b64_tr_b16 v[178:179], v226 offset:4608
buffer_load_dwordx4 v230, s[28:31], s44 offen offset:0 lds
v_mfma_f32_16x16x32_bf16 v[4:7], v[164:167], a[0:3], 0
ds_read_b128 a[24:27], v239 offset:4608
v_mfma_f32_16x16x32_bf16 v[12:15], v[164:167], a[4:7], 0
ds_read_b64_tr_b16 v[180:181], v227 offset:4096
buffer_load_dwordx4 v231, s[28:31], s44 offen offset:1024 lds
v_mfma_f32_16x16x32_bf16 v[20:23], v[164:167], a[8:11], 0
ds_read_b128 a[28:31], v239 offset:4864
v_mfma_f32_16x16x32_bf16 v[28:31], v[164:167], a[12:15], 0
ds_read_b64_tr_b16 v[182:183], v227 offset:4608
v_mfma_f32_16x16x32_bf16 v[32:35], v[168:171], a[0:3], 0
v_mfma_f32_16x16x32_bf16 v[40:43], v[168:171], a[4:7], 0
ds_read_b64_tr_b16 v[184:185], v228 offset:4096
buffer_load_dwordx4 v232, s[28:31], s44 offen offset:2048 lds
v_mfma_f32_16x16x32_bf16 v[48:51], v[168:171], a[8:11], 0
v_mfma_f32_16x16x32_bf16 v[56:59], v[168:171], a[12:15], 0
ds_read_b64_tr_b16 v[186:187], v228 offset:4608
buffer_load_dwordx4 v233, s[28:31], s44 offen offset:3072 lds
v_mfma_f32_16x16x32_bf16 v[36:39], v[172:175], a[0:3], 0
s_add_u32 m0, s43, 0
s_add_u32 s44, s58, 1310720
v_mfma_f32_16x16x32_bf16 v[44:47], v[172:175], a[4:7], 0
ds_read_b64_tr_b16 v[188:189], v229 offset:4096
buffer_load_dwordx4 v230, s[28:31], s44 offen offset:0 lds
v_mfma_f32_16x16x32_bf16 v[52:55], v[172:175], a[8:11], 0
v_mfma_f32_16x16x32_bf16 v[60:63], v[172:175], a[12:15], 0
ds_read_b64_tr_b16 v[190:191], v229 offset:4608
s_waitcnt vmcnt(10) lgkmcnt(4)
v_mfma_f32_16x16x32_bf16 v[0:3], v[176:179], a[16:19], v[0:3]
buffer_load_dwordx4 v231, s[28:31], s44 offen offset:1024 lds
ds_read_b128 a[32:35], v238 offset:8192
v_mfma_f32_16x16x32_bf16 v[8:11], v[176:179], a[20:23], v[8:11]
ds_read_b64_tr_b16 v[160:161], v226 offset:8192
v_mfma_f32_16x16x32_bf16 v[16:19], v[176:179], a[24:27], v[16:19]
buffer_load_dwordx4 v232, s[28:31], s44 offen offset:2048 lds
ds_read_b128 a[36:39], v238 offset:8448
v_mfma_f32_16x16x32_bf16 v[24:27], v[176:179], a[28:31], v[24:27]
ds_read_b64_tr_b16 v[162:163], v226 offset:8704
v_mfma_f32_16x16x32_bf16 v[4:7], v[180:183], a[16:19], v[4:7]
buffer_load_dwordx4 v233, s[28:31], s44 offen offset:3072 lds
ds_read_b128 a[40:43], v238 offset:8704
v_mfma_f32_16x16x32_bf16 v[12:15], v[180:183], a[20:23], v[12:15]
ds_read_b64_tr_b16 v[164:165], v227 offset:8192
s_add_u32 m0, s43, 4096
v_mfma_f32_16x16x32_bf16 v[20:23], v[180:183], a[24:27], v[20:23]
ds_read_b128 a[44:47], v238 offset:8960
v_mfma_f32_16x16x32_bf16 v[28:31], v[180:183], a[28:31], v[28:31]
ds_read_b64_tr_b16 v[166:167], v227 offset:8704
s_waitcnt lgkmcnt(8)
v_mfma_f32_16x16x32_bf16 v[32:35], v[184:187], a[16:19], v[32:35]
s_add_u32 s44, s58, 1572864
v_mfma_f32_16x16x32_bf16 v[40:43], v[184:187], a[20:23], v[40:43]
ds_read_b64_tr_b16 v[168:169], v228 offset:8192
buffer_load_dwordx4 v230, s[28:31], s44 offen offset:0 lds
v_mfma_f32_16x16x32_bf16 v[48:51], v[184:187], a[24:27], v[48:51]
v_mfma_f32_16x16x32_bf16 v[56:59], v[184:187], a[28:31], v[56:59]
ds_read_b64_tr_b16 v[170:171], v228 offset:8704
buffer_load_dwordx4 v231, s[28:31], s44 offen offset:1024 lds
v_mfma_f32_16x16x32_bf16 v[36:39], v[188:191], a[16:19], v[36:39]
v_mfma_f32_16x16x32_bf16 v[44:47], v[188:191], a[20:23], v[44:47]
ds_read_b64_tr_b16 v[172:173], v229 offset:8192
buffer_load_dwordx4 v232, s[28:31], s44 offen offset:2048 lds
v_mfma_f32_16x16x32_bf16 v[52:55], v[188:191], a[24:27], v[52:55]
v_mfma_f32_16x16x32_bf16 v[60:63], v[188:191], a[28:31], v[60:63]
ds_read_b64_tr_b16 v[174:175], v229 offset:8704
s_waitcnt vmcnt(12) lgkmcnt(4)
v_mfma_f32_16x16x32_bf16 v[0:3], v[160:163], a[32:35], v[0:3]
ds_read_b128 a[48:51], v239 offset:12288
v_mfma_f32_16x16x32_bf16 v[8:11], v[160:163], a[36:39], v[8:11]
ds_read_b64_tr_b16 v[176:177], v226 offset:12288
buffer_load_dwordx4 v233, s[28:31], s44 offen offset:3072 lds
v_mfma_f32_16x16x32_bf16 v[16:19], v[160:163], a[40:43], v[16:19]
ds_read_b128 a[52:55], v239 offset:12544
v_mfma_f32_16x16x32_bf16 v[24:27], v[160:163], a[44:47], v[24:27]
ds_read_b64_tr_b16 v[178:179], v226 offset:12800
s_add_u32 m0, s43, 8192
v_mfma_f32_16x16x32_bf16 v[4:7], v[164:167], a[32:35], v[4:7]
ds_read_b128 a[56:59], v239 offset:12800
v_mfma_f32_16x16x32_bf16 v[12:15], v[164:167], a[36:39], v[12:15]
ds_read_b64_tr_b16 v[180:181], v227 offset:12288
s_add_u32 s44, s58, 1835008
v_mfma_f32_16x16x32_bf16 v[20:23], v[164:167], a[40:43], v[20:23]
ds_read_b128 a[60:63], v239 offset:13056
v_mfma_f32_16x16x32_bf16 v[28:31], v[164:167], a[44:47], v[28:31]
ds_read_b64_tr_b16 v[182:183], v227 offset:12800
s_waitcnt lgkmcnt(8)
v_mfma_f32_16x16x32_bf16 v[32:35], v[168:171], a[32:35], v[32:35]
v_mfma_f32_16x16x32_bf16 v[40:43], v[168:171], a[36:39], v[40:43]
ds_read_b64_tr_b16 v[184:185], v228 offset:12288
buffer_load_dwordx4 v230, s[28:31], s44 offen offset:0 lds
v_mfma_f32_16x16x32_bf16 v[48:51], v[168:171], a[40:43], v[48:51]
v_mfma_f32_16x16x32_bf16 v[56:59], v[168:171], a[44:47], v[56:59]
ds_read_b64_tr_b16 v[186:187], v228 offset:12800
buffer_load_dwordx4 v231, s[28:31], s44 offen offset:1024 lds
v_mfma_f32_16x16x32_bf16 v[36:39], v[172:175], a[32:35], v[36:39]
v_mfma_f32_16x16x32_bf16 v[44:47], v[172:175], a[36:39], v[44:47]
ds_read_b64_tr_b16 v[188:189], v229 offset:12288
buffer_load_dwordx4 v232, s[28:31], s44 offen offset:2048 lds
v_mfma_f32_16x16x32_bf16 v[52:55], v[172:175], a[40:43], v[52:55]
v_mfma_f32_16x16x32_bf16 v[60:63], v[172:175], a[44:47], v[60:63]
ds_read_b64_tr_b16 v[190:191], v229 offset:12800
s_waitcnt vmcnt(11) lgkmcnt(4)
v_mfma_f32_16x16x32_bf16 v[0:3], v[176:179], a[48:51], v[0:3]
ds_read_b128 a[64:67], v238 offset:16384
v_mfma_f32_16x16x32_bf16 v[8:11], v[176:179], a[52:55], v[8:11]
ds_read_b64_tr_b16 v[160:161], v226 offset:16384
buffer_load_dwordx4 v233, s[28:31], s44 offen offset:3072 lds
v_mfma_f32_16x16x32_bf16 v[16:19], v[176:179], a[56:59], v[16:19]
ds_read_b128 a[68:71], v238 offset:16640
v_mfma_f32_16x16x32_bf16 v[24:27], v[176:179], a[60:63], v[24:27]
ds_read_b64_tr_b16 v[162:163], v226 offset:16896
s_add_u32 m0, s43, 12288
v_mfma_f32_16x16x32_bf16 v[4:7], v[180:183], a[48:51], v[4:7]
ds_read_b128 a[72:75], v238 offset:16896
v_mfma_f32_16x16x32_bf16 v[12:15], v[180:183], a[52:55], v[12:15]
ds_read_b64_tr_b16 v[164:165], v227 offset:16384
s_add_u32 s44, s58, 2097152
v_mfma_f32_16x16x32_bf16 v[20:23], v[180:183], a[56:59], v[20:23]
ds_read_b128 a[76:79], v238 offset:17152
v_mfma_f32_16x16x32_bf16 v[28:31], v[180:183], a[60:63], v[28:31]
ds_read_b64_tr_b16 v[166:167], v227 offset:16896
s_waitcnt lgkmcnt(8)
v_mfma_f32_16x16x32_bf16 v[32:35], v[184:187], a[48:51], v[32:35]
v_mfma_f32_16x16x32_bf16 v[40:43], v[184:187], a[52:55], v[40:43]
ds_read_b64_tr_b16 v[168:169], v228 offset:16384
buffer_load_dwordx4 v230, s[28:31], s44 offen offset:0 lds
v_mfma_f32_16x16x32_bf16 v[48:51], v[184:187], a[56:59], v[48:51]
v_mfma_f32_16x16x32_bf16 v[56:59], v[184:187], a[60:63], v[56:59]
ds_read_b64_tr_b16 v[170:171], v228 offset:16896
buffer_load_dwordx4 v231, s[28:31], s44 offen offset:1024 lds
v_mfma_f32_16x16x32_bf16 v[36:39], v[188:191], a[48:51], v[36:39]
v_mfma_f32_16x16x32_bf16 v[44:47], v[188:191], a[52:55], v[44:47]
ds_read_b64_tr_b16 v[172:173], v229 offset:16384
buffer_load_dwordx4 v232, s[28:31], s44 offen offset:2048 lds
v_mfma_f32_16x16x32_bf16 v[52:55], v[188:191], a[56:59], v[52:55]
v_mfma_f32_16x16x32_bf16 v[60:63], v[188:191], a[60:63], v[60:63]
ds_read_b64_tr_b16 v[174:175], v229 offset:16896
s_waitcnt vmcnt(11) lgkmcnt(4)
v_mfma_f32_16x16x32_bf16 v[0:3], v[160:163], a[64:67], v[0:3]
ds_read_b128 a[80:83], v239 offset:20480
v_mfma_f32_16x16x32_bf16 v[8:11], v[160:163], a[68:71], v[8:11]
ds_read_b64_tr_b16 v[176:177], v226 offset:0
buffer_load_dwordx4 v233, s[28:31], s44 offen offset:3072 lds
v_mfma_f32_16x16x32_bf16 v[16:19], v[160:163], a[72:75], v[16:19]
ds_read_b128 a[84:87], v239 offset:20736
v_mfma_f32_16x16x32_bf16 v[24:27], v[160:163], a[76:79], v[24:27]
ds_read_b64_tr_b16 v[178:179], v226 offset:512
s_add_u32 m0, s43, 16384
v_mfma_f32_16x16x32_bf16 v[4:7], v[164:167], a[64:67], v[4:7]
ds_read_b128 a[88:91], v239 offset:20992
v_mfma_f32_16x16x32_bf16 v[12:15], v[164:167], a[68:71], v[12:15]
ds_read_b64_tr_b16 v[180:181], v227 offset:0
s_add_u32 s44, s58, 2359296
v_mfma_f32_16x16x32_bf16 v[20:23], v[164:167], a[72:75], v[20:23]
ds_read_b128 a[92:95], v239 offset:21248
v_mfma_f32_16x16x32_bf16 v[28:31], v[164:167], a[76:79], v[28:31]
ds_read_b64_tr_b16 v[182:183], v227 offset:512
s_waitcnt lgkmcnt(8)
v_mfma_f32_16x16x32_bf16 v[32:35], v[168:171], a[64:67], v[32:35]
v_mfma_f32_16x16x32_bf16 v[40:43], v[168:171], a[68:71], v[40:43]
ds_read_b64_tr_b16 v[184:185], v228 offset:0
buffer_load_dwordx4 v230, s[28:31], s44 offen offset:0 lds
v_mfma_f32_16x16x32_bf16 v[48:51], v[168:171], a[72:75], v[48:51]
v_mfma_f32_16x16x32_bf16 v[56:59], v[168:171], a[76:79], v[56:59]
ds_read_b64_tr_b16 v[186:187], v228 offset:512
buffer_load_dwordx4 v231, s[28:31], s44 offen offset:1024 lds
v_mfma_f32_16x16x32_bf16 v[36:39], v[172:175], a[64:67], v[36:39]
v_mfma_f32_16x16x32_bf16 v[44:47], v[172:175], a[68:71], v[44:47]
ds_read_b64_tr_b16 v[188:189], v229 offset:0
buffer_load_dwordx4 v232, s[28:31], s44 offen offset:2048 lds
v_mfma_f32_16x16x32_bf16 v[52:55], v[172:175], a[72:75], v[52:55]
v_mfma_f32_16x16x32_bf16 v[60:63], v[172:175], a[76:79], v[60:63]
ds_read_b64_tr_b16 v[190:191], v229 offset:512
s_waitcnt vmcnt(11) lgkmcnt(4)
v_mfma_f32_16x16x32_bf16 v[0:3], v[176:179], a[80:83], v[0:3]
ds_read_b128 a[96:99], v238 offset:24576
v_mfma_f32_16x16x32_bf16 v[8:11], v[176:179], a[84:87], v[8:11]
ds_read_b64_tr_b16 v[160:161], v226 offset:4096
buffer_load_dwordx4 v233, s[28:31], s44 offen offset:3072 lds
v_mfma_f32_16x16x32_bf16 v[16:19], v[176:179], a[88:91], v[16:19]
ds_read_b128 a[100:103], v238 offset:24832
v_mfma_f32_16x16x32_bf16 v[24:27], v[176:179], a[92:95], v[24:27]
ds_read_b64_tr_b16 v[162:163], v226 offset:4608
s_add_u32 m0, s43, 0
v_mfma_f32_16x16x32_bf16 v[4:7], v[180:183], a[80:83], v[4:7]
ds_read_b128 a[104:107], v238 offset:25088
v_mfma_f32_16x16x32_bf16 v[12:15], v[180:183], a[84:87], v[12:15]
ds_read_b64_tr_b16 v[164:165], v227 offset:4096
s_add_u32 s44, s58, 2621440
v_mfma_f32_16x16x32_bf16 v[20:23], v[180:183], a[88:91], v[20:23]
ds_read_b128 a[108:111], v238 offset:25344
v_mfma_f32_16x16x32_bf16 v[28:31], v[180:183], a[92:95], v[28:31]
ds_read_b64_tr_b16 v[166:167], v227 offset:4608
s_waitcnt lgkmcnt(8)
v_mfma_f32_16x16x32_bf16 v[32:35], v[184:187], a[80:83], v[32:35]
v_mfma_f32_16x16x32_bf16 v[40:43], v[184:187], a[84:87], v[40:43]
ds_read_b64_tr_b16 v[168:169], v228 offset:4096
buffer_load_dwordx4 v230, s[28:31], s44 offen offset:0 lds
v_mfma_f32_16x16x32_bf16 v[48:51], v[184:187], a[88:91], v[48:51]
v_mfma_f32_16x16x32_bf16 v[56:59], v[184:187], a[92:95], v[56:59]
ds_read_b64_tr_b16 v[170:171], v228 offset:4608
buffer_load_dwordx4 v231, s[28:31], s44 offen offset:1024 lds
v_mfma_f32_16x16x32_bf16 v[36:39], v[188:191], a[80:83], v[36:39]
v_mfma_f32_16x16x32_bf16 v[44:47], v[188:191], a[84:87], v[44:47]
ds_read_b64_tr_b16 v[172:173], v229 offset:4096
buffer_load_dwordx4 v232, s[28:31], s44 offen offset:2048 lds
v_mfma_f32_16x16x32_bf16 v[52:55], v[188:191], a[88:91], v[52:55]
v_mfma_f32_16x16x32_bf16 v[60:63], v[188:191], a[92:95], v[60:63]
ds_read_b64_tr_b16 v[174:175], v229 offset:4608
s_waitcnt vmcnt(11) lgkmcnt(4)
v_mfma_f32_16x16x32_bf16 v[0:3], v[160:163], a[96:99], v[0:3]
ds_read_b128 a[112:115], v239 offset:28672
v_mfma_f32_16x16x32_bf16 v[8:11], v[160:163], a[100:103], v[8:11]
ds_read_b64_tr_b16 v[176:177], v226 offset:8192
buffer_load_dwordx4 v233, s[28:31], s44 offen offset:3072 lds
v_mfma_f32_16x16x32_bf16 v[16:19], v[160:163], a[104:107], v[16:19]
ds_read_b128 a[116:119], v239 offset:28928
v_mfma_f32_16x16x32_bf16 v[24:27], v[160:163], a[108:111], v[24:27]
ds_read_b64_tr_b16 v[178:179], v226 offset:8704
s_add_u32 m0, s43, 4096
v_mfma_f32_16x16x32_bf16 v[4:7], v[164:167], a[96:99], v[4:7]
ds_read_b128 a[120:123], v239 offset:29184
v_mfma_f32_16x16x32_bf16 v[12:15], v[164:167], a[100:103], v[12:15]
ds_read_b64_tr_b16 v[180:181], v227 offset:8192
s_add_u32 s44, s58, 2883584
v_mfma_f32_16x16x32_bf16 v[20:23], v[164:167], a[104:107], v[20:23]
ds_read_b128 a[124:127], v239 offset:29440
v_mfma_f32_16x16x32_bf16 v[28:31], v[164:167], a[108:111], v[28:31]
ds_read_b64_tr_b16 v[182:183], v227 offset:8704
s_waitcnt lgkmcnt(8)
v_mfma_f32_16x16x32_bf16 v[32:35], v[168:171], a[96:99], v[32:35]
v_mfma_f32_16x16x32_bf16 v[40:43], v[168:171], a[100:103], v[40:43]
ds_read_b64_tr_b16 v[184:185], v228 offset:8192
buffer_load_dwordx4 v230, s[28:31], s44 offen offset:0 lds
v_mfma_f32_16x16x32_bf16 v[48:51], v[168:171], a[104:107], v[48:51]
v_mfma_f32_16x16x32_bf16 v[56:59], v[168:171], a[108:111], v[56:59]
ds_read_b64_tr_b16 v[186:187], v228 offset:8704
buffer_load_dwordx4 v231, s[28:31], s44 offen offset:1024 lds
v_mfma_f32_16x16x32_bf16 v[36:39], v[172:175], a[96:99], v[36:39]
v_mfma_f32_16x16x32_bf16 v[44:47], v[172:175], a[100:103], v[44:47]
ds_read_b64_tr_b16 v[188:189], v229 offset:8192
buffer_load_dwordx4 v232, s[28:31], s44 offen offset:2048 lds
v_mfma_f32_16x16x32_bf16 v[52:55], v[172:175], a[104:107], v[52:55]
v_mfma_f32_16x16x32_bf16 v[60:63], v[172:175], a[108:111], v[60:63]
ds_read_b64_tr_b16 v[190:191], v229 offset:8704
s_waitcnt vmcnt(11) lgkmcnt(4)
v_mfma_f32_16x16x32_bf16 v[0:3], v[176:179], a[112:115], v[0:3]
ds_read_b128 a[128:131], v238 offset:32768
v_mfma_f32_16x16x32_bf16 v[8:11], v[176:179], a[116:119], v[8:11]
ds_read_b64_tr_b16 v[160:161], v226 offset:12288
buffer_load_dwordx4 v233, s[28:31], s44 offen offset:3072 lds
v_mfma_f32_16x16x32_bf16 v[16:19], v[176:179], a[120:123], v[16:19]
ds_read_b128 a[132:135], v238 offset:33024
v_mfma_f32_16x16x32_bf16 v[24:27], v[176:179], a[124:127], v[24:27]
ds_read_b64_tr_b16 v[162:163], v226 offset:12800
s_add_u32 m0, s43, 8192
v_mfma_f32_16x16x32_bf16 v[4:7], v[180:183], a[112:115], v[4:7]
ds_read_b128 a[136:139], v238 offset:33280
v_mfma_f32_16x16x32_bf16 v[12:15], v[180:183], a[116:119], v[12:15]
ds_read_b64_tr_b16 v[164:165], v227 offset:12288
s_add_u32 s44, s58, 3145728
v_mfma_f32_16x16x32_bf16 v[20:23], v[180:183], a[120:123], v[20:23]
ds_read_b128 a[140:143], v238 offset:33536
v_mfma_f32_16x16x32_bf16 v[28:31], v[180:183], a[124:127], v[28:31]
ds_read_b64_tr_b16 v[166:167], v227 offset:12800
s_waitcnt lgkmcnt(8)
v_mfma_f32_16x16x32_bf16 v[32:35], v[184:187], a[112:115], v[32:35]
v_mfma_f32_16x16x32_bf16 v[40:43], v[184:187], a[116:119], v[40:43]
ds_read_b64_tr_b16 v[168:169], v228 offset:12288
buffer_load_dwordx4 v230, s[28:31], s44 offen offset:0 lds
v_mfma_f32_16x16x32_bf16 v[48:51], v[184:187], a[120:123], v[48:51]
v_mfma_f32_16x16x32_bf16 v[56:59], v[184:187], a[124:127], v[56:59]
ds_read_b64_tr_b16 v[170:171], v228 offset:12800
buffer_load_dwordx4 v231, s[28:31], s44 offen offset:1024 lds
v_mfma_f32_16x16x32_bf16 v[36:39], v[188:191], a[112:115], v[36:39]
v_mfma_f32_16x16x32_bf16 v[44:47], v[188:191], a[116:119], v[44:47]
ds_read_b64_tr_b16 v[172:173], v229 offset:12288
buffer_load_dwordx4 v232, s[28:31], s44 offen offset:2048 lds
v_mfma_f32_16x16x32_bf16 v[52:55], v[188:191], a[120:123], v[52:55]
v_mfma_f32_16x16x32_bf16 v[60:63], v[188:191], a[124:127], v[60:63]
ds_read_b64_tr_b16 v[174:175], v229 offset:12800
s_waitcnt vmcnt(11) lgkmcnt(4)
v_mfma_f32_16x16x32_bf16 v[0:3], v[160:163], a[128:131], v[0:3]
ds_read_b128 a[144:147], v239 offset:36864
v_mfma_f32_16x16x32_bf16 v[8:11], v[160:163], a[132:135], v[8:11]
ds_read_b64_tr_b16 v[176:177], v226 offset:16384
buffer_load_dwordx4 v233, s[28:31], s44 offen offset:3072 lds
v_mfma_f32_16x16x32_bf16 v[16:19], v[160:163], a[136:139], v[16:19]
ds_read_b128 a[148:151], v239 offset:37120
v_mfma_f32_16x16x32_bf16 v[24:27], v[160:163], a[140:143], v[24:27]
ds_read_b64_tr_b16 v[178:179], v226 offset:16896
s_add_u32 m0, s43, 12288
v_mfma_f32_16x16x32_bf16 v[4:7], v[164:167], a[128:131], v[4:7]
ds_read_b128 a[152:155], v239 offset:37376
v_mfma_f32_16x16x32_bf16 v[12:15], v[164:167], a[132:135], v[12:15]
ds_read_b64_tr_b16 v[180:181], v227 offset:16384
s_add_u32 s44, s58, 3407872
v_mfma_f32_16x16x32_bf16 v[20:23], v[164:167], a[136:139], v[20:23]
ds_read_b128 a[156:159], v239 offset:37632
v_mfma_f32_16x16x32_bf16 v[28:31], v[164:167], a[140:143], v[28:31]
ds_read_b64_tr_b16 v[182:183], v227 offset:16896
s_waitcnt lgkmcnt(8)
v_mfma_f32_16x16x32_bf16 v[32:35], v[168:171], a[128:131], v[32:35]
v_mfma_f32_16x16x32_bf16 v[40:43], v[168:171], a[132:135], v[40:43]
ds_read_b64_tr_b16 v[184:185], v228 offset:16384
buffer_load_dwordx4 v230, s[28:31], s44 offen offset:0 lds
v_mfma_f32_16x16x32_bf16 v[48:51], v[168:171], a[136:139], v[48:51]
v_mfma_f32_16x16x32_bf16 v[56:59], v[168:171], a[140:143], v[56:59]
ds_read_b64_tr_b16 v[186:187], v228 offset:16896
buffer_load_dwordx4 v231, s[28:31], s44 offen offset:1024 lds
v_mfma_f32_16x16x32_bf16 v[36:39], v[172:175], a[128:131], v[36:39]
v_mfma_f32_16x16x32_bf16 v[44:47], v[172:175], a[132:135], v[44:47]
ds_read_b64_tr_b16 v[188:189], v229 offset:16384
buffer_load_dwordx4 v232, s[28:31], s44 offen offset:2048 lds
v_mfma_f32_16x16x32_bf16 v[52:55], v[172:175], a[136:139], v[52:55]
v_mfma_f32_16x16x32_bf16 v[60:63], v[172:175], a[140:143], v[60:63]
ds_read_b64_tr_b16 v[190:191], v229 offset:16896
s_waitcnt vmcnt(11) lgkmcnt(4)
v_mfma_f32_16x16x32_bf16 v[0:3], v[176:179], a[144:147], v[0:3]
ds_read_b128 a[160:163], v238 offset:40960
v_mfma_f32_16x16x32_bf16 v[8:11], v[176:179], a[148:151], v[8:11]
ds_read_b64_tr_b16 v[160:161], v226 offset:0
buffer_load_dwordx4 v233, s[28:31], s44 offen offset:3072 lds
v_mfma_f32_16x16x32_bf16 v[16:19], v[176:179], a[152:155], v[16:19]
ds_read_b128 a[164:167], v238 offset:41216
v_mfma_f32_16x16x32_bf16 v[24:27], v[176:179], a[156:159], v[24:27]
ds_read_b64_tr_b16 v[162:163], v226 offset:512
s_add_u32 m0, s43, 16384
v_mfma_f32_16x16x32_bf16 v[4:7], v[180:183], a[144:147], v[4:7]
ds_read_b128 a[168:171], v238 offset:41472
v_mfma_f32_16x16x32_bf16 v[12:15], v[180:183], a[148:151], v[12:15]
ds_read_b64_tr_b16 v[164:165], v227 offset:0
s_add_u32 s44, s58, 3670016
v_mfma_f32_16x16x32_bf16 v[20:23], v[180:183], a[152:155], v[20:23]
ds_read_b128 a[172:175], v238 offset:41728
v_mfma_f32_16x16x32_bf16 v[28:31], v[180:183], a[156:159], v[28:31]
ds_read_b64_tr_b16 v[166:167], v227 offset:512
s_waitcnt lgkmcnt(8)
v_mfma_f32_16x16x32_bf16 v[32:35], v[184:187], a[144:147], v[32:35]
v_mfma_f32_16x16x32_bf16 v[40:43], v[184:187], a[148:151], v[40:43]
ds_read_b64_tr_b16 v[168:169], v228 offset:0
buffer_load_dwordx4 v230, s[28:31], s44 offen offset:0 lds
v_mfma_f32_16x16x32_bf16 v[48:51], v[184:187], a[152:155], v[48:51]
v_mfma_f32_16x16x32_bf16 v[56:59], v[184:187], a[156:159], v[56:59]
ds_read_b64_tr_b16 v[170:171], v228 offset:512
buffer_load_dwordx4 v231, s[28:31], s44 offen offset:1024 lds
v_mfma_f32_16x16x32_bf16 v[36:39], v[188:191], a[144:147], v[36:39]
v_mfma_f32_16x16x32_bf16 v[44:47], v[188:191], a[148:151], v[44:47]
ds_read_b64_tr_b16 v[172:173], v229 offset:0
buffer_load_dwordx4 v232, s[28:31], s44 offen offset:2048 lds
v_mfma_f32_16x16x32_bf16 v[52:55], v[188:191], a[152:155], v[52:55]
v_mfma_f32_16x16x32_bf16 v[60:63], v[188:191], a[156:159], v[60:63]
ds_read_b64_tr_b16 v[174:175], v229 offset:512
s_waitcnt vmcnt(11) lgkmcnt(4)
v_mfma_f32_16x16x32_bf16 v[0:3], v[160:163], a[160:163], v[0:3]
ds_read_b128 a[176:179], v239 offset:45056
v_mfma_f32_16x16x32_bf16 v[8:11], v[160:163], a[164:167], v[8:11]
ds_read_b64_tr_b16 v[176:177], v226 offset:4096
buffer_load_dwordx4 v233, s[28:31], s44 offen offset:3072 lds
v_mfma_f32_16x16x32_bf16 v[16:19], v[160:163], a[168:171], v[16:19]
ds_read_b128 a[180:183], v239 offset:45312
v_mfma_f32_16x16x32_bf16 v[24:27], v[160:163], a[172:175], v[24:27]
ds_read_b64_tr_b16 v[178:179], v226 offset:4608
s_add_u32 m0, s43, 0
v_mfma_f32_16x16x32_bf16 v[4:7], v[164:167], a[160:163], v[4:7]
ds_read_b128 a[184:187], v239 offset:45568
v_mfma_f32_16x16x32_bf16 v[12:15], v[164:167], a[164:167], v[12:15]
ds_read_b64_tr_b16 v[180:181], v227 offset:4096
s_add_u32 s44, s58, 3932160
v_mfma_f32_16x16x32_bf16 v[20:23], v[164:167], a[168:171], v[20:23]
ds_read_b128 a[188:191], v239 offset:45824
v_mfma_f32_16x16x32_bf16 v[28:31], v[164:167], a[172:175], v[28:31]
ds_read_b64_tr_b16 v[182:183], v227 offset:4608
s_waitcnt lgkmcnt(8)
v_mfma_f32_16x16x32_bf16 v[32:35], v[168:171], a[160:163], v[32:35]
v_mfma_f32_16x16x32_bf16 v[40:43], v[168:171], a[164:167], v[40:43]
ds_read_b64_tr_b16 v[184:185], v228 offset:4096
buffer_load_dwordx4 v230, s[28:31], s44 offen offset:0 lds
v_mfma_f32_16x16x32_bf16 v[48:51], v[168:171], a[168:171], v[48:51]
v_mfma_f32_16x16x32_bf16 v[56:59], v[168:171], a[172:175], v[56:59]
ds_read_b64_tr_b16 v[186:187], v228 offset:4608
buffer_load_dwordx4 v231, s[28:31], s44 offen offset:1024 lds
v_mfma_f32_16x16x32_bf16 v[36:39], v[172:175], a[160:163], v[36:39]
v_mfma_f32_16x16x32_bf16 v[44:47], v[172:175], a[164:167], v[44:47]
ds_read_b64_tr_b16 v[188:189], v229 offset:4096
buffer_load_dwordx4 v232, s[28:31], s44 offen offset:2048 lds
v_mfma_f32_16x16x32_bf16 v[52:55], v[172:175], a[168:171], v[52:55]
v_mfma_f32_16x16x32_bf16 v[60:63], v[172:175], a[172:175], v[60:63]
ds_read_b64_tr_b16 v[190:191], v229 offset:4608
s_waitcnt vmcnt(11) lgkmcnt(4)
v_mfma_f32_16x16x32_bf16 v[0:3], v[176:179], a[176:179], v[0:3]
ds_read_b128 a[192:195], v238 offset:49152
v_mfma_f32_16x16x32_bf16 v[8:11], v[176:179], a[180:183], v[8:11]
ds_read_b64_tr_b16 v[160:161], v226 offset:8192
buffer_load_dwordx4 v233, s[28:31], s44 offen offset:3072 lds
v_mfma_f32_16x16x32_bf16 v[16:19], v[176:179], a[184:187], v[16:19]
ds_read_b128 a[196:199], v238 offset:49408
v_mfma_f32_16x16x32_bf16 v[24:27], v[176:179], a[188:191], v[24:27]
ds_read_b64_tr_b16 v[162:163], v226 offset:8704
s_add_u32 m0, s43, 4096
v_mfma_f32_16x16x32_bf16 v[4:7], v[180:183], a[176:179], v[4:7]
ds_read_b128 a[200:203], v238 offset:49664
v_mfma_f32_16x16x32_bf16 v[12:15], v[180:183], a[180:183], v[12:15]
ds_read_b64_tr_b16 v[164:165], v227 offset:8192
s_add_u32 s44, s58, 4194304
v_mfma_f32_16x16x32_bf16 v[20:23], v[180:183], a[184:187], v[20:23]
ds_read_b128 a[204:207], v238 offset:49920
v_mfma_f32_16x16x32_bf16 v[28:31], v[180:183], a[188:191], v[28:31]
ds_read_b64_tr_b16 v[166:167], v227 offset:8704
s_waitcnt lgkmcnt(8)
v_mfma_f32_16x16x32_bf16 v[32:35], v[184:187], a[176:179], v[32:35]
v_mfma_f32_16x16x32_bf16 v[40:43], v[184:187], a[180:183], v[40:43]
ds_read_b64_tr_b16 v[168:169], v228 offset:8192
buffer_load_dwordx4 v230, s[28:31], s44 offen offset:0 lds
v_mfma_f32_16x16x32_bf16 v[48:51], v[184:187], a[184:187], v[48:51]
v_mfma_f32_16x16x32_bf16 v[56:59], v[184:187], a[188:191], v[56:59]
ds_read_b64_tr_b16 v[170:171], v228 offset:8704
buffer_load_dwordx4 v231, s[28:31], s44 offen offset:1024 lds
v_mfma_f32_16x16x32_bf16 v[36:39], v[188:191], a[176:179], v[36:39]
v_mfma_f32_16x16x32_bf16 v[44:47], v[188:191], a[180:183], v[44:47]
ds_read_b64_tr_b16 v[172:173], v229 offset:8192
buffer_load_dwordx4 v232, s[28:31], s44 offen offset:2048 lds
v_mfma_f32_16x16x32_bf16 v[52:55], v[188:191], a[184:187], v[52:55]
v_mfma_f32_16x16x32_bf16 v[60:63], v[188:191], a[188:191], v[60:63]
ds_read_b64_tr_b16 v[174:175], v229 offset:8704
s_waitcnt vmcnt(11) lgkmcnt(4)
v_mfma_f32_16x16x32_bf16 v[0:3], v[160:163], a[192:195], v[0:3]
ds_read_b128 a[208:211], v239 offset:53248
v_mfma_f32_16x16x32_bf16 v[8:11], v[160:163], a[196:199], v[8:11]
ds_read_b64_tr_b16 v[176:177], v226 offset:12288
buffer_load_dwordx4 v233, s[28:31], s44 offen offset:3072 lds
v_mfma_f32_16x16x32_bf16 v[16:19], v[160:163], a[200:203], v[16:19]
ds_read_b128 a[212:215], v239 offset:53504
v_mfma_f32_16x16x32_bf16 v[24:27], v[160:163], a[204:207], v[24:27]
ds_read_b64_tr_b16 v[178:179], v226 offset:12800
s_add_u32 m0, s43, 8192
v_mfma_f32_16x16x32_bf16 v[4:7], v[164:167], a[192:195], v[4:7]
ds_read_b128 a[216:219], v239 offset:53760
v_mfma_f32_16x16x32_bf16 v[12:15], v[164:167], a[196:199], v[12:15]
ds_read_b64_tr_b16 v[180:181], v227 offset:12288
s_add_u32 s44, s58, 4456448
v_mfma_f32_16x16x32_bf16 v[20:23], v[164:167], a[200:203], v[20:23]
ds_read_b128 a[220:223], v239 offset:54016
v_mfma_f32_16x16x32_bf16 v[28:31], v[164:167], a[204:207], v[28:31]
ds_read_b64_tr_b16 v[182:183], v227 offset:12800
s_waitcnt lgkmcnt(8)
v_mfma_f32_16x16x32_bf16 v[32:35], v[168:171], a[192:195], v[32:35]
v_mfma_f32_16x16x32_bf16 v[40:43], v[168:171], a[196:199], v[40:43]
ds_read_b64_tr_b16 v[184:185], v228 offset:12288
buffer_load_dwordx4 v230, s[28:31], s44 offen offset:0 lds
v_mfma_f32_16x16x32_bf16 v[48:51], v[168:171], a[200:203], v[48:51]
v_mfma_f32_16x16x32_bf16 v[56:59], v[168:171], a[204:207], v[56:59]
ds_read_b64_tr_b16 v[186:187], v228 offset:12800
buffer_load_dwordx4 v231, s[28:31], s44 offen offset:1024 lds
v_mfma_f32_16x16x32_bf16 v[36:39], v[172:175], a[192:195], v[36:39]
v_mfma_f32_16x16x32_bf16 v[44:47], v[172:175], a[196:199], v[44:47]
ds_read_b64_tr_b16 v[188:189], v229 offset:12288
buffer_load_dwordx4 v232, s[28:31], s44 offen offset:2048 lds
v_mfma_f32_16x16x32_bf16 v[52:55], v[172:175], a[200:203], v[52:55]
v_mfma_f32_16x16x32_bf16 v[60:63], v[172:175], a[204:207], v[60:63]
ds_read_b64_tr_b16 v[190:191], v229 offset:12800
s_waitcnt vmcnt(11) lgkmcnt(4)
v_mfma_f32_16x16x32_bf16 v[0:3], v[176:179], a[208:211], v[0:3]
ds_read_b128 a[224:227], v238 offset:57344
v_mfma_f32_16x16x32_bf16 v[8:11], v[176:179], a[212:215], v[8:11]
ds_read_b64_tr_b16 v[160:161], v226 offset:16384
buffer_load_dwordx4 v233, s[28:31], s44 offen offset:3072 lds
v_mfma_f32_16x16x32_bf16 v[16:19], v[176:179], a[216:219], v[16:19]
ds_read_b128 a[228:231], v238 offset:57600
v_mfma_f32_16x16x32_bf16 v[24:27], v[176:179], a[220:223], v[24:27]
ds_read_b64_tr_b16 v[162:163], v226 offset:16896
s_add_u32 m0, s43, 12288
v_mfma_f32_16x16x32_bf16 v[4:7], v[180:183], a[208:211], v[4:7]
ds_read_b128 a[232:235], v238 offset:57856
v_mfma_f32_16x16x32_bf16 v[12:15], v[180:183], a[212:215], v[12:15]
ds_read_b64_tr_b16 v[164:165], v227 offset:16384
s_add_u32 s44, s58, 128
v_mfma_f32_16x16x32_bf16 v[20:23], v[180:183], a[216:219], v[20:23]
ds_read_b128 a[236:239], v238 offset:58112
v_mfma_f32_16x16x32_bf16 v[28:31], v[180:183], a[220:223], v[28:31]
ds_read_b64_tr_b16 v[166:167], v227 offset:16896
s_waitcnt lgkmcnt(8)
v_mfma_f32_16x16x32_bf16 v[32:35], v[184:187], a[208:211], v[32:35]
v_mfma_f32_16x16x32_bf16 v[40:43], v[184:187], a[212:215], v[40:43]
ds_read_b64_tr_b16 v[168:169], v228 offset:16384
buffer_load_dwordx4 v230, s[28:31], s44 offen offset:0 lds
v_mfma_f32_16x16x32_bf16 v[48:51], v[184:187], a[216:219], v[48:51]
v_mfma_f32_16x16x32_bf16 v[56:59], v[184:187], a[220:223], v[56:59]
ds_read_b64_tr_b16 v[170:171], v228 offset:16896
buffer_load_dwordx4 v231, s[28:31], s44 offen offset:1024 lds
v_mfma_f32_16x16x32_bf16 v[36:39], v[188:191], a[208:211], v[36:39]
v_mfma_f32_16x16x32_bf16 v[44:47], v[188:191], a[212:215], v[44:47]
ds_read_b64_tr_b16 v[172:173], v229 offset:16384
buffer_load_dwordx4 v232, s[28:31], s44 offen offset:2048 lds
v_mfma_f32_16x16x32_bf16 v[52:55], v[188:191], a[216:219], v[52:55]
v_mfma_f32_16x16x32_bf16 v[60:63], v[188:191], a[220:223], v[60:63]
ds_read_b64_tr_b16 v[174:175], v229 offset:16896
s_waitcnt vmcnt(11) lgkmcnt(4)
v_mfma_f32_16x16x32_bf16 v[0:3], v[160:163], a[224:227], v[0:3]
ds_read_b128 a[240:243], v239 offset:61440
v_mfma_f32_16x16x32_bf16 v[8:11], v[160:163], a[228:231], v[8:11]
ds_read_b64_tr_b16 v[176:177], v226 offset:0
buffer_load_dwordx4 v233, s[28:31], s44 offen offset:3072 lds
v_mfma_f32_16x16x32_bf16 v[16:19], v[160:163], a[232:235], v[16:19]
ds_read_b128 a[244:247], v239 offset:61696
v_mfma_f32_16x16x32_bf16 v[24:27], v[160:163], a[236:239], v[24:27]
ds_read_b64_tr_b16 v[178:179], v226 offset:512
s_add_u32 m0, s43, 16384
v_mfma_f32_16x16x32_bf16 v[4:7], v[164:167], a[224:227], v[4:7]
buffer_load_dwordx4 v[192:195], v252, s[36:39], s13 offen offset:0
ds_read_b128 a[248:251], v239 offset:61952
v_mfma_f32_16x16x32_bf16 v[12:15], v[164:167], a[228:231], v[12:15]
ds_read_b64_tr_b16 v[180:181], v227 offset:0
s_add_u32 s44, s58, 262272
v_mfma_f32_16x16x32_bf16 v[20:23], v[164:167], a[232:235], v[20:23]
ds_read_b128 a[252:255], v239 offset:62208
v_mfma_f32_16x16x32_bf16 v[28:31], v[164:167], a[236:239], v[28:31]
ds_read_b64_tr_b16 v[182:183], v227 offset:512
s_waitcnt lgkmcnt(8)
v_mfma_f32_16x16x32_bf16 v[32:35], v[168:171], a[224:227], v[32:35]
buffer_load_dwordx4 v[196:199], v252, s[36:39], s13 offen offset:2304
v_mfma_f32_16x16x32_bf16 v[40:43], v[168:171], a[228:231], v[40:43]
ds_read_b64_tr_b16 v[184:185], v228 offset:0
buffer_load_dwordx4 v230, s[28:31], s44 offen offset:0 lds
v_mfma_f32_16x16x32_bf16 v[48:51], v[168:171], a[232:235], v[48:51]
v_mfma_f32_16x16x32_bf16 v[56:59], v[168:171], a[236:239], v[56:59]
ds_read_b64_tr_b16 v[186:187], v228 offset:512
buffer_load_dwordx4 v231, s[28:31], s44 offen offset:1024 lds
v_mfma_f32_16x16x32_bf16 v[36:39], v[172:175], a[224:227], v[36:39]
buffer_load_dwordx4 v[200:203], v252, s[36:39], s14 offen offset:0
v_mfma_f32_16x16x32_bf16 v[44:47], v[172:175], a[228:231], v[44:47]
ds_read_b64_tr_b16 v[188:189], v229 offset:0
buffer_load_dwordx4 v232, s[28:31], s44 offen offset:2048 lds
v_mfma_f32_16x16x32_bf16 v[52:55], v[172:175], a[232:235], v[52:55]
v_mfma_f32_16x16x32_bf16 v[60:63], v[172:175], a[236:239], v[60:63]
ds_read_b64_tr_b16 v[190:191], v229 offset:512
s_waitcnt vmcnt(14) lgkmcnt(4)
v_mfma_f32_16x16x32_bf16 v[0:3], v[176:179], a[240:243], v[0:3]
buffer_load_dwordx4 v[204:207], v252, s[36:39], s14 offen offset:2304
ds_read_b128 v[128:131], v240 offset:0
v_mfma_f32_16x16x32_bf16 v[8:11], v[176:179], a[244:247], v[8:11]
ds_read_b64_tr_b16 v[160:161], v226 offset:4096
buffer_load_dwordx4 v233, s[28:31], s44 offen offset:3072 lds
v_mfma_f32_16x16x32_bf16 v[16:19], v[176:179], a[248:251], v[16:19]
ds_read_b128 v[132:135], v240 offset:256
v_mfma_f32_16x16x32_bf16 v[24:27], v[176:179], a[252:255], v[24:27]
ds_read_b64_tr_b16 v[162:163], v226 offset:4608
s_add_u32 m0, s43, 0
v_mfma_f32_16x16x32_bf16 v[4:7], v[180:183], a[240:243], v[4:7]
buffer_load_dword v208, v254, s[36:39], s12 offen
ds_read_b128 v[136:139], v240 offset:512
v_mfma_f32_16x16x32_bf16 v[12:15], v[180:183], a[244:247], v[12:15]
ds_read_b64_tr_b16 v[164:165], v227 offset:4096
s_add_u32 s44, s58, 524416
v_mfma_f32_16x16x32_bf16 v[20:23], v[180:183], a[248:251], v[20:23]
ds_read_b128 v[140:143], v240 offset:768
v_mfma_f32_16x16x32_bf16 v[28:31], v[180:183], a[252:255], v[28:31]
ds_read_b64_tr_b16 v[166:167], v227 offset:4608
s_waitcnt lgkmcnt(8)
v_mfma_f32_16x16x32_bf16 v[32:35], v[184:187], a[240:243], v[32:35]
v_mfma_f32_16x16x32_bf16 v[40:43], v[184:187], a[244:247], v[40:43]
ds_read_b64_tr_b16 v[168:169], v228 offset:4096
buffer_load_dwordx4 v230, s[28:31], s44 offen offset:0 lds
v_mfma_f32_16x16x32_bf16 v[48:51], v[184:187], a[248:251], v[48:51]
v_mfma_f32_16x16x32_bf16 v[56:59], v[184:187], a[252:255], v[56:59]
ds_read_b64_tr_b16 v[170:171], v228 offset:4608
buffer_load_dwordx4 v231, s[28:31], s44 offen offset:1024 lds
v_mfma_f32_16x16x32_bf16 v[36:39], v[188:191], a[240:243], v[36:39]
v_mfma_f32_16x16x32_bf16 v[44:47], v[188:191], a[244:247], v[44:47]
ds_read_b64_tr_b16 v[172:173], v229 offset:4096
buffer_load_dwordx4 v232, s[28:31], s44 offen offset:2048 lds
v_mfma_f32_16x16x32_bf16 v[52:55], v[188:191], a[248:251], v[52:55]
v_mfma_f32_16x16x32_bf16 v[60:63], v[188:191], a[252:255], v[60:63]
ds_read_b64_tr_b16 v[174:175], v229 offset:4608
s_waitcnt vmcnt(16) lgkmcnt(4)
v_mfma_f32_16x16x32_bf16 v[0:3], v[160:163], v[128:131], v[0:3]
ds_read_b128 v[144:147], v241 offset:4096
v_mfma_f32_16x16x32_bf16 v[8:11], v[160:163], v[132:135], v[8:11]
ds_read_b64_tr_b16 v[176:177], v226 offset:8192
buffer_load_dwordx4 v233, s[28:31], s44 offen offset:3072 lds
v_mfma_f32_16x16x32_bf16 v[16:19], v[160:163], v[136:139], v[16:19]
ds_read_b128 v[148:151], v241 offset:4352
v_mfma_f32_16x16x32_bf16 v[24:27], v[160:163], v[140:143], v[24:27]
ds_read_b64_tr_b16 v[178:179], v226 offset:8704
s_add_u32 m0, s43, 4096
v_mfma_f32_16x16x32_bf16 v[4:7], v[164:167], v[128:131], v[4:7]
ds_read_b128 v[152:155], v241 offset:4608
v_mfma_f32_16x16x32_bf16 v[12:15], v[164:167], v[132:135], v[12:15]
ds_read_b64_tr_b16 v[180:181], v227 offset:8192
s_add_u32 s44, s58, 786560
v_mfma_f32_16x16x32_bf16 v[20:23], v[164:167], v[136:139], v[20:23]
ds_read_b128 v[156:159], v241 offset:4864
v_mfma_f32_16x16x32_bf16 v[28:31], v[164:167], v[140:143], v[28:31]
ds_read_b64_tr_b16 v[182:183], v227 offset:8704
s_waitcnt lgkmcnt(8)
v_mfma_f32_16x16x32_bf16 v[32:35], v[168:171], v[128:131], v[32:35]
v_mfma_f32_16x16x32_bf16 v[40:43], v[168:171], v[132:135], v[40:43]
ds_read_b64_tr_b16 v[184:185], v228 offset:8192
buffer_load_dwordx4 v230, s[28:31], s44 offen offset:0 lds
v_mfma_f32_16x16x32_bf16 v[48:51], v[168:171], v[136:139], v[48:51]
v_mfma_f32_16x16x32_bf16 v[56:59], v[168:171], v[140:143], v[56:59]
ds_read_b64_tr_b16 v[186:187], v228 offset:8704
buffer_load_dwordx4 v231, s[28:31], s44 offen offset:1024 lds
v_mfma_f32_16x16x32_bf16 v[36:39], v[172:175], v[128:131], v[36:39]
v_mfma_f32_16x16x32_bf16 v[44:47], v[172:175], v[132:135], v[44:47]
ds_read_b64_tr_b16 v[188:189], v229 offset:8192
buffer_load_dwordx4 v232, s[28:31], s44 offen offset:2048 lds
v_mfma_f32_16x16x32_bf16 v[52:55], v[172:175], v[136:139], v[52:55]
v_mfma_f32_16x16x32_bf16 v[60:63], v[172:175], v[140:143], v[60:63]
ds_read_b64_tr_b16 v[190:191], v229 offset:8704
s_waitcnt vmcnt(16) lgkmcnt(4)
v_mfma_f32_16x16x32_bf16 v[0:3], v[176:179], v[144:147], v[0:3]
v_mfma_f32_16x16x32_bf16 v[8:11], v[176:179], v[148:151], v[8:11]
ds_read_b64_tr_b16 v[160:161], v226 offset:12288
buffer_load_dwordx4 v233, s[28:31], s44 offen offset:3072 lds
v_mfma_f32_16x16x32_bf16 v[16:19], v[176:179], v[152:155], v[16:19]
v_mfma_f32_16x16x32_bf16 v[24:27], v[176:179], v[156:159], v[24:27]
ds_read_b64_tr_b16 v[162:163], v226 offset:12800
s_add_u32 m0, s43, 8192
v_mfma_f32_16x16x32_bf16 v[4:7], v[180:183], v[144:147], v[4:7]
v_mfma_f32_16x16x32_bf16 v[12:15], v[180:183], v[148:151], v[12:15]
ds_read_b64_tr_b16 v[164:165], v227 offset:12288
s_add_u32 s44, s58, 1048704
v_mfma_f32_16x16x32_bf16 v[20:23], v[180:183], v[152:155], v[20:23]
v_mfma_f32_16x16x32_bf16 v[28:31], v[180:183], v[156:159], v[28:31]
ds_read_b64_tr_b16 v[166:167], v227 offset:12800
s_waitcnt lgkmcnt(4)
v_mfma_f32_16x16x32_bf16 v[32:35], v[184:187], v[144:147], v[32:35]
v_mfma_f32_16x16x32_bf16 v[40:43], v[184:187], v[148:151], v[40:43]
ds_read_b64_tr_b16 v[168:169], v228 offset:12288
buffer_load_dwordx4 v230, s[28:31], s44 offen offset:0 lds
v_mfma_f32_16x16x32_bf16 v[48:51], v[184:187], v[152:155], v[48:51]
v_mfma_f32_16x16x32_bf16 v[56:59], v[184:187], v[156:159], v[56:59]
ds_read_b64_tr_b16 v[170:171], v228 offset:12800
buffer_load_dwordx4 v231, s[28:31], s44 offen offset:1024 lds
v_mfma_f32_16x16x32_bf16 v[36:39], v[188:191], v[144:147], v[36:39]
v_mfma_f32_16x16x32_bf16 v[44:47], v[188:191], v[148:151], v[44:47]
ds_read_b64_tr_b16 v[172:173], v229 offset:12288
buffer_load_dwordx4 v232, s[28:31], s44 offen offset:2048 lds
v_mfma_f32_16x16x32_bf16 v[52:55], v[188:191], v[152:155], v[52:55]
v_mfma_f32_16x16x32_bf16 v[60:63], v[188:191], v[156:159], v[60:63]
ds_read_b64_tr_b16 v[174:175], v229 offset:12800
s_waitcnt vmcnt(12) lgkmcnt(4)
v_mfma_f32_16x16x32_bf16 v[64:67], v[160:163], a[0:3], 0
s_barrier
v_mfma_f32_16x16x32_bf16 v[72:75], v[160:163], a[4:7], 0
ds_read_b64_tr_b16 v[176:177], v226 offset:16384
buffer_load_dwordx4 v233, s[28:31], s44 offen offset:3072 lds
v_mfma_f32_16x16x32_bf16 v[80:83], v[160:163], a[8:11], 0
v_xor_b32 v210, s3, v193
v_mfma_f32_16x16x32_bf16 v[88:91], v[160:163], a[12:15], 0
ds_read_b64_tr_b16 v[178:179], v226 offset:16896
s_add_u32 m0, s43, 12288
v_mfma_f32_16x16x32_bf16 v[68:71], v[164:167], a[0:3], 0
v_xor_b32 v211, s3, v195
v_or_b32 v210, v210, v211
v_mfma_f32_16x16x32_bf16 v[76:79], v[164:167], a[4:7], 0
ds_read_b64_tr_b16 v[180:181], v227 offset:16384
s_add_u32 s44, s58, 1310848
v_mfma_f32_16x16x32_bf16 v[84:87], v[164:167], a[8:11], 0
v_xor_b32 v211, s3, v197
v_mfma_f32_16x16x32_bf16 v[92:95], v[164:167], a[12:15], 0
ds_read_b64_tr_b16 v[182:183], v227 offset:16896
s_waitcnt lgkmcnt(4)
v_mfma_f32_16x16x32_bf16 v[96:99], v[168:171], a[0:3], 0
v_or_b32 v210, v210, v211
v_xor_b32 v211, s3, v199
v_mfma_f32_16x16x32_bf16 v[104:107], v[168:171], a[4:7], 0
ds_read_b64_tr_b16 v[184:185], v228 offset:16384
buffer_load_dwordx4 v230, s[28:31], s44 offen offset:0 lds
v_mfma_f32_16x16x32_bf16 v[112:115], v[168:171], a[8:11], 0
v_or_b32 v210, v210, v211
v_mfma_f32_16x16x32_bf16 v[120:123], v[168:171], a[12:15], 0
ds_read_b64_tr_b16 v[186:187], v228 offset:16896
buffer_load_dwordx4 v231, s[28:31], s44 offen offset:1024 lds
v_mfma_f32_16x16x32_bf16 v[100:103], v[172:175], a[0:3], 0
v_xor_b32 v211, s3, v201
v_or_b32 v210, v210, v211
v_mfma_f32_16x16x32_bf16 v[108:111], v[172:175], a[4:7], 0
ds_read_b64_tr_b16 v[188:189], v229 offset:16384
buffer_load_dwordx4 v232, s[28:31], s44 offen offset:2048 lds
v_mfma_f32_16x16x32_bf16 v[116:119], v[172:175], a[8:11], 0
v_xor_b32 v211, s3, v203
v_mfma_f32_16x16x32_bf16 v[124:127], v[172:175], a[12:15], 0
ds_read_b64_tr_b16 v[190:191], v229 offset:16896
s_waitcnt vmcnt(11) lgkmcnt(4)
v_mfma_f32_16x16x32_bf16 v[64:67], v[176:179], a[16:19], v[64:67]
v_or_b32 v210, v210, v211
v_xor_b32 v211, s3, v205
v_mfma_f32_16x16x32_bf16 v[72:75], v[176:179], a[20:23], v[72:75]
ds_read_b64_tr_b16 v[160:161], v226 offset:0
buffer_load_dwordx4 v233, s[28:31], s44 offen offset:3072 lds
v_mfma_f32_16x16x32_bf16 v[80:83], v[176:179], a[24:27], v[80:83]
v_or_b32 v210, v210, v211
v_mfma_f32_16x16x32_bf16 v[88:91], v[176:179], a[28:31], v[88:91]
ds_read_b64_tr_b16 v[162:163], v226 offset:512
s_add_u32 m0, s43, 16384
v_mfma_f32_16x16x32_bf16 v[68:71], v[180:183], a[16:19], v[68:71]
v_xor_b32 v211, s3, v207
v_or_b32 v210, v210, v211
v_mfma_f32_16x16x32_bf16 v[76:79], v[180:183], a[20:23], v[76:79]
ds_read_b64_tr_b16 v[164:165], v227 offset:0
s_add_u32 s44, s58, 1572992
v_mfma_f32_16x16x32_bf16 v[84:87], v[180:183], a[24:27], v[84:87]
v_xor_b32 v211, s3, v208
v_mfma_f32_16x16x32_bf16 v[92:95], v[180:183], a[28:31], v[92:95]
ds_read_b64_tr_b16 v[166:167], v227 offset:512
s_waitcnt lgkmcnt(4)
v_mfma_f32_16x16x32_bf16 v[96:99], v[184:187], a[16:19], v[96:99]
v_or_b32 v210, v210, v211
v_cmp_ne_u32 vcc, 0, v210
v_mfma_f32_16x16x32_bf16 v[104:107], v[184:187], a[20:23], v[104:107]
ds_read_b64_tr_b16 v[168:169], v228 offset:0
buffer_load_dwordx4 v230, s[28:31], s44 offen offset:0 lds
v_mfma_f32_16x16x32_bf16 v[112:115], v[184:187], a[24:27], v[112:115]
s_nop 0
s_cbranch_vccnz P2_RETRY
P2_OK:
v_mfma_f32_16x16x32_bf16 v[120:123], v[184:187], a[28:31], v[120:123]
ds_read_b64_tr_b16 v[170:171], v228 offset:512
buffer_load_dwordx4 v231, s[28:31], s44 offen offset:1024 lds
v_mfma_f32_16x16x32_bf16 v[100:103], v[188:191], a[16:19], v[100:103]
v_mov_b32 v193, v194
v_mov_b32 v197, v198
v_mfma_f32_16x16x32_bf16 v[108:111], v[188:191], a[20:23], v[108:111]
ds_read_b64_tr_b16 v[172:173], v229 offset:0
buffer_load_dwordx4 v232, s[28:31], s44 offen offset:2048 lds
v_mfma_f32_16x16x32_bf16 v[116:119], v[188:191], a[24:27], v[116:119]
v_mov_b32 v201, v202
v_mov_b32 v205, v206
v_mfma_f32_16x16x32_bf16 v[124:127], v[188:191], a[28:31], v[124:127]
ds_read_b64_tr_b16 v[174:175], v229 offset:512
s_waitcnt vmcnt(11) lgkmcnt(4)
v_mfma_f32_16x16x32_bf16 v[64:67], v[160:163], a[32:35], v[64:67]
ds_write_b64 v253, v[192:193] offset:0
ds_write_b64 v253, v[196:197] offset:1152
v_mfma_f32_16x16x32_bf16 v[72:75], v[160:163], a[36:39], v[72:75]
ds_read_b64_tr_b16 v[176:177], v226 offset:4096
buffer_load_dwordx4 v233, s[28:31], s44 offen offset:3072 lds
v_mfma_f32_16x16x32_bf16 v[80:83], v[160:163], a[40:43], v[80:83]
ds_write_b64 v253, v[200:201] offset:2304
v_mfma_f32_16x16x32_bf16 v[88:91], v[160:163], a[44:47], v[88:91]
ds_read_b64_tr_b16 v[178:179], v226 offset:4608
s_add_u32 m0, s43, 0
v_mfma_f32_16x16x32_bf16 v[68:71], v[164:167], a[32:35], v[68:71]
ds_write_b64 v253, v[204:205] offset:3456
s_and_b32 s45, s40, 1
v_mfma_f32_16x16x32_bf16 v[76:79], v[164:167], a[36:39], v[76:79]
ds_read_b64_tr_b16 v[180:181], v227 offset:4096
s_add_u32 s44, s58, 1835136
v_mfma_f32_16x16x32_bf16 v[84:87], v[164:167], a[40:43], v[84:87]
s_lshl_b32 s45, s45, 11
v_add_u32 v238, s45, v224
v_mfma_f32_16x16x32_bf16 v[92:95], v[164:167], a[44:47], v[92:95]
ds_read_b64_tr_b16 v[182:183], v227 offset:4608
s_waitcnt lgkmcnt(8)
v_mfma_f32_16x16x32_bf16 v[96:99], v[168:171], a[32:35], v[96:99]
v_xor_b32 v239, 2048, v238
v_add_u32 v240, 65536, v238
v_mfma_f32_16x16x32_bf16 v[104:107], v[168:171], a[36:39], v[104:107]
ds_read_b64_tr_b16 v[184:185], v228 offset:4096
buffer_load_dwordx4 v230, s[28:31], s44 offen offset:0 lds
v_mfma_f32_16x16x32_bf16 v[112:115], v[168:171], a[40:43], v[112:115]
v_add_u32 v241, 65536, v239
v_mfma_f32_16x16x32_bf16 v[120:123], v[168:171], a[44:47], v[120:123]
ds_read_b64_tr_b16 v[186:187], v228 offset:4608
buffer_load_dwordx4 v231, s[28:31], s44 offen offset:1024 lds
v_mfma_f32_16x16x32_bf16 v[100:103], v[172:175], a[32:35], v[100:103]
v_mov_b32 v209, s3
v_cvt_pk_bf16_f32 v0, v0, v1
v_mfma_f32_16x16x32_bf16 v[108:111], v[172:175], a[36:39], v[108:111]
ds_read_b64_tr_b16 v[188:189], v229 offset:4096
buffer_load_dwordx4 v232, s[28:31], s44 offen offset:2048 lds
v_mfma_f32_16x16x32_bf16 v[116:119], v[172:175], a[40:43], v[116:119]
v_cvt_pk_bf16_f32 v1, v2, v3
v_cvt_pk_bf16_f32 v2, v4, v5
v_mfma_f32_16x16x32_bf16 v[124:127], v[172:175], a[44:47], v[124:127]
ds_read_b64_tr_b16 v[190:191], v229 offset:4608
s_waitcnt vmcnt(11) lgkmcnt(4)
v_mfma_f32_16x16x32_bf16 v[64:67], v[176:179], a[48:51], v[64:67]
v_cvt_pk_bf16_f32 v3, v6, v7
v_cvt_pk_bf16_f32 v8, v8, v9
v_mfma_f32_16x16x32_bf16 v[72:75], v[176:179], a[52:55], v[72:75]
ds_read_b64_tr_b16 v[160:161], v226 offset:8192
buffer_load_dwordx4 v233, s[28:31], s44 offen offset:3072 lds
v_mfma_f32_16x16x32_bf16 v[80:83], v[176:179], a[56:59], v[80:83]
v_cvt_pk_bf16_f32 v9, v10, v11
v_mfma_f32_16x16x32_bf16 v[88:91], v[176:179], a[60:63], v[88:91]
ds_read_b64_tr_b16 v[162:163], v226 offset:8704
s_add_u32 m0, s43, 4096
v_mfma_f32_16x16x32_bf16 v[68:71], v[180:183], a[48:51], v[68:71]
v_cvt_pk_bf16_f32 v10, v12, v13
v_cvt_pk_bf16_f32 v11, v14, v15
v_mfma_f32_16x16x32_bf16 v[76:79], v[180:183], a[52:55], v[76:79]
ds_read_b64_tr_b16 v[164:165], v227 offset:8192
s_add_u32 s44, s58, 2097280
v_mfma_f32_16x16x32_bf16 v[84:87], v[180:183], a[56:59], v[84:87]
v_permlane32_swap_b32 v0, v2
v_permlane32_swap_b32 v1, v3
v_mfma_f32_16x16x32_bf16 v[92:95], v[180:183], a[60:63], v[92:95]
ds_read_b64_tr_b16 v[166:167], v227 offset:8704
s_waitcnt lgkmcnt(4)
v_mfma_f32_16x16x32_bf16 v[96:99], v[184:187], a[48:51], v[96:99]
v_permlane32_swap_b32 v8, v10
v_mfma_f32_16x16x32_bf16 v[104:107], v[184:187], a[52:55], v[104:107]
ds_read_b64_tr_b16 v[168:169], v228 offset:8192
buffer_load_dwordx4 v230, s[28:31], s44 offen offset:0 lds
v_mfma_f32_16x16x32_bf16 v[112:115], v[184:187], a[56:59], v[112:115]
v_permlane32_swap_b32 v9, v11
v_accvgpr_write_b32 a0, v0
v_mfma_f32_16x16x32_bf16 v[120:123], v[184:187], a[60:63], v[120:123]
ds_read_b64_tr_b16 v[170:171], v228 offset:8704
buffer_load_dwordx4 v231, s[28:31], s44 offen offset:1024 lds
v_mfma_f32_16x16x32_bf16 v[100:103], v[188:191], a[48:51], v[100:103]
v_accvgpr_write_b32 a1, v1
v_accvgpr_write_b32 a2, v2
v_mfma_f32_16x16x32_bf16 v[108:111], v[188:191], a[52:55], v[108:111]
ds_read_b64_tr_b16 v[172:173], v229 offset:8192
buffer_load_dwordx4 v232, s[28:31], s44 offen offset:2048 lds
v_mfma_f32_16x16x32_bf16 v[116:119], v[188:191], a[56:59], v[116:119]
v_accvgpr_write_b32 a3, v3
v_accvgpr_write_b32 a4, v8
v_mfma_f32_16x16x32_bf16 v[124:127], v[188:191], a[60:63], v[124:127]
ds_read_b64_tr_b16 v[174:175], v229 offset:8704
s_waitcnt vmcnt(11) lgkmcnt(4)
v_mfma_f32_16x16x32_bf16 v[64:67], v[160:163], a[64:67], v[64:67]
v_accvgpr_write_b32 a5, v9
v_mfma_f32_16x16x32_bf16 v[72:75], v[160:163], a[68:71], v[72:75]
ds_read_b64_tr_b16 v[176:177], v226 offset:12288
buffer_load_dwordx4 v233, s[28:31], s44 offen offset:3072 lds
v_mfma_f32_16x16x32_bf16 v[80:83], v[160:163], a[72:75], v[80:83]
v_accvgpr_write_b32 a6, v10
v_accvgpr_write_b32 a7, v11
v_mfma_f32_16x16x32_bf16 v[88:91], v[160:163], a[76:79], v[88:91]
ds_read_b64_tr_b16 v[178:179], v226 offset:12800
s_add_u32 m0, s43, 8192
v_mfma_f32_16x16x32_bf16 v[68:71], v[164:167], a[64:67], v[68:71]
v_cvt_pk_bf16_f32 v16, v16, v17
v_cvt_pk_bf16_f32 v17, v18, v19
v_mfma_f32_16x16x32_bf16 v[76:79], v[164:167], a[68:71], v[76:79]
ds_read_b64_tr_b16 v[180:181], v227 offset:12288
s_add_u32 s44, s58, 2359424
v_mfma_f32_16x16x32_bf16 v[84:87], v[164:167], a[72:75], v[84:87]
v_cvt_pk_bf16_f32 v18, v20, v21
v_cvt_pk_bf16_f32 v19, v22, v23
v_mfma_f32_16x16x32_bf16 v[92:95], v[164:167], a[76:79], v[92:95]
ds_read_b64_tr_b16 v[182:183], v227 offset:12800
s_waitcnt lgkmcnt(4)
v_mfma_f32_16x16x32_bf16 v[96:99], v[168:171], a[64:67], v[96:99]
v_cvt_pk_bf16_f32 v24, v24, v25
v_mfma_f32_16x16x32_bf16 v[104:107], v[168:171], a[68:71], v[104:107]
ds_read_b64_tr_b16 v[184:185], v228 offset:12288
buffer_load_dwordx4 v230, s[28:31], s44 offen offset:0 lds
v_mfma_f32_16x16x32_bf16 v[112:115], v[168:171], a[72:75], v[112:115]
v_cvt_pk_bf16_f32 v25, v26, v27
v_cvt_pk_bf16_f32 v26, v28, v29
v_mfma_f32_16x16x32_bf16 v[120:123], v[168:171], a[76:79], v[120:123]
ds_read_b64_tr_b16 v[186:187], v228 offset:12800
buffer_load_dwordx4 v231, s[28:31], s44 offen offset:1024 lds
v_mfma_f32_16x16x32_bf16 v[100:103], v[172:175], a[64:67], v[100:103]
v_cvt_pk_bf16_f32 v27, v30, v31
v_permlane32_swap_b32 v16, v18
v_mfma_f32_16x16x32_bf16 v[108:111], v[172:175], a[68:71], v[108:111]
ds_read_b64_tr_b16 v[188:189], v229 offset:12288
buffer_load_dwordx4 v232, s[28:31], s44 offen offset:2048 lds
v_mfma_f32_16x16x32_bf16 v[116:119], v[172:175], a[72:75], v[116:119]
v_permlane32_swap_b32 v17, v19
v_mfma_f32_16x16x32_bf16 v[124:127], v[172:175], a[76:79], v[124:127]
ds_read_b64_tr_b16 v[190:191], v229 offset:12800
s_waitcnt vmcnt(11) lgkmcnt(4)
v_mfma_f32_16x16x32_bf16 v[64:67], v[176:179], a[80:83], v[64:67]
v_permlane32_swap_b32 v24, v26
v_permlane32_swap_b32 v25, v27
v_mfma_f32_16x16x32_bf16 v[72:75], v[176:179], a[84:87], v[72:75]
ds_read_b64_tr_b16 v[160:161], v226 offset:16384
buffer_load_dwordx4 v233, s[28:31], s44 offen offset:3072 lds
v_mfma_f32_16x16x32_bf16 v[80:83], v[176:179], a[88:91], v[80:83]
v_accvgpr_write_b32 a8, v16
v_accvgpr_write_b32 a9, v17
v_mfma_f32_16x16x32_bf16 v[88:91], v[176:179], a[92:95], v[88:91]
ds_read_b64_tr_b16 v[162:163], v226 offset:16896
s_add_u32 m0, s43, 12288
v_mfma_f32_16x16x32_bf16 v[68:71], v[180:183], a[80:83], v[68:71]
v_accvgpr_write_b32 a10, v18
v_accvgpr_write_b32 a11, v19
v_mfma_f32_16x16x32_bf16 v[76:79], v[180:183], a[84:87], v[76:79]
ds_read_b64_tr_b16 v[164:165], v227 offset:16384
s_add_u32 s44, s58, 2621568
v_mfma_f32_16x16x32_bf16 v[84:87], v[180:183], a[88:91], v[84:87]
v_accvgpr_write_b32 a12, v24
v_mfma_f32_16x16x32_bf16 v[92:95], v[180:183], a[92:95], v[92:95]
ds_read_b64_tr_b16 v[166:167], v227 offset:16896
s_waitcnt lgkmcnt(4)
v_mfma_f32_16x16x32_bf16 v[96:99], v[184:187], a[80:83], v[96:99]
v_accvgpr_write_b32 a13, v25
v_accvgpr_write_b32 a14, v26
v_mfma_f32_16x16x32_bf16 v[104:107], v[184:187], a[84:87], v[104:107]
ds_read_b64_tr_b16 v[168:169], v228 offset:16384
buffer_load_dwordx4 v230, s[28:31], s44 offen offset:0 lds
v_mfma_f32_16x16x32_bf16 v[112:115], v[184:187], a[88:91], v[112:115]
v_accvgpr_write_b32 a15, v27
v_cvt_pk_bf16_f32 v32, v32, v33
v_mfma_f32_16x16x32_bf16 v[120:123], v[184:187], a[92:95], v[120:123]
ds_read_b64_tr_b16 v[170:171], v228 offset:16896
buffer_load_dwordx4 v231, s[28:31], s44 offen offset:1024 lds
v_mfma_f32_16x16x32_bf16 v[100:103], v[188:191], a[80:83], v[100:103]
v_cvt_pk_bf16_f32 v33, v34, v35
v_cvt_pk_bf16_f32 v34, v36, v37
v_mfma_f32_16x16x32_bf16 v[108:111], v[188:191], a[84:87], v[108:111]
ds_read_b64_tr_b16 v[172:173], v229 offset:16384
buffer_load_dwordx4 v232, s[28:31], s44 offen offset:2048 lds
v_mfma_f32_16x16x32_bf16 v[116:119], v[188:191], a[88:91], v[116:119]
v_cvt_pk_bf16_f32 v35, v38, v39
v_mfma_f32_16x16x32_bf16 v[124:127], v[188:191], a[92:95], v[124:127]
ds_read_b64_tr_b16 v[174:175], v229 offset:16896
s_waitcnt vmcnt(11) lgkmcnt(4)
v_mfma_f32_16x16x32_bf16 v[64:67], v[160:163], a[96:99], v[64:67]
v_cvt_pk_bf16_f32 v40, v40, v41
v_cvt_pk_bf16_f32 v41, v42, v43
v_mfma_f32_16x16x32_bf16 v[72:75], v[160:163], a[100:103], v[72:75]
ds_read_b64_tr_b16 v[176:177], v226 offset:0
buffer_load_dwordx4 v233, s[28:31], s44 offen offset:3072 lds
v_mfma_f32_16x16x32_bf16 v[80:83], v[160:163], a[104:107], v[80:83]
v_cvt_pk_bf16_f32 v42, v44, v45
v_cvt_pk_bf16_f32 v43, v46, v47
v_mfma_f32_16x16x32_bf16 v[88:91], v[160:163], a[108:111], v[88:91]
ds_read_b64_tr_b16 v[178:179], v226 offset:512
s_add_u32 m0, s43, 16384
v_mfma_f32_16x16x32_bf16 v[68:71], v[164:167], a[96:99], v[68:71]
v_permlane32_swap_b32 v32, v34
v_mfma_f32_16x16x32_bf16 v[76:79], v[164:167], a[100:103], v[76:79]
ds_read_b64_tr_b16 v[180:181], v227 offset:0
s_add_u32 s44, s58, 2883712
v_mfma_f32_16x16x32_bf16 v[84:87], v[164:167], a[104:107], v[84:87]
v_permlane32_swap_b32 v33, v35
v_permlane32_swap_b32 v40, v42
v_mfma_f32_16x16x32_bf16 v[92:95], v[164:167], a[108:111], v[92:95]
ds_read_b64_tr_b16 v[182:183], v227 offset:512
s_waitcnt lgkmcnt(4)
v_mfma_f32_16x16x32_bf16 v[96:99], v[168:171], a[96:99], v[96:99]
v_permlane32_swap_b32 v41, v43
v_accvgpr_write_b32 a16, v32
v_mfma_f32_16x16x32_bf16 v[104:107], v[168:171], a[100:103], v[104:107]
ds_read_b64_tr_b16 v[184:185], v228 offset:0
buffer_load_dwordx4 v230, s[28:31], s44 offen offset:0 lds
v_mfma_f32_16x16x32_bf16 v[112:115], v[168:171], a[104:107], v[112:115]
v_accvgpr_write_b32 a17, v33
v_accvgpr_write_b32 a18, v34
v_mfma_f32_16x16x32_bf16 v[120:123], v[168:171], a[108:111], v[120:123]
ds_read_b64_tr_b16 v[186:187], v228 offset:512
buffer_load_dwordx4 v231, s[28:31], s44 offen offset:1024 lds
v_mfma_f32_16x16x32_bf16 v[100:103], v[172:175], a[96:99], v[100:103]
v_accvgpr_write_b32 a19, v35
v_mfma_f32_16x16x32_bf16 v[108:111], v[172:175], a[100:103], v[108:111]
ds_read_b64_tr_b16 v[188:189], v229 offset:0
buffer_load_dwordx4 v232, s[28:31], s44 offen offset:2048 lds
v_mfma_f32_16x16x32_bf16 v[116:119], v[172:175], a[104:107], v[116:119]
v_accvgpr_write_b32 a20, v40
v_accvgpr_write_b32 a21, v41
v_mfma_f32_16x16x32_bf16 v[124:127], v[172:175], a[108:111], v[124:127]
ds_read_b64_tr_b16 v[190:191], v229 offset:512
s_waitcnt vmcnt(11) lgkmcnt(4)
v_mfma_f32_16x16x32_bf16 v[64:67], v[176:179], a[112:115], v[64:67]
v_accvgpr_write_b32 a22, v42
v_accvgpr_write_b32 a23, v43
v_mfma_f32_16x16x32_bf16 v[72:75], v[176:179], a[116:119], v[72:75]
ds_read_b64_tr_b16 v[160:161], v226 offset:4096
buffer_load_dwordx4 v233, s[28:31], s44 offen offset:3072 lds
v_mfma_f32_16x16x32_bf16 v[80:83], v[176:179], a[120:123], v[80:83]
v_cvt_pk_bf16_f32 v48, v48, v49
v_cvt_pk_bf16_f32 v49, v50, v51
v_mfma_f32_16x16x32_bf16 v[88:91], v[176:179], a[124:127], v[88:91]
ds_read_b64_tr_b16 v[162:163], v226 offset:4608
s_add_u32 m0, s43, 0
v_mfma_f32_16x16x32_bf16 v[68:71], v[180:183], a[112:115], v[68:71]
v_cvt_pk_bf16_f32 v50, v52, v53
v_mfma_f32_16x16x32_bf16 v[76:79], v[180:183], a[116:119], v[76:79]
ds_read_b64_tr_b16 v[164:165], v227 offset:4096
s_add_u32 s44, s58, 3145856
v_mfma_f32_16x16x32_bf16 v[84:87], v[180:183], a[120:123], v[84:87]
v_cvt_pk_bf16_f32 v51, v54, v55
v_cvt_pk_bf16_f32 v56, v56, v57
v_mfma_f32_16x16x32_bf16 v[92:95], v[180:183], a[124:127], v[92:95]
ds_read_b64_tr_b16 v[166:167], v227 offset:4608
s_waitcnt lgkmcnt(4)
v_mfma_f32_16x16x32_bf16 v[96:99], v[184:187], a[112:115], v[96:99]
v_cvt_pk_bf16_f32 v57, v58, v59
v_cvt_pk_bf16_f32 v58, v60, v61
v_mfma_f32_16x16x32_bf16 v[104:107], v[184:187], a[116:119], v[104:107]
ds_read_b64_tr_b16 v[168:169], v228 offset:4096
buffer_load_dwordx4 v230, s[28:31], s44 offen offset:0 lds
v_mfma_f32_16x16x32_bf16 v[112:115], v[184:187], a[120:123], v[112:115]
v_cvt_pk_bf16_f32 v59, v62, v63
v_permlane32_swap_b32 v48, v50
v_mfma_f32_16x16x32_bf16 v[120:123], v[184:187], a[124:127], v[120:123]
ds_read_b64_tr_b16 v[170:171], v228 offset:4608
buffer_load_dwordx4 v231, s[28:31], s44 offen offset:1024 lds
v_mfma_f32_16x16x32_bf16 v[100:103], v[188:191], a[112:115], v[100:103]
v_permlane32_swap_b32 v49, v51
v_mfma_f32_16x16x32_bf16 v[108:111], v[188:191], a[116:119], v[108:111]
ds_read_b64_tr_b16 v[172:173], v229 offset:4096
buffer_load_dwordx4 v232, s[28:31], s44 offen offset:2048 lds
v_mfma_f32_16x16x32_bf16 v[116:119], v[188:191], a[120:123], v[116:119]
v_permlane32_swap_b32 v56, v58
v_permlane32_swap_b32 v57, v59
v_mfma_f32_16x16x32_bf16 v[124:127], v[188:191], a[124:127], v[124:127]
ds_read_b64_tr_b16 v[174:175], v229 offset:4608
s_waitcnt vmcnt(11) lgkmcnt(4)
v_mfma_f32_16x16x32_bf16 v[64:67], v[160:163], a[128:131], v[64:67]
v_accvgpr_write_b32 a24, v48
v_accvgpr_write_b32 a25, v49
v_mfma_f32_16x16x32_bf16 v[72:75], v[160:163], a[132:135], v[72:75]
ds_read_b64_tr_b16 v[176:177], v226 offset:8192
buffer_load_dwordx4 v233, s[28:31], s44 offen offset:3072 lds
v_mfma_f32_16x16x32_bf16 v[80:83], v[160:163], a[136:139], v[80:83]
v_accvgpr_write_b32 a26, v50
v_mfma_f32_16x16x32_bf16 v[88:91], v[160:163], a[140:143], v[88:91]
ds_read_b64_tr_b16 v[178:179], v226 offset:8704
s_add_u32 m0, s43, 4096
v_mfma_f32_16x16x32_bf16 v[68:71], v[164:167], a[128:131], v[68:71]
v_accvgpr_write_b32 a27, v51
v_accvgpr_write_b32 a28, v56
v_mfma_f32_16x16x32_bf16 v[76:79], v[164:167], a[132:135], v[76:79]
ds_read_b64_tr_b16 v[180:181], v227 offset:8192
s_add_u32 s44, s58, 3408000
v_mfma_f32_16x16x32_bf16 v[84:87], v[164:167], a[136:139], v[84:87]
v_accvgpr_write_b32 a29, v57
v_accvgpr_write_b32 a30, v58
v_mfma_f32_16x16x32_bf16 v[92:95], v[164:167], a[140:143], v[92:95]
ds_read_b64_tr_b16 v[182:183], v227 offset:8704
s_waitcnt lgkmcnt(4)
v_mfma_f32_16x16x32_bf16 v[96:99], v[168:171], a[128:131], v[96:99]
v_accvgpr_write_b32 a31, v59
v_mfma_f32_16x16x32_bf16 v[104:107], v[168:171], a[132:135], v[104:107]
ds_read_b64_tr_b16 v[184:185], v228 offset:8192
buffer_load_dwordx4 v230, s[28:31], s44 offen offset:0 lds
v_mfma_f32_16x16x32_bf16 v[112:115], v[168:171], a[136:139], v[112:115]
s_lshl_b32 s45, s41, 3
s_add_u32 s45, s45, s42
v_mfma_f32_16x16x32_bf16 v[120:123], v[168:171], a[140:143], v[120:123]
ds_read_b64_tr_b16 v[186:187], v228 offset:8704
buffer_load_dwordx4 v231, s[28:31], s44 offen offset:1024 lds
v_mfma_f32_16x16x32_bf16 v[100:103], v[172:175], a[128:131], v[100:103]
s_mul_i32 s45, s45, 73728
s_add_u32 s45, s45, 1048576
v_mfma_f32_16x16x32_bf16 v[108:111], v[172:175], a[132:135], v[108:111]
ds_read_b64_tr_b16 v[188:189], v229 offset:8192
buffer_load_dwordx4 v232, s[28:31], s44 offen offset:2048 lds
v_mfma_f32_16x16x32_bf16 v[116:119], v[172:175], a[136:139], v[116:119]
s_lshl_b32 s46, s40, 13
s_add_u32 s60, s45, s46
v_mfma_f32_16x16x32_bf16 v[124:127], v[172:175], a[140:143], v[124:127]
ds_read_b64_tr_b16 v[190:191], v229 offset:8704
s_waitcnt vmcnt(11) lgkmcnt(4)
v_mfma_f32_16x16x32_bf16 v[64:67], v[176:179], a[144:147], v[64:67]
s_add_u32 s61, s60, 4096
s_add_u32 s62, s60, 32768
v_mfma_f32_16x16x32_bf16 v[72:75], v[176:179], a[148:151], v[72:75]
ds_read_b64_tr_b16 v[160:161], v226 offset:12288
buffer_load_dwordx4 v233, s[28:31], s44 offen offset:3072 lds
v_mfma_f32_16x16x32_bf16 v[80:83], v[176:179], a[152:155], v[80:83]
s_add_u32 s63, s60, 36864
v_mfma_f32_16x16x32_bf16 v[88:91], v[176:179], a[156:159], v[88:91]
ds_read_b64_tr_b16 v[162:163], v226 offset:12800
s_add_u32 m0, s43, 8192
v_mfma_f32_16x16x32_bf16 v[68:71], v[180:183], a[144:147], v[68:71]
s_lshr_b32 s46, s40, 1
s_lshl_b32 s46, s46, 12
v_mfma_f32_16x16x32_bf16 v[76:79], v[180:183], a[148:151], v[76:79]
ds_read_b64_tr_b16 v[164:165], v227 offset:12288
s_add_u32 s44, s58, 3670144
v_mfma_f32_16x16x32_bf16 v[84:87], v[180:183], a[152:155], v[84:87]
s_add_u32 s46, s46, s45
s_add_u32 s64, s46, 65536
v_mfma_f32_16x16x32_bf16 v[92:95], v[180:183], a[156:159], v[92:95]
ds_read_b64_tr_b16 v[166:167], v227 offset:12800
s_waitcnt lgkmcnt(4)
v_mfma_f32_16x16x32_bf16 v[96:99], v[184:187], a[144:147], v[96:99]
s_mul_i32 s45, s42, 589824
v_mfma_f32_16x16x32_bf16 v[104:107], v[184:187], a[148:151], v[104:107]
ds_read_b64_tr_b16 v[168:169], v228 offset:12288
buffer_load_dwordx4 v230, s[28:31], s44 offen offset:0 lds
v_mfma_f32_16x16x32_bf16 v[112:115], v[184:187], a[152:155], v[112:115]
s_add_u32 s45, s45, 1024
s_mul_i32 s46, s40, 18432
v_mfma_f32_16x16x32_bf16 v[120:123], v[184:187], a[156:159], v[120:123]
ds_read_b64_tr_b16 v[170:171], v228 offset:12800
buffer_load_dwordx4 v231, s[28:31], s44 offen offset:1024 lds
v_mfma_f32_16x16x32_bf16 v[100:103], v[188:191], a[144:147], v[100:103]
s_add_u32 s68, s45, s46
s_add_u32 s66, s68, s46
v_mfma_f32_16x16x32_bf16 v[108:111], v[188:191], a[148:151], v[108:111]
ds_read_b64_tr_b16 v[172:173], v229 offset:12288
buffer_load_dwordx4 v232, s[28:31], s44 offen offset:2048 lds
v_mfma_f32_16x16x32_bf16 v[116:119], v[188:191], a[152:155], v[116:119]
s_lshl_b32 s67, s40, 12
s_lshl_b32 s69, s40, 11
v_mfma_f32_16x16x32_bf16 v[124:127], v[188:191], a[156:159], v[124:127]
ds_read_b64_tr_b16 v[174:175], v229 offset:12800
s_movk_i32 s46, 1152
s_cmp_ge_u32 s40, 2
s_cselect_b32 s88, s80, s72
s_cselect_b32 s89, s81, s73
s_cselect_b32 s92, s32, s76
s_cselect_b32 s93, s33, s77
s_cselect_b32 s94, s34, s78
s_waitcnt vmcnt(11) lgkmcnt(4)
v_mfma_f32_16x16x32_bf16 v[64:67], v[160:163], a[160:163], v[64:67]
v_mfma_f32_16x16x32_bf16 v[72:75], v[160:163], a[164:167], v[72:75]
ds_read_b64_tr_b16 v[176:177], v226 offset:16384
buffer_load_dwordx4 v233, s[28:31], s44 offen offset:3072 lds
s_cmp_ge_u32 s40, 2
s_cselect_b32 s45, s46, 9216
s_cselect_b32 s47, 589824, s46
s_cselect_b32 s46, 663552, s46
s_cselect_b32 s48, 16, 18
v_mfma_f32_16x16x32_bf16 v[80:83], v[160:163], a[168:171], v[80:83]
s_mov_b32 s91, 0x20000
v_mfma_f32_16x16x32_bf16 v[88:91], v[160:163], a[172:175], v[88:91]
ds_read_b64_tr_b16 v[178:179], v226 offset:16896
s_add_u32 m0, s43, 12288
v_mfma_f32_16x16x32_bf16 v[68:71], v[164:167], a[160:163], v[68:71]
s_mov_b32 s90, 5308416
s_mul_i32 s46, s46, s42
v_mfma_f32_16x16x32_bf16 v[76:79], v[164:167], a[164:167], v[76:79]
ds_read_b64_tr_b16 v[180:181], v227 offset:16384
s_add_u32 s44, s58, 3932288
v_mfma_f32_16x16x32_bf16 v[84:87], v[164:167], a[168:171], v[84:87]
s_mul_i32 s47, s47, s42
v_mfma_f32_16x16x32_bf16 v[92:95], v[164:167], a[172:175], v[92:95]
ds_read_b64_tr_b16 v[182:183], v227 offset:16896
s_waitcnt lgkmcnt(4)
v_mfma_f32_16x16x32_bf16 v[96:99], v[168:171], a[160:163], v[96:99]
s_andn2_b32 s57, s41, 0
s_mul_i32 s57, s45, s57
v_mfma_f32_16x16x32_bf16 v[104:107], v[168:171], a[164:167], v[104:107]
ds_read_b64_tr_b16 v[184:185], v228 offset:16384
buffer_load_dwordx4 v230, s[28:31], s44 offen offset:0 lds
v_mfma_f32_16x16x32_bf16 v[112:115], v[168:171], a[168:171], v[112:115]
s_mul_i32 s48, s48, s57
s_add_u32 s9, s47, s48
v_mfma_f32_16x16x32_bf16 v[120:123], v[168:171], a[172:175], v[120:123]
ds_read_b64_tr_b16 v[186:187], v228 offset:16896
buffer_load_dwordx4 v231, s[28:31], s44 offen offset:1024 lds
v_mfma_f32_16x16x32_bf16 v[100:103], v[172:175], a[160:163], v[100:103]
s_andn2_b32 s48, s41, 0
v_mfma_f32_16x16x32_bf16 v[108:111], v[172:175], a[164:167], v[108:111]
ds_read_b64_tr_b16 v[188:189], v229 offset:16384
buffer_load_dwordx4 v232, s[28:31], s44 offen offset:2048 lds
v_mfma_f32_16x16x32_bf16 v[116:119], v[172:175], a[168:171], v[116:119]
s_mul_i32 s48, s48, s45
s_mul_i32 s48, s48, 18
v_mfma_f32_16x16x32_bf16 v[124:127], v[172:175], a[172:175], v[124:127]
ds_read_b64_tr_b16 v[190:191], v229 offset:16896
s_waitcnt vmcnt(11) lgkmcnt(4)
v_mfma_f32_16x16x32_bf16 v[64:67], v[176:179], a[176:179], v[64:67]
s_add_u32 s70, s46, s48
v_mfma_f32_16x16x32_bf16 v[72:75], v[176:179], a[180:183], v[72:75]
ds_read_b64_tr_b16 v[160:161], v226 offset:0
buffer_load_dwordx4 v233, s[28:31], s44 offen offset:3072 lds
v_mfma_f32_16x16x32_bf16 v[80:83], v[176:179], a[184:187], v[80:83]
s_mul_i32 s57, s45, 3
v_lshrrev_b32 v210, 4, v224
v_mfma_f32_16x16x32_bf16 v[88:91], v[176:179], a[188:191], v[88:91]
ds_read_b64_tr_b16 v[162:163], v226 offset:512
s_add_u32 m0, s43, 16384
v_mfma_f32_16x16x32_bf16 v[68:71], v[180:183], a[176:179], v[68:71]
v_min_u32 v210, 53, v210
v_mfma_f32_16x16x32_bf16 v[76:79], v[180:183], a[180:183], v[76:79]
ds_read_b64_tr_b16 v[164:165], v227 offset:0
s_add_u32 s44, s58, 4194432
v_mfma_f32_16x16x32_bf16 v[84:87], v[180:183], a[184:187], v[84:87]
v_mul_u32_u24 v211, 3641, v210
v_lshrrev_b32 v211, 16, v211
v_mfma_f32_16x16x32_bf16 v[92:95], v[180:183], a[188:191], v[92:95]
ds_read_b64_tr_b16 v[166:167], v227 offset:512
s_waitcnt lgkmcnt(4)
v_mfma_f32_16x16x32_bf16 v[96:99], v[184:187], a[176:179], v[96:99]
v_mul_u32_u24 v216, 18, v211
v_sub_u32 v210, v210, v216
v_mfma_f32_16x16x32_bf16 v[104:107], v[184:187], a[180:183], v[104:107]
ds_read_b64_tr_b16 v[168:169], v228 offset:0
buffer_load_dwordx4 v230, s[28:31], s44 offen offset:0 lds
v_mfma_f32_16x16x32_bf16 v[112:115], v[184:187], a[184:187], v[112:115]
v_lshlrev_b32 v210, 6, v210
v_mfma_f32_16x16x32_bf16 v[120:123], v[184:187], a[188:191], v[120:123]
ds_read_b64_tr_b16 v[170:171], v228 offset:512
buffer_load_dwordx4 v231, s[28:31], s44 offen offset:1024 lds
v_mfma_f32_16x16x32_bf16 v[100:103], v[188:191], a[176:179], v[100:103]
v_mul_u32_u24 v216, s45, v211
v_add_u32 v247, v210, v216
v_mfma_f32_16x16x32_bf16 v[108:111], v[188:191], a[180:183], v[108:111]
ds_read_b64_tr_b16 v[172:173], v229 offset:0
buffer_load_dwordx4 v232, s[28:31], s44 offen offset:2048 lds
v_mfma_f32_16x16x32_bf16 v[116:119], v[188:191], a[184:187], v[116:119]
v_mov_b32 v212, 0xff800000
v_mfma_f32_16x16x32_bf16 v[124:127], v[188:191], a[188:191], v[124:127]
ds_read_b64_tr_b16 v[174:175], v229 offset:512
s_waitcnt vmcnt(11) lgkmcnt(4)
v_mfma_f32_16x16x32_bf16 v[64:67], v[160:163], a[192:195], v[64:67]
v_mov_b32 v213, 0xff800000
v_mov_b32 v214, 0xff800000
v_mfma_f32_16x16x32_bf16 v[72:75], v[160:163], a[196:199], v[72:75]
ds_read_b64_tr_b16 v[176:177], v226 offset:4096
buffer_load_dwordx4 v233, s[28:31], s44 offen offset:3072 lds
v_mfma_f32_16x16x32_bf16 v[80:83], v[160:163], a[200:203], v[80:83]
v_mov_b32 v215, 0xff800000
v_accvgpr_write_b32 a128, s100
v_mfma_f32_16x16x32_bf16 v[88:91], v[160:163], a[204:207], v[88:91]
ds_read_b64_tr_b16 v[178:179], v226 offset:4608
s_add_u32 m0, s43, 0
v_mfma_f32_16x16x32_bf16 v[68:71], v[164:167], a[192:195], v[68:71]
v_accvgpr_write_b32 a129, s100
v_mfma_f32_16x16x32_bf16 v[76:79], v[164:167], a[196:199], v[76:79]
ds_read_b64_tr_b16 v[180:181], v227 offset:4096
s_add_u32 s44, s58, 4456576
v_mfma_f32_16x16x32_bf16 v[84:87], v[164:167], a[200:203], v[84:87]
v_accvgpr_write_b32 a130, s100
v_accvgpr_write_b32 a131, s100
v_mfma_f32_16x16x32_bf16 v[92:95], v[164:167], a[204:207], v[92:95]
ds_read_b64_tr_b16 v[182:183], v227 offset:4608
s_waitcnt lgkmcnt(4)
v_mfma_f32_16x16x32_bf16 v[96:99], v[168:171], a[192:195], v[96:99]
v_mfma_f32_16x16x32_bf16 v[104:107], v[168:171], a[196:199], v[104:107]
ds_read_b64_tr_b16 v[184:185], v228 offset:4096
buffer_load_dwordx4 v230, s[28:31], s44 offen offset:0 lds
v_mfma_f32_16x16x32_bf16 v[112:115], v[168:171], a[200:203], v[112:115]
v_mfma_f32_16x16x32_bf16 v[120:123], v[168:171], a[204:207], v[120:123]
ds_read_b64_tr_b16 v[186:187], v228 offset:4608
buffer_load_dwordx4 v231, s[28:31], s44 offen offset:1024 lds
v_mfma_f32_16x16x32_bf16 v[100:103], v[172:175], a[192:195], v[100:103]
v_mfma_f32_16x16x32_bf16 v[108:111], v[172:175], a[196:199], v[108:111]
ds_read_b64_tr_b16 v[188:189], v229 offset:4096
buffer_load_dwordx4 v232, s[28:31], s44 offen offset:2048 lds
v_mfma_f32_16x16x32_bf16 v[116:119], v[172:175], a[200:203], v[116:119]
v_mfma_f32_16x16x32_bf16 v[124:127], v[172:175], a[204:207], v[124:127]
ds_read_b64_tr_b16 v[190:191], v229 offset:4608
s_waitcnt vmcnt(11) lgkmcnt(4)
v_mfma_f32_16x16x32_bf16 v[64:67], v[176:179], a[208:211], v[64:67]
v_mfma_f32_16x16x32_bf16 v[72:75], v[176:179], a[212:215], v[72:75]
ds_read_b64_tr_b16 v[160:161], v226 offset:8192
buffer_load_dwordx4 v233, s[28:31], s44 offen offset:3072 lds
v_mfma_f32_16x16x32_bf16 v[80:83], v[176:179], a[216:219], v[80:83]
s_add_u32 m0, s50, 0
s_add_u32 s44, s55, 0
v_mfma_f32_16x16x32_bf16 v[88:91], v[176:179], a[220:223], v[88:91]
ds_read_b64_tr_b16 v[162:163], v226 offset:8704
buffer_load_dwordx4 v234, s[20:23], s44 offen offset:0 lds
v_mfma_f32_16x16x32_bf16 v[68:71], v[180:183], a[208:211], v[68:71]
v_lshrrev_b32 v210, 7, v224
v_mul_u32_u24 v210, 1152, v210
v_mfma_f32_16x16x32_bf16 v[76:79], v[180:183], a[212:215], v[76:79]
ds_read_b64_tr_b16 v[164:165], v227 offset:8192
buffer_load_dwordx4 v235, s[20:23], s44 offen offset:1024 lds
v_mfma_f32_16x16x32_bf16 v[84:87], v[180:183], a[216:219], v[84:87]
v_bfe_u32 v211, v224, 8, 2
v_mfma_f32_16x16x32_bf16 v[92:95], v[180:183], a[220:223], v[92:95]
ds_read_b64_tr_b16 v[166:167], v227 offset:8704
s_waitcnt lgkmcnt(4)
v_mfma_f32_16x16x32_bf16 v[96:99], v[184:187], a[208:211], v[96:99]
v_lshlrev_b32 v211, 5, v211
v_mfma_f32_16x16x32_bf16 v[104:107], v[184:187], a[212:215], v[104:107]
ds_read_b64_tr_b16 v[168:169], v228 offset:8192
buffer_load_dwordx4 v236, s[20:23], s44 offen offset:2048 lds
v_mfma_f32_16x16x32_bf16 v[112:115], v[184:187], a[216:219], v[112:115]
v_xor_b32 v211, v211, v224
v_mfma_f32_16x16x32_bf16 v[120:123], v[184:187], a[220:223], v[120:123]
ds_read_b64_tr_b16 v[170:171], v228 offset:8704
buffer_load_dwordx4 v237, s[20:23], s44 offen offset:3072 lds
v_mfma_f32_16x16x32_bf16 v[100:103], v[188:191], a[208:211], v[100:103]
s_add_u32 m0, s50, 16384
s_add_u32 s44, s55, 8192
v_mfma_f32_16x16x32_bf16 v[108:111], v[188:191], a[212:215], v[108:111]
ds_read_b64_tr_b16 v[172:173], v229 offset:8192
buffer_load_dwordx4 v234, s[20:23], s44 offen offset:0 lds
v_mfma_f32_16x16x32_bf16 v[116:119], v[188:191], a[216:219], v[116:119]
v_and_b32 v211, 0x70, v211
v_add_u32 v230, v210, v211
v_mfma_f32_16x16x32_bf16 v[124:127], v[188:191], a[220:223], v[124:127]
ds_read_b64_tr_b16 v[174:175], v229 offset:8704
s_waitcnt vmcnt(13) lgkmcnt(4)
v_mfma_f32_16x16x32_bf16 v[64:67], v[160:163], a[224:227], v[64:67]
buffer_load_dwordx4 v235, s[20:23], s44 offen offset:1024 lds
v_add_u32 v231, 8192, v230
v_mfma_f32_16x16x32_bf16 v[72:75], v[160:163], a[228:231], v[72:75]
ds_read_b64_tr_b16 v[176:177], v226 offset:12288
v_add_u32 v232, 16384, v230
v_mfma_f32_16x16x32_bf16 v[80:83], v[160:163], a[232:235], v[80:83]
buffer_load_dwordx4 v236, s[20:23], s44 offen offset:2048 lds
v_mfma_f32_16x16x32_bf16 v[88:91], v[160:163], a[236:239], v[88:91]
ds_read_b64_tr_b16 v[178:179], v226 offset:12800
v_add_u32 v233, 16384, v231
v_mfma_f32_16x16x32_bf16 v[68:71], v[164:167], a[224:227], v[68:71]
buffer_load_dwordx4 v237, s[20:23], s44 offen offset:3072 lds
s_add_u32 m0, s50, 32768
v_mfma_f32_16x16x32_bf16 v[76:79], v[164:167], a[228:231], v[76:79]
ds_read_b64_tr_b16 v[180:181], v227 offset:12288
s_add_u32 s44, s55, 0
v_mfma_f32_16x16x32_bf16 v[84:87], v[164:167], a[232:235], v[84:87]
buffer_load_dwordx4 v234, s[24:27], s44 offen offset:0 lds
v_mfma_f32_16x16x32_bf16 v[92:95], v[164:167], a[236:239], v[92:95]
ds_read_b64_tr_b16 v[182:183], v227 offset:12800
s_waitcnt lgkmcnt(4)
v_mfma_f32_16x16x32_bf16 v[96:99], v[168:171], a[224:227], v[96:99]
buffer_load_dwordx4 v235, s[24:27], s44 offen offset:1024 lds
v_mfma_f32_16x16x32_bf16 v[104:107], v[168:171], a[228:231], v[104:107]
ds_read_b64_tr_b16 v[184:185], v228 offset:12288
v_mfma_f32_16x16x32_bf16 v[112:115], v[168:171], a[232:235], v[112:115]
buffer_load_dwordx4 v236, s[24:27], s44 offen offset:2048 lds
v_mfma_f32_16x16x32_bf16 v[120:123], v[168:171], a[236:239], v[120:123]
ds_read_b64_tr_b16 v[186:187], v228 offset:12800
v_mfma_f32_16x16x32_bf16 v[100:103], v[172:175], a[224:227], v[100:103]
buffer_load_dwordx4 v237, s[24:27], s44 offen offset:3072 lds
s_add_u32 m0, s50, 49152
v_mfma_f32_16x16x32_bf16 v[108:111], v[172:175], a[228:231], v[108:111]
ds_read_b64_tr_b16 v[188:189], v229 offset:12288
s_add_u32 s44, s55, 8192
v_mfma_f32_16x16x32_bf16 v[116:119], v[172:175], a[232:235], v[116:119]
buffer_load_dwordx4 v234, s[24:27], s44 offen offset:0 lds
v_mfma_f32_16x16x32_bf16 v[124:127], v[172:175], a[236:239], v[124:127]
ds_read_b64_tr_b16 v[190:191], v229 offset:12800
s_waitcnt vmcnt(13) lgkmcnt(4)
v_mfma_f32_16x16x32_bf16 v[64:67], v[176:179], a[240:243], v[64:67]
buffer_load_dwordx4 v235, s[24:27], s44 offen offset:1024 lds
v_mfma_f32_16x16x32_bf16 v[72:75], v[176:179], a[244:247], v[72:75]
ds_read_b64_tr_b16 v[160:161], v226 offset:16384
v_mfma_f32_16x16x32_bf16 v[80:83], v[176:179], a[248:251], v[80:83]
buffer_load_dwordx4 v236, s[24:27], s44 offen offset:2048 lds
v_mfma_f32_16x16x32_bf16 v[88:91], v[176:179], a[252:255], v[88:91]
ds_read_b64_tr_b16 v[162:163], v226 offset:16896
v_mfma_f32_16x16x32_bf16 v[68:71], v[180:183], a[240:243], v[68:71]
buffer_load_dwordx4 v237, s[24:27], s44 offen offset:3072 lds
v_mfma_f32_16x16x32_bf16 v[76:79], v[180:183], a[244:247], v[76:79]
ds_read_b64_tr_b16 v[164:165], v226 offset:0
v_mfma_f32_16x16x32_bf16 v[84:87], v[180:183], a[248:251], v[84:87]
v_mfma_f32_16x16x32_bf16 v[92:95], v[180:183], a[252:255], v[92:95]
ds_read_b64_tr_b16 v[166:167], v226 offset:512
s_waitcnt lgkmcnt(4)
v_mfma_f32_16x16x32_bf16 v[96:99], v[184:187], a[240:243], v[96:99]
v_mfma_f32_16x16x32_bf16 v[104:107], v[184:187], a[244:247], v[104:107]
ds_read_b64_tr_b16 v[168:169], v227 offset:16384
v_mfma_f32_16x16x32_bf16 v[112:115], v[184:187], a[248:251], v[112:115]
v_mfma_f32_16x16x32_bf16 v[120:123], v[184:187], a[252:255], v[120:123]
ds_read_b64_tr_b16 v[170:171], v227 offset:16896
v_mfma_f32_16x16x32_bf16 v[100:103], v[188:191], a[240:243], v[100:103]
v_mfma_f32_16x16x32_bf16 v[108:111], v[188:191], a[244:247], v[108:111]
ds_read_b64_tr_b16 v[172:173], v227 offset:0
v_mfma_f32_16x16x32_bf16 v[116:119], v[188:191], a[248:251], v[116:119]
v_mfma_f32_16x16x32_bf16 v[124:127], v[188:191], a[252:255], v[124:127]
ds_read_b64_tr_b16 v[174:175], v227 offset:512
s_waitcnt lgkmcnt(4)
v_mfma_f32_16x16x32_bf16 v[64:67], v[160:163], v[128:131], v[64:67]
v_mfma_f32_16x16x32_bf16 v[72:75], v[160:163], v[132:135], v[72:75]
ds_read_b64_tr_b16 v[176:177], v228 offset:16384
v_mfma_f32_16x16x32_bf16 v[80:83], v[160:163], v[136:139], v[80:83]
v_mfma_f32_16x16x32_bf16 v[88:91], v[160:163], v[140:143], v[88:91]
ds_read_b64_tr_b16 v[178:179], v228 offset:16896
v_mfma_f32_16x16x32_bf16 v[64:67], v[164:167], v[144:147], v[64:67]
v_mfma_f32_16x16x32_bf16 v[72:75], v[164:167], v[148:151], v[72:75]
ds_read_b64_tr_b16 v[180:181], v228 offset:0
v_mfma_f32_16x16x32_bf16 v[80:83], v[164:167], v[152:155], v[80:83]
v_mfma_f32_16x16x32_bf16 v[88:91], v[164:167], v[156:159], v[88:91]
ds_read_b64_tr_b16 v[182:183], v228 offset:512
s_waitcnt lgkmcnt(4)
v_mfma_f32_16x16x32_bf16 v[68:71], v[168:171], v[128:131], v[68:71]
v_mfma_f32_16x16x32_bf16 v[76:79], v[168:171], v[132:135], v[76:79]
ds_read_b64_tr_b16 v[184:185], v229 offset:16384
v_mfma_f32_16x16x32_bf16 v[84:87], v[168:171], v[136:139], v[84:87]
v_mfma_f32_16x16x32_bf16 v[92:95], v[168:171], v[140:143], v[92:95]
ds_read_b64_tr_b16 v[186:187], v229 offset:16896
v_mfma_f32_16x16x32_bf16 v[68:71], v[172:175], v[144:147], v[68:71]
v_mfma_f32_16x16x32_bf16 v[76:79], v[172:175], v[148:151], v[76:79]
ds_read_b64_tr_b16 v[188:189], v229 offset:0
v_mfma_f32_16x16x32_bf16 v[84:87], v[172:175], v[152:155], v[84:87]
v_mfma_f32_16x16x32_bf16 v[92:95], v[172:175], v[156:159], v[92:95]
ds_read_b64_tr_b16 v[190:191], v229 offset:512
s_waitcnt lgkmcnt(4)
v_mfma_f32_16x16x32_bf16 v[96:99], v[176:179], v[128:131], v[96:99]
v_mfma_f32_16x16x32_bf16 v[104:107], v[176:179], v[132:135], v[104:107]
v_mfma_f32_16x16x32_bf16 v[112:115], v[176:179], v[136:139], v[112:115]
v_cvt_pk_bf16_f32 v64, v64, v65
v_cvt_pk_bf16_f32 v65, v66, v67
v_cvt_pk_bf16_f32 v66, v68, v69
v_mfma_f32_16x16x32_bf16 v[120:123], v[176:179], v[140:143], v[120:123]
s_waitcnt vmcnt(12)
s_barrier
v_cvt_pk_bf16_f32 v67, v70, v71
v_cvt_pk_bf16_f32 v72, v72, v73
v_mfma_f32_16x16x32_bf16 v[96:99], v[180:183], v[144:147], v[96:99]
ds_read_b128 a[64:67], v244 offset:0
v_add_u32 v226, s56, v225
v_cvt_pk_bf16_f32 v73, v74, v75
v_mfma_f32_16x16x32_bf16 v[104:107], v[180:183], v[148:151], v[104:107]
ds_read_b128 a[68:71], v245 offset:0
v_xor_b32 v227, 32, v226
v_cvt_pk_bf16_f32 v74, v76, v77
v_cvt_pk_bf16_f32 v75, v78, v79
v_mfma_f32_16x16x32_bf16 v[112:115], v[180:183], v[152:155], v[112:115]
ds_read_b128 a[72:75], v244 offset:4096
v_xor_b32 v228, 64, v226
v_permlane32_swap_b32 v64, v66
v_mfma_f32_16x16x32_bf16 v[120:123], v[180:183], v[156:159], v[120:123]
ds_read_b128 a[76:79], v245 offset:4096
s_waitcnt lgkmcnt(4)
v_permlane32_swap_b32 v65, v67
v_permlane32_swap_b32 v72, v74
v_mfma_f32_16x16x32_bf16 v[100:103], v[184:187], v[128:131], v[100:103]
v_xor_b32 v229, 96, v226
v_permlane32_swap_b32 v73, v75
v_accvgpr_write_b32 a32, v64
v_mfma_f32_16x16x32_bf16 v[108:111], v[184:187], v[132:135], v[108:111]
ds_read_b128 a[80:83], v244 offset:2048
v_accvgpr_write_b32 a33, v65
v_accvgpr_write_b32 a34, v66
v_accvgpr_write_b32 a35, v67
v_mfma_f32_16x16x32_bf16 v[116:119], v[184:187], v[136:139], v[116:119]
v_accvgpr_write_b32 a36, v72
v_accvgpr_write_b32 a37, v73
v_accvgpr_write_b32 a38, v74
v_mfma_f32_16x16x32_bf16 v[124:127], v[184:187], v[140:143], v[124:127]
ds_read_b128 a[84:87], v245 offset:2048
v_accvgpr_write_b32 a39, v75
v_cvt_pk_bf16_f32 v80, v80, v81
v_cvt_pk_bf16_f32 v81, v82, v83
v_mfma_f32_16x16x32_bf16 v[100:103], v[188:191], v[144:147], v[100:103]
v_cvt_pk_bf16_f32 v82, v84, v85
v_cvt_pk_bf16_f32 v83, v86, v87
v_cvt_pk_bf16_f32 v88, v88, v89
v_mfma_f32_16x16x32_bf16 v[108:111], v[188:191], v[148:151], v[108:111]
ds_read_b128 a[88:91], v244 offset:6144
v_cvt_pk_bf16_f32 v89, v90, v91
v_cvt_pk_bf16_f32 v90, v92, v93
v_cvt_pk_bf16_f32 v91, v94, v95
v_mfma_f32_16x16x32_bf16 v[116:119], v[188:191], v[152:155], v[116:119]
buffer_store_dword v209, v255, s[36:39], 0 offen sc1
v_permlane32_swap_b32 v80, v82
v_permlane32_swap_b32 v81, v83
v_mfma_f32_16x16x32_bf16 v[124:127], v[188:191], v[156:159], v[124:127]
ds_read_b128 a[92:95], v245 offset:6144
v_permlane32_swap_b32 v88, v90
v_permlane32_swap_b32 v89, v91
v_accvgpr_write_b32 a40, v80
s_waitcnt lgkmcnt(7)
v_mfma_f32_16x16x32_bf16 v[160:163], a[64:67], a[0:3], 0
v_accvgpr_write_b32 a41, v81
v_accvgpr_write_b32 a42, v82
v_accvgpr_write_b32 a43, v83
v_mfma_f32_16x16x32_bf16 v[168:171], a[64:67], a[4:7], 0
v_accvgpr_write_b32 a44, v88
v_accvgpr_write_b32 a45, v89
v_accvgpr_write_b32 a46, v90
v_accvgpr_write_b32 a47, v91
v_mfma_f32_16x16x32_bf16 v[176:179], a[64:67], a[8:11], 0
v_cvt_pk_bf16_f32 v96, v96, v97
v_cvt_pk_bf16_f32 v97, v98, v99
v_cvt_pk_bf16_f32 v98, v100, v101
v_cvt_pk_bf16_f32 v99, v102, v103
v_mfma_f32_16x16x32_bf16 v[184:187], a[64:67], a[12:15], 0
v_cvt_pk_bf16_f32 v104, v104, v105
v_cvt_pk_bf16_f32 v105, v106, v107
v_cvt_pk_bf16_f32 v106, v108, v109
v_cvt_pk_bf16_f32 v107, v110, v111
s_waitcnt lgkmcnt(6)
v_mfma_f32_16x16x32_bf16 v[160:163], a[68:71], a[16:19], v[160:163]
v_permlane32_swap_b32 v96, v98
v_permlane32_swap_b32 v97, v99
v_permlane32_swap_b32 v104, v106
v_permlane32_swap_b32 v105, v107
v_mfma_f32_16x16x32_bf16 v[168:171], a[68:71], a[20:23], v[168:171]
v_accvgpr_write_b32 a48, v96
v_accvgpr_write_b32 a49, v97
v_accvgpr_write_b32 a50, v98
v_accvgpr_write_b32 a51, v99
v_mfma_f32_16x16x32_bf16 v[176:179], a[68:71], a[24:27], v[176:179]
v_accvgpr_write_b32 a52, v104
v_accvgpr_write_b32 a53, v105
v_accvgpr_write_b32 a54, v106
v_accvgpr_write_b32 a55, v107
v_mfma_f32_16x16x32_bf16 v[184:187], a[68:71], a[28:31], v[184:187]
v_cvt_pk_bf16_f32 v112, v112, v113
v_cvt_pk_bf16_f32 v113, v114, v115
v_cvt_pk_bf16_f32 v114, v116, v117
v_cvt_pk_bf16_f32 v115, v118, v119
s_waitcnt lgkmcnt(5)
v_mfma_f32_16x16x32_bf16 v[160:163], a[72:75], a[32:35], v[160:163]
v_cvt_pk_bf16_f32 v120, v120, v121
v_cvt_pk_bf16_f32 v121, v122, v123
v_cvt_pk_bf16_f32 v122, v124, v125
v_cvt_pk_bf16_f32 v123, v126, v127
v_mfma_f32_16x16x32_bf16 v[168:171], a[72:75], a[36:39], v[168:171]
v_permlane32_swap_b32 v112, v114
v_permlane32_swap_b32 v113, v115
v_permlane32_swap_b32 v120, v122
v_permlane32_swap_b32 v121, v123
v_mfma_f32_16x16x32_bf16 v[176:179], a[72:75], a[40:43], v[176:179]
v_accvgpr_write_b32 a56, v112
v_accvgpr_write_b32 a57, v113
v_accvgpr_write_b32 a58, v114
v_accvgpr_write_b32 a59, v115
v_mfma_f32_16x16x32_bf16 v[184:187], a[72:75], a[44:47], v[184:187]
v_accvgpr_write_b32 a60, v120
v_accvgpr_write_b32 a61, v121
v_accvgpr_write_b32 a62, v122
v_accvgpr_write_b32 a63, v123
s_waitcnt lgkmcnt(4)
v_mfma_f32_16x16x32_bf16 v[160:163], a[76:79], a[48:51], v[160:163]
v_mfma_f32_16x16x32_bf16 v[168:171], a[76:79], a[52:55], v[168:171]
v_mfma_f32_16x16x32_bf16 v[176:179], a[76:79], a[56:59], v[176:179]
v_mfma_f32_16x16x32_bf16 v[184:187], a[76:79], a[60:63], v[184:187]
HAVE_MAX:
s_add_u32 m0, s50, 0
s_add_u32 s51, s55, 16384
s_mov_b32 s8, s51
s_waitcnt vmcnt(1) lgkmcnt(0)
s_barrier
v_mfma_f32_16x16x32_bf16 v[164:167], a[80:83], a[0:3], 0
ds_read_b128 a[64:67], v244 offset:16384
buffer_load_dwordx4 v234, s[20:23], s51 offen offset:0 lds
v_mfma_f32_16x16x32_bf16 v[172:175], a[80:83], a[4:7], 0
ds_read_b128 a[68:71], v245 offset:16384
v_max3_f32 v212, v160, v161, v212
v_max3_f32 v212, v162, v163, v212
v_mfma_f32_16x16x32_bf16 v[180:183], a[80:83], a[8:11], 0
ds_read_b128 a[72:75], v244 offset:20480
v_max3_f32 v213, v168, v169, v213
v_max3_f32 v213, v170, v171, v213
v_mfma_f32_16x16x32_bf16 v[188:191], a[80:83], a[12:15], 0
buffer_load_dwordx4 v235, s[20:23], s51 offen offset:1024 lds
ds_read_b128 a[76:79], v245 offset:20480
v_max3_f32 v214, v176, v177, v214
v_max3_f32 v214, v178, v179, v214
v_mfma_f32_16x16x32_bf16 v[164:167], a[84:87], a[16:19], v[164:167]
v_max3_f32 v215, v184, v185, v215
v_max3_f32 v215, v186, v187, v215
v_mfma_f32_16x16x32_bf16 v[172:175], a[84:87], a[20:23], v[172:175]
ds_read_b128 a[80:83], v244 offset:18432
v_permlane32_swap_b32 v212, v213
v_mfma_f32_16x16x32_bf16 v[180:183], a[84:87], a[24:27], v[180:183]
buffer_load_dwordx4 v236, s[20:23], s51 offen offset:2048 lds
v_permlane32_swap_b32 v214, v215
v_max_f32 v212, v212, v213
v_mfma_f32_16x16x32_bf16 v[188:191], a[84:87], a[28:31], v[188:191]
v_max_f32 v214, v214, v215
v_mfma_f32_16x16x32_bf16 v[164:167], a[88:91], a[32:35], v[164:167]
s_nop 0
v_permlane16_swap_b32 v212, v214
v_max_f32 v212, v212, v214
v_mfma_f32_16x16x32_bf16 v[172:175], a[88:91], a[36:39], v[172:175]
ds_read_b128 a[84:87], v245 offset:18432
buffer_load_dwordx4 v237, s[20:23], s51 offen offset:3072 lds
v_sub_f32 v192, s54, v212
v_sub_f32 v200, s54, v212
v_mfma_f32_16x16x32_bf16 v[180:183], a[88:91], a[40:43], v[180:183]
s_nop 0
v_permlane16_swap_b32 v192, v200
v_mov_b32 v196, v192
v_mfma_f32_16x16x32_bf16 v[188:191], a[88:91], a[44:47], v[188:191]
v_mov_b32 v204, v200
v_mfma_f32_16x16x32_bf16 v[164:167], a[92:95], a[48:51], v[164:167]
v_permlane32_swap_b32 v192, v196
v_permlane32_swap_b32 v200, v204
v_mfma_f32_16x16x32_bf16 v[172:175], a[92:95], a[52:55], v[172:175]
ds_read_b128 a[88:91], v244 offset:22528
v_mov_b32 v193, v192
v_mov_b32 v194, v192
v_mov_b32 v195, v192
v_mov_b32 v197, v196
v_mfma_f32_16x16x32_bf16 v[180:183], a[92:95], a[56:59], v[180:183]
v_mov_b32 v198, v196
v_mov_b32 v199, v196
v_mov_b32 v201, v200
v_mov_b32 v202, v200
v_mfma_f32_16x16x32_bf16 v[188:191], a[92:95], a[60:63], v[188:191]
v_mov_b32 v203, v200
v_mov_b32 v205, v204
v_mov_b32 v206, v204
v_mov_b32 v207, v204
s_waitcnt lgkmcnt(6)
v_mfma_f32_16x16x32_bf16 v[128:131], a[64:67], a[0:3], v[192:195]
v_add_f32 v160, v160, v192
v_add_f32 v161, v161, v192
v_exp_f32 v160, v160
v_add_f32 v162, v162, v192
v_mfma_f32_16x16x32_bf16 v[136:139], a[64:67], a[4:7], v[196:199]
ds_read_b128 a[92:95], v245 offset:22528
ds_read_b64_tr_b16 a[96:97], v226 offset:0
v_exp_f32 v161, v161
v_add_f32 v163, v163, v192
v_mfma_f32_16x16x32_bf16 v[144:147], a[64:67], a[8:11], v[200:203]
v_exp_f32 v162, v162
v_cvt_pk_bf16_f32 v160, v160, v161
v_add_f32 v168, v168, v196
v_mfma_f32_16x16x32_bf16 v[152:155], a[64:67], a[12:15], v[204:207]
ds_read_b64_tr_b16 a[98:99], v226 offset:2048
v_exp_f32 v163, v163
v_add_f32 v169, v169, v196
v_exp_f32 v168, v168
s_waitcnt lgkmcnt(8)
v_mfma_f32_16x16x32_bf16 v[128:131], a[68:71], a[16:19], v[128:131]
v_cvt_pk_bf16_f32 v161, v162, v163
v_add_f32 v170, v170, v196
v_exp_f32 v169, v169
v_add_f32 v171, v171, v196
v_mfma_f32_16x16x32_bf16 v[136:139], a[68:71], a[20:23], v[136:139]
ds_read_b64_tr_b16 a[100:101], v227 offset:0
v_exp_f32 v170, v170
v_cvt_pk_bf16_f32 v168, v168, v169
v_add_f32 v176, v176, v200
v_mfma_f32_16x16x32_bf16 v[144:147], a[68:71], a[24:27], v[144:147]
v_exp_f32 v171, v171
v_add_f32 v177, v177, v200
v_exp_f32 v176, v176
v_mfma_f32_16x16x32_bf16 v[152:155], a[68:71], a[28:31], v[152:155]
ds_read_b64_tr_b16 a[102:103], v227 offset:2048
v_cvt_pk_bf16_f32 v169, v170, v171
v_add_f32 v178, v178, v200
v_exp_f32 v177, v177
v_add_f32 v179, v179, v200
s_waitcnt lgkmcnt(9)
v_mfma_f32_16x16x32_bf16 v[128:131], a[72:75], a[32:35], v[128:131]
v_exp_f32 v178, v178
v_cvt_pk_bf16_f32 v176, v176, v177
v_add_f32 v184, v184, v204
v_mfma_f32_16x16x32_bf16 v[136:139], a[72:75], a[36:39], v[136:139]
ds_read_b64_tr_b16 a[104:105], v228 offset:0
v_exp_f32 v179, v179
v_add_f32 v185, v185, v204
v_mfma_f32_16x16x32_bf16 v[144:147], a[72:75], a[40:43], v[144:147]
v_exp_f32 v184, v184
v_cvt_pk_bf16_f32 v177, v178, v179
v_add_f32 v186, v186, v204
v_mfma_f32_16x16x32_bf16 v[152:155], a[72:75], a[44:47], v[152:155]
ds_read_b64_tr_b16 a[106:107], v228 offset:2048
v_exp_f32 v185, v185
v_add_f32 v187, v187, v204
v_exp_f32 v186, v186
s_waitcnt lgkmcnt(10)
v_mfma_f32_16x16x32_bf16 v[128:131], a[76:79], a[48:51], v[128:131]
v_cvt_pk_bf16_f32 v184, v184, v185
v_add_f32 v164, v164, v192
v_exp_f32 v187, v187
v_add_f32 v165, v165, v192
v_mfma_f32_16x16x32_bf16 v[136:139], a[76:79], a[52:55], v[136:139]
ds_read_b64_tr_b16 a[108:109], v229 offset:0
v_exp_f32 v164, v164
v_cvt_pk_bf16_f32 v185, v186, v187
v_add_f32 v166, v166, v192
v_mfma_f32_16x16x32_bf16 v[144:147], a[76:79], a[56:59], v[144:147]
ds_read_b64_tr_b16 a[110:111], v229 offset:2048
ds_read_b64_tr_b16 a[112:113], v226 offset:4096
v_exp_f32 v165, v165
v_add_f32 v167, v167, v192
v_mfma_f32_16x16x32_bf16 v[152:155], a[76:79], a[60:63], v[152:155]
ds_read_b64_tr_b16 a[114:115], v226 offset:6144
v_exp_f32 v166, v166
v_cvt_pk_bf16_f32 v162, v164, v165
v_add_f32 v172, v172, v196
s_waitcnt lgkmcnt(13)
v_mfma_f32_16x16x32_bf16 v[132:135], a[80:83], a[0:3], v[192:195]
ds_read_b64_tr_b16 a[116:117], v227 offset:4096
v_exp_f32 v167, v167
v_add_f32 v173, v173, v196
v_mfma_f32_16x16x32_bf16 v[140:143], a[80:83], a[4:7], v[196:199]
ds_read_b64_tr_b16 a[118:119], v227 offset:6144
ds_read_b64_tr_b16 a[120:121], v228 offset:4096
v_exp_f32 v172, v172
v_cvt_pk_bf16_f32 v163, v166, v167
v_mfma_f32_16x16x32_bf16 v[148:151], a[80:83], a[8:11], v[200:203]
v_exp_f32 v128, v128
v_add_f32 v174, v174, v196
v_exp_f32 v173, v173
v_mfma_f32_16x16x32_bf16 v[156:159], a[80:83], a[12:15], v[204:207]
ds_read_b64_tr_b16 a[122:123], v228 offset:6144
v_add_f32 v175, v175, v196
v_exp_f32 v174, v174
v_cvt_pk_bf16_f32 v170, v172, v173
v_add_f32 v180, v180, v200
s_waitcnt lgkmcnt(15)
v_mfma_f32_16x16x32_bf16 v[132:135], a[84:87], a[16:19], v[132:135]
v_exp_f32 v129, v129
v_exp_f32 v175, v175
v_add_f32 v181, v181, v200
v_mfma_f32_16x16x32_bf16 v[140:143], a[84:87], a[20:23], v[140:143]
ds_read_b64_tr_b16 a[124:125], v229 offset:4096
v_cvt_pk_bf16_f32 v128, v128, v129
v_exp_f32 v180, v180
v_cvt_pk_bf16_f32 v171, v174, v175
v_mfma_f32_16x16x32_bf16 v[148:151], a[84:87], a[24:27], v[148:151]
v_exp_f32 v130, v130
v_add_f32 v182, v182, v200
v_exp_f32 v181, v181
v_mfma_f32_16x16x32_bf16 v[156:159], a[84:87], a[28:31], v[156:159]
ds_read_b64_tr_b16 a[126:127], v229 offset:6144
v_add_f32 v183, v183, v200
v_exp_f32 v182, v182
v_cvt_pk_bf16_f32 v178, v180, v181
v_add_f32 v188, v188, v204
v_mfma_f32_16x16x32_bf16 v[132:135], a[88:91], a[32:35], v[132:135]
v_exp_f32 v131, v131
v_exp_f32 v183, v183
v_add_f32 v189, v189, v204
v_mfma_f32_16x16x32_bf16 v[140:143], a[88:91], a[36:39], v[140:143]
v_cvt_pk_bf16_f32 v129, v130, v131
v_exp_f32 v188, v188
v_cvt_pk_bf16_f32 v179, v182, v183
v_add_f32 v190, v190, v204
v_mfma_f32_16x16x32_bf16 v[148:151], a[88:91], a[40:43], v[148:151]
v_exp_f32 v136, v136
v_exp_f32 v189, v189
v_add_f32 v191, v191, v204
v_mfma_f32_16x16x32_bf16 v[156:159], a[88:91], a[44:47], v[156:159]
s_add_u32 m0, s50, 16384
v_exp_f32 v190, v190
v_cvt_pk_bf16_f32 v186, v188, v189
v_exp_f32 v191, v191
s_waitcnt lgkmcnt(15)
v_mfma_f32_16x16x32_bf16 v[132:135], a[92:95], a[48:51], v[132:135]
v_exp_f32 v137, v137
v_cvt_pk_bf16_f32 v187, v190, v191
v_mfma_f32_16x16x32_bf16 v[140:143], a[92:95], a[52:55], v[140:143]
s_add_u32 s51, s51, 8192
v_cvt_pk_bf16_f32 v136, v136, v137
v_mfma_f32_16x16x32_bf16 v[148:151], a[92:95], a[56:59], v[148:151]
v_exp_f32 v138, v138
v_mfma_f32_16x16x32_bf16 v[156:159], a[92:95], a[60:63], v[156:159]
s_waitcnt vmcnt(0) lgkmcnt(0)
s_barrier
v_mfma_f32_16x16x32_bf16 v[208:211], a[128:131], v[160:163], 0
v_exp_f32 v139, v139
v_mfma_f32_16x16x32_bf16 v[212:215], a[128:131], v[168:171], 0
buffer_load_dwordx4 v234, s[20:23], s51 offen offset:0 lds
v_cvt_pk_bf16_f32 v137, v138, v139
v_mfma_f32_16x16x32_bf16 v[216:219], a[128:131], v[176:179], 0
v_exp_f32 v144, v144
v_mfma_f32_16x16x32_bf16 v[220:223], a[128:131], v[184:187], 0
ds_read_b128 a[64:67], v244 offset:0
ds_read_b128 a[68:71], v245 offset:0
v_mfma_f32_16x16x32_bf16 v[0:3], a[96:99], v[160:163], 0
v_exp_f32 v145, v145
v_mfma_f32_16x16x32_bf16 v[8:11], a[96:99], v[168:171], 0
buffer_load_dwordx4 v235, s[20:23], s51 offen offset:1024 lds
v_cvt_pk_bf16_f32 v144, v144, v145
v_mfma_f32_16x16x32_bf16 v[16:19], a[96:99], v[176:179], 0
v_exp_f32 v146, v146
v_mfma_f32_16x16x32_bf16 v[24:27], a[96:99], v[184:187], 0
buffer_load_dwordx4 v236, s[20:23], s51 offen offset:2048 lds
ds_read_b128 a[72:75], v244 offset:4096
v_mfma_f32_16x16x32_bf16 v[4:7], a[100:103], v[160:163], 0
v_exp_f32 v147, v147
v_mfma_f32_16x16x32_bf16 v[12:15], a[100:103], v[168:171], 0
ds_read_b128 a[76:79], v245 offset:4096
v_cvt_pk_bf16_f32 v145, v146, v147
v_mfma_f32_16x16x32_bf16 v[20:23], a[100:103], v[176:179], 0
v_exp_f32 v152, v152
v_mfma_f32_16x16x32_bf16 v[28:31], a[100:103], v[184:187], 0
buffer_load_dwordx4 v237, s[20:23], s51 offen offset:3072 lds
s_add_u32 m0, s50, 32768
v_mfma_f32_16x16x32_bf16 v[32:35], a[104:107], v[160:163], 0
v_exp_f32 v153, v153
v_mfma_f32_16x16x32_bf16 v[40:43], a[104:107], v[168:171], 0
ds_read_b128 a[80:83], v244 offset:2048
v_cvt_pk_bf16_f32 v152, v152, v153
v_mfma_f32_16x16x32_bf16 v[48:51], a[104:107], v[176:179], 0
v_exp_f32 v154, v154
v_mfma_f32_16x16x32_bf16 v[56:59], a[104:107], v[184:187], 0
buffer_load_dwordx4 v234, s[24:27], s8 offen offset:0 lds
ds_read_b128 a[84:87], v245 offset:2048
v_mfma_f32_16x16x32_bf16 v[36:39], a[108:111], v[160:163], 0
v_exp_f32 v155, v155
v_mfma_f32_16x16x32_bf16 v[44:47], a[108:111], v[168:171], 0
ds_read_b128 a[88:91], v244 offset:6144
v_cvt_pk_bf16_f32 v153, v154, v155
v_mfma_f32_16x16x32_bf16 v[52:55], a[108:111], v[176:179], 0
v_exp_f32 v132, v132
v_mfma_f32_16x16x32_bf16 v[60:63], a[108:111], v[184:187], 0
buffer_load_dwordx4 v235, s[24:27], s8 offen offset:1024 lds
ds_read_b128 a[92:95], v245 offset:6144
v_mfma_f32_16x16x32_bf16 v[64:67], a[112:115], v[160:163], 0
v_exp_f32 v133, v133
v_mfma_f32_16x16x32_bf16 v[72:75], a[112:115], v[168:171], 0
v_cvt_pk_bf16_f32 v130, v132, v133
v_mfma_f32_16x16x32_bf16 v[80:83], a[112:115], v[176:179], 0
v_exp_f32 v134, v134
v_mfma_f32_16x16x32_bf16 v[88:91], a[112:115], v[184:187], 0
buffer_load_dwordx4 v236, s[24:27], s8 offen offset:2048 lds
v_mfma_f32_16x16x32_bf16 v[68:71], a[116:119], v[160:163], 0
v_exp_f32 v135, v135
v_mfma_f32_16x16x32_bf16 v[76:79], a[116:119], v[168:171], 0
s_add_u32 s51, s51, 8192
v_cvt_pk_bf16_f32 v131, v134, v135
v_mfma_f32_16x16x32_bf16 v[84:87], a[116:119], v[176:179], 0
v_exp_f32 v140, v140
v_mfma_f32_16x16x32_bf16 v[92:95], a[116:119], v[184:187], 0
buffer_load_dwordx4 v237, s[24:27], s8 offen offset:3072 lds
s_add_u32 m0, s50, 0
v_mfma_f32_16x16x32_bf16 v[96:99], a[120:123], v[160:163], 0
v_exp_f32 v141, v141
v_mfma_f32_16x16x32_bf16 v[104:107], a[120:123], v[168:171], 0
s_add_u32 s8, s8, 8192
v_cvt_pk_bf16_f32 v138, v140, v141
v_mfma_f32_16x16x32_bf16 v[112:115], a[120:123], v[176:179], 0
v_exp_f32 v142, v142
v_mfma_f32_16x16x32_bf16 v[120:123], a[120:123], v[184:187], 0
s_bitcmp1_b32 s40, 0
v_mfma_f32_16x16x32_bf16 v[100:103], a[124:127], v[160:163], 0
v_exp_f32 v143, v143
v_mfma_f32_16x16x32_bf16 v[108:111], a[124:127], v[168:171], 0
v_cvt_pk_bf16_f32 v139, v142, v143
v_mfma_f32_16x16x32_bf16 v[116:119], a[124:127], v[176:179], 0
v_exp_f32 v148, v148
v_mfma_f32_16x16x32_bf16 v[124:127], a[124:127], v[184:187], 0
s_cbranch_scc1 ATT_LOOP1
ATT_LOOP0:
s_waitcnt vmcnt(16) lgkmcnt(0)
s_barrier
v_mfma_f32_16x16x32_bf16 v[160:163], a[64:67], a[0:3], v[192:195]
v_exp_f32 v149, v149
v_mfma_f32_16x16x32_bf16 v[168:171], a[64:67], a[4:7], v[196:199]
ds_read_b64_tr_b16 a[96:97], v226 offset:16384
v_cvt_pk_bf16_f32 v146, v148, v149
v_mfma_f32_16x16x32_bf16 v[176:179], a[64:67], a[8:11], v[200:203]
v_exp_f32 v150, v150
v_mfma_f32_16x16x32_bf16 v[184:187], a[64:67], a[12:15], v[204:207]
ds_read_b64_tr_b16 a[98:99], v226 offset:18432
buffer_load_dwordx4 v234, s[20:23], s51 offen offset:0 lds
v_mfma_f32_16x16x32_bf16 v[160:163], a[68:71], a[16:19], v[160:163]
v_exp_f32 v151, v151
v_mfma_f32_16x16x32_bf16 v[168:171], a[68:71], a[20:23], v[168:171]
ds_read_b64_tr_b16 a[100:101], v227 offset:16384
v_cvt_pk_bf16_f32 v147, v150, v151
v_mfma_f32_16x16x32_bf16 v[176:179], a[68:71], a[24:27], v[176:179]
v_exp_f32 v156, v156
v_mfma_f32_16x16x32_bf16 v[184:187], a[68:71], a[28:31], v[184:187]
ds_read_b64_tr_b16 a[102:103], v227 offset:18432
buffer_load_dwordx4 v235, s[20:23], s51 offen offset:1024 lds
v_mfma_f32_16x16x32_bf16 v[160:163], a[72:75], a[32:35], v[160:163]
v_exp_f32 v157, v157
v_mfma_f32_16x16x32_bf16 v[168:171], a[72:75], a[36:39], v[168:171]
ds_read_b64_tr_b16 a[104:105], v228 offset:16384
v_cvt_pk_bf16_f32 v154, v156, v157
v_mfma_f32_16x16x32_bf16 v[176:179], a[72:75], a[40:43], v[176:179]
v_exp_f32 v158, v158
v_mfma_f32_16x16x32_bf16 v[184:187], a[72:75], a[44:47], v[184:187]
ds_read_b64_tr_b16 a[106:107], v228 offset:18432
buffer_load_dwordx4 v236, s[20:23], s51 offen offset:2048 lds
v_mfma_f32_16x16x32_bf16 v[160:163], a[76:79], a[48:51], v[160:163]
v_exp_f32 v159, v159
v_mfma_f32_16x16x32_bf16 v[168:171], a[76:79], a[52:55], v[168:171]
ds_read_b64_tr_b16 a[108:109], v229 offset:16384
v_cvt_pk_bf16_f32 v155, v158, v159
v_mfma_f32_16x16x32_bf16 v[176:179], a[76:79], a[56:59], v[176:179]
ds_read_b64_tr_b16 a[110:111], v229 offset:18432
ds_read_b64_tr_b16 a[112:113], v226 offset:20480
v_mfma_f32_16x16x32_bf16 v[184:187], a[76:79], a[60:63], v[184:187]
ds_read_b64_tr_b16 a[114:115], v226 offset:22528
buffer_load_dwordx4 v237, s[20:23], s51 offen offset:3072 lds
v_mfma_f32_16x16x32_bf16 v[164:167], a[80:83], a[0:3], v[192:195]
ds_read_b64_tr_b16 a[116:117], v227 offset:20480
s_add_u32 m0, s50, 3968
v_mfma_f32_16x16x32_bf16 v[172:175], a[80:83], a[4:7], v[196:199]
ds_read_b64_tr_b16 a[118:119], v227 offset:22528
ds_read_b64_tr_b16 a[120:121], v228 offset:20480
v_mfma_f32_16x16x32_bf16 v[180:183], a[80:83], a[8:11], v[200:203]
v_exp_f32 v160, v160
v_mfma_f32_16x16x32_bf16 v[188:191], a[80:83], a[12:15], v[204:207]
ds_read_b64_tr_b16 a[122:123], v228 offset:22528
buffer_load_dwordx4 v234, s[20:23], s51 offen offset:128 lds
v_mfma_f32_16x16x32_bf16 v[164:167], a[84:87], a[16:19], v[164:167]
v_exp_f32 v161, v161
v_mfma_f32_16x16x32_bf16 v[172:175], a[84:87], a[20:23], v[172:175]
ds_read_b64_tr_b16 a[124:125], v229 offset:20480
v_cvt_pk_bf16_f32 v160, v160, v161
v_mfma_f32_16x16x32_bf16 v[180:183], a[84:87], a[24:27], v[180:183]
v_exp_f32 v162, v162
v_mfma_f32_16x16x32_bf16 v[188:191], a[84:87], a[28:31], v[188:191]
ds_read_b64_tr_b16 a[126:127], v229 offset:22528
buffer_load_dwordx4 v235, s[20:23], s51 offen offset:1152 lds
v_mfma_f32_16x16x32_bf16 v[164:167], a[88:91], a[32:35], v[164:167]
v_exp_f32 v163, v163
v_mfma_f32_16x16x32_bf16 v[172:175], a[88:91], a[36:39], v[172:175]
buffer_load_dwordx4 v236, s[20:23], s51 offen offset:2176 lds
v_cvt_pk_bf16_f32 v161, v162, v163
v_mfma_f32_16x16x32_bf16 v[180:183], a[88:91], a[40:43], v[180:183]
v_exp_f32 v168, v168
v_mfma_f32_16x16x32_bf16 v[188:191], a[88:91], a[44:47], v[188:191]
buffer_load_dwordx4 v237, s[20:23], s51 offen offset:3200 lds
s_add_u32 m0, s50, 49152
v_mfma_f32_16x16x32_bf16 v[164:167], a[92:95], a[48:51], v[164:167]
v_exp_f32 v169, v169
v_mfma_f32_16x16x32_bf16 v[172:175], a[92:95], a[52:55], v[172:175]
s_add_u32 s51, s51, 8192
v_cvt_pk_bf16_f32 v168, v168, v169
v_mfma_f32_16x16x32_bf16 v[180:183], a[92:95], a[56:59], v[180:183]
v_exp_f32 v170, v170
v_mfma_f32_16x16x32_bf16 v[188:191], a[92:95], a[60:63], v[188:191]
s_waitcnt vmcnt(12) lgkmcnt(0)
s_barrier
v_mfma_f32_16x16x32_bf16 v[208:211], a[128:131], v[128:131], v[208:211]
v_exp_f32 v171, v171
v_mfma_f32_16x16x32_bf16 v[212:215], a[128:131], v[136:139], v[212:215]
buffer_load_dwordx4 v234, s[24:27], s8 offen offset:0 lds
v_cvt_pk_bf16_f32 v169, v170, v171
v_mfma_f32_16x16x32_bf16 v[216:219], a[128:131], v[144:147], v[216:219]
v_exp_f32 v176, v176
v_mfma_f32_16x16x32_bf16 v[220:223], a[128:131], v[152:155], v[220:223]
ds_read_b128 a[64:67], v244 offset:16384
ds_read_b128 a[68:71], v245 offset:16384
v_mfma_f32_16x16x32_bf16 v[0:3], a[96:99], v[128:131], v[0:3]
v_exp_f32 v177, v177
v_mfma_f32_16x16x32_bf16 v[8:11], a[96:99], v[136:139], v[8:11]
buffer_load_dwordx4 v235, s[24:27], s8 offen offset:1024 lds
v_cvt_pk_bf16_f32 v176, v176, v177
v_mfma_f32_16x16x32_bf16 v[16:19], a[96:99], v[144:147], v[16:19]
v_exp_f32 v178, v178
v_mfma_f32_16x16x32_bf16 v[24:27], a[96:99], v[152:155], v[24:27]
buffer_load_dwordx4 v236, s[24:27], s8 offen offset:2048 lds
ds_read_b128 a[72:75], v244 offset:20480
v_mfma_f32_16x16x32_bf16 v[4:7], a[100:103], v[128:131], v[4:7]
v_exp_f32 v179, v179
v_mfma_f32_16x16x32_bf16 v[12:15], a[100:103], v[136:139], v[12:15]
ds_read_b128 a[76:79], v245 offset:20480
v_cvt_pk_bf16_f32 v177, v178, v179
v_mfma_f32_16x16x32_bf16 v[20:23], a[100:103], v[144:147], v[20:23]
v_exp_f32 v184, v184
v_mfma_f32_16x16x32_bf16 v[28:31], a[100:103], v[152:155], v[28:31]
buffer_load_dwordx4 v237, s[24:27], s8 offen offset:3072 lds
s_add_u32 m0, s50, 53120
v_mfma_f32_16x16x32_bf16 v[32:35], a[104:107], v[128:131], v[32:35]
v_exp_f32 v185, v185
v_mfma_f32_16x16x32_bf16 v[40:43], a[104:107], v[136:139], v[40:43]
ds_read_b128 a[80:83], v244 offset:18432
v_cvt_pk_bf16_f32 v184, v184, v185
v_mfma_f32_16x16x32_bf16 v[48:51], a[104:107], v[144:147], v[48:51]
v_exp_f32 v186, v186
v_mfma_f32_16x16x32_bf16 v[56:59], a[104:107], v[152:155], v[56:59]
buffer_load_dwordx4 v234, s[24:27], s8 offen offset:128 lds
ds_read_b128 a[84:87], v245 offset:18432
v_mfma_f32_16x16x32_bf16 v[36:39], a[108:111], v[128:131], v[36:39]
v_exp_f32 v187, v187
v_mfma_f32_16x16x32_bf16 v[44:47], a[108:111], v[136:139], v[44:47]
ds_read_b128 a[88:91], v244 offset:22528
v_cvt_pk_bf16_f32 v185, v186, v187
v_mfma_f32_16x16x32_bf16 v[52:55], a[108:111], v[144:147], v[52:55]
v_exp_f32 v164, v164
v_mfma_f32_16x16x32_bf16 v[60:63], a[108:111], v[152:155], v[60:63]
buffer_load_dwordx4 v235, s[24:27], s8 offen offset:1152 lds
ds_read_b128 a[92:95], v245 offset:22528
v_mfma_f32_16x16x32_bf16 v[64:67], a[112:115], v[128:131], v[64:67]
v_exp_f32 v165, v165
v_mfma_f32_16x16x32_bf16 v[72:75], a[112:115], v[136:139], v[72:75]
v_cvt_pk_bf16_f32 v162, v164, v165
v_mfma_f32_16x16x32_bf16 v[80:83], a[112:115], v[144:147], v[80:83]
v_exp_f32 v166, v166
v_mfma_f32_16x16x32_bf16 v[88:91], a[112:115], v[152:155], v[88:91]
buffer_load_dwordx4 v236, s[24:27], s8 offen offset:2176 lds
v_mfma_f32_16x16x32_bf16 v[68:71], a[116:119], v[128:131], v[68:71]
v_exp_f32 v167, v167
v_mfma_f32_16x16x32_bf16 v[76:79], a[116:119], v[136:139], v[76:79]
v_cvt_pk_bf16_f32 v163, v166, v167
v_mfma_f32_16x16x32_bf16 v[84:87], a[116:119], v[144:147], v[84:87]
v_exp_f32 v172, v172
v_mfma_f32_16x16x32_bf16 v[92:95], a[116:119], v[152:155], v[92:95]
buffer_load_dwordx4 v237, s[24:27], s8 offen offset:3200 lds
s_add_u32 m0, s50, 16384
v_mfma_f32_16x16x32_bf16 v[96:99], a[120:123], v[128:131], v[96:99]
v_exp_f32 v173, v173
v_mfma_f32_16x16x32_bf16 v[104:107], a[120:123], v[136:139], v[104:107]
s_add_u32 s8, s8, 8192
v_cvt_pk_bf16_f32 v170, v172, v173
v_mfma_f32_16x16x32_bf16 v[112:115], a[120:123], v[144:147], v[112:115]
v_exp_f32 v174, v174
v_mfma_f32_16x16x32_bf16 v[120:123], a[120:123], v[152:155], v[120:123]
v_mfma_f32_16x16x32_bf16 v[100:103], a[124:127], v[128:131], v[100:103]
v_exp_f32 v175, v175
v_mfma_f32_16x16x32_bf16 v[108:111], a[124:127], v[136:139], v[108:111]
v_cvt_pk_bf16_f32 v171, v174, v175
v_mfma_f32_16x16x32_bf16 v[116:119], a[124:127], v[144:147], v[116:119]
v_exp_f32 v180, v180
v_mfma_f32_16x16x32_bf16 v[124:127], a[124:127], v[152:155], v[124:127]
s_waitcnt vmcnt(16) lgkmcnt(0)
s_barrier
v_mfma_f32_16x16x32_bf16 v[128:131], a[64:67], a[0:3], v[192:195]
v_exp_f32 v181, v181
v_mfma_f32_16x16x32_bf16 v[136:139], a[64:67], a[4:7], v[196:199]
ds_read_b64_tr_b16 a[96:97], v226 offset:0
v_cvt_pk_bf16_f32 v178, v180, v181
v_mfma_f32_16x16x32_bf16 v[144:147], a[64:67], a[8:11], v[200:203]
v_exp_f32 v182, v182
v_mfma_f32_16x16x32_bf16 v[152:155], a[64:67], a[12:15], v[204:207]
ds_read_b64_tr_b16 a[98:99], v226 offset:2048
buffer_load_dwordx4 v234, s[20:23], s51 offen offset:0 lds
v_mfma_f32_16x16x32_bf16 v[128:131], a[68:71], a[16:19], v[128:131]
v_exp_f32 v183, v183
v_mfma_f32_16x16x32_bf16 v[136:139], a[68:71], a[20:23], v[136:139]
ds_read_b64_tr_b16 a[100:101], v227 offset:0
v_cvt_pk_bf16_f32 v179, v182, v183
v_mfma_f32_16x16x32_bf16 v[144:147], a[68:71], a[24:27], v[144:147]
v_exp_f32 v188, v188
v_mfma_f32_16x16x32_bf16 v[152:155], a[68:71], a[28:31], v[152:155]
ds_read_b64_tr_b16 a[102:103], v227 offset:2048
buffer_load_dwordx4 v235, s[20:23], s51 offen offset:1024 lds
v_mfma_f32_16x16x32_bf16 v[128:131], a[72:75], a[32:35], v[128:131]
v_exp_f32 v189, v189
v_mfma_f32_16x16x32_bf16 v[136:139], a[72:75], a[36:39], v[136:139]
ds_read_b64_tr_b16 a[104:105], v228 offset:0
v_cvt_pk_bf16_f32 v186, v188, v189
v_mfma_f32_16x16x32_bf16 v[144:147], a[72:75], a[40:43], v[144:147]
v_exp_f32 v190, v190
v_mfma_f32_16x16x32_bf16 v[152:155], a[72:75], a[44:47], v[152:155]
ds_read_b64_tr_b16 a[106:107], v228 offset:2048
buffer_load_dwordx4 v236, s[20:23], s51 offen offset:2048 lds
v_mfma_f32_16x16x32_bf16 v[128:131], a[76:79], a[48:51], v[128:131]
v_exp_f32 v191, v191
v_mfma_f32_16x16x32_bf16 v[136:139], a[76:79], a[52:55], v[136:139]
ds_read_b64_tr_b16 a[108:109], v229 offset:0
v_cvt_pk_bf16_f32 v187, v190, v191
v_mfma_f32_16x16x32_bf16 v[144:147], a[76:79], a[56:59], v[144:147]
ds_read_b64_tr_b16 a[110:111], v229 offset:2048
ds_read_b64_tr_b16 a[112:113], v226 offset:4096
v_mfma_f32_16x16x32_bf16 v[152:155], a[76:79], a[60:63], v[152:155]
ds_read_b64_tr_b16 a[114:115], v226 offset:6144
buffer_load_dwordx4 v237, s[20:23], s51 offen offset:3072 lds
v_mfma_f32_16x16x32_bf16 v[132:135], a[80:83], a[0:3], v[192:195]
ds_read_b64_tr_b16 a[116:117], v227 offset:4096
s_add_u32 m0, s50, 20352
v_mfma_f32_16x16x32_bf16 v[140:143], a[80:83], a[4:7], v[196:199]
ds_read_b64_tr_b16 a[118:119], v227 offset:6144
ds_read_b64_tr_b16 a[120:121], v228 offset:4096
v_mfma_f32_16x16x32_bf16 v[148:151], a[80:83], a[8:11], v[200:203]
v_exp_f32 v128, v128
v_mfma_f32_16x16x32_bf16 v[156:159], a[80:83], a[12:15], v[204:207]
ds_read_b64_tr_b16 a[122:123], v228 offset:6144
buffer_load_dwordx4 v234, s[20:23], s51 offen offset:128 lds
v_mfma_f32_16x16x32_bf16 v[132:135], a[84:87], a[16:19], v[132:135]
v_exp_f32 v129, v129
v_mfma_f32_16x16x32_bf16 v[140:143], a[84:87], a[20:23], v[140:143]
ds_read_b64_tr_b16 a[124:125], v229 offset:4096
v_cvt_pk_bf16_f32 v128, v128, v129
v_mfma_f32_16x16x32_bf16 v[148:151], a[84:87], a[24:27], v[148:151]
v_exp_f32 v130, v130
v_mfma_f32_16x16x32_bf16 v[156:159], a[84:87], a[28:31], v[156:159]
ds_read_b64_tr_b16 a[126:127], v229 offset:6144
buffer_load_dwordx4 v235, s[20:23], s51 offen offset:1152 lds
v_mfma_f32_16x16x32_bf16 v[132:135], a[88:91], a[32:35], v[132:135]
v_exp_f32 v131, v131
v_mfma_f32_16x16x32_bf16 v[140:143], a[88:91], a[36:39], v[140:143]
buffer_load_dwordx4 v236, s[20:23], s51 offen offset:2176 lds
v_cvt_pk_bf16_f32 v129, v130, v131
v_mfma_f32_16x16x32_bf16 v[148:151], a[88:91], a[40:43], v[148:151]
v_exp_f32 v136, v136
v_mfma_f32_16x16x32_bf16 v[156:159], a[88:91], a[44:47], v[156:159]
buffer_load_dwordx4 v237, s[20:23], s51 offen offset:3200 lds
s_add_u32 m0, s50, 32768
v_mfma_f32_16x16x32_bf16 v[132:135], a[92:95], a[48:51], v[132:135]
v_exp_f32 v137, v137
v_mfma_f32_16x16x32_bf16 v[140:143], a[92:95], a[52:55], v[140:143]
s_add_u32 s51, s51, 8192
v_cvt_pk_bf16_f32 v136, v136, v137
v_mfma_f32_16x16x32_bf16 v[148:151], a[92:95], a[56:59], v[148:151]
v_exp_f32 v138, v138
v_mfma_f32_16x16x32_bf16 v[156:159], a[92:95], a[60:63], v[156:159]
s_waitcnt vmcnt(16) lgkmcnt(0)
s_barrier
v_mfma_f32_16x16x32_bf16 v[208:211], a[128:131], v[160:163], v[208:211]
v_exp_f32 v139, v139
v_mfma_f32_16x16x32_bf16 v[212:215], a[128:131], v[168:171], v[212:215]
buffer_load_dwordx4 v234, s[24:27], s8 offen offset:0 lds
v_cvt_pk_bf16_f32 v137, v138, v139
v_mfma_f32_16x16x32_bf16 v[216:219], a[128:131], v[176:179], v[216:219]
v_exp_f32 v144, v144
v_mfma_f32_16x16x32_bf16 v[220:223], a[128:131], v[184:187], v[220:223]
ds_read_b128 a[64:67], v244 offset:0
ds_read_b128 a[68:71], v245 offset:0
v_mfma_f32_16x16x32_bf16 v[0:3], a[96:99], v[160:163], v[0:3]
v_exp_f32 v145, v145
v_mfma_f32_16x16x32_bf16 v[8:11], a[96:99], v[168:171], v[8:11]
buffer_load_dwordx4 v235, s[24:27], s8 offen offset:1024 lds
v_cvt_pk_bf16_f32 v144, v144, v145
v_mfma_f32_16x16x32_bf16 v[16:19], a[96:99], v[176:179], v[16:19]
v_exp_f32 v146, v146
v_mfma_f32_16x16x32_bf16 v[24:27], a[96:99], v[184:187], v[24:27]
buffer_load_dwordx4 v236, s[24:27], s8 offen offset:2048 lds
ds_read_b128 a[72:75], v244 offset:4096
v_mfma_f32_16x16x32_bf16 v[4:7], a[100:103], v[160:163], v[4:7]
v_exp_f32 v147, v147
v_mfma_f32_16x16x32_bf16 v[12:15], a[100:103], v[168:171], v[12:15]
ds_read_b128 a[76:79], v245 offset:4096
v_cvt_pk_bf16_f32 v145, v146, v147
v_mfma_f32_16x16x32_bf16 v[20:23], a[100:103], v[176:179], v[20:23]
v_exp_f32 v152, v152
v_mfma_f32_16x16x32_bf16 v[28:31], a[100:103], v[184:187], v[28:31]
buffer_load_dwordx4 v237, s[24:27], s8 offen offset:3072 lds
s_add_u32 m0, s50, 36736
v_mfma_f32_16x16x32_bf16 v[32:35], a[104:107], v[160:163], v[32:35]
v_exp_f32 v153, v153
v_mfma_f32_16x16x32_bf16 v[40:43], a[104:107], v[168:171], v[40:43]
ds_read_b128 a[80:83], v244 offset:2048
v_cvt_pk_bf16_f32 v152, v152, v153
v_mfma_f32_16x16x32_bf16 v[48:51], a[104:107], v[176:179], v[48:51]
v_exp_f32 v154, v154
v_mfma_f32_16x16x32_bf16 v[56:59], a[104:107], v[184:187], v[56:59]
buffer_load_dwordx4 v234, s[24:27], s8 offen offset:128 lds
ds_read_b128 a[84:87], v245 offset:2048
v_mfma_f32_16x16x32_bf16 v[36:39], a[108:111], v[160:163], v[36:39]
v_exp_f32 v155, v155
v_mfma_f32_16x16x32_bf16 v[44:47], a[108:111], v[168:171], v[44:47]
ds_read_b128 a[88:91], v244 offset:6144
v_cvt_pk_bf16_f32 v153, v154, v155
v_mfma_f32_16x16x32_bf16 v[52:55], a[108:111], v[176:179], v[52:55]
v_exp_f32 v132, v132
v_mfma_f32_16x16x32_bf16 v[60:63], a[108:111], v[184:187], v[60:63]
buffer_load_dwordx4 v235, s[24:27], s8 offen offset:1152 lds
ds_read_b128 a[92:95], v245 offset:6144
v_mfma_f32_16x16x32_bf16 v[64:67], a[112:115], v[160:163], v[64:67]
v_exp_f32 v133, v133
v_mfma_f32_16x16x32_bf16 v[72:75], a[112:115], v[168:171], v[72:75]
v_cvt_pk_bf16_f32 v130, v132, v133
v_mfma_f32_16x16x32_bf16 v[80:83], a[112:115], v[176:179], v[80:83]
v_exp_f32 v134, v134
v_mfma_f32_16x16x32_bf16 v[88:91], a[112:115], v[184:187], v[88:91]
buffer_load_dwordx4 v236, s[24:27], s8 offen offset:2176 lds
v_mfma_f32_16x16x32_bf16 v[68:71], a[116:119], v[160:163], v[68:71]
v_exp_f32 v135, v135
v_mfma_f32_16x16x32_bf16 v[76:79], a[116:119], v[168:171], v[76:79]
v_cvt_pk_bf16_f32 v131, v134, v135
v_mfma_f32_16x16x32_bf16 v[84:87], a[116:119], v[176:179], v[84:87]
v_exp_f32 v140, v140
v_mfma_f32_16x16x32_bf16 v[92:95], a[116:119], v[184:187], v[92:95]
buffer_load_dwordx4 v237, s[24:27], s8 offen offset:3200 lds
s_add_u32 m0, s50, 0
v_mfma_f32_16x16x32_bf16 v[96:99], a[120:123], v[160:163], v[96:99]
v_exp_f32 v141, v141
v_mfma_f32_16x16x32_bf16 v[104:107], a[120:123], v[168:171], v[104:107]
s_add_u32 s8, s8, 8192
v_cvt_pk_bf16_f32 v138, v140, v141
v_mfma_f32_16x16x32_bf16 v[112:115], a[120:123], v[176:179], v[112:115]
v_exp_f32 v142, v142
v_mfma_f32_16x16x32_bf16 v[120:123], a[120:123], v[184:187], v[120:123]
s_cmp_lt_u32 s8, s52
v_mfma_f32_16x16x32_bf16 v[100:103], a[124:127], v[160:163], v[100:103]
v_exp_f32 v143, v143
v_mfma_f32_16x16x32_bf16 v[108:111], a[124:127], v[168:171], v[108:111]
v_cvt_pk_bf16_f32 v139, v142, v143
v_mfma_f32_16x16x32_bf16 v[116:119], a[124:127], v[176:179], v[116:119]
v_exp_f32 v148, v148
v_mfma_f32_16x16x32_bf16 v[124:127], a[124:127], v[184:187], v[124:127]
s_cbranch_scc1 ATT_LOOP0
ATT_DONE:
s_waitcnt vmcnt(16) lgkmcnt(0)
s_barrier
v_mfma_f32_16x16x32_bf16 v[160:163], a[64:67], a[0:3], v[192:195]
v_exp_f32 v149, v149
v_mfma_f32_16x16x32_bf16 v[168:171], a[64:67], a[4:7], v[196:199]
ds_read_b64_tr_b16 a[96:97], v226 offset:16384
v_cvt_pk_bf16_f32 v146, v148, v149
v_mfma_f32_16x16x32_bf16 v[176:179], a[64:67], a[8:11], v[200:203]
v_exp_f32 v150, v150
v_mfma_f32_16x16x32_bf16 v[184:187], a[64:67], a[12:15], v[204:207]
ds_read_b64_tr_b16 a[98:99], v226 offset:18432
s_add_u32 m0, s43, 0
v_mfma_f32_16x16x32_bf16 v[160:163], a[68:71], a[16:19], v[160:163]
v_exp_f32 v151, v151
v_mfma_f32_16x16x32_bf16 v[168:171], a[68:71], a[20:23], v[168:171]
ds_read_b64_tr_b16 a[100:101], v227 offset:16384
v_cvt_pk_bf16_f32 v147, v150, v151
v_mfma_f32_16x16x32_bf16 v[176:179], a[68:71], a[24:27], v[176:179]
v_exp_f32 v156, v156
v_mfma_f32_16x16x32_bf16 v[184:187], a[68:71], a[28:31], v[184:187]
ds_read_b64_tr_b16 a[102:103], v227 offset:18432
s_add_u32 s44, s59, 0
v_mfma_f32_16x16x32_bf16 v[160:163], a[72:75], a[32:35], v[160:163]
v_exp_f32 v157, v157
v_mfma_f32_16x16x32_bf16 v[168:171], a[72:75], a[36:39], v[168:171]
ds_read_b64_tr_b16 a[104:105], v228 offset:16384
v_cvt_pk_bf16_f32 v154, v156, v157
v_mfma_f32_16x16x32_bf16 v[176:179], a[72:75], a[40:43], v[176:179]
v_exp_f32 v158, v158
v_mfma_f32_16x16x32_bf16 v[184:187], a[72:75], a[44:47], v[184:187]
ds_read_b64_tr_b16 a[106:107], v228 offset:18432
buffer_load_dwordx4 v230, s[32:35], s44 offen offset:0 lds
v_mfma_f32_16x16x32_bf16 v[160:163], a[76:79], a[48:51], v[160:163]
v_exp_f32 v159, v159
v_mfma_f32_16x16x32_bf16 v[168:171], a[76:79], a[52:55], v[168:171]
ds_read_b64_tr_b16 a[108:109], v229 offset:16384
v_cvt_pk_bf16_f32 v155, v158, v159
v_mfma_f32_16x16x32_bf16 v[176:179], a[76:79], a[56:59], v[176:179]
ds_read_b64_tr_b16 a[110:111], v229 offset:18432
ds_read_b64_tr_b16 a[112:113], v226 offset:20480
v_mfma_f32_16x16x32_bf16 v[184:187], a[76:79], a[60:63], v[184:187]
ds_read_b64_tr_b16 a[114:115], v226 offset:22528
buffer_load_dwordx4 v231, s[32:35], s44 offen offset:1024 lds
v_mfma_f32_16x16x32_bf16 v[164:167], a[80:83], a[0:3], v[192:195]
ds_read_b64_tr_b16 a[116:117], v227 offset:20480
v_mfma_f32_16x16x32_bf16 v[172:175], a[80:83], a[4:7], v[196:199]
ds_read_b64_tr_b16 a[118:119], v227 offset:22528
ds_read_b64_tr_b16 a[120:121], v228 offset:20480
v_mfma_f32_16x16x32_bf16 v[180:183], a[80:83], a[8:11], v[200:203]
v_exp_f32 v160, v160
v_mfma_f32_16x16x32_bf16 v[188:191], a[80:83], a[12:15], v[204:207]
ds_read_b64_tr_b16 a[122:123], v228 offset:22528
buffer_load_dwordx4 v232, s[32:35], s44 offen offset:2048 lds
v_mfma_f32_16x16x32_bf16 v[164:167], a[84:87], a[16:19], v[164:167]
v_exp_f32 v161, v161
v_mfma_f32_16x16x32_bf16 v[172:175], a[84:87], a[20:23], v[172:175]
ds_read_b64_tr_b16 a[124:125], v229 offset:20480
v_cvt_pk_bf16_f32 v160, v160, v161
v_mfma_f32_16x16x32_bf16 v[180:183], a[84:87], a[24:27], v[180:183]
v_exp_f32 v162, v162
v_mfma_f32_16x16x32_bf16 v[188:191], a[84:87], a[28:31], v[188:191]
ds_read_b64_tr_b16 a[126:127], v229 offset:22528
buffer_load_dwordx4 v233, s[32:35], s44 offen offset:3072 lds
v_mfma_f32_16x16x32_bf16 v[164:167], a[88:91], a[32:35], v[164:167]
v_exp_f32 v163, v163
v_mfma_f32_16x16x32_bf16 v[172:175], a[88:91], a[36:39], v[172:175]
v_cvt_pk_bf16_f32 v161, v162, v163
v_mfma_f32_16x16x32_bf16 v[180:183], a[88:91], a[40:43], v[180:183]
v_exp_f32 v168, v168
v_mfma_f32_16x16x32_bf16 v[188:191], a[88:91], a[44:47], v[188:191]
v_mfma_f32_16x16x32_bf16 v[164:167], a[92:95], a[48:51], v[164:167]
v_exp_f32 v169, v169
v_mfma_f32_16x16x32_bf16 v[172:175], a[92:95], a[52:55], v[172:175]
s_add_u32 m0, s50, 49152
v_cvt_pk_bf16_f32 v168, v168, v169
v_mfma_f32_16x16x32_bf16 v[180:183], a[92:95], a[56:59], v[180:183]
v_exp_f32 v170, v170
v_mfma_f32_16x16x32_bf16 v[188:191], a[92:95], a[60:63], v[188:191]
s_waitcnt vmcnt(12) lgkmcnt(0)
s_barrier
v_mfma_f32_16x16x32_bf16 v[208:211], a[128:131], v[128:131], v[208:211]
v_exp_f32 v171, v171
v_mfma_f32_16x16x32_bf16 v[212:215], a[128:131], v[136:139], v[212:215]
buffer_load_dwordx4 v234, s[24:27], s8 offen offset:0 lds
v_cvt_pk_bf16_f32 v169, v170, v171
v_mfma_f32_16x16x32_bf16 v[216:219], a[128:131], v[144:147], v[216:219]
v_exp_f32 v176, v176
v_mfma_f32_16x16x32_bf16 v[220:223], a[128:131], v[152:155], v[220:223]
ds_read_b128 a[64:67], v244 offset:16384
ds_read_b128 a[68:71], v245 offset:16384
v_mfma_f32_16x16x32_bf16 v[0:3], a[96:99], v[128:131], v[0:3]
v_exp_f32 v177, v177
v_mfma_f32_16x16x32_bf16 v[8:11], a[96:99], v[136:139], v[8:11]
buffer_load_dwordx4 v235, s[24:27], s8 offen offset:1024 lds
v_cvt_pk_bf16_f32 v176, v176, v177
v_mfma_f32_16x16x32_bf16 v[16:19], a[96:99], v[144:147], v[16:19]
v_exp_f32 v178, v178
v_mfma_f32_16x16x32_bf16 v[24:27], a[96:99], v[152:155], v[24:27]
ds_read_b128 a[72:75], v244 offset:20480
buffer_load_dwordx4 v236, s[24:27], s8 offen offset:2048 lds
v_mfma_f32_16x16x32_bf16 v[4:7], a[100:103], v[128:131], v[4:7]
v_exp_f32 v179, v179
v_mfma_f32_16x16x32_bf16 v[12:15], a[100:103], v[136:139], v[12:15]
ds_read_b128 a[76:79], v245 offset:20480
v_cvt_pk_bf16_f32 v177, v178, v179
v_mfma_f32_16x16x32_bf16 v[20:23], a[100:103], v[144:147], v[20:23]
v_exp_f32 v184, v184
v_mfma_f32_16x16x32_bf16 v[28:31], a[100:103], v[152:155], v[28:31]
buffer_load_dwordx4 v237, s[24:27], s8 offen offset:3072 lds
s_add_u32 m0, s43, 4096
v_mfma_f32_16x16x32_bf16 v[32:35], a[104:107], v[128:131], v[32:35]
v_exp_f32 v185, v185
v_mfma_f32_16x16x32_bf16 v[40:43], a[104:107], v[136:139], v[40:43]
ds_read_b128 a[80:83], v244 offset:18432
v_cvt_pk_bf16_f32 v184, v184, v185
v_mfma_f32_16x16x32_bf16 v[48:51], a[104:107], v[144:147], v[48:51]
v_exp_f32 v186, v186
v_mfma_f32_16x16x32_bf16 v[56:59], a[104:107], v[152:155], v[56:59]
ds_read_b128 a[84:87], v245 offset:18432
s_add_u32 s44, s59, 36864
v_mfma_f32_16x16x32_bf16 v[36:39], a[108:111], v[128:131], v[36:39]
v_exp_f32 v187, v187
v_mfma_f32_16x16x32_bf16 v[44:47], a[108:111], v[136:139], v[44:47]
ds_read_b128 a[88:91], v244 offset:22528
v_cvt_pk_bf16_f32 v185, v186, v187
v_mfma_f32_16x16x32_bf16 v[52:55], a[108:111], v[144:147], v[52:55]
v_exp_f32 v164, v164
v_mfma_f32_16x16x32_bf16 v[60:63], a[108:111], v[152:155], v[60:63]
ds_read_b128 a[92:95], v245 offset:22528
buffer_load_dwordx4 v230, s[32:35], s44 offen offset:0 lds
v_mfma_f32_16x16x32_bf16 v[64:67], a[112:115], v[128:131], v[64:67]
v_exp_f32 v165, v165
v_mfma_f32_16x16x32_bf16 v[72:75], a[112:115], v[136:139], v[72:75]
buffer_load_dwordx4 v231, s[32:35], s44 offen offset:1024 lds
v_cvt_pk_bf16_f32 v162, v164, v165
v_mfma_f32_16x16x32_bf16 v[80:83], a[112:115], v[144:147], v[80:83]
v_exp_f32 v166, v166
v_mfma_f32_16x16x32_bf16 v[88:91], a[112:115], v[152:155], v[88:91]
buffer_load_dwordx4 v232, s[32:35], s44 offen offset:2048 lds
v_mfma_f32_16x16x32_bf16 v[68:71], a[116:119], v[128:131], v[68:71]
v_exp_f32 v167, v167
v_mfma_f32_16x16x32_bf16 v[76:79], a[116:119], v[136:139], v[76:79]
buffer_load_dwordx4 v233, s[32:35], s44 offen offset:3072 lds
v_cvt_pk_bf16_f32 v163, v166, v167
v_mfma_f32_16x16x32_bf16 v[84:87], a[116:119], v[144:147], v[84:87]
v_exp_f32 v172, v172
v_mfma_f32_16x16x32_bf16 v[92:95], a[116:119], v[152:155], v[92:95]
s_add_u32 m0, s43, 8192
s_add_u32 s44, s59, 147456
v_mfma_f32_16x16x32_bf16 v[96:99], a[120:123], v[128:131], v[96:99]
v_exp_f32 v173, v173
v_mfma_f32_16x16x32_bf16 v[104:107], a[120:123], v[136:139], v[104:107]
buffer_load_dwordx4 v230, s[32:35], s44 offen offset:0 lds
v_cvt_pk_bf16_f32 v170, v172, v173
v_mfma_f32_16x16x32_bf16 v[112:115], a[120:123], v[144:147], v[112:115]
v_exp_f32 v174, v174
v_mfma_f32_16x16x32_bf16 v[120:123], a[120:123], v[152:155], v[120:123]
buffer_load_dwordx4 v231, s[32:35], s44 offen offset:1024 lds
v_mfma_f32_16x16x32_bf16 v[100:103], a[124:127], v[128:131], v[100:103]
v_exp_f32 v175, v175
v_mfma_f32_16x16x32_bf16 v[108:111], a[124:127], v[136:139], v[108:111]
buffer_load_dwordx4 v232, s[32:35], s44 offen offset:2048 lds
v_cvt_pk_bf16_f32 v171, v174, v175
v_mfma_f32_16x16x32_bf16 v[116:119], a[124:127], v[144:147], v[116:119]
v_exp_f32 v180, v180
v_mfma_f32_16x16x32_bf16 v[124:127], a[124:127], v[152:155], v[124:127]
s_waitcnt vmcnt(15) lgkmcnt(0)
s_barrier
v_mfma_f32_16x16x32_bf16 v[128:131], a[64:67], a[0:3], v[192:195]
v_exp_f32 v181, v181
v_mfma_f32_16x16x32_bf16 v[136:139], a[64:67], a[4:7], v[196:199]
ds_read_b64_tr_b16 a[96:97], v226 offset:0
v_cvt_pk_bf16_f32 v178, v180, v181
v_mfma_f32_16x16x32_bf16 v[144:147], a[64:67], a[8:11], v[200:203]
v_exp_f32 v182, v182
v_mfma_f32_16x16x32_bf16 v[152:155], a[64:67], a[12:15], v[204:207]
ds_read_b64_tr_b16 a[98:99], v226 offset:2048
buffer_load_dwordx4 v233, s[32:35], s44 offen offset:3072 lds
v_mfma_f32_16x16x32_bf16 v[128:131], a[68:71], a[16:19], v[128:131]
v_exp_f32 v183, v183
v_mfma_f32_16x16x32_bf16 v[136:139], a[68:71], a[20:23], v[136:139]
ds_read_b64_tr_b16 a[100:101], v227 offset:0
v_cvt_pk_bf16_f32 v179, v182, v183
v_mfma_f32_16x16x32_bf16 v[144:147], a[68:71], a[24:27], v[144:147]
v_exp_f32 v188, v188
v_mfma_f32_16x16x32_bf16 v[152:155], a[68:71], a[28:31], v[152:155]
ds_read_b64_tr_b16 a[102:103], v227 offset:2048
s_add_u32 m0, s43, 12288
v_mfma_f32_16x16x32_bf16 v[128:131], a[72:75], a[32:35], v[128:131]
v_exp_f32 v189, v189
v_mfma_f32_16x16x32_bf16 v[136:139], a[72:75], a[36:39], v[136:139]
ds_read_b64_tr_b16 a[104:105], v228 offset:0
v_cvt_pk_bf16_f32 v186, v188, v189
v_mfma_f32_16x16x32_bf16 v[144:147], a[72:75], a[40:43], v[144:147]
v_exp_f32 v190, v190
v_mfma_f32_16x16x32_bf16 v[152:155], a[72:75], a[44:47], v[152:155]
ds_read_b64_tr_b16 a[106:107], v228 offset:2048
s_add_u32 s44, s59, 184320
v_mfma_f32_16x16x32_bf16 v[128:131], a[76:79], a[48:51], v[128:131]
v_exp_f32 v191, v191
v_mfma_f32_16x16x32_bf16 v[136:139], a[76:79], a[52:55], v[136:139]
ds_read_b64_tr_b16 a[108:109], v229 offset:0
v_cvt_pk_bf16_f32 v187, v190, v191
v_mfma_f32_16x16x32_bf16 v[144:147], a[76:79], a[56:59], v[144:147]
ds_read_b64_tr_b16 a[110:111], v229 offset:2048
ds_read_b64_tr_b16 a[112:113], v226 offset:4096
v_mfma_f32_16x16x32_bf16 v[152:155], a[76:79], a[60:63], v[152:155]
ds_read_b64_tr_b16 a[114:115], v226 offset:6144
buffer_load_dwordx4 v230, s[32:35], s44 offen offset:0 lds
v_mfma_f32_16x16x32_bf16 v[132:135], a[80:83], a[0:3], v[192:195]
ds_read_b64_tr_b16 a[116:117], v227 offset:4096
v_mfma_f32_16x16x32_bf16 v[140:143], a[80:83], a[4:7], v[196:199]
ds_read_b64_tr_b16 a[118:119], v227 offset:6144
ds_read_b64_tr_b16 a[120:121], v228 offset:4096
v_mfma_f32_16x16x32_bf16 v[148:151], a[80:83], a[8:11], v[200:203]
buffer_load_dwordx4 v231, s[32:35], s44 offen offset:1024 lds
v_mfma_f32_16x16x32_bf16 v[156:159], a[80:83], a[12:15], v[204:207]
ds_read_b64_tr_b16 a[122:123], v228 offset:6144
v_exp_f32 v128, v128
v_mfma_f32_16x16x32_bf16 v[132:135], a[84:87], a[16:19], v[132:135]
buffer_load_dwordx4 v232, s[32:35], s44 offen offset:2048 lds
v_exp_f32 v129, v129
v_mfma_f32_16x16x32_bf16 v[140:143], a[84:87], a[20:23], v[140:143]
ds_read_b64_tr_b16 a[124:125], v229 offset:4096
v_exp_f32 v130, v130
v_mfma_f32_16x16x32_bf16 v[148:151], a[84:87], a[24:27], v[148:151]
buffer_load_dwordx4 v233, s[32:35], s44 offen offset:3072 lds
s_add_u32 m0, s43, 16384
v_mfma_f32_16x16x32_bf16 v[156:159], a[84:87], a[28:31], v[156:159]
ds_read_b64_tr_b16 a[126:127], v229 offset:6144
s_add_u32 s44, s59, 294912
v_cvt_pk_bf16_f32 v128, v128, v129
v_mfma_f32_16x16x32_bf16 v[132:135], a[88:91], a[32:35], v[132:135]
buffer_load_dwordx4 v230, s[32:35], s44 offen offset:0 lds
v_exp_f32 v131, v131
v_mfma_f32_16x16x32_bf16 v[140:143], a[88:91], a[36:39], v[140:143]
v_exp_f32 v136, v136
v_cvt_pk_bf16_f32 v129, v130, v131
v_mfma_f32_16x16x32_bf16 v[148:151], a[88:91], a[40:43], v[148:151]
buffer_load_dwordx4 v231, s[32:35], s44 offen offset:1024 lds
v_mfma_f32_16x16x32_bf16 v[156:159], a[88:91], a[44:47], v[156:159]
v_exp_f32 v137, v137
v_mfma_f32_16x16x32_bf16 v[132:135], a[92:95], a[48:51], v[132:135]
buffer_load_dwordx4 v232, s[32:35], s44 offen offset:2048 lds
v_exp_f32 v138, v138
v_mfma_f32_16x16x32_bf16 v[140:143], a[92:95], a[52:55], v[140:143]
v_cvt_pk_bf16_f32 v136, v136, v137
v_exp_f32 v139, v139
v_mfma_f32_16x16x32_bf16 v[148:151], a[92:95], a[56:59], v[148:151]
buffer_load_dwordx4 v233, s[32:35], s44 offen offset:3072 lds
v_mfma_f32_16x16x32_bf16 v[156:159], a[92:95], a[60:63], v[156:159]
s_waitcnt vmcnt(16) lgkmcnt(0)
s_barrier
v_mfma_f32_16x16x32_bf16 v[208:211], a[128:131], v[160:163], v[208:211]
v_exp_f32 v144, v144
v_cvt_pk_bf16_f32 v137, v138, v139
v_mfma_f32_16x16x32_bf16 v[212:215], a[128:131], v[168:171], v[212:215]
v_exp_f32 v145, v145
v_mfma_f32_16x16x32_bf16 v[216:219], a[128:131], v[176:179], v[216:219]
v_exp_f32 v146, v146
v_mfma_f32_16x16x32_bf16 v[220:223], a[128:131], v[184:187], v[220:223]
v_cvt_pk_bf16_f32 v144, v144, v145
v_exp_f32 v147, v147
v_mfma_f32_16x16x32_bf16 v[0:3], a[96:99], v[160:163], v[0:3]
v_exp_f32 v152, v152
v_cvt_pk_bf16_f32 v145, v146, v147
v_mfma_f32_16x16x32_bf16 v[8:11], a[96:99], v[168:171], v[8:11]
v_exp_f32 v153, v153
v_mfma_f32_16x16x32_bf16 v[16:19], a[96:99], v[176:179], v[16:19]
v_exp_f32 v154, v154
v_mfma_f32_16x16x32_bf16 v[24:27], a[96:99], v[184:187], v[24:27]
v_cvt_pk_bf16_f32 v152, v152, v153
v_exp_f32 v155, v155
v_mfma_f32_16x16x32_bf16 v[4:7], a[100:103], v[160:163], v[4:7]
v_cvt_pk_bf16_f32 v153, v154, v155
v_mfma_f32_16x16x32_bf16 v[12:15], a[100:103], v[168:171], v[12:15]
v_exp_f32 v132, v132
v_mfma_f32_16x16x32_bf16 v[20:23], a[100:103], v[176:179], v[20:23]
v_exp_f32 v133, v133
v_mfma_f32_16x16x32_bf16 v[28:31], a[100:103], v[184:187], v[28:31]
v_exp_f32 v134, v134
v_mfma_f32_16x16x32_bf16 v[32:35], a[104:107], v[160:163], v[32:35]
v_cvt_pk_bf16_f32 v130, v132, v133
v_mfma_f32_16x16x32_bf16 v[40:43], a[104:107], v[168:171], v[40:43]
v_exp_f32 v135, v135
v_mfma_f32_16x16x32_bf16 v[48:51], a[104:107], v[176:179], v[48:51]
v_exp_f32 v140, v140
v_mfma_f32_16x16x32_bf16 v[56:59], a[104:107], v[184:187], v[56:59]
v_cvt_pk_bf16_f32 v131, v134, v135
v_mfma_f32_16x16x32_bf16 v[36:39], a[108:111], v[160:163], v[36:39]
v_exp_f32 v141, v141
v_mfma_f32_16x16x32_bf16 v[44:47], a[108:111], v[168:171], v[44:47]
v_exp_f32 v142, v142
v_mfma_f32_16x16x32_bf16 v[52:55], a[108:111], v[176:179], v[52:55]
v_cvt_pk_bf16_f32 v138, v140, v141
v_mfma_f32_16x16x32_bf16 v[60:63], a[108:111], v[184:187], v[60:63]
v_exp_f32 v143, v143
v_mfma_f32_16x16x32_bf16 v[64:67], a[112:115], v[160:163], v[64:67]
v_exp_f32 v148, v148
v_mfma_f32_16x16x32_bf16 v[72:75], a[112:115], v[168:171], v[72:75]
v_cvt_pk_bf16_f32 v139, v142, v143
v_mfma_f32_16x16x32_bf16 v[80:83], a[112:115], v[176:179], v[80:83]
v_exp_f32 v149, v149
v_mfma_f32_16x16x32_bf16 v[88:91], a[112:115], v[184:187], v[88:91]
v_exp_f32 v150, v150
v_mfma_f32_16x16x32_bf16 v[68:71], a[116:119], v[160:163], v[68:71]
v_cvt_pk_bf16_f32 v146, v148, v149
v_mfma_f32_16x16x32_bf16 v[76:79], a[116:119], v[168:171], v[76:79]
v_exp_f32 v151, v151
v_mfma_f32_16x16x32_bf16 v[84:87], a[116:119], v[176:179], v[84:87]
v_exp_f32 v156, v156
v_mfma_f32_16x16x32_bf16 v[92:95], a[116:119], v[184:187], v[92:95]
ds_read_b64_tr_b16 a[96:97], v226 offset:16384
v_cvt_pk_bf16_f32 v147, v150, v151
v_mfma_f32_16x16x32_bf16 v[96:99], a[120:123], v[160:163], v[96:99]
v_exp_f32 v157, v157
v_mfma_f32_16x16x32_bf16 v[104:107], a[120:123], v[168:171], v[104:107]
ds_read_b64_tr_b16 a[98:99], v226 offset:18432
s_lshl_b32 s45, s40, 2
v_mfma_f32_16x16x32_bf16 v[112:115], a[120:123], v[176:179], v[112:115]
v_exp_f32 v158, v158
v_mfma_f32_16x16x32_bf16 v[120:123], a[120:123], v[184:187], v[120:123]
ds_read_b64_tr_b16 a[100:101], v227 offset:16384
v_cvt_pk_bf16_f32 v154, v156, v157
v_mfma_f32_16x16x32_bf16 v[100:103], a[124:127], v[160:163], v[100:103]
v_exp_f32 v159, v159
v_mfma_f32_16x16x32_bf16 v[108:111], a[124:127], v[168:171], v[108:111]
ds_read_b64_tr_b16 a[102:103], v227 offset:18432
v_cvt_pk_bf16_f32 v155, v158, v159
v_mfma_f32_16x16x32_bf16 v[116:119], a[124:127], v[176:179], v[116:119]
s_add_u32 s45, s45, 161024
v_mov_b32 v250, 161024
v_mfma_f32_16x16x32_bf16 v[124:127], a[124:127], v[184:187], v[124:127]
ds_read_b64_tr_b16 a[104:105], v228 offset:16384
v_mfma_f32_16x16x32_bf16 v[208:211], a[128:131], v[128:131], v[208:211]
ds_read_b64_tr_b16 a[106:107], v228 offset:18432
v_mov_b32 v251, s45
v_mfma_f32_16x16x32_bf16 v[212:215], a[128:131], v[136:139], v[212:215]
ds_read_b64_tr_b16 a[108:109], v229 offset:16384
v_mfma_f32_16x16x32_bf16 v[216:219], a[128:131], v[144:147], v[216:219]
ds_read_b64_tr_b16 a[110:111], v229 offset:18432
v_mfma_f32_16x16x32_bf16 v[220:223], a[128:131], v[152:155], v[220:223]
ds_read_b64_tr_b16 a[112:113], v226 offset:20480
s_waitcnt lgkmcnt(5)
v_mfma_f32_16x16x32_bf16 v[0:3], a[96:99], v[128:131], v[0:3]
ds_read_b64_tr_b16 a[114:115], v226 offset:22528
v_rcp_f32 v210, v208
v_mfma_f32_16x16x32_bf16 v[8:11], a[96:99], v[136:139], v[8:11]
ds_read_b64_tr_b16 a[116:117], v227 offset:20480
v_rcp_f32 v214, v212
v_mfma_f32_16x16x32_bf16 v[16:19], a[96:99], v[144:147], v[16:19]
ds_read_b64_tr_b16 a[118:119], v227 offset:22528
v_rcp_f32 v218, v216
v_mfma_f32_16x16x32_bf16 v[24:27], a[96:99], v[152:155], v[24:27]
ds_read_b64_tr_b16 a[120:121], v228 offset:20480
v_rcp_f32 v222, v220
v_mfma_f32_16x16x32_bf16 v[4:7], a[100:103], v[128:131], v[4:7]
ds_read_b64_tr_b16 a[122:123], v228 offset:22528
v_add_f32 v209, v208, v212
v_mfma_f32_16x16x32_bf16 v[12:15], a[100:103], v[136:139], v[12:15]
ds_read_b64_tr_b16 a[124:125], v229 offset:20480
v_add_f32 v213, v216, v220
v_mfma_f32_16x16x32_bf16 v[20:23], a[100:103], v[144:147], v[20:23]
ds_read_b64_tr_b16 a[126:127], v229 offset:22528
v_add_f32 v209, v209, v213
v_mfma_f32_16x16x32_bf16 v[28:31], a[100:103], v[152:155], v[28:31]
s_waitcnt lgkmcnt(6)
v_cmp_nge_f32 vcc, 0x5d800000, v209
v_mfma_f32_16x16x32_bf16 v[32:35], a[104:107], v[128:131], v[32:35]
v_add_u32 v226, s43, v225
v_xor_b32 v227, 32, v226
v_mfma_f32_16x16x32_bf16 v[40:43], a[104:107], v[136:139], v[40:43]
v_xor_b32 v228, 64, v226
v_xor_b32 v229, 96, v226
v_mfma_f32_16x16x32_bf16 v[48:51], a[104:107], v[144:147], v[48:51]
v_mov_b32 v209, vcc_lo
v_or_b32 v209, vcc_hi, v209
v_mfma_f32_16x16x32_bf16 v[56:59], a[104:107], v[152:155], v[56:59]
ds_write_b32 v251, v209
v_mul_f32 v0, v0, v210
v_mul_f32 v1, v1, v210
v_mfma_f32_16x16x32_bf16 v[36:39], a[108:111], v[128:131], v[36:39]
v_mul_f32 v2, v2, v210
v_mul_f32 v3, v3, v210
v_mul_f32 v4, v4, v210
v_mul_f32 v5, v5, v210
v_mfma_f32_16x16x32_bf16 v[44:47], a[108:111], v[136:139], v[44:47]
v_mul_f32 v6, v6, v210
v_mul_f32 v7, v7, v210
v_cvt_pk_bf16_f32 v0, v0, v1
v_mfma_f32_16x16x32_bf16 v[52:55], a[108:111], v[144:147], v[52:55]
v_cvt_pk_bf16_f32 v1, v2, v3
v_cvt_pk_bf16_f32 v2, v4, v5
v_cvt_pk_bf16_f32 v3, v6, v7
v_mfma_f32_16x16x32_bf16 v[60:63], a[108:111], v[152:155], v[60:63]
ds_write_b128 v246, v[0:3] offset:0
v_mul_f32 v8, v8, v214
v_mfma_f32_16x16x32_bf16 v[64:67], a[112:115], v[128:131], v[64:67]
v_mul_f32 v9, v9, v214
v_mul_f32 v10, v10, v214
v_mul_f32 v11, v11, v214
v_mul_f32 v12, v12, v214
v_mfma_f32_16x16x32_bf16 v[72:75], a[112:115], v[136:139], v[72:75]
ds_read_b64_tr_b16 v[160:161], v226 offset:0
v_mul_f32 v13, v13, v214
v_mul_f32 v14, v14, v214
v_mfma_f32_16x16x32_bf16 v[80:83], a[112:115], v[144:147], v[80:83]
v_mul_f32 v15, v15, v214
v_cvt_pk_bf16_f32 v8, v8, v9
v_cvt_pk_bf16_f32 v9, v10, v11
v_cvt_pk_bf16_f32 v10, v12, v13
v_mfma_f32_16x16x32_bf16 v[88:91], a[112:115], v[152:155], v[88:91]
ds_read_b64_tr_b16 v[162:163], v226 offset:2048
s_waitcnt lgkmcnt(4)
v_cvt_pk_bf16_f32 v11, v14, v15
v_mfma_f32_16x16x32_bf16 v[68:71], a[116:119], v[128:131], v[68:71]
ds_write_b128 v246, v[8:11] offset:1024
v_mul_f32 v16, v16, v218
v_mul_f32 v17, v17, v218
v_mul_f32 v18, v18, v218
v_mfma_f32_16x16x32_bf16 v[76:79], a[116:119], v[136:139], v[76:79]
ds_read_b64_tr_b16 v[164:165], v227 offset:0
v_mul_f32 v19, v19, v218
v_mul_f32 v20, v20, v218
v_mfma_f32_16x16x32_bf16 v[84:87], a[116:119], v[144:147], v[84:87]
v_mul_f32 v21, v21, v218
v_mul_f32 v22, v22, v218
v_mul_f32 v23, v23, v218
v_cvt_pk_bf16_f32 v16, v16, v17
v_mfma_f32_16x16x32_bf16 v[92:95], a[116:119], v[152:155], v[92:95]
ds_read_b64_tr_b16 v[166:167], v227 offset:2048
v_cvt_pk_bf16_f32 v17, v18, v19
v_mfma_f32_16x16x32_bf16 v[96:99], a[120:123], v[128:131], v[96:99]
v_cvt_pk_bf16_f32 v18, v20, v21
v_cvt_pk_bf16_f32 v19, v22, v23
v_mfma_f32_16x16x32_bf16 v[104:107], a[120:123], v[136:139], v[104:107]
ds_read_b64_tr_b16 v[168:169], v228 offset:0
ds_write_b128 v246, v[16:19] offset:2048
v_mul_f32 v24, v24, v222
v_mfma_f32_16x16x32_bf16 v[112:115], a[120:123], v[144:147], v[112:115]
v_mul_f32 v25, v25, v222
v_mul_f32 v26, v26, v222
v_mul_f32 v27, v27, v222
v_mul_f32 v28, v28, v222
v_mfma_f32_16x16x32_bf16 v[120:123], a[120:123], v[152:155], v[120:123]
ds_read_b64_tr_b16 v[170:171], v228 offset:2048
v_mul_f32 v29, v29, v222
v_mul_f32 v30, v30, v222
v_mfma_f32_16x16x32_bf16 v[100:103], a[124:127], v[128:131], v[100:103]
v_mul_f32 v31, v31, v222
v_cvt_pk_bf16_f32 v24, v24, v25
v_cvt_pk_bf16_f32 v25, v26, v27
v_cvt_pk_bf16_f32 v26, v28, v29
v_mfma_f32_16x16x32_bf16 v[108:111], a[124:127], v[136:139], v[108:111]
ds_read_b64_tr_b16 v[172:173], v229 offset:0
v_cvt_pk_bf16_f32 v27, v30, v31
v_mfma_f32_16x16x32_bf16 v[116:119], a[124:127], v[144:147], v[116:119]
ds_write_b128 v246, v[24:27] offset:3072
v_mfma_f32_16x16x32_bf16 v[124:127], a[124:127], v[152:155], v[124:127]
ds_read_b64_tr_b16 v[174:175], v229 offset:2048
v_pk_mul_f32 v[32:33], v[32:33], v[210:211] op_sel_hi:[1,0]
v_pk_mul_f32 v[34:35], v[34:35], v[210:211] op_sel_hi:[1,0]
v_pk_mul_f32 v[36:37], v[36:37], v[210:211] op_sel_hi:[1,0]
v_pk_mul_f32 v[38:39], v[38:39], v[210:211] op_sel_hi:[1,0]
v_cvt_pk_bf16_f32 v32, v32, v33
v_cvt_pk_bf16_f32 v33, v34, v35
v_cvt_pk_bf16_f32 v34, v36, v37
v_cvt_pk_bf16_f32 v35, v38, v39
ds_write_b128 v246, v[32:35] offset:4096
v_pk_mul_f32 v[40:41], v[40:41], v[214:215] op_sel_hi:[1,0]
v_pk_mul_f32 v[42:43], v[42:43], v[214:215] op_sel_hi:[1,0]
v_pk_mul_f32 v[44:45], v[44:45], v[214:215] op_sel_hi:[1,0]
v_pk_mul_f32 v[46:47], v[46:47], v[214:215] op_sel_hi:[1,0]
v_cvt_pk_bf16_f32 v40, v40, v41
v_cvt_pk_bf16_f32 v41, v42, v43
v_cvt_pk_bf16_f32 v42, v44, v45
v_cvt_pk_bf16_f32 v43, v46, v47
ds_write_b128 v246, v[40:43] offset:5120
v_pk_mul_f32 v[48:49], v[48:49], v[218:219] op_sel_hi:[1,0]
v_pk_mul_f32 v[50:51], v[50:51], v[218:219] op_sel_hi:[1,0]
v_pk_mul_f32 v[52:53], v[52:53], v[218:219] op_sel_hi:[1,0]
v_pk_mul_f32 v[54:55], v[54:55], v[218:219] op_sel_hi:[1,0]
v_cvt_pk_bf16_f32 v48, v48, v49
v_cvt_pk_bf16_f32 v49, v50, v51
v_cvt_pk_bf16_f32 v50, v52, v53
v_cvt_pk_bf16_f32 v51, v54, v55
ds_write_b128 v246, v[48:51] offset:6144
v_pk_mul_f32 v[56:57], v[56:57], v[222:223] op_sel_hi:[1,0]
v_pk_mul_f32 v[58:59], v[58:59], v[222:223] op_sel_hi:[1,0]
v_pk_mul_f32 v[60:61], v[60:61], v[222:223] op_sel_hi:[1,0]
v_pk_mul_f32 v[62:63], v[62:63], v[222:223] op_sel_hi:[1,0]
v_cvt_pk_bf16_f32 v56, v56, v57
v_cvt_pk_bf16_f32 v57, v58, v59
v_cvt_pk_bf16_f32 v58, v60, v61
v_cvt_pk_bf16_f32 v59, v62, v63
ds_write_b128 v246, v[56:59] offset:7168
s_waitcnt lgkmcnt(0)
s_barrier
ds_read_b128 a[128:131], v238 offset:0
ds_read_b128 a[132:135], v238 offset:1024
ds_read_b128 a[136:139], v239 offset:0
ds_read_b128 a[140:143], v239 offset:1024
s_waitcnt vmcnt(12) lgkmcnt(0)
v_mfma_f32_16x16x32_bf16 v[0:3], v[160:163], a[128:131], 0
ds_read_b128 a[144:147], v238 offset:4096
v_mfma_f32_16x16x32_bf16 v[8:11], v[160:163], a[132:135], 0
ds_read_b64_tr_b16 v[176:177], v226 offset:4096
ds_read_b128 v[192:195], v250
v_mfma_f32_16x16x32_bf16 v[16:19], v[160:163], a[136:139], 0
ds_read_b128 a[148:151], v238 offset:5120
v_mul_f32 v64, v64, v210
v_mfma_f32_16x16x32_bf16 v[24:27], v[160:163], a[140:143], 0
ds_read_b64_tr_b16 v[178:179], v226 offset:6144
s_add_u32 m0, s43, 0
v_mfma_f32_16x16x32_bf16 v[4:7], v[164:167], a[128:131], 0
ds_read_b128 a[152:155], v239 offset:4096
v_mul_f32 v65, v65, v210
v_mfma_f32_16x16x32_bf16 v[12:15], v[164:167], a[132:135], 0
ds_read_b64_tr_b16 v[180:181], v227 offset:4096
s_add_u32 s44, s59, 331776
v_mfma_f32_16x16x32_bf16 v[20:23], v[164:167], a[136:139], 0
ds_read_b128 a[156:159], v239 offset:5120
v_mul_f32 v66, v66, v210
v_mfma_f32_16x16x32_bf16 v[28:31], v[164:167], a[140:143], 0
ds_read_b64_tr_b16 v[182:183], v227 offset:6144
v_mfma_f32_16x16x32_bf16 v[32:35], v[168:171], a[128:131], 0
s_waitcnt lgkmcnt(6)
v_or3_b32 v192, v192, v193, v194
v_mul_f32 v67, v67, v210
v_mfma_f32_16x16x32_bf16 v[40:43], v[168:171], a[132:135], 0
ds_read_b64_tr_b16 v[184:185], v228 offset:4096
buffer_load_dwordx4 v230, s[32:35], s44 offen offset:0 lds
v_mfma_f32_16x16x32_bf16 v[48:51], v[168:171], a[136:139], 0
v_or_b32 v192, v192, v195
v_mul_f32 v68, v68, v210
v_mfma_f32_16x16x32_bf16 v[56:59], v[168:171], a[140:143], 0
ds_read_b64_tr_b16 v[186:187], v228 offset:6144
buffer_load_dwordx4 v231, s[32:35], s44 offen offset:1024 lds
v_readfirstlane_b32 s45, v192
v_mfma_f32_16x16x32_bf16 v[36:39], v[172:175], a[128:131], 0
v_mul_f32 v69, v69, v210
v_mul_f32 v70, v70, v210
v_mfma_f32_16x16x32_bf16 v[44:47], v[172:175], a[132:135], 0
ds_read_b64_tr_b16 v[188:189], v229 offset:4096
buffer_load_dwordx4 v232, s[32:35], s44 offen offset:2048 lds
v_mfma_f32_16x16x32_bf16 v[52:55], v[172:175], a[136:139], 0
v_mul_f32 v71, v71, v210
v_cvt_pk_bf16_f32 v64, v64, v65
v_mfma_f32_16x16x32_bf16 v[60:63], v[172:175], a[140:143], 0
ds_read_b64_tr_b16 v[190:191], v229 offset:6144
s_waitcnt vmcnt(11) lgkmcnt(4)
v_mfma_f32_16x16x32_bf16 v[0:3], v[176:179], a[144:147], v[0:3]
s_and_b32 s45, s45, s53
s_cbranch_scc1 FALLBACK
ds_read_b128 a[160:163], v238 offset:8192
v_mfma_f32_16x16x32_bf16 v[8:11], v[176:179], a[148:151], v[8:11]
ds_read_b64_tr_b16 v[160:161], v226 offset:8192
buffer_load_dwordx4 v233, s[32:35], s44 offen offset:3072 lds
v_mfma_f32_16x16x32_bf16 v[16:19], v[176:179], a[152:155], v[16:19]
ds_read_b128 a[164:167], v238 offset:9216
v_cvt_pk_bf16_f32 v65, v66, v67
v_mfma_f32_16x16x32_bf16 v[24:27], v[176:179], a[156:159], v[24:27]
ds_read_b64_tr_b16 v[162:163], v226 offset:10240
s_add_u32 m0, s43, 4096
v_mfma_f32_16x16x32_bf16 v[4:7], v[180:183], a[144:147], v[4:7]
ds_read_b128 a[168:171], v239 offset:8192
v_cvt_pk_bf16_f32 v66, v68, v69
v_mfma_f32_16x16x32_bf16 v[12:15], v[180:183], a[148:151], v[12:15]
ds_read_b64_tr_b16 v[164:165], v227 offset:8192
s_add_u32 s44, s59, 442368
v_mfma_f32_16x16x32_bf16 v[20:23], v[180:183], a[152:155], v[20:23]
ds_read_b128 a[172:175], v239 offset:9216
v_cvt_pk_bf16_f32 v67, v70, v71
v_mfma_f32_16x16x32_bf16 v[28:31], v[180:183], a[156:159], v[28:31]
ds_read_b64_tr_b16 v[166:167], v227 offset:10240
s_waitcnt lgkmcnt(8)
v_mfma_f32_16x16x32_bf16 v[32:35], v[184:187], a[144:147], v[32:35]
ds_write_b128 v246, v[64:67] offset:32768
v_mul_f32 v72, v72, v214
v_mfma_f32_16x16x32_bf16 v[40:43], v[184:187], a[148:151], v[40:43]
ds_read_b64_tr_b16 v[168:169], v228 offset:8192
buffer_load_dwordx4 v230, s[32:35], s44 offen offset:0 lds
v_mfma_f32_16x16x32_bf16 v[48:51], v[184:187], a[152:155], v[48:51]
v_mul_f32 v73, v73, v214
v_mul_f32 v74, v74, v214
v_mfma_f32_16x16x32_bf16 v[56:59], v[184:187], a[156:159], v[56:59]
ds_read_b64_tr_b16 v[170:171], v228 offset:10240
buffer_load_dwordx4 v231, s[32:35], s44 offen offset:1024 lds
v_mfma_f32_16x16x32_bf16 v[36:39], v[188:191], a[144:147], v[36:39]
v_mul_f32 v75, v75, v214
v_mul_f32 v76, v76, v214
v_mfma_f32_16x16x32_bf16 v[44:47], v[188:191], a[148:151], v[44:47]
ds_read_b64_tr_b16 v[172:173], v229 offset:8192
buffer_load_dwordx4 v232, s[32:35], s44 offen offset:2048 lds
v_mfma_f32_16x16x32_bf16 v[52:55], v[188:191], a[152:155], v[52:55]
v_mul_f32 v77, v77, v214
v_mul_f32 v78, v78, v214
v_mfma_f32_16x16x32_bf16 v[60:63], v[188:191], a[156:159], v[60:63]
ds_read_b64_tr_b16 v[174:175], v229 offset:10240
s_waitcnt vmcnt(11) lgkmcnt(5)
v_mfma_f32_16x16x32_bf16 v[0:3], v[160:163], a[160:163], v[0:3]
ds_read_b128 a[176:179], v238 offset:12288
v_mul_f32 v79, v79, v214
v_mfma_f32_16x16x32_bf16 v[8:11], v[160:163], a[164:167], v[8:11]
ds_read_b64_tr_b16 v[176:177], v226 offset:12288
buffer_load_dwordx4 v233, s[32:35], s44 offen offset:3072 lds
v_mfma_f32_16x16x32_bf16 v[16:19], v[160:163], a[168:171], v[16:19]
ds_read_b128 a[180:183], v238 offset:13312
v_cvt_pk_bf16_f32 v72, v72, v73
v_mfma_f32_16x16x32_bf16 v[24:27], v[160:163], a[172:175], v[24:27]
ds_read_b64_tr_b16 v[178:179], v226 offset:14336
s_add_u32 m0, s43, 8192
v_mfma_f32_16x16x32_bf16 v[4:7], v[164:167], a[160:163], v[4:7]
ds_read_b128 a[184:187], v239 offset:12288
v_cvt_pk_bf16_f32 v73, v74, v75
v_mfma_f32_16x16x32_bf16 v[12:15], v[164:167], a[164:167], v[12:15]
ds_read_b64_tr_b16 v[180:181], v227 offset:12288
s_add_u32 s44, s59, 479232
v_mfma_f32_16x16x32_bf16 v[20:23], v[164:167], a[168:171], v[20:23]
ds_read_b128 a[188:191], v239 offset:13312
v_cvt_pk_bf16_f32 v74, v76, v77
v_mfma_f32_16x16x32_bf16 v[28:31], v[164:167], a[172:175], v[28:31]
ds_read_b64_tr_b16 v[182:183], v227 offset:14336
s_waitcnt lgkmcnt(8)
v_mfma_f32_16x16x32_bf16 v[32:35], v[168:171], a[160:163], v[32:35]
v_cvt_pk_bf16_f32 v75, v78, v79
v_mfma_f32_16x16x32_bf16 v[40:43], v[168:171], a[164:167], v[40:43]
ds_read_b64_tr_b16 v[184:185], v228 offset:12288
buffer_load_dwordx4 v230, s[32:35], s44 offen offset:0 lds
v_mfma_f32_16x16x32_bf16 v[48:51], v[168:171], a[168:171], v[48:51]
ds_write_b128 v246, v[72:75] offset:33792
v_mul_f32 v80, v80, v218
v_mfma_f32_16x16x32_bf16 v[56:59], v[168:171], a[172:175], v[56:59]
ds_read_b64_tr_b16 v[186:187], v228 offset:14336
buffer_load_dwordx4 v231, s[32:35], s44 offen offset:1024 lds
v_mfma_f32_16x16x32_bf16 v[36:39], v[172:175], a[160:163], v[36:39]
v_mul_f32 v81, v81, v218
v_mul_f32 v82, v82, v218
v_mfma_f32_16x16x32_bf16 v[44:47], v[172:175], a[164:167], v[44:47]
ds_read_b64_tr_b16 v[188:189], v229 offset:12288
buffer_load_dwordx4 v232, s[32:35], s44 offen offset:2048 lds
v_mfma_f32_16x16x32_bf16 v[52:55], v[172:175], a[168:171], v[52:55]
v_mul_f32 v83, v83, v218
v_mul_f32 v84, v84, v218
v_mfma_f32_16x16x32_bf16 v[60:63], v[172:175], a[172:175], v[60:63]
ds_read_b64_tr_b16 v[190:191], v229 offset:14336
s_waitcnt vmcnt(11) lgkmcnt(5)
v_mfma_f32_16x16x32_bf16 v[0:3], v[176:179], a[176:179], v[0:3]
ds_read_b128 a[192:195], v238 offset:16384
v_mul_f32 v85, v85, v218
v_mfma_f32_16x16x32_bf16 v[8:11], v[176:179], a[180:183], v[8:11]
ds_read_b64_tr_b16 v[160:161], v226 offset:16384
buffer_load_dwordx4 v233, s[32:35], s44 offen offset:3072 lds
v_mfma_f32_16x16x32_bf16 v[16:19], v[176:179], a[184:187], v[16:19]
ds_read_b128 a[196:199], v238 offset:17408
v_mul_f32 v86, v86, v218
v_mfma_f32_16x16x32_bf16 v[24:27], v[176:179], a[188:191], v[24:27]
ds_read_b64_tr_b16 v[162:163], v226 offset:18432
s_add_u32 m0, s43, 12288
v_mfma_f32_16x16x32_bf16 v[4:7], v[180:183], a[176:179], v[4:7]
ds_read_b128 a[200:203], v239 offset:16384
v_mul_f32 v87, v87, v218
v_mfma_f32_16x16x32_bf16 v[12:15], v[180:183], a[180:183], v[12:15]
ds_read_b64_tr_b16 v[164:165], v227 offset:16384
s_add_u32 s44, s59, 73728
v_mfma_f32_16x16x32_bf16 v[20:23], v[180:183], a[184:187], v[20:23]
ds_read_b128 a[204:207], v239 offset:17408
v_cvt_pk_bf16_f32 v80, v80, v81
v_mfma_f32_16x16x32_bf16 v[28:31], v[180:183], a[188:191], v[28:31]
ds_read_b64_tr_b16 v[166:167], v227 offset:18432
s_waitcnt lgkmcnt(8)
v_mfma_f32_16x16x32_bf16 v[32:35], v[184:187], a[176:179], v[32:35]
v_cvt_pk_bf16_f32 v81, v82, v83
v_cvt_pk_bf16_f32 v82, v84, v85
v_mfma_f32_16x16x32_bf16 v[40:43], v[184:187], a[180:183], v[40:43]
ds_read_b64_tr_b16 v[168:169], v228 offset:16384
buffer_load_dwordx4 v230, s[32:35], s44 offen offset:0 lds
v_mfma_f32_16x16x32_bf16 v[48:51], v[184:187], a[184:187], v[48:51]
v_cvt_pk_bf16_f32 v83, v86, v87
v_mfma_f32_16x16x32_bf16 v[56:59], v[184:187], a[188:191], v[56:59]
ds_read_b64_tr_b16 v[170:171], v228 offset:18432
buffer_load_dwordx4 v231, s[32:35], s44 offen offset:1024 lds
v_mfma_f32_16x16x32_bf16 v[36:39], v[188:191], a[176:179], v[36:39]
ds_write_b128 v246, v[80:83] offset:34816
v_mul_f32 v88, v88, v222
v_mfma_f32_16x16x32_bf16 v[44:47], v[188:191], a[180:183], v[44:47]
ds_read_b64_tr_b16 v[172:173], v229 offset:16384
buffer_load_dwordx4 v232, s[32:35], s44 offen offset:2048 lds
v_mfma_f32_16x16x32_bf16 v[52:55], v[188:191], a[184:187], v[52:55]
v_mul_f32 v89, v89, v222
v_mul_f32 v90, v90, v222
v_mfma_f32_16x16x32_bf16 v[60:63], v[188:191], a[188:191], v[60:63]
ds_read_b64_tr_b16 v[174:175], v229 offset:18432
s_waitcnt vmcnt(11) lgkmcnt(5)
v_mfma_f32_16x16x32_bf16 v[0:3], v[160:163], a[192:195], v[0:3]
ds_read_b128 a[208:211], v238 offset:20480
v_mul_f32 v91, v91, v222
v_mfma_f32_16x16x32_bf16 v[8:11], v[160:163], a[196:199], v[8:11]
ds_read_b64_tr_b16 v[176:177], v226 offset:0
buffer_load_dwordx4 v233, s[32:35], s44 offen offset:3072 lds
v_mfma_f32_16x16x32_bf16 v[16:19], v[160:163], a[200:203], v[16:19]
ds_read_b128 a[212:215], v238 offset:21504
v_mul_f32 v92, v92, v222
v_mfma_f32_16x16x32_bf16 v[24:27], v[160:163], a[204:207], v[24:27]
ds_read_b64_tr_b16 v[178:179], v226 offset:2048
s_add_u32 m0, s43, 16384
v_mfma_f32_16x16x32_bf16 v[4:7], v[164:167], a[192:195], v[4:7]
ds_read_b128 a[216:219], v239 offset:20480
v_mul_f32 v93, v93, v222
v_mfma_f32_16x16x32_bf16 v[12:15], v[164:167], a[196:199], v[12:15]
ds_read_b64_tr_b16 v[180:181], v227 offset:0
s_add_u32 s44, s59, 110592
v_mfma_f32_16x16x32_bf16 v[20:23], v[164:167], a[200:203], v[20:23]
ds_read_b128 a[220:223], v239 offset:21504
v_mul_f32 v94, v94, v222
v_mfma_f32_16x16x32_bf16 v[28:31], v[164:167], a[204:207], v[28:31]
ds_read_b64_tr_b16 v[182:183], v227 offset:2048
s_waitcnt lgkmcnt(8)
v_mfma_f32_16x16x32_bf16 v[32:35], v[168:171], a[192:195], v[32:35]
v_mul_f32 v95, v95, v222
v_cvt_pk_bf16_f32 v88, v88, v89
v_mfma_f32_16x16x32_bf16 v[40:43], v[168:171], a[196:199], v[40:43]
ds_read_b64_tr_b16 v[184:185], v228 offset:0
buffer_load_dwordx4 v230, s[32:35], s44 offen offset:0 lds
v_mfma_f32_16x16x32_bf16 v[48:51], v[168:171], a[200:203], v[48:51]
v_cvt_pk_bf16_f32 v89, v90, v91
v_cvt_pk_bf16_f32 v90, v92, v93
v_mfma_f32_16x16x32_bf16 v[56:59], v[168:171], a[204:207], v[56:59]
ds_read_b64_tr_b16 v[186:187], v228 offset:2048
buffer_load_dwordx4 v231, s[32:35], s44 offen offset:1024 lds
v_mfma_f32_16x16x32_bf16 v[36:39], v[172:175], a[192:195], v[36:39]
v_cvt_pk_bf16_f32 v91, v94, v95
v_mfma_f32_16x16x32_bf16 v[44:47], v[172:175], a[196:199], v[44:47]
ds_read_b64_tr_b16 v[188:189], v229 offset:0
buffer_load_dwordx4 v232, s[32:35], s44 offen offset:2048 lds
v_mfma_f32_16x16x32_bf16 v[52:55], v[172:175], a[200:203], v[52:55]
ds_write_b128 v246, v[88:91] offset:35840
v_mul_f32 v96, v96, v210
v_mfma_f32_16x16x32_bf16 v[60:63], v[172:175], a[204:207], v[60:63]
ds_read_b64_tr_b16 v[190:191], v229 offset:2048
s_waitcnt vmcnt(11) lgkmcnt(5)
v_mfma_f32_16x16x32_bf16 v[0:3], v[176:179], a[208:211], v[0:3]
ds_read_b128 a[224:227], v238 offset:24576
v_mul_f32 v97, v97, v210
v_mfma_f32_16x16x32_bf16 v[8:11], v[176:179], a[212:215], v[8:11]
ds_read_b64_tr_b16 v[160:161], v226 offset:4096
buffer_load_dwordx4 v233, s[32:35], s44 offen offset:3072 lds
v_mfma_f32_16x16x32_bf16 v[16:19], v[176:179], a[216:219], v[16:19]
ds_read_b128 a[228:231], v238 offset:25600
v_mul_f32 v98, v98, v210
v_mfma_f32_16x16x32_bf16 v[24:27], v[176:179], a[220:223], v[24:27]
ds_read_b64_tr_b16 v[162:163], v226 offset:6144
s_add_u32 m0, s43, 0
v_mfma_f32_16x16x32_bf16 v[4:7], v[180:183], a[208:211], v[4:7]
ds_read_b128 a[232:235], v239 offset:24576
v_mul_f32 v99, v99, v210
v_mfma_f32_16x16x32_bf16 v[12:15], v[180:183], a[212:215], v[12:15]
ds_read_b64_tr_b16 v[164:165], v227 offset:4096
s_add_u32 s44, s59, 221184
v_mfma_f32_16x16x32_bf16 v[20:23], v[180:183], a[216:219], v[20:23]
ds_read_b128 a[236:239], v239 offset:25600
v_mul_f32 v100, v100, v210
v_mfma_f32_16x16x32_bf16 v[28:31], v[180:183], a[220:223], v[28:31]
ds_read_b64_tr_b16 v[166:167], v227 offset:6144
s_waitcnt lgkmcnt(8)
v_mfma_f32_16x16x32_bf16 v[32:35], v[184:187], a[208:211], v[32:35]
v_mul_f32 v101, v101, v210
v_mul_f32 v102, v102, v210
v_mfma_f32_16x16x32_bf16 v[40:43], v[184:187], a[212:215], v[40:43]
ds_read_b64_tr_b16 v[168:169], v228 offset:4096
buffer_load_dwordx4 v230, s[32:35], s44 offen offset:0 lds
v_mfma_f32_16x16x32_bf16 v[48:51], v[184:187], a[216:219], v[48:51]
v_mul_f32 v103, v103, v210
v_cvt_pk_bf16_f32 v96, v96, v97
v_mfma_f32_16x16x32_bf16 v[56:59], v[184:187], a[220:223], v[56:59]
ds_read_b64_tr_b16 v[170:171], v228 offset:6144
buffer_load_dwordx4 v231, s[32:35], s44 offen offset:1024 lds
v_mfma_f32_16x16x32_bf16 v[36:39], v[188:191], a[208:211], v[36:39]
v_cvt_pk_bf16_f32 v97, v98, v99
v_cvt_pk_bf16_f32 v98, v100, v101
v_mfma_f32_16x16x32_bf16 v[44:47], v[188:191], a[212:215], v[44:47]
ds_read_b64_tr_b16 v[172:173], v229 offset:4096
buffer_load_dwordx4 v232, s[32:35], s44 offen offset:2048 lds
v_mfma_f32_16x16x32_bf16 v[52:55], v[188:191], a[216:219], v[52:55]
v_cvt_pk_bf16_f32 v99, v102, v103
v_mfma_f32_16x16x32_bf16 v[60:63], v[188:191], a[220:223], v[60:63]
ds_read_b64_tr_b16 v[174:175], v229 offset:6144
s_waitcnt vmcnt(11) lgkmcnt(4)
v_mfma_f32_16x16x32_bf16 v[0:3], v[160:163], a[224:227], v[0:3]
ds_write_b128 v246, v[96:99] offset:36864
ds_read_b128 a[240:243], v238 offset:28672
v_mfma_f32_16x16x32_bf16 v[8:11], v[160:163], a[228:231], v[8:11]
ds_read_b64_tr_b16 v[176:177], v226 offset:8192
buffer_load_dwordx4 v233, s[32:35], s44 offen offset:3072 lds
v_mfma_f32_16x16x32_bf16 v[16:19], v[160:163], a[232:235], v[16:19]
ds_read_b128 a[244:247], v238 offset:29696
v_mul_f32 v104, v104, v214
v_mfma_f32_16x16x32_bf16 v[24:27], v[160:163], a[236:239], v[24:27]
ds_read_b64_tr_b16 v[178:179], v226 offset:10240
s_add_u32 m0, s43, 4096
v_mfma_f32_16x16x32_bf16 v[4:7], v[164:167], a[224:227], v[4:7]
ds_read_b128 a[248:251], v239 offset:28672
v_mul_f32 v105, v105, v214
v_mfma_f32_16x16x32_bf16 v[12:15], v[164:167], a[228:231], v[12:15]
ds_read_b64_tr_b16 v[180:181], v227 offset:8192
s_add_u32 s44, s59, 258048
v_mfma_f32_16x16x32_bf16 v[20:23], v[164:167], a[232:235], v[20:23]
ds_read_b128 a[252:255], v239 offset:29696
v_mul_f32 v106, v106, v214
v_mul_f32 v107, v107, v214
v_mul_f32 v108, v108, v214
v_mul_f32 v109, v109, v214
v_mul_f32 v110, v110, v214
v_mul_f32 v111, v111, v214
v_cvt_pk_bf16_f32 v104, v104, v105
v_cvt_pk_bf16_f32 v105, v106, v107
v_cvt_pk_bf16_f32 v106, v108, v109
v_cvt_pk_bf16_f32 v107, v110, v111
v_mfma_f32_16x16x32_bf16 v[28:31], v[164:167], a[236:239], v[28:31]
ds_read_b64_tr_b16 v[182:183], v227 offset:10240
ds_write_b128 v246, v[104:107] offset:37888
s_waitcnt lgkmcnt(10)
v_mul_f32 v112, v112, v218
v_mul_f32 v113, v113, v218
v_mul_f32 v114, v114, v218
v_mul_f32 v115, v115, v218
v_mul_f32 v116, v116, v218
v_mul_f32 v117, v117, v218
v_mul_f32 v118, v118, v218
v_mul_f32 v119, v119, v218
v_cvt_pk_bf16_f32 v112, v112, v113
v_cvt_pk_bf16_f32 v113, v114, v115
v_cvt_pk_bf16_f32 v114, v116, v117
v_cvt_pk_bf16_f32 v115, v118, v119
v_mfma_f32_16x16x32_bf16 v[32:35], v[168:171], a[224:227], v[32:35]
ds_write_b128 v246, v[112:115] offset:38912
v_mul_f32 v120, v120, v222
v_mul_f32 v121, v121, v222
v_mul_f32 v122, v122, v222
v_mul_f32 v123, v123, v222
v_mul_f32 v124, v124, v222
v_mul_f32 v125, v125, v222
v_mul_f32 v126, v126, v222
v_mul_f32 v127, v127, v222
v_cvt_pk_bf16_f32 v120, v120, v121
v_cvt_pk_bf16_f32 v121, v122, v123
v_cvt_pk_bf16_f32 v122, v124, v125
v_cvt_pk_bf16_f32 v123, v126, v127
v_mfma_f32_16x16x32_bf16 v[40:43], v[168:171], a[228:231], v[40:43]
ds_read_b64_tr_b16 v[184:185], v228 offset:8192
buffer_load_dwordx4 v230, s[32:35], s44 offen offset:0 lds
ds_write_b128 v246, v[120:123] offset:39936
v_mfma_f32_16x16x32_bf16 v[48:51], v[168:171], a[232:235], v[48:51]
v_mfma_f32_16x16x32_bf16 v[56:59], v[168:171], a[236:239], v[56:59]
ds_read_b64_tr_b16 v[186:187], v228 offset:10240
buffer_load_dwordx4 v231, s[32:35], s44 offen offset:1024 lds
v_mfma_f32_16x16x32_bf16 v[36:39], v[172:175], a[224:227], v[36:39]
v_mfma_f32_16x16x32_bf16 v[44:47], v[172:175], a[228:231], v[44:47]
ds_read_b64_tr_b16 v[188:189], v229 offset:8192
buffer_load_dwordx4 v232, s[32:35], s44 offen offset:2048 lds
v_mfma_f32_16x16x32_bf16 v[52:55], v[172:175], a[232:235], v[52:55]
v_mfma_f32_16x16x32_bf16 v[60:63], v[172:175], a[236:239], v[60:63]
ds_read_b64_tr_b16 v[190:191], v229 offset:10240
s_waitcnt vmcnt(11) lgkmcnt(7)
s_waitcnt lgkmcnt(3)
s_barrier
v_mfma_f32_16x16x32_bf16 v[0:3], v[176:179], a[240:243], v[0:3]
ds_read_b128 a[0:3], v238 offset:32768
v_mfma_f32_16x16x32_bf16 v[8:11], v[176:179], a[244:247], v[8:11]
ds_read_b64_tr_b16 v[160:161], v226 offset:12288
buffer_load_dwordx4 v233, s[32:35], s44 offen offset:3072 lds
v_mfma_f32_16x16x32_bf16 v[16:19], v[176:179], a[248:251], v[16:19]
ds_read_b128 a[4:7], v238 offset:33792
v_mfma_f32_16x16x32_bf16 v[24:27], v[176:179], a[252:255], v[24:27]
ds_read_b64_tr_b16 v[162:163], v226 offset:14336
s_add_u32 m0, s43, 8192
v_mfma_f32_16x16x32_bf16 v[4:7], v[180:183], a[240:243], v[4:7]
ds_read_b128 a[8:11], v239 offset:32768
v_mfma_f32_16x16x32_bf16 v[12:15], v[180:183], a[244:247], v[12:15]
ds_read_b64_tr_b16 v[164:165], v227 offset:12288
s_add_u32 s44, s59, 368640
v_mfma_f32_16x16x32_bf16 v[20:23], v[180:183], a[248:251], v[20:23]
ds_read_b128 a[12:15], v239 offset:33792
v_mfma_f32_16x16x32_bf16 v[28:31], v[180:183], a[252:255], v[28:31]
ds_read_b64_tr_b16 v[166:167], v227 offset:14336
s_waitcnt lgkmcnt(8)
v_mfma_f32_16x16x32_bf16 v[32:35], v[184:187], a[240:243], v[32:35]
s_cmp_lt_u32 s40, 2
s_cselect_b32 s88, s72, s76
s_cselect_b32 s89, s73, s77
v_mfma_f32_16x16x32_bf16 v[40:43], v[184:187], a[244:247], v[40:43]
ds_read_b64_tr_b16 v[168:169], v228 offset:12288
buffer_load_dwordx4 v230, s[32:35], s44 offen offset:0 lds
v_mfma_f32_16x16x32_bf16 v[48:51], v[184:187], a[248:251], v[48:51]
v_lshrrev_b32 v250, 7, v224
v_mfma_f32_16x16x32_bf16 v[56:59], v[184:187], a[252:255], v[56:59]
ds_read_b64_tr_b16 v[170:171], v228 offset:14336
buffer_load_dwordx4 v231, s[32:35], s44 offen offset:1024 lds
v_mfma_f32_16x16x32_bf16 v[36:39], v[188:191], a[240:243], v[36:39]
v_mfma_f32_16x16x32_bf16 v[44:47], v[188:191], a[244:247], v[44:47]
ds_read_b64_tr_b16 v[172:173], v229 offset:12288
buffer_load_dwordx4 v232, s[32:35], s44 offen offset:2048 lds
v_mfma_f32_16x16x32_bf16 v[52:55], v[188:191], a[248:251], v[52:55]
v_mul_u32_u24 v250, 9216, v250
v_mfma_f32_16x16x32_bf16 v[60:63], v[188:191], a[252:255], v[60:63]
ds_read_b64_tr_b16 v[174:175], v229 offset:14336
s_waitcnt vmcnt(11) lgkmcnt(4)
v_mfma_f32_16x16x32_bf16 v[0:3], v[160:163], a[0:3], v[0:3]
ds_read_b128 a[16:19], v238 offset:36864
v_bfe_u32 v251, v224, 8, 2
v_mfma_f32_16x16x32_bf16 v[8:11], v[160:163], a[4:7], v[8:11]
ds_read_b64_tr_b16 v[176:177], v226 offset:16384
buffer_load_dwordx4 v233, s[32:35], s44 offen offset:3072 lds
v_mfma_f32_16x16x32_bf16 v[16:19], v[160:163], a[8:11], v[16:19]
ds_read_b128 a[20:23], v238 offset:37888
v_mfma_f32_16x16x32_bf16 v[24:27], v[160:163], a[12:15], v[24:27]
ds_read_b64_tr_b16 v[178:179], v226 offset:18432
s_add_u32 m0, s43, 12288
v_mfma_f32_16x16x32_bf16 v[4:7], v[164:167], a[0:3], v[4:7]
ds_read_b128 a[24:27], v239 offset:36864
v_lshlrev_b32 v251, 5, v251
v_mfma_f32_16x16x32_bf16 v[12:15], v[164:167], a[4:7], v[12:15]
ds_read_b64_tr_b16 v[180:181], v227 offset:16384
s_add_u32 s44, s59, 405504
v_mfma_f32_16x16x32_bf16 v[20:23], v[164:167], a[8:11], v[20:23]
ds_read_b128 a[28:31], v239 offset:37888
v_xor_b32 v251, v251, v224
v_mfma_f32_16x16x32_bf16 v[28:31], v[164:167], a[12:15], v[28:31]
ds_read_b64_tr_b16 v[182:183], v227 offset:18432
s_waitcnt lgkmcnt(8)
v_mfma_f32_16x16x32_bf16 v[32:35], v[168:171], a[0:3], v[32:35]
v_mfma_f32_16x16x32_bf16 v[40:43], v[168:171], a[4:7], v[40:43]
ds_read_b64_tr_b16 v[184:185], v228 offset:16384
buffer_load_dwordx4 v230, s[32:35], s44 offen offset:0 lds
v_mfma_f32_16x16x32_bf16 v[48:51], v[168:171], a[8:11], v[48:51]
v_and_b32 v251, 0x70, v251
v_mfma_f32_16x16x32_bf16 v[56:59], v[168:171], a[12:15], v[56:59]
ds_read_b64_tr_b16 v[186:187], v228 offset:18432
buffer_load_dwordx4 v231, s[32:35], s44 offen offset:1024 lds
v_mfma_f32_16x16x32_bf16 v[36:39], v[172:175], a[0:3], v[36:39]
v_add_u32 v234, v250, v251
v_mfma_f32_16x16x32_bf16 v[44:47], v[172:175], a[4:7], v[44:47]
ds_read_b64_tr_b16 v[188:189], v229 offset:16384
buffer_load_dwordx4 v232, s[32:35], s44 offen offset:2048 lds
v_mfma_f32_16x16x32_bf16 v[52:55], v[172:175], a[8:11], v[52:55]
v_mfma_f32_16x16x32_bf16 v[60:63], v[172:175], a[12:15], v[60:63]
ds_read_b64_tr_b16 v[190:191], v229 offset:18432
s_waitcnt vmcnt(11) lgkmcnt(4)
v_mfma_f32_16x16x32_bf16 v[0:3], v[176:179], a[16:19], v[0:3]
ds_read_b128 a[32:35], v238 offset:40960
v_add_u32 v235, 72704, v234
v_mfma_f32_16x16x32_bf16 v[8:11], v[176:179], a[20:23], v[8:11]
ds_read_b64_tr_b16 v[160:161], v226 offset:0
buffer_load_dwordx4 v233, s[32:35], s44 offen offset:3072 lds
v_mfma_f32_16x16x32_bf16 v[16:19], v[176:179], a[24:27], v[16:19]
ds_read_b128 a[36:39], v238 offset:41984
v_add_u32 v236, 145408, v234
v_mfma_f32_16x16x32_bf16 v[24:27], v[176:179], a[28:31], v[24:27]
ds_read_b64_tr_b16 v[162:163], v226 offset:2048
s_add_u32 m0, s43, 16384
v_mfma_f32_16x16x32_bf16 v[4:7], v[180:183], a[16:19], v[4:7]
ds_read_b128 a[40:43], v239 offset:40960
v_mfma_f32_16x16x32_bf16 v[12:15], v[180:183], a[20:23], v[12:15]
ds_read_b64_tr_b16 v[164:165], v227 offset:0
s_add_u32 s44, s59, 516096
v_mfma_f32_16x16x32_bf16 v[20:23], v[180:183], a[24:27], v[20:23]
ds_read_b128 a[44:47], v239 offset:41984
v_add_u32 v237, 145408, v235
v_mfma_f32_16x16x32_bf16 v[28:31], v[180:183], a[28:31], v[28:31]
ds_read_b64_tr_b16 v[166:167], v227 offset:2048
s_waitcnt lgkmcnt(8)
v_mfma_f32_16x16x32_bf16 v[32:35], v[184:187], a[16:19], v[32:35]
s_mul_i32 s50, s42, 1152
v_mfma_f32_16x16x32_bf16 v[40:43], v[184:187], a[20:23], v[40:43]
ds_read_b64_tr_b16 v[168:169], v228 offset:0
buffer_load_dwordx4 v230, s[32:35], s44 offen offset:0 lds
v_mfma_f32_16x16x32_bf16 v[48:51], v[184:187], a[24:27], v[48:51]
v_mfma_f32_16x16x32_bf16 v[56:59], v[184:187], a[28:31], v[56:59]
ds_read_b64_tr_b16 v[170:171], v228 offset:2048
buffer_load_dwordx4 v231, s[32:35], s44 offen offset:1024 lds
v_mfma_f32_16x16x32_bf16 v[36:39], v[188:191], a[16:19], v[36:39]
s_and_b32 s45, s40, 1
v_mfma_f32_16x16x32_bf16 v[44:47], v[188:191], a[20:23], v[44:47]
ds_read_b64_tr_b16 v[172:173], v229 offset:0
buffer_load_dwordx4 v232, s[32:35], s44 offen offset:2048 lds
v_mfma_f32_16x16x32_bf16 v[52:55], v[188:191], a[24:27], v[52:55]
v_mfma_f32_16x16x32_bf16 v[60:63], v[188:191], a[28:31], v[60:63]
ds_read_b64_tr_b16 v[174:175], v229 offset:2048
s_waitcnt vmcnt(11) lgkmcnt(4)
v_mfma_f32_16x16x32_bf16 v[0:3], v[160:163], a[32:35], v[0:3]
s_mul_i32 s45, s45, 294912
ds_read_b128 a[48:51], v238 offset:45056
v_mfma_f32_16x16x32_bf16 v[8:11], v[160:163], a[36:39], v[8:11]
ds_read_b64_tr_b16 v[176:177], v226 offset:4096
buffer_load_dwordx4 v233, s[32:35], s44 offen offset:3072 lds
v_mfma_f32_16x16x32_bf16 v[16:19], v[160:163], a[40:43], v[16:19]
s_add_u32 s45, s45, 1024
ds_read_b128 a[52:55], v238 offset:46080
v_mfma_f32_16x16x32_bf16 v[24:27], v[160:163], a[44:47], v[24:27]
ds_read_b64_tr_b16 v[178:179], v226 offset:6144
s_add_u32 m0, s43, 0
v_mfma_f32_16x16x32_bf16 v[4:7], v[164:167], a[32:35], v[4:7]
s_add_u32 s52, s45, s50
ds_read_b128 a[56:59], v239 offset:45056
v_mfma_f32_16x16x32_bf16 v[12:15], v[164:167], a[36:39], v[12:15]
ds_read_b64_tr_b16 v[180:181], v227 offset:4096
s_add_u32 s44, s59, 552960
v_mfma_f32_16x16x32_bf16 v[20:23], v[164:167], a[40:43], v[20:23]
ds_read_b128 a[60:63], v239 offset:46080
v_mfma_f32_16x16x32_bf16 v[28:31], v[164:167], a[44:47], v[28:31]
ds_read_b64_tr_b16 v[182:183], v227 offset:6144
s_waitcnt lgkmcnt(8)
v_mfma_f32_16x16x32_bf16 v[32:35], v[168:171], a[32:35], v[32:35]
s_lshl_b32 s45, s40, 7
v_mfma_f32_16x16x32_bf16 v[40:43], v[168:171], a[36:39], v[40:43]
ds_read_b64_tr_b16 v[184:185], v228 offset:4096
buffer_load_dwordx4 v230, s[32:35], s44 offen offset:0 lds
v_mfma_f32_16x16x32_bf16 v[48:51], v[168:171], a[40:43], v[48:51]
s_add_u32 s50, s50, s45
v_mfma_f32_16x16x32_bf16 v[56:59], v[168:171], a[44:47], v[56:59]
ds_read_b64_tr_b16 v[186:187], v228 offset:6144
buffer_load_dwordx4 v231, s[32:35], s44 offen offset:1024 lds
v_mfma_f32_16x16x32_bf16 v[36:39], v[172:175], a[32:35], v[36:39]
v_mfma_f32_16x16x32_bf16 v[44:47], v[172:175], a[36:39], v[44:47]
ds_read_b64_tr_b16 v[188:189], v229 offset:4096
buffer_load_dwordx4 v232, s[32:35], s44 offen offset:2048 lds
v_mfma_f32_16x16x32_bf16 v[52:55], v[172:175], a[40:43], v[52:55]
s_mul_i32 s51, s42, 663552
v_mfma_f32_16x16x32_bf16 v[60:63], v[172:175], a[44:47], v[60:63]
ds_read_b64_tr_b16 v[190:191], v229 offset:6144
s_waitcnt vmcnt(11) lgkmcnt(4)
v_mfma_f32_16x16x32_bf16 v[0:3], v[176:179], a[48:51], v[0:3]
s_add_u32 s51, s51, s45
ds_read_b128 a[64:67], v238 offset:49152
v_mfma_f32_16x16x32_bf16 v[8:11], v[176:179], a[52:55], v[8:11]
ds_read_b64_tr_b16 v[160:161], v226 offset:8192
buffer_load_dwordx4 v233, s[32:35], s44 offen offset:3072 lds
v_mfma_f32_16x16x32_bf16 v[16:19], v[176:179], a[56:59], v[16:19]
ds_read_b128 a[68:71], v238 offset:50176
v_mfma_f32_16x16x32_bf16 v[24:27], v[176:179], a[60:63], v[24:27]
ds_read_b64_tr_b16 v[162:163], v226 offset:10240
s_add_u32 m0, s43, 4096
v_mfma_f32_16x16x32_bf16 v[4:7], v[180:183], a[48:51], v[4:7]
ds_read_b128 a[72:75], v239 offset:49152
v_mfma_f32_16x16x32_bf16 v[12:15], v[180:183], a[52:55], v[12:15]
ds_read_b64_tr_b16 v[164:165], v227 offset:8192
s_add_u32 s44, s59, 512
v_mfma_f32_16x16x32_bf16 v[20:23], v[180:183], a[56:59], v[20:23]
ds_read_b128 a[76:79], v239 offset:50176
v_mfma_f32_16x16x32_bf16 v[28:31], v[180:183], a[60:63], v[28:31]
ds_read_b64_tr_b16 v[166:167], v227 offset:10240
s_waitcnt lgkmcnt(8)
v_mfma_f32_16x16x32_bf16 v[32:35], v[184:187], a[48:51], v[32:35]
v_mfma_f32_16x16x32_bf16 v[40:43], v[184:187], a[52:55], v[40:43]
ds_read_b64_tr_b16 v[168:169], v228 offset:8192
buffer_load_dwordx4 v230, s[32:35], s44 offen offset:0 lds
v_mfma_f32_16x16x32_bf16 v[48:51], v[184:187], a[56:59], v[48:51]
v_mfma_f32_16x16x32_bf16 v[56:59], v[184:187], a[60:63], v[56:59]
ds_read_b64_tr_b16 v[170:171], v228 offset:10240
buffer_load_dwordx4 v231, s[32:35], s44 offen offset:1024 lds
v_mfma_f32_16x16x32_bf16 v[36:39], v[188:191], a[48:51], v[36:39]
v_mfma_f32_16x16x32_bf16 v[44:47], v[188:191], a[52:55], v[44:47]
ds_read_b64_tr_b16 v[172:173], v229 offset:8192
buffer_load_dwordx4 v232, s[32:35], s44 offen offset:2048 lds
v_mfma_f32_16x16x32_bf16 v[52:55], v[188:191], a[56:59], v[52:55]
v_mfma_f32_16x16x32_bf16 v[60:63], v[188:191], a[60:63], v[60:63]
ds_read_b64_tr_b16 v[174:175], v229 offset:10240
s_waitcnt vmcnt(11) lgkmcnt(4)
v_mfma_f32_16x16x32_bf16 v[0:3], v[160:163], a[64:67], v[0:3]
ds_read_b128 a[80:83], v238 offset:53248
v_mfma_f32_16x16x32_bf16 v[8:11], v[160:163], a[68:71], v[8:11]
ds_read_b64_tr_b16 v[176:177], v226 offset:12288
buffer_load_dwordx4 v233, s[32:35], s44 offen offset:3072 lds
v_mfma_f32_16x16x32_bf16 v[16:19], v[160:163], a[72:75], v[16:19]
ds_read_b128 a[84:87], v238 offset:54272
v_mfma_f32_16x16x32_bf16 v[24:27], v[160:163], a[76:79], v[24:27]
ds_read_b64_tr_b16 v[178:179], v226 offset:14336
s_add_u32 m0, s43, 8192
v_mfma_f32_16x16x32_bf16 v[4:7], v[164:167], a[64:67], v[4:7]
ds_read_b128 a[88:91], v239 offset:53248
v_mfma_f32_16x16x32_bf16 v[12:15], v[164:167], a[68:71], v[12:15]
ds_read_b64_tr_b16 v[180:181], v227 offset:12288
s_add_u32 s44, s59, 37376
v_mfma_f32_16x16x32_bf16 v[20:23], v[164:167], a[72:75], v[20:23]
ds_read_b128 a[92:95], v239 offset:54272
v_mfma_f32_16x16x32_bf16 v[28:31], v[164:167], a[76:79], v[28:31]
ds_read_b64_tr_b16 v[182:183], v227 offset:14336
s_waitcnt lgkmcnt(8)
v_mfma_f32_16x16x32_bf16 v[32:35], v[168:171], a[64:67], v[32:35]
v_mfma_f32_16x16x32_bf16 v[40:43], v[168:171], a[68:71], v[40:43]
ds_read_b64_tr_b16 v[184:185], v228 offset:12288
buffer_load_dwordx4 v230, s[32:35], s44 offen offset:0 lds
v_mfma_f32_16x16x32_bf16 v[48:51], v[168:171], a[72:75], v[48:51]
v_mfma_f32_16x16x32_bf16 v[56:59], v[168:171], a[76:79], v[56:59]
ds_read_b64_tr_b16 v[186:187], v228 offset:14336
buffer_load_dwordx4 v231, s[32:35], s44 offen offset:1024 lds
v_mfma_f32_16x16x32_bf16 v[36:39], v[172:175], a[64:67], v[36:39]
v_mfma_f32_16x16x32_bf16 v[44:47], v[172:175], a[68:71], v[44:47]
ds_read_b64_tr_b16 v[188:189], v229 offset:12288
buffer_load_dwordx4 v232, s[32:35], s44 offen offset:2048 lds
v_mfma_f32_16x16x32_bf16 v[52:55], v[172:175], a[72:75], v[52:55]
v_mfma_f32_16x16x32_bf16 v[60:63], v[172:175], a[76:79], v[60:63]
ds_read_b64_tr_b16 v[190:191], v229 offset:14336
s_waitcnt vmcnt(11) lgkmcnt(4)
v_mfma_f32_16x16x32_bf16 v[0:3], v[176:179], a[80:83], v[0:3]
ds_read_b128 a[96:99], v238 offset:57344
v_mfma_f32_16x16x32_bf16 v[8:11], v[176:179], a[84:87], v[8:11]
ds_read_b64_tr_b16 v[160:161], v226 offset:16384
buffer_load_dwordx4 v233, s[32:35], s44 offen offset:3072 lds
v_mfma_f32_16x16x32_bf16 v[16:19], v[176:179], a[88:91], v[16:19]
ds_read_b128 a[100:103], v238 offset:58368
v_mfma_f32_16x16x32_bf16 v[24:27], v[176:179], a[92:95], v[24:27]
ds_read_b64_tr_b16 v[162:163], v226 offset:18432
s_add_u32 m0, s43, 12288
v_mfma_f32_16x16x32_bf16 v[4:7], v[180:183], a[80:83], v[4:7]
ds_read_b128 a[104:107], v239 offset:57344
v_mfma_f32_16x16x32_bf16 v[12:15], v[180:183], a[84:87], v[12:15]
ds_read_b64_tr_b16 v[164:165], v227 offset:16384
s_add_u32 s44, s59, 147968
v_mfma_f32_16x16x32_bf16 v[20:23], v[180:183], a[88:91], v[20:23]
ds_read_b128 a[108:111], v239 offset:58368
v_mfma_f32_16x16x32_bf16 v[28:31], v[180:183], a[92:95], v[28:31]
ds_read_b64_tr_b16 v[166:167], v227 offset:18432
s_waitcnt lgkmcnt(8)
v_mfma_f32_16x16x32_bf16 v[32:35], v[184:187], a[80:83], v[32:35]
v_and_b32 v244, 0x880, v238
v_mfma_f32_16x16x32_bf16 v[40:43], v[184:187], a[84:87], v[40:43]
ds_read_b64_tr_b16 v[168:169], v228 offset:16384
buffer_load_dwordx4 v230, s[32:35], s44 offen offset:0 lds
v_mfma_f32_16x16x32_bf16 v[48:51], v[184:187], a[88:91], v[48:51]
v_mfma_f32_16x16x32_bf16 v[56:59], v[184:187], a[92:95], v[56:59]
ds_read_b64_tr_b16 v[170:171], v228 offset:18432
buffer_load_dwordx4 v231, s[32:35], s44 offen offset:1024 lds
v_mfma_f32_16x16x32_bf16 v[36:39], v[188:191], a[80:83], v[36:39]
v_min_u32 v244, 1, v244
v_mfma_f32_16x16x32_bf16 v[44:47], v[188:191], a[84:87], v[44:47]
ds_read_b64_tr_b16 v[172:173], v229 offset:16384
buffer_load_dwordx4 v232, s[32:35], s44 offen offset:2048 lds
v_mfma_f32_16x16x32_bf16 v[52:55], v[188:191], a[88:91], v[52:55]
v_mfma_f32_16x16x32_bf16 v[60:63], v[188:191], a[92:95], v[60:63]
ds_read_b64_tr_b16 v[174:175], v229 offset:18432
s_waitcnt vmcnt(11) lgkmcnt(4)
v_mfma_f32_16x16x32_bf16 v[0:3], v[160:163], a[96:99], v[0:3]
ds_read_b128 a[112:115], v238 offset:61440
v_xor_b32 v244, 1, v244
v_mfma_f32_16x16x32_bf16 v[8:11], v[160:163], a[100:103], v[8:11]
ds_read_b64_tr_b16 v[176:177], v226 offset:0
buffer_load_dwordx4 v233, s[32:35], s44 offen offset:3072 lds
v_mfma_f32_16x16x32_bf16 v[16:19], v[160:163], a[104:107], v[16:19]
ds_read_b128 a[116:119], v238 offset:62464
v_mfma_f32_16x16x32_bf16 v[24:27], v[160:163], a[108:111], v[24:27]
ds_read_b64_tr_b16 v[178:179], v226 offset:2048
s_add_u32 m0, s43, 16384
v_mfma_f32_16x16x32_bf16 v[4:7], v[164:167], a[96:99], v[4:7]
ds_read_b128 a[120:123], v239 offset:61440
v_lshl_add_u32 v244, v244, 30, v238
v_mfma_f32_16x16x32_bf16 v[12:15], v[164:167], a[100:103], v[12:15]
ds_read_b64_tr_b16 v[180:181], v227 offset:0
s_add_u32 s44, s59, 184832
v_mfma_f32_16x16x32_bf16 v[20:23], v[164:167], a[104:107], v[20:23]
ds_read_b128 a[124:127], v239 offset:62464
v_mfma_f32_16x16x32_bf16 v[28:31], v[164:167], a[108:111], v[28:31]
ds_read_b64_tr_b16 v[182:183], v227 offset:2048
s_waitcnt lgkmcnt(8)
v_mfma_f32_16x16x32_bf16 v[32:35], v[168:171], a[96:99], v[32:35]
v_and_b32 v245, 0x880, v239
v_mfma_f32_16x16x32_bf16 v[40:43], v[168:171], a[100:103], v[40:43]
ds_read_b64_tr_b16 v[184:185], v228 offset:0
buffer_load_dwordx4 v230, s[32:35], s44 offen offset:0 lds
v_mfma_f32_16x16x32_bf16 v[48:51], v[168:171], a[104:107], v[48:51]
v_min_u32 v245, 1, v245
v_mfma_f32_16x16x32_bf16 v[56:59], v[168:171], a[108:111], v[56:59]
ds_read_b64_tr_b16 v[186:187], v228 offset:2048
buffer_load_dwordx4 v231, s[32:35], s44 offen offset:1024 lds
v_mfma_f32_16x16x32_bf16 v[36:39], v[172:175], a[96:99], v[36:39]
v_mfma_f32_16x16x32_bf16 v[44:47], v[172:175], a[100:103], v[44:47]
ds_read_b64_tr_b16 v[188:189], v229 offset:0
buffer_load_dwordx4 v232, s[32:35], s44 offen offset:2048 lds
v_mfma_f32_16x16x32_bf16 v[52:55], v[172:175], a[104:107], v[52:55]
v_xor_b32 v245, 1, v245
v_mfma_f32_16x16x32_bf16 v[60:63], v[172:175], a[108:111], v[60:63]
ds_read_b64_tr_b16 v[190:191], v229 offset:2048
s_waitcnt vmcnt(11) lgkmcnt(4)
v_mfma_f32_16x16x32_bf16 v[0:3], v[176:179], a[112:115], v[0:3]
v_mfma_f32_16x16x32_bf16 v[8:11], v[176:179], a[116:119], v[8:11]
ds_read_b64_tr_b16 v[160:161], v226 offset:4096
buffer_load_dwordx4 v233, s[32:35], s44 offen offset:3072 lds
v_mfma_f32_16x16x32_bf16 v[16:19], v[176:179], a[120:123], v[16:19]
v_lshl_add_u32 v245, v245, 30, v239
v_mfma_f32_16x16x32_bf16 v[24:27], v[176:179], a[124:127], v[24:27]
ds_read_b64_tr_b16 v[162:163], v226 offset:6144
s_add_u32 m0, s43, 0
v_mfma_f32_16x16x32_bf16 v[4:7], v[180:183], a[112:115], v[4:7]
v_mfma_f32_16x16x32_bf16 v[12:15], v[180:183], a[116:119], v[12:15]
ds_read_b64_tr_b16 v[164:165], v227 offset:4096
s_add_u32 s44, s59, 295424
v_mfma_f32_16x16x32_bf16 v[20:23], v[180:183], a[120:123], v[20:23]
v_mfma_f32_16x16x32_bf16 v[28:31], v[180:183], a[124:127], v[28:31]
ds_read_b64_tr_b16 v[166:167], v227 offset:6144
s_waitcnt lgkmcnt(4)
v_mfma_f32_16x16x32_bf16 v[32:35], v[184:187], a[112:115], v[32:35]
v_mfma_f32_16x16x32_bf16 v[40:43], v[184:187], a[116:119], v[40:43]
ds_read_b64_tr_b16 v[168:169], v228 offset:4096
buffer_load_dwordx4 v230, s[32:35], s44 offen offset:0 lds
v_mfma_f32_16x16x32_bf16 v[48:51], v[184:187], a[120:123], v[48:51]
v_mfma_f32_16x16x32_bf16 v[56:59], v[184:187], a[124:127], v[56:59]
ds_read_b64_tr_b16 v[170:171], v228 offset:6144
buffer_load_dwordx4 v231, s[32:35], s44 offen offset:1024 lds
v_mfma_f32_16x16x32_bf16 v[36:39], v[188:191], a[112:115], v[36:39]
v_mfma_f32_16x16x32_bf16 v[44:47], v[188:191], a[116:119], v[44:47]
ds_read_b64_tr_b16 v[172:173], v229 offset:4096
buffer_load_dwordx4 v232, s[32:35], s44 offen offset:2048 lds
v_mfma_f32_16x16x32_bf16 v[52:55], v[188:191], a[120:123], v[52:55]
v_mfma_f32_16x16x32_bf16 v[60:63], v[188:191], a[124:127], v[60:63]
ds_read_b64_tr_b16 v[174:175], v229 offset:6144
s_waitcnt vmcnt(11) lgkmcnt(4)
v_mfma_f32_16x16x32_bf16 v[64:67], v[160:163], a[128:131], 0
s_barrier
v_mfma_f32_16x16x32_bf16 v[72:75], v[160:163], a[132:135], 0
ds_read_b64_tr_b16 v[176:177], v226 offset:8192
buffer_load_dwordx4 v233, s[32:35], s44 offen offset:3072 lds
v_mfma_f32_16x16x32_bf16 v[80:83], v[160:163], a[136:139], 0
v_mfma_f32_16x16x32_bf16 v[88:91], v[160:163], a[140:143], 0
ds_read_b64_tr_b16 v[178:179], v226 offset:10240
s_add_u32 m0, s43, 4096
v_mfma_f32_16x16x32_bf16 v[68:71], v[164:167], a[128:131], 0
v_mfma_f32_16x16x32_bf16 v[76:79], v[164:167], a[132:135], 0
ds_read_b64_tr_b16 v[180:181], v227 offset:8192
s_add_u32 s44, s59, 332288
v_mfma_f32_16x16x32_bf16 v[84:87], v[164:167], a[136:139], 0
v_mfma_f32_16x16x32_bf16 v[92:95], v[164:167], a[140:143], 0
ds_read_b64_tr_b16 v[182:183], v227 offset:10240
s_waitcnt lgkmcnt(4)
v_mfma_f32_16x16x32_bf16 v[96:99], v[168:171], a[128:131], 0
v_cvt_pk_bf16_f32 v0, v0, v1
v_mfma_f32_16x16x32_bf16 v[104:107], v[168:171], a[132:135], 0
ds_read_b64_tr_b16 v[184:185], v228 offset:8192
buffer_load_dwordx4 v230, s[32:35], s44 offen offset:0 lds
v_mfma_f32_16x16x32_bf16 v[112:115], v[168:171], a[136:139], 0
v_cvt_pk_bf16_f32 v1, v2, v3
v_mfma_f32_16x16x32_bf16 v[120:123], v[168:171], a[140:143], 0
ds_read_b64_tr_b16 v[186:187], v228 offset:10240
buffer_load_dwordx4 v231, s[32:35], s44 offen offset:1024 lds
v_mfma_f32_16x16x32_bf16 v[100:103], v[172:175], a[128:131], 0
v_cvt_pk_bf16_f32 v2, v4, v5
v_cvt_pk_bf16_f32 v3, v6, v7
v_mfma_f32_16x16x32_bf16 v[108:111], v[172:175], a[132:135], 0
ds_read_b64_tr_b16 v[188:189], v229 offset:8192
buffer_load_dwordx4 v232, s[32:35], s44 offen offset:2048 lds
v_mfma_f32_16x16x32_bf16 v[116:119], v[172:175], a[136:139], 0
buffer_store_dwordx4 v[0:3], v244, s[36:39], s60 offen offset:0 sc1
v_mfma_f32_16x16x32_bf16 v[124:127], v[172:175], a[140:143], 0
ds_read_b64_tr_b16 v[190:191], v229 offset:10240
s_waitcnt vmcnt(12) lgkmcnt(4)
v_mfma_f32_16x16x32_bf16 v[64:67], v[176:179], a[144:147], v[64:67]
v_cvt_pk_bf16_f32 v8, v8, v9
v_cvt_pk_bf16_f32 v9, v10, v11
v_mfma_f32_16x16x32_bf16 v[72:75], v[176:179], a[148:151], v[72:75]
ds_read_b64_tr_b16 v[160:161], v226 offset:12288
buffer_load_dwordx4 v233, s[32:35], s44 offen offset:3072 lds
v_mfma_f32_16x16x32_bf16 v[80:83], v[176:179], a[152:155], v[80:83]
v_cvt_pk_bf16_f32 v10, v12, v13
v_mfma_f32_16x16x32_bf16 v[88:91], v[176:179], a[156:159], v[88:91]
ds_read_b64_tr_b16 v[162:163], v226 offset:14336
s_add_u32 m0, s43, 8192
v_mfma_f32_16x16x32_bf16 v[68:71], v[180:183], a[144:147], v[68:71]
v_cvt_pk_bf16_f32 v11, v14, v15
v_mfma_f32_16x16x32_bf16 v[76:79], v[180:183], a[148:151], v[76:79]
ds_read_b64_tr_b16 v[164:165], v227 offset:12288
s_mul_i32 s45, s41, 34816
v_mfma_f32_16x16x32_bf16 v[84:87], v[180:183], a[152:155], v[84:87]
buffer_store_dwordx4 v[8:11], v238, s[36:39], s60 offen offset:1024 sc1
v_cvt_pk_bf16_f32 v16, v16, v17
v_mfma_f32_16x16x32_bf16 v[92:95], v[180:183], a[156:159], v[92:95]
ds_read_b64_tr_b16 v[166:167], v227 offset:14336
s_waitcnt lgkmcnt(4)
v_mfma_f32_16x16x32_bf16 v[96:99], v[184:187], a[144:147], v[96:99]
s_add_u32 s44, s59, 442880
v_cvt_pk_bf16_f32 v17, v18, v19
v_mfma_f32_16x16x32_bf16 v[104:107], v[184:187], a[148:151], v[104:107]
ds_read_b64_tr_b16 v[168:169], v228 offset:12288
s_add_u32 s53, s45, 67108864
v_mfma_f32_16x16x32_bf16 v[112:115], v[184:187], a[152:155], v[112:115]
buffer_load_dwordx4 v230, s[32:35], s44 offen offset:0 lds
v_cvt_pk_bf16_f32 v18, v20, v21
v_mfma_f32_16x16x32_bf16 v[120:123], v[184:187], a[156:159], v[120:123]
ds_read_b64_tr_b16 v[170:171], v228 offset:14336
s_lshl_b32 s46, s42, 2
v_mfma_f32_16x16x32_bf16 v[100:103], v[188:191], a[144:147], v[100:103]
v_cvt_pk_bf16_f32 v19, v22, v23
v_mfma_f32_16x16x32_bf16 v[108:111], v[188:191], a[148:151], v[108:111]
ds_read_b64_tr_b16 v[172:173], v229 offset:12288
buffer_load_dwordx4 v231, s[32:35], s44 offen offset:1024 lds
v_mfma_f32_16x16x32_bf16 v[116:119], v[188:191], a[152:155], v[116:119]
s_mul_i32 s47, s42, 4352
buffer_store_dwordx4 v[16:19], v245, s[36:39], s60 offen offset:0 sc1
v_mfma_f32_16x16x32_bf16 v[124:127], v[188:191], a[156:159], v[124:127]
ds_read_b64_tr_b16 v[174:175], v229 offset:14336
s_waitcnt vmcnt(13) lgkmcnt(4)
v_mfma_f32_16x16x32_bf16 v[64:67], v[160:163], a[160:163], v[64:67]
buffer_load_dwordx4 v232, s[32:35], s44 offen offset:2048 lds
v_cvt_pk_bf16_f32 v24, v24, v25
v_mfma_f32_16x16x32_bf16 v[72:75], v[160:163], a[164:167], v[72:75]
ds_read_b64_tr_b16 v[176:177], v226 offset:16384
s_add_u32 s54, s53, s47
v_mfma_f32_16x16x32_bf16 v[80:83], v[160:163], a[168:171], v[80:83]
v_cvt_pk_bf16_f32 v25, v26, v27
v_cvt_pk_bf16_f32 v26, v28, v29
v_mfma_f32_16x16x32_bf16 v[88:91], v[160:163], a[172:175], v[88:91]
ds_read_b64_tr_b16 v[178:179], v226 offset:18432
buffer_load_dwordx4 v233, s[32:35], s44 offen offset:3072 lds
v_mfma_f32_16x16x32_bf16 v[68:71], v[164:167], a[160:163], v[68:71]
v_cvt_pk_bf16_f32 v27, v30, v31
v_cvt_pk_bf16_f32 v32, v32, v33
v_mfma_f32_16x16x32_bf16 v[76:79], v[164:167], a[164:167], v[76:79]
ds_read_b64_tr_b16 v[180:181], v227 offset:16384
buffer_store_dwordx4 v[24:27], v239, s[36:39], s60 offen offset:1024 sc1
v_bfe_u32 v252, v224, 2, 5
v_mfma_f32_16x16x32_bf16 v[84:87], v[164:167], a[168:171], v[84:87]
v_cvt_pk_bf16_f32 v33, v34, v35
v_mfma_f32_16x16x32_bf16 v[92:95], v[164:167], a[172:175], v[92:95]
ds_read_b64_tr_b16 v[182:183], v227 offset:18432
s_waitcnt lgkmcnt(4)
v_mfma_f32_16x16x32_bf16 v[96:99], v[168:171], a[160:163], v[96:99]
s_add_u32 m0, s43, 12288
s_add_u32 s44, s59, 479744
v_mfma_f32_16x16x32_bf16 v[104:107], v[168:171], a[164:167], v[104:107]
ds_read_b64_tr_b16 v[184:185], v228 offset:16384
v_xor_b32 v254, s46, v252
v_mfma_f32_16x16x32_bf16 v[112:115], v[168:171], a[168:171], v[112:115]
buffer_load_dwordx4 v230, s[32:35], s44 offen offset:0 lds
v_cvt_pk_bf16_f32 v34, v36, v37
v_mfma_f32_16x16x32_bf16 v[120:123], v[168:171], a[172:175], v[120:123]
ds_read_b64_tr_b16 v[186:187], v228 offset:18432
v_mul_u32_u24 v254, 1088, v254
v_mfma_f32_16x16x32_bf16 v[100:103], v[172:175], a[160:163], v[100:103]
v_cvt_pk_bf16_f32 v35, v38, v39
v_cvt_pk_bf16_f32 v40, v40, v41
v_mfma_f32_16x16x32_bf16 v[108:111], v[172:175], a[164:167], v[108:111]
ds_read_b64_tr_b16 v[188:189], v229 offset:16384
buffer_load_dwordx4 v231, s[32:35], s44 offen offset:1024 lds
buffer_store_dwordx4 v[32:35], v244, s[36:39], s61 offen offset:0 sc1
v_mfma_f32_16x16x32_bf16 v[116:119], v[172:175], a[168:171], v[116:119]
v_and_b32 v255, 0x80, v224
v_cvt_pk_bf16_f32 v41, v42, v43
v_mfma_f32_16x16x32_bf16 v[124:127], v[172:175], a[172:175], v[124:127]
ds_read_b64_tr_b16 v[190:191], v229 offset:18432
s_waitcnt vmcnt(15) lgkmcnt(4)
v_mfma_f32_16x16x32_bf16 v[64:67], v[176:179], a[176:179], v[64:67]
buffer_load_dwordx4 v232, s[32:35], s44 offen offset:2048 lds
v_cvt_pk_bf16_f32 v42, v44, v45
v_mfma_f32_16x16x32_bf16 v[72:75], v[176:179], a[180:183], v[72:75]
ds_read_b64_tr_b16 v[160:161], v226 offset:0
v_cvt_pk_bf16_f32 v43, v46, v47
v_mfma_f32_16x16x32_bf16 v[80:83], v[176:179], a[184:187], v[80:83]
buffer_store_dwordx4 v[40:43], v238, s[36:39], s61 offen offset:1024 sc1
v_cvt_pk_bf16_f32 v48, v48, v49
v_mfma_f32_16x16x32_bf16 v[88:91], v[176:179], a[188:191], v[88:91]
ds_read_b64_tr_b16 v[162:163], v226 offset:2048
v_add3_u32 v254, v254, v252, v255
v_mfma_f32_16x16x32_bf16 v[68:71], v[180:183], a[176:179], v[68:71]
buffer_load_dwordx4 v233, s[32:35], s44 offen offset:3072 lds
v_cvt_pk_bf16_f32 v49, v50, v51
v_mfma_f32_16x16x32_bf16 v[76:79], v[180:183], a[180:183], v[76:79]
ds_read_b64_tr_b16 v[164:165], v227 offset:0
v_lshrrev_b32 v255, 8, v224
v_mfma_f32_16x16x32_bf16 v[84:87], v[180:183], a[184:187], v[84:87]
v_cvt_pk_bf16_f32 v50, v52, v53
v_cvt_pk_bf16_f32 v51, v54, v55
v_mfma_f32_16x16x32_bf16 v[92:95], v[180:183], a[188:191], v[92:95]
ds_read_b64_tr_b16 v[166:167], v227 offset:2048
s_waitcnt lgkmcnt(4)
v_mfma_f32_16x16x32_bf16 v[96:99], v[184:187], a[176:179], v[96:99]
s_add_u32 m0, s43, 16384
s_add_u32 s44, s59, 74240
v_mfma_f32_16x16x32_bf16 v[104:107], v[184:187], a[180:183], v[104:107]
ds_read_b64_tr_b16 v[168:169], v228 offset:0
v_or_b32 v255, s40, v255
v_mfma_f32_16x16x32_bf16 v[112:115], v[184:187], a[184:187], v[112:115]
buffer_load_dwordx4 v230, s[32:35], s44 offen offset:0 lds
buffer_store_dwordx4 v[48:51], v245, s[36:39], s61 offen offset:0 sc1
v_mfma_f32_16x16x32_bf16 v[120:123], v[184:187], a[188:191], v[120:123]
ds_read_b64_tr_b16 v[170:171], v228 offset:2048
v_cvt_pk_bf16_f32 v56, v56, v57
v_mfma_f32_16x16x32_bf16 v[100:103], v[188:191], a[176:179], v[100:103]
v_cvt_pk_bf16_f32 v57, v58, v59
v_cvt_pk_bf16_f32 v58, v60, v61
v_mfma_f32_16x16x32_bf16 v[108:111], v[188:191], a[180:183], v[108:111]
ds_read_b64_tr_b16 v[172:173], v229 offset:0
v_cmp_eq_u32 vcc, 0, v252
v_mfma_f32_16x16x32_bf16 v[116:119], v[188:191], a[184:187], v[116:119]
buffer_load_dwordx4 v231, s[32:35], s44 offen offset:1024 lds
v_cvt_pk_bf16_f32 v59, v62, v63
v_mfma_f32_16x16x32_bf16 v[124:127], v[188:191], a[188:191], v[124:127]
ds_read_b64_tr_b16 v[174:175], v229 offset:2048
s_waitcnt vmcnt(16) lgkmcnt(4)
v_mfma_f32_16x16x32_bf16 v[64:67], v[160:163], a[192:195], v[64:67]
buffer_load_dwordx4 v232, s[32:35], s44 offen offset:2048 lds
buffer_store_dwordx4 v[56:59], v239, s[36:39], s61 offen offset:1024 sc1
v_mfma_f32_16x16x32_bf16 v[72:75], v[160:163], a[196:199], v[72:75]
ds_read_b64_tr_b16 v[176:177], v226 offset:4096
v_addc_co_u32 v255, vcc, 0, v255, vcc
v_mfma_f32_16x16x32_bf16 v[80:83], v[160:163], a[200:203], v[80:83]
v_mfma_f32_16x16x32_bf16 v[88:91], v[160:163], a[204:207], v[88:91]
ds_read_b64_tr_b16 v[178:179], v226 offset:6144
v_min_u32 v255, 1, v255
v_mfma_f32_16x16x32_bf16 v[68:71], v[164:167], a[192:195], v[68:71]
buffer_load_dwordx4 v233, s[32:35], s44 offen offset:3072 lds
v_mfma_f32_16x16x32_bf16 v[76:79], v[164:167], a[196:199], v[76:79]
ds_read_b64_tr_b16 v[180:181], v227 offset:4096
s_add_u32 m0, s43, 0
v_mfma_f32_16x16x32_bf16 v[84:87], v[164:167], a[200:203], v[84:87]
v_lshl_add_u32 v254, v255, 30, v254
v_mfma_f32_16x16x32_bf16 v[92:95], v[164:167], a[204:207], v[92:95]
ds_read_b64_tr_b16 v[182:183], v227 offset:6144
s_waitcnt lgkmcnt(4)
v_mfma_f32_16x16x32_bf16 v[96:99], v[168:171], a[192:195], v[96:99]
s_add_u32 s44, s59, 111104
v_mfma_f32_16x16x32_bf16 v[104:107], v[168:171], a[196:199], v[104:107]
ds_read_b64_tr_b16 v[184:185], v228 offset:4096
v_max_u32 v252, 4, v252
v_mfma_f32_16x16x32_bf16 v[112:115], v[168:171], a[200:203], v[112:115]
buffer_load_dwordx4 v230, s[32:35], s44 offen offset:0 lds
v_mfma_f32_16x16x32_bf16 v[120:123], v[168:171], a[204:207], v[120:123]
ds_read_b64_tr_b16 v[186:187], v228 offset:6144
v_mfma_f32_16x16x32_bf16 v[100:103], v[172:175], a[192:195], v[100:103]
v_mfma_f32_16x16x32_bf16 v[108:111], v[172:175], a[196:199], v[108:111]
ds_read_b64_tr_b16 v[188:189], v229 offset:4096
v_mov_b32 v255, s3
v_mfma_f32_16x16x32_bf16 v[116:119], v[172:175], a[200:203], v[116:119]
buffer_load_dwordx4 v231, s[32:35], s44 offen offset:1024 lds
v_mfma_f32_16x16x32_bf16 v[124:127], v[172:175], a[204:207], v[124:127]
ds_read_b64_tr_b16 v[190:191], v229 offset:6144
s_waitcnt vmcnt(15) lgkmcnt(4)
v_mfma_f32_16x16x32_bf16 v[64:67], v[176:179], a[208:211], v[64:67]
buffer_load_dwordx4 v232, s[32:35], s44 offen offset:2048 lds
v_mfma_f32_16x16x32_bf16 v[72:75], v[176:179], a[212:215], v[72:75]
ds_read_b64_tr_b16 v[160:161], v226 offset:8192
v_mfma_f32_16x16x32_bf16 v[80:83], v[176:179], a[216:219], v[80:83]
v_mfma_f32_16x16x32_bf16 v[88:91], v[176:179], a[220:223], v[88:91]
ds_read_b64_tr_b16 v[162:163], v226 offset:10240
buffer_load_dwordx4 v233, s[32:35], s44 offen offset:3072 lds
v_mfma_f32_16x16x32_bf16 v[68:71], v[180:183], a[208:211], v[68:71]
v_mfma_f32_16x16x32_bf16 v[76:79], v[180:183], a[212:215], v[76:79]
ds_read_b64_tr_b16 v[164:165], v227 offset:8192
s_add_u32 m0, s43, 4096
v_mfma_f32_16x16x32_bf16 v[84:87], v[180:183], a[216:219], v[84:87]
v_mfma_f32_16x16x32_bf16 v[92:95], v[180:183], a[220:223], v[92:95]
ds_read_b64_tr_b16 v[166:167], v227 offset:10240
s_waitcnt lgkmcnt(4)
v_mfma_f32_16x16x32_bf16 v[96:99], v[184:187], a[208:211], v[96:99]
s_add_u32 s44, s59, 221696
v_mfma_f32_16x16x32_bf16 v[104:107], v[184:187], a[212:215], v[104:107]
ds_read_b64_tr_b16 v[168:169], v228 offset:8192
buffer_load_dwordx4 v230, s[32:35], s44 offen offset:0 lds
v_mfma_f32_16x16x32_bf16 v[112:115], v[184:187], a[216:219], v[112:115]
s_lshl_b32 s45, s41, 3
v_mfma_f32_16x16x32_bf16 v[120:123], v[184:187], a[220:223], v[120:123]
ds_read_b64_tr_b16 v[170:171], v228 offset:10240
buffer_load_dwordx4 v231, s[32:35], s44 offen offset:1024 lds
v_mfma_f32_16x16x32_bf16 v[100:103], v[188:191], a[208:211], v[100:103]
v_mfma_f32_16x16x32_bf16 v[108:111], v[188:191], a[212:215], v[108:111]
ds_read_b64_tr_b16 v[172:173], v229 offset:8192
buffer_load_dwordx4 v232, s[32:35], s44 offen offset:2048 lds
v_mfma_f32_16x16x32_bf16 v[116:119], v[188:191], a[216:219], v[116:119]
s_add_u32 s45, s45, s42
v_mfma_f32_16x16x32_bf16 v[124:127], v[188:191], a[220:223], v[124:127]
ds_read_b64_tr_b16 v[174:175], v229 offset:10240
s_waitcnt vmcnt(13) lgkmcnt(4)
v_mfma_f32_16x16x32_bf16 v[64:67], v[160:163], a[224:227], v[64:67]
s_mul_i32 s45, s45, 9216
v_mfma_f32_16x16x32_bf16 v[72:75], v[160:163], a[228:231], v[72:75]
ds_read_b64_tr_b16 v[176:177], v226 offset:12288
buffer_load_dwordx4 v233, s[32:35], s44 offen offset:3072 lds
v_mfma_f32_16x16x32_bf16 v[80:83], v[160:163], a[232:235], v[80:83]
v_mfma_f32_16x16x32_bf16 v[88:91], v[160:163], a[236:239], v[88:91]
ds_read_b64_tr_b16 v[178:179], v226 offset:14336
s_add_u32 m0, s43, 8192
v_mfma_f32_16x16x32_bf16 v[68:71], v[164:167], a[224:227], v[68:71]
s_lshl_b32 s46, s40, 7
v_mfma_f32_16x16x32_bf16 v[76:79], v[164:167], a[228:231], v[76:79]
ds_read_b64_tr_b16 v[180:181], v227 offset:12288
s_add_u32 s44, s59, 258560
v_mfma_f32_16x16x32_bf16 v[84:87], v[164:167], a[232:235], v[84:87]
v_mfma_f32_16x16x32_bf16 v[92:95], v[164:167], a[236:239], v[92:95]
ds_read_b64_tr_b16 v[182:183], v227 offset:14336
s_waitcnt lgkmcnt(4)
v_mfma_f32_16x16x32_bf16 v[96:99], v[168:171], a[224:227], v[96:99]
s_add_u32 s8, s45, s46
v_mfma_f32_16x16x32_bf16 v[104:107], v[168:171], a[228:231], v[104:107]
ds_read_b64_tr_b16 v[184:185], v228 offset:12288
buffer_load_dwordx4 v230, s[32:35], s44 offen offset:0 lds
v_mfma_f32_16x16x32_bf16 v[112:115], v[168:171], a[232:235], v[112:115]
s_lshr_b32 s46, s40, 1
v_mfma_f32_16x16x32_bf16 v[120:123], v[168:171], a[236:239], v[120:123]
ds_read_b64_tr_b16 v[186:187], v228 offset:14336
buffer_load_dwordx4 v231, s[32:35], s44 offen offset:1024 lds
v_mfma_f32_16x16x32_bf16 v[100:103], v[172:175], a[224:227], v[100:103]
v_mfma_f32_16x16x32_bf16 v[108:111], v[172:175], a[228:231], v[108:111]
ds_read_b64_tr_b16 v[188:189], v229 offset:12288
buffer_load_dwordx4 v232, s[32:35], s44 offen offset:2048 lds
v_mfma_f32_16x16x32_bf16 v[116:119], v[172:175], a[232:235], v[116:119]
s_mul_i32 s46, s46, 32
v_mfma_f32_16x16x32_bf16 v[124:127], v[172:175], a[236:239], v[124:127]
ds_read_b64_tr_b16 v[190:191], v229 offset:14336
s_waitcnt vmcnt(11) lgkmcnt(4)
v_mfma_f32_16x16x32_bf16 v[64:67], v[176:179], a[240:243], v[64:67]
v_mfma_f32_16x16x32_bf16 v[72:75], v[176:179], a[244:247], v[72:75]
ds_read_b64_tr_b16 v[160:161], v226 offset:16384
buffer_load_dwordx4 v233, s[32:35], s44 offen offset:3072 lds
v_mfma_f32_16x16x32_bf16 v[80:83], v[176:179], a[248:251], v[80:83]
s_lshl_b32 s47, s40, 4
v_mfma_f32_16x16x32_bf16 v[88:91], v[176:179], a[252:255], v[88:91]
ds_read_b64_tr_b16 v[162:163], v226 offset:18432
s_add_u32 m0, s43, 12288
v_mfma_f32_16x16x32_bf16 v[68:71], v[180:183], a[240:243], v[68:71]
s_add_u32 s46, s46, s47
v_mfma_f32_16x16x32_bf16 v[76:79], v[180:183], a[244:247], v[76:79]
ds_read_b64_tr_b16 v[164:165], v227 offset:16384
s_add_u32 s44, s59, 369152
v_mfma_f32_16x16x32_bf16 v[84:87], v[180:183], a[248:251], v[84:87]
v_mfma_f32_16x16x32_bf16 v[92:95], v[180:183], a[252:255], v[92:95]
ds_read_b64_tr_b16 v[166:167], v227 offset:18432
s_waitcnt lgkmcnt(4)
v_mfma_f32_16x16x32_bf16 v[96:99], v[184:187], a[240:243], v[96:99]
s_add_u32 s9, s45, s46
v_mfma_f32_16x16x32_bf16 v[104:107], v[184:187], a[244:247], v[104:107]
ds_read_b64_tr_b16 v[168:169], v228 offset:16384
buffer_load_dwordx4 v230, s[32:35], s44 offen offset:0 lds
v_mfma_f32_16x16x32_bf16 v[112:115], v[184:187], a[248:251], v[112:115]
v_mfma_f32_16x16x32_bf16 v[120:123], v[184:187], a[252:255], v[120:123]
ds_read_b64_tr_b16 v[170:171], v228 offset:18432
buffer_load_dwordx4 v231, s[32:35], s44 offen offset:1024 lds
v_mfma_f32_16x16x32_bf16 v[100:103], v[188:191], a[240:243], v[100:103]
v_and_b32 v220, 0x70, v224
v_mfma_f32_16x16x32_bf16 v[108:111], v[188:191], a[244:247], v[108:111]
ds_read_b64_tr_b16 v[172:173], v229 offset:16384
buffer_load_dwordx4 v232, s[32:35], s44 offen offset:2048 lds
v_mfma_f32_16x16x32_bf16 v[116:119], v[188:191], a[248:251], v[116:119]
v_mul_u32_u24 v220, 72, v220
v_mfma_f32_16x16x32_bf16 v[124:127], v[188:191], a[252:255], v[124:127]
ds_read_b64_tr_b16 v[174:175], v229 offset:18432
s_waitcnt vmcnt(11) lgkmcnt(4)
v_mfma_f32_16x16x32_bf16 v[64:67], v[160:163], a[0:3], v[64:67]
v_mfma_f32_16x16x32_bf16 v[72:75], v[160:163], a[4:7], v[72:75]
ds_read_b64_tr_b16 v[176:177], v226 offset:0
buffer_load_dwordx4 v233, s[32:35], s44 offen offset:3072 lds
v_mfma_f32_16x16x32_bf16 v[80:83], v[160:163], a[8:11], v[80:83]
v_bfe_u32 v221, v224, 8, 1
v_mfma_f32_16x16x32_bf16 v[88:91], v[160:163], a[12:15], v[88:91]
ds_read_b64_tr_b16 v[178:179], v226 offset:2048
s_add_u32 m0, s43, 16384
v_mfma_f32_16x16x32_bf16 v[68:71], v[164:167], a[0:3], v[68:71]
v_mfma_f32_16x16x32_bf16 v[76:79], v[164:167], a[4:7], v[76:79]
ds_read_b64_tr_b16 v[180:181], v227 offset:0
s_add_u32 s44, s59, 406016
v_mfma_f32_16x16x32_bf16 v[84:87], v[164:167], a[8:11], v[84:87]
v_lshl_add_u32 v221, v221, 5, v220
v_mfma_f32_16x16x32_bf16 v[92:95], v[164:167], a[12:15], v[92:95]
ds_read_b64_tr_b16 v[182:183], v227 offset:2048
s_waitcnt lgkmcnt(4)
v_mfma_f32_16x16x32_bf16 v[96:99], v[168:171], a[0:3], v[96:99]
v_bfe_u32 v222, v224, 7, 1
v_mfma_f32_16x16x32_bf16 v[104:107], v[168:171], a[4:7], v[104:107]
ds_read_b64_tr_b16 v[184:185], v228 offset:0
buffer_load_dwordx4 v230, s[32:35], s44 offen offset:0 lds
v_mfma_f32_16x16x32_bf16 v[112:115], v[168:171], a[8:11], v[112:115]
v_mfma_f32_16x16x32_bf16 v[120:123], v[168:171], a[12:15], v[120:123]
ds_read_b64_tr_b16 v[186:187], v228 offset:2048
buffer_load_dwordx4 v231, s[32:35], s44 offen offset:1024 lds
v_mfma_f32_16x16x32_bf16 v[100:103], v[172:175], a[0:3], v[100:103]
v_lshl_add_u32 v220, v222, 6, v221
v_mfma_f32_16x16x32_bf16 v[108:111], v[172:175], a[4:7], v[108:111]
ds_read_b64_tr_b16 v[188:189], v229 offset:0
buffer_load_dwordx4 v232, s[32:35], s44 offen offset:2048 lds
v_mfma_f32_16x16x32_bf16 v[116:119], v[172:175], a[8:11], v[116:119]
v_mfma_f32_16x16x32_bf16 v[124:127], v[172:175], a[12:15], v[124:127]
ds_read_b64_tr_b16 v[190:191], v229 offset:2048
s_waitcnt vmcnt(11) lgkmcnt(4)
v_mfma_f32_16x16x32_bf16 v[64:67], v[176:179], a[16:19], v[64:67]
v_bfe_u32 v222, v224, 9, 1
v_mfma_f32_16x16x32_bf16 v[72:75], v[176:179], a[20:23], v[72:75]
ds_read_b64_tr_b16 v[160:161], v226 offset:4096
buffer_load_dwordx4 v233, s[32:35], s44 offen offset:3072 lds
v_mfma_f32_16x16x32_bf16 v[80:83], v[176:179], a[24:27], v[80:83]
v_lshl_add_u32 v220, v222, 4, v220
v_mfma_f32_16x16x32_bf16 v[88:91], v[176:179], a[28:31], v[88:91]
ds_read_b64_tr_b16 v[162:163], v226 offset:6144
s_add_u32 m0, s43, 0
v_mfma_f32_16x16x32_bf16 v[68:71], v[180:183], a[16:19], v[68:71]
v_mfma_f32_16x16x32_bf16 v[76:79], v[180:183], a[20:23], v[76:79]
ds_read_b64_tr_b16 v[164:165], v227 offset:4096
s_add_u32 s44, s59, 516608
v_mfma_f32_16x16x32_bf16 v[84:87], v[180:183], a[24:27], v[84:87]
v_mfma_f32_16x16x32_bf16 v[92:95], v[180:183], a[28:31], v[92:95]
ds_read_b64_tr_b16 v[166:167], v227 offset:6144
s_waitcnt lgkmcnt(4)
v_mfma_f32_16x16x32_bf16 v[96:99], v[184:187], a[16:19], v[96:99]
v_mfma_f32_16x16x32_bf16 v[104:107], v[184:187], a[20:23], v[104:107]
ds_read_b64_tr_b16 v[168:169], v228 offset:4096
buffer_load_dwordx4 v230, s[32:35], s44 offen offset:0 lds
v_mfma_f32_16x16x32_bf16 v[112:115], v[184:187], a[24:27], v[112:115]
v_mfma_f32_16x16x32_bf16 v[120:123], v[184:187], a[28:31], v[120:123]
ds_read_b64_tr_b16 v[170:171], v228 offset:6144
buffer_load_dwordx4 v231, s[32:35], s44 offen offset:1024 lds
v_mfma_f32_16x16x32_bf16 v[100:103], v[188:191], a[16:19], v[100:103]
v_mfma_f32_16x16x32_bf16 v[108:111], v[188:191], a[20:23], v[108:111]
ds_read_b64_tr_b16 v[172:173], v229 offset:4096
buffer_load_dwordx4 v232, s[32:35], s44 offen offset:2048 lds
v_mfma_f32_16x16x32_bf16 v[116:119], v[188:191], a[24:27], v[116:119]
v_mfma_f32_16x16x32_bf16 v[124:127], v[188:191], a[28:31], v[124:127]
ds_read_b64_tr_b16 v[174:175], v229 offset:6144
s_waitcnt vmcnt(11) lgkmcnt(4)
v_mfma_f32_16x16x32_bf16 v[64:67], v[160:163], a[32:35], v[64:67]
v_mfma_f32_16x16x32_bf16 v[72:75], v[160:163], a[36:39], v[72:75]
ds_read_b64_tr_b16 v[176:177], v226 offset:8192
buffer_load_dwordx4 v233, s[32:35], s44 offen offset:3072 lds
v_mfma_f32_16x16x32_bf16 v[80:83], v[160:163], a[40:43], v[80:83]
v_mfma_f32_16x16x32_bf16 v[88:91], v[160:163], a[44:47], v[88:91]
ds_read_b64_tr_b16 v[178:179], v226 offset:10240
s_add_u32 m0, s43, 4096
v_mfma_f32_16x16x32_bf16 v[68:71], v[164:167], a[32:35], v[68:71]
v_mfma_f32_16x16x32_bf16 v[76:79], v[164:167], a[36:39], v[76:79]
ds_read_b64_tr_b16 v[180:181], v227 offset:8192
s_add_u32 s44, s59, 553472
v_mfma_f32_16x16x32_bf16 v[84:87], v[164:167], a[40:43], v[84:87]
v_mfma_f32_16x16x32_bf16 v[92:95], v[164:167], a[44:47], v[92:95]
ds_read_b64_tr_b16 v[182:183], v227 offset:10240
s_waitcnt lgkmcnt(4)
v_mfma_f32_16x16x32_bf16 v[96:99], v[168:171], a[32:35], v[96:99]
v_mfma_f32_16x16x32_bf16 v[104:107], v[168:171], a[36:39], v[104:107]
ds_read_b64_tr_b16 v[184:185], v228 offset:8192
buffer_load_dwordx4 v230, s[32:35], s44 offen offset:0 lds
v_mfma_f32_16x16x32_bf16 v[112:115], v[168:171], a[40:43], v[112:115]
v_mfma_f32_16x16x32_bf16 v[120:123], v[168:171], a[44:47], v[120:123]
ds_read_b64_tr_b16 v[186:187], v228 offset:10240
buffer_load_dwordx4 v231, s[32:35], s44 offen offset:1024 lds
v_mfma_f32_16x16x32_bf16 v[100:103], v[172:175], a[32:35], v[100:103]
v_mfma_f32_16x16x32_bf16 v[108:111], v[172:175], a[36:39], v[108:111]
ds_read_b64_tr_b16 v[188:189], v229 offset:8192
buffer_load_dwordx4 v232, s[32:35], s44 offen offset:2048 lds
v_mfma_f32_16x16x32_bf16 v[116:119], v[172:175], a[40:43], v[116:119]
v_mfma_f32_16x16x32_bf16 v[124:127], v[172:175], a[44:47], v[124:127]
ds_read_b64_tr_b16 v[190:191], v229 offset:10240
s_waitcnt vmcnt(11) lgkmcnt(4)
v_mfma_f32_16x16x32_bf16 v[64:67], v[176:179], a[48:51], v[64:67]
v_mfma_f32_16x16x32_bf16 v[72:75], v[176:179], a[52:55], v[72:75]
ds_read_b64_tr_b16 v[160:161], v226 offset:12288
buffer_load_dwordx4 v233, s[32:35], s44 offen offset:3072 lds
v_mfma_f32_16x16x32_bf16 v[80:83], v[176:179], a[56:59], v[80:83]
s_add_u32 m0, s67, 0
s_add_u32 s44, s66, 0
v_mfma_f32_16x16x32_bf16 v[88:91], v[176:179], a[60:63], v[88:91]
ds_read_b64_tr_b16 v[162:163], v226 offset:14336
buffer_load_dwordx4 v230, s[32:35], s44 offen offset:0 lds
v_mfma_f32_16x16x32_bf16 v[68:71], v[180:183], a[48:51], v[68:71]
v_mfma_f32_16x16x32_bf16 v[76:79], v[180:183], a[52:55], v[76:79]
ds_read_b64_tr_b16 v[164:165], v227 offset:12288
buffer_load_dwordx4 v231, s[32:35], s44 offen offset:1024 lds
v_mfma_f32_16x16x32_bf16 v[84:87], v[180:183], a[56:59], v[84:87]
v_mfma_f32_16x16x32_bf16 v[92:95], v[180:183], a[60:63], v[92:95]
ds_read_b64_tr_b16 v[166:167], v227 offset:14336
s_waitcnt lgkmcnt(4)
v_mfma_f32_16x16x32_bf16 v[96:99], v[184:187], a[48:51], v[96:99]
buffer_load_dwordx4 v232, s[32:35], s44 offen offset:2048 lds
v_mfma_f32_16x16x32_bf16 v[104:107], v[184:187], a[52:55], v[104:107]
ds_read_b64_tr_b16 v[168:169], v228 offset:12288
v_mfma_f32_16x16x32_bf16 v[112:115], v[184:187], a[56:59], v[112:115]
buffer_load_dwordx4 v233, s[32:35], s44 offen offset:3072 lds
s_add_u32 m0, s67, 16384
v_mfma_f32_16x16x32_bf16 v[120:123], v[184:187], a[60:63], v[120:123]
ds_read_b64_tr_b16 v[170:171], v228 offset:14336
s_add_u32 s44, s66, 147456
v_mfma_f32_16x16x32_bf16 v[100:103], v[188:191], a[48:51], v[100:103]
buffer_load_dwordx4 v230, s[32:35], s44 offen offset:0 lds
v_mfma_f32_16x16x32_bf16 v[108:111], v[188:191], a[52:55], v[108:111]
ds_read_b64_tr_b16 v[172:173], v229 offset:12288
v_mfma_f32_16x16x32_bf16 v[116:119], v[188:191], a[56:59], v[116:119]
buffer_load_dwordx4 v231, s[32:35], s44 offen offset:1024 lds
v_mfma_f32_16x16x32_bf16 v[124:127], v[188:191], a[60:63], v[124:127]
ds_read_b64_tr_b16 v[174:175], v229 offset:14336
s_waitcnt vmcnt(14) lgkmcnt(4)
v_mfma_f32_16x16x32_bf16 v[64:67], v[160:163], a[64:67], v[64:67]
buffer_load_dwordx4 v232, s[32:35], s44 offen offset:2048 lds
v_mfma_f32_16x16x32_bf16 v[72:75], v[160:163], a[68:71], v[72:75]
ds_read_b64_tr_b16 v[176:177], v226 offset:16384
v_mfma_f32_16x16x32_bf16 v[80:83], v[160:163], a[72:75], v[80:83]
buffer_load_dwordx4 v233, s[32:35], s44 offen offset:3072 lds
s_add_u32 m0, s67, 32768
v_mfma_f32_16x16x32_bf16 v[88:91], v[160:163], a[76:79], v[88:91]
ds_read_b64_tr_b16 v[178:179], v226 offset:18432
s_barrier
v_mfma_f32_16x16x32_bf16 v[68:71], v[164:167], a[64:67], v[68:71]
buffer_store_dword v255, v254, s[36:39], s53 offen offset:1536 sc1
s_add_u32 s44, s66, 294912
v_mfma_f32_16x16x32_bf16 v[76:79], v[164:167], a[68:71], v[76:79]
ds_read_b64_tr_b16 v[180:181], v227 offset:16384
buffer_load_dwordx4 v230, s[32:35], s44 offen offset:0 lds
v_mfma_f32_16x16x32_bf16 v[84:87], v[164:167], a[72:75], v[84:87]
v_mfma_f32_16x16x32_bf16 v[92:95], v[164:167], a[76:79], v[92:95]
ds_read_b64_tr_b16 v[182:183], v227 offset:18432
s_waitcnt lgkmcnt(4)
v_mfma_f32_16x16x32_bf16 v[96:99], v[168:171], a[64:67], v[96:99]
buffer_load_dwordx4 v231, s[32:35], s44 offen offset:1024 lds
s_bitcmp1_b32 s40, 0
s_cselect_b64 vcc, -1, 0
v_mfma_f32_16x16x32_bf16 v[104:107], v[168:171], a[68:71], v[104:107]
ds_read_b64_tr_b16 v[184:185], v228 offset:16384
v_cndmask_b32 v0, v0, v16, vcc
v_mfma_f32_16x16x32_bf16 v[112:115], v[168:171], a[72:75], v[112:115]
buffer_load_dwordx4 v232, s[32:35], s44 offen offset:2048 lds
v_mfma_f32_16x16x32_bf16 v[120:123], v[168:171], a[76:79], v[120:123]
ds_read_b64_tr_b16 v[186:187], v228 offset:18432
v_cndmask_b32 v1, v1, v17, vcc
v_mfma_f32_16x16x32_bf16 v[100:103], v[172:175], a[64:67], v[100:103]
buffer_load_dwordx4 v233, s[32:35], s44 offen offset:3072 lds
s_add_u32 m0, s67, 49152
v_mfma_f32_16x16x32_bf16 v[108:111], v[172:175], a[68:71], v[108:111]
ds_read_b64_tr_b16 v[188:189], v229 offset:16384
s_add_u32 s44, s66, 442368
v_mfma_f32_16x16x32_bf16 v[116:119], v[172:175], a[72:75], v[116:119]
buffer_load_dwordx4 v230, s[32:35], s44 offen offset:0 lds
v_cndmask_b32 v2, v2, v18, vcc
v_mfma_f32_16x16x32_bf16 v[124:127], v[172:175], a[76:79], v[124:127]
ds_read_b64_tr_b16 v[190:191], v229 offset:18432
s_waitcnt vmcnt(18) lgkmcnt(4)
v_mfma_f32_16x16x32_bf16 v[64:67], v[176:179], a[80:83], v[64:67]
buffer_load_dwordx4 v231, s[32:35], s44 offen offset:1024 lds
v_mfma_f32_16x16x32_bf16 v[72:75], v[176:179], a[84:87], v[72:75]
ds_read_b64_tr_b16 v[160:161], v226 offset:0
v_cndmask_b32 v3, v3, v19, vcc
v_mfma_f32_16x16x32_bf16 v[80:83], v[176:179], a[88:91], v[80:83]
buffer_load_dwordx4 v232, s[32:35], s44 offen offset:2048 lds
v_mfma_f32_16x16x32_bf16 v[88:91], v[176:179], a[92:95], v[88:91]
ds_read_b64_tr_b16 v[162:163], v226 offset:2048
v_mfma_f32_16x16x32_bf16 v[68:71], v[180:183], a[80:83], v[68:71]
buffer_load_dwordx4 v233, s[32:35], s44 offen offset:3072 lds
v_cndmask_b32 v32, v32, v48, vcc
v_mfma_f32_16x16x32_bf16 v[76:79], v[180:183], a[84:87], v[76:79]
ds_read_b64_tr_b16 v[164:165], v227 offset:0
v_mfma_f32_16x16x32_bf16 v[84:87], v[180:183], a[88:91], v[84:87]
v_mfma_f32_16x16x32_bf16 v[92:95], v[180:183], a[92:95], v[92:95]
ds_read_b64_tr_b16 v[166:167], v227 offset:2048
s_waitcnt lgkmcnt(4)
v_mfma_f32_16x16x32_bf16 v[96:99], v[184:187], a[80:83], v[96:99]
v_mfma_f32_16x16x32_bf16 v[104:107], v[184:187], a[84:87], v[104:107]
ds_read_b64_tr_b16 v[168:169], v228 offset:0
v_cndmask_b32 v33, v33, v49, vcc
v_mfma_f32_16x16x32_bf16 v[112:115], v[184:187], a[88:91], v[112:115]
v_mfma_f32_16x16x32_bf16 v[120:123], v[184:187], a[92:95], v[120:123]
ds_read_b64_tr_b16 v[170:171], v228 offset:2048
v_cndmask_b32 v34, v34, v50, vcc
v_mfma_f32_16x16x32_bf16 v[100:103], v[188:191], a[80:83], v[100:103]
v_mfma_f32_16x16x32_bf16 v[108:111], v[188:191], a[84:87], v[108:111]
ds_read_b64_tr_b16 v[172:173], v229 offset:0
v_cndmask_b32 v35, v35, v51, vcc
v_mfma_f32_16x16x32_bf16 v[116:119], v[188:191], a[88:91], v[116:119]
v_mfma_f32_16x16x32_bf16 v[124:127], v[188:191], a[92:95], v[124:127]
ds_read_b64_tr_b16 v[174:175], v229 offset:2048
s_waitcnt vmcnt(17) lgkmcnt(4)
v_mfma_f32_16x16x32_bf16 v[64:67], v[160:163], a[96:99], v[64:67]
v_mfma_f32_16x16x32_bf16 v[72:75], v[160:163], a[100:103], v[72:75]
ds_read_b64_tr_b16 v[176:177], v226 offset:4096
v_mov_b32_dpp v0, v32 row_shr:8 row_mask:0xf bank_mask:0xc
v_mfma_f32_16x16x32_bf16 v[80:83], v[160:163], a[104:107], v[80:83]
v_mfma_f32_16x16x32_bf16 v[88:91], v[160:163], a[108:111], v[88:91]
ds_read_b64_tr_b16 v[178:179], v226 offset:6144
v_mov_b32_dpp v1, v33 row_shr:8 row_mask:0xf bank_mask:0xc
v_mfma_f32_16x16x32_bf16 v[68:71], v[164:167], a[96:99], v[68:71]
v_mfma_f32_16x16x32_bf16 v[76:79], v[164:167], a[100:103], v[76:79]
ds_read_b64_tr_b16 v[180:181], v227 offset:4096
v_mfma_f32_16x16x32_bf16 v[84:87], v[164:167], a[104:107], v[84:87]
v_mov_b32_dpp v2, v34 row_shr:8 row_mask:0xf bank_mask:0xc
v_mfma_f32_16x16x32_bf16 v[92:95], v[164:167], a[108:111], v[92:95]
ds_read_b64_tr_b16 v[182:183], v227 offset:6144
s_waitcnt lgkmcnt(4)
v_mfma_f32_16x16x32_bf16 v[96:99], v[168:171], a[96:99], v[96:99]
v_mfma_f32_16x16x32_bf16 v[104:107], v[168:171], a[100:103], v[104:107]
ds_read_b64_tr_b16 v[184:185], v228 offset:4096
v_mov_b32_dpp v3, v35 row_shr:8 row_mask:0xf bank_mask:0xc
v_mfma_f32_16x16x32_bf16 v[112:115], v[168:171], a[104:107], v[112:115]
v_mfma_f32_16x16x32_bf16 v[120:123], v[168:171], a[108:111], v[120:123]
ds_read_b64_tr_b16 v[186:187], v228 offset:6144
v_mfma_f32_16x16x32_bf16 v[100:103], v[172:175], a[96:99], v[100:103]
v_mfma_f32_16x16x32_bf16 v[108:111], v[172:175], a[100:103], v[108:111]
ds_read_b64_tr_b16 v[188:189], v229 offset:4096
v_mfma_f32_16x16x32_bf16 v[116:119], v[172:175], a[104:107], v[116:119]
v_mfma_f32_16x16x32_bf16 v[124:127], v[172:175], a[108:111], v[124:127]
ds_read_b64_tr_b16 v[190:191], v229 offset:6144
s_waitcnt lgkmcnt(4)
v_mfma_f32_16x16x32_bf16 v[64:67], v[176:179], a[112:115], v[64:67]
v_mfma_f32_16x16x32_bf16 v[72:75], v[176:179], a[116:119], v[72:75]
v_mfma_f32_16x16x32_bf16 v[80:83], v[176:179], a[120:123], v[80:83]
v_mfma_f32_16x16x32_bf16 v[88:91], v[176:179], a[124:127], v[88:91]
s_waitcnt vmcnt(9)
s_barrier
v_mfma_f32_16x16x32_bf16 v[68:71], v[180:183], a[112:115], v[68:71]
ds_read_b64_tr_b16 v[160:161], v242 offset:0
buffer_load_dwordx4 v[208:211], v220, s[16:19], s8 offen offset:0
v_mfma_f32_16x16x32_bf16 v[76:79], v[180:183], a[116:119], v[76:79]
ds_read_b64_tr_b16 v[162:163], v242 offset:2048
v_mfma_f32_16x16x32_bf16 v[84:87], v[180:183], a[120:123], v[84:87]
ds_read_b64_tr_b16 v[164:165], v243 offset:0
buffer_load_dwordx4 v[212:215], v220, s[16:19], s8 offen offset:512
v_mfma_f32_16x16x32_bf16 v[92:95], v[180:183], a[124:127], v[92:95]
ds_read_b64_tr_b16 v[166:167], v243 offset:2048
s_waitcnt lgkmcnt(4)
v_mfma_f32_16x16x32_bf16 v[96:99], v[184:187], a[112:115], v[96:99]
ds_read_b64_tr_b16 v[168:169], v242 offset:4096
buffer_load_dwordx4 v[216:219], v221, s[16:19], s9 offen offset:1024
v_mfma_f32_16x16x32_bf16 v[104:107], v[184:187], a[116:119], v[104:107]
ds_read_b64_tr_b16 v[170:171], v242 offset:6144
v_mfma_f32_16x16x32_bf16 v[112:115], v[184:187], a[120:123], v[112:115]
ds_read_b64_tr_b16 v[172:173], v243 offset:4096
v_mfma_f32_16x16x32_bf16 v[120:123], v[184:187], a[124:127], v[120:123]
ds_read_b64_tr_b16 v[174:175], v243 offset:6144
v_mfma_f32_16x16x32_bf16 v[100:103], v[188:191], a[112:115], v[100:103]
ds_read_b64_tr_b16 v[176:177], v242 offset:8192
v_mfma_f32_16x16x32_bf16 v[108:111], v[188:191], a[116:119], v[108:111]
ds_read_b64_tr_b16 v[178:179], v242 offset:10240
v_mfma_f32_16x16x32_bf16 v[116:119], v[188:191], a[120:123], v[116:119]
ds_read_b64_tr_b16 v[180:181], v243 offset:8192
v_mfma_f32_16x16x32_bf16 v[124:127], v[188:191], a[124:127], v[124:127]
ds_read_b64_tr_b16 v[182:183], v243 offset:10240
s_waitcnt lgkmcnt(8)
v_mfma_f32_16x16x32_bf16 v[192:195], v[160:163], a[128:131], 0
ds_read_b64_tr_b16 v[184:185], v242 offset:12288
v_mfma_f32_16x16x32_bf16 v[200:203], v[160:163], a[132:135], 0
ds_read_b64_tr_b16 v[186:187], v242 offset:14336
v_cvt_pk_bf16_f32 v64, v64, v65
v_mfma_f32_16x16x32_bf16 v[196:199], v[164:167], a[128:131], 0
ds_read_b64_tr_b16 v[188:189], v243 offset:12288
v_cvt_pk_bf16_f32 v65, v66, v67
v_mfma_f32_16x16x32_bf16 v[204:207], v[164:167], a[132:135], 0
ds_read_b64_tr_b16 v[190:191], v243 offset:14336
s_waitcnt lgkmcnt(8)
v_mfma_f32_16x16x32_bf16 v[192:195], v[168:171], a[144:147], v[192:195]
ds_read_b64_tr_b16 v[160:161], v242 offset:16384
v_cvt_pk_bf16_f32 v66, v68, v69
v_mfma_f32_16x16x32_bf16 v[200:203], v[168:171], a[148:151], v[200:203]
ds_read_b64_tr_b16 v[162:163], v242 offset:18432
v_cvt_pk_bf16_f32 v67, v70, v71
v_mfma_f32_16x16x32_bf16 v[196:199], v[172:175], a[144:147], v[196:199]
ds_read_b64_tr_b16 v[164:165], v243 offset:16384
buffer_store_dwordx4 v[64:67], v244, s[36:39], s62 offen offset:0 sc1
v_mfma_f32_16x16x32_bf16 v[204:207], v[172:175], a[148:151], v[204:207]
ds_read_b64_tr_b16 v[166:167], v243 offset:18432
s_waitcnt lgkmcnt(8)
v_mfma_f32_16x16x32_bf16 v[192:195], v[176:179], a[0:3], v[192:195]
ds_read_b64_tr_b16 v[168:169], v242 offset:20480
v_cvt_pk_bf16_f32 v72, v72, v73
v_mfma_f32_16x16x32_bf16 v[200:203], v[176:179], a[4:7], v[200:203]
ds_read_b64_tr_b16 v[170:171], v242 offset:22528
v_cvt_pk_bf16_f32 v73, v74, v75
v_mfma_f32_16x16x32_bf16 v[196:199], v[180:183], a[0:3], v[196:199]
ds_read_b64_tr_b16 v[172:173], v243 offset:20480
v_cvt_pk_bf16_f32 v74, v76, v77
v_mfma_f32_16x16x32_bf16 v[204:207], v[180:183], a[4:7], v[204:207]
ds_read_b64_tr_b16 v[174:175], v243 offset:22528
s_waitcnt lgkmcnt(8)
v_mfma_f32_16x16x32_bf16 v[192:195], v[184:187], a[16:19], v[192:195]
ds_read_b64_tr_b16 v[176:177], v242 offset:24576
v_cvt_pk_bf16_f32 v75, v78, v79
v_mfma_f32_16x16x32_bf16 v[200:203], v[184:187], a[20:23], v[200:203]
ds_read_b64_tr_b16 v[178:179], v242 offset:26624
buffer_store_dwordx4 v[72:75], v238, s[36:39], s62 offen offset:1024 sc1
v_mfma_f32_16x16x32_bf16 v[196:199], v[188:191], a[16:19], v[196:199]
ds_read_b64_tr_b16 v[180:181], v243 offset:24576
v_cvt_pk_bf16_f32 v80, v80, v81
v_mfma_f32_16x16x32_bf16 v[204:207], v[188:191], a[20:23], v[204:207]
ds_read_b64_tr_b16 v[182:183], v243 offset:26624
s_waitcnt lgkmcnt(8)
v_mfma_f32_16x16x32_bf16 v[192:195], v[160:163], a[160:163], v[192:195]
ds_read_b64_tr_b16 v[184:185], v242 offset:28672
v_cvt_pk_bf16_f32 v81, v82, v83
v_mfma_f32_16x16x32_bf16 v[200:203], v[160:163], a[164:167], v[200:203]
ds_read_b64_tr_b16 v[186:187], v242 offset:30720
v_cvt_pk_bf16_f32 v82, v84, v85
v_mfma_f32_16x16x32_bf16 v[196:199], v[164:167], a[160:163], v[196:199]
ds_read_b64_tr_b16 v[188:189], v243 offset:28672
v_cvt_pk_bf16_f32 v83, v86, v87
v_mfma_f32_16x16x32_bf16 v[204:207], v[164:167], a[164:167], v[204:207]
ds_read_b64_tr_b16 v[190:191], v243 offset:30720
s_waitcnt lgkmcnt(8)
s_waitcnt vmcnt(5)
s_barrier
v_mfma_f32_16x16x32_bf16 v[192:195], v[168:171], a[176:179], v[192:195]
ds_read_b64_tr_b16 v[160:161], v242 offset:32768
buffer_store_dwordx4 v[80:83], v245, s[36:39], s62 offen offset:0 sc1
v_mfma_f32_16x16x32_bf16 v[200:203], v[168:171], a[180:183], v[200:203]
ds_read_b64_tr_b16 v[162:163], v242 offset:34816
v_cvt_pk_bf16_f32 v88, v88, v89
v_mfma_f32_16x16x32_bf16 v[196:199], v[172:175], a[176:179], v[196:199]
ds_read_b64_tr_b16 v[164:165], v243 offset:32768
v_cvt_pk_bf16_f32 v89, v90, v91
v_mfma_f32_16x16x32_bf16 v[204:207], v[172:175], a[180:183], v[204:207]
ds_read_b64_tr_b16 v[166:167], v243 offset:34816
s_waitcnt lgkmcnt(8)
v_mfma_f32_16x16x32_bf16 v[192:195], v[176:179], a[32:35], v[192:195]
ds_read_b64_tr_b16 v[168:169], v242 offset:36864
v_cvt_pk_bf16_f32 v90, v92, v93
v_mfma_f32_16x16x32_bf16 v[200:203], v[176:179], a[36:39], v[200:203]
ds_read_b64_tr_b16 v[170:171], v242 offset:38912
v_cvt_pk_bf16_f32 v91, v94, v95
v_mfma_f32_16x16x32_bf16 v[196:199], v[180:183], a[32:35], v[196:199]
ds_read_b64_tr_b16 v[172:173], v243 offset:36864
buffer_store_dwordx4 v[88:91], v239, s[36:39], s62 offen offset:1024 sc1
v_mfma_f32_16x16x32_bf16 v[204:207], v[180:183], a[36:39], v[204:207]
ds_read_b64_tr_b16 v[174:175], v243 offset:38912
s_waitcnt lgkmcnt(8)
v_mfma_f32_16x16x32_bf16 v[192:195], v[184:187], a[48:51], v[192:195]
ds_read_b64_tr_b16 v[176:177], v242 offset:40960
v_cvt_pk_bf16_f32 v96, v96, v97
v_mfma_f32_16x16x32_bf16 v[200:203], v[184:187], a[52:55], v[200:203]
ds_read_b64_tr_b16 v[178:179], v242 offset:43008
v_cvt_pk_bf16_f32 v97, v98, v99
v_mfma_f32_16x16x32_bf16 v[196:199], v[188:191], a[48:51], v[196:199]
ds_read_b64_tr_b16 v[180:181], v243 offset:40960
v_cvt_pk_bf16_f32 v98, v100, v101
v_mfma_f32_16x16x32_bf16 v[204:207], v[188:191], a[52:55], v[204:207]
ds_read_b64_tr_b16 v[182:183], v243 offset:43008
s_waitcnt lgkmcnt(8)
v_mfma_f32_16x16x32_bf16 v[192:195], v[160:163], a[192:195], v[192:195]
ds_read_b64_tr_b16 v[184:185], v242 offset:45056
v_cvt_pk_bf16_f32 v99, v102, v103
v_mfma_f32_16x16x32_bf16 v[200:203], v[160:163], a[196:199], v[200:203]
ds_read_b64_tr_b16 v[186:187], v242 offset:47104
buffer_store_dwordx4 v[96:99], v244, s[36:39], s63 offen offset:0 sc1
v_mfma_f32_16x16x32_bf16 v[196:199], v[164:167], a[192:195], v[196:199]
ds_read_b64_tr_b16 v[188:189], v243 offset:45056
v_cvt_pk_bf16_f32 v104, v104, v105
v_mfma_f32_16x16x32_bf16 v[204:207], v[164:167], a[196:199], v[204:207]
ds_read_b64_tr_b16 v[190:191], v243 offset:47104
s_waitcnt lgkmcnt(8)
v_mfma_f32_16x16x32_bf16 v[192:195], v[168:171], a[208:211], v[192:195]
ds_read_b64_tr_b16 v[160:161], v242 offset:49152
v_cvt_pk_bf16_f32 v105, v106, v107
v_mfma_f32_16x16x32_bf16 v[200:203], v[168:171], a[212:215], v[200:203]
ds_read_b64_tr_b16 v[162:163], v242 offset:51200
v_cvt_pk_bf16_f32 v106, v108, v109
v_mfma_f32_16x16x32_bf16 v[196:199], v[172:175], a[208:211], v[196:199]
ds_read_b64_tr_b16 v[164:165], v243 offset:49152
v_cvt_pk_bf16_f32 v107, v110, v111
v_mfma_f32_16x16x32_bf16 v[204:207], v[172:175], a[212:215], v[204:207]
ds_read_b64_tr_b16 v[166:167], v243 offset:51200
s_waitcnt lgkmcnt(8)
v_mfma_f32_16x16x32_bf16 v[192:195], v[176:179], a[64:67], v[192:195]
ds_read_b64_tr_b16 v[168:169], v242 offset:53248
buffer_store_dwordx4 v[104:107], v238, s[36:39], s63 offen offset:1024 sc1
v_mfma_f32_16x16x32_bf16 v[200:203], v[176:179], a[68:71], v[200:203]
ds_read_b64_tr_b16 v[170:171], v242 offset:55296
v_cvt_pk_bf16_f32 v112, v112, v113
v_mfma_f32_16x16x32_bf16 v[196:199], v[180:183], a[64:67], v[196:199]
ds_read_b64_tr_b16 v[172:173], v243 offset:53248
v_cvt_pk_bf16_f32 v113, v114, v115
v_mfma_f32_16x16x32_bf16 v[204:207], v[180:183], a[68:71], v[204:207]
ds_read_b64_tr_b16 v[174:175], v243 offset:55296
s_waitcnt lgkmcnt(8)
v_mfma_f32_16x16x32_bf16 v[192:195], v[184:187], a[80:83], v[192:195]
ds_read_b64_tr_b16 v[176:177], v242 offset:57344
v_cvt_pk_bf16_f32 v114, v116, v117
v_mfma_f32_16x16x32_bf16 v[200:203], v[184:187], a[84:87], v[200:203]
ds_read_b64_tr_b16 v[178:179], v242 offset:59392
v_cvt_pk_bf16_f32 v115, v118, v119
v_mfma_f32_16x16x32_bf16 v[196:199], v[188:191], a[80:83], v[196:199]
ds_read_b64_tr_b16 v[180:181], v243 offset:57344
buffer_store_dwordx4 v[112:115], v245, s[36:39], s63 offen offset:0 sc1
v_mfma_f32_16x16x32_bf16 v[204:207], v[188:191], a[84:87], v[204:207]
ds_read_b64_tr_b16 v[182:183], v243 offset:59392
s_waitcnt lgkmcnt(8)
v_mfma_f32_16x16x32_bf16 v[192:195], v[160:163], a[224:227], v[192:195]
ds_read_b64_tr_b16 v[184:185], v242 offset:61440
v_cvt_pk_bf16_f32 v120, v120, v121
v_mfma_f32_16x16x32_bf16 v[200:203], v[160:163], a[228:231], v[200:203]
ds_read_b64_tr_b16 v[186:187], v242 offset:63488
v_cvt_pk_bf16_f32 v121, v122, v123
v_mfma_f32_16x16x32_bf16 v[196:199], v[164:167], a[224:227], v[196:199]
ds_read_b64_tr_b16 v[188:189], v243 offset:61440
v_cvt_pk_bf16_f32 v122, v124, v125
v_mfma_f32_16x16x32_bf16 v[204:207], v[164:167], a[228:231], v[204:207]
ds_read_b64_tr_b16 v[190:191], v243 offset:63488
s_waitcnt lgkmcnt(8)
v_mfma_f32_16x16x32_bf16 v[192:195], v[168:171], a[240:243], v[192:195]
v_cvt_pk_bf16_f32 v123, v126, v127
v_mfma_f32_16x16x32_bf16 v[200:203], v[168:171], a[244:247], v[200:203]
buffer_store_dwordx4 v[120:123], v239, s[36:39], s63 offen offset:1024 sc1
v_mfma_f32_16x16x32_bf16 v[196:199], v[172:175], a[240:243], v[196:199]
v_mfma_f32_16x16x32_bf16 v[204:207], v[172:175], a[244:247], v[204:207]
s_waitcnt lgkmcnt(4)
v_mfma_f32_16x16x32_bf16 v[192:195], v[176:179], a[96:99], v[192:195]
v_mfma_f32_16x16x32_bf16 v[200:203], v[176:179], a[100:103], v[200:203]
v_mfma_f32_16x16x32_bf16 v[196:199], v[180:183], a[96:99], v[196:199]
v_mfma_f32_16x16x32_bf16 v[204:207], v[180:183], a[100:103], v[204:207]
s_waitcnt lgkmcnt(0)
v_mfma_f32_16x16x32_bf16 v[192:195], v[184:187], a[112:115], v[192:195]
v_mfma_f32_16x16x32_bf16 v[200:203], v[184:187], a[116:119], v[200:203]
v_mfma_f32_16x16x32_bf16 v[196:199], v[188:191], a[112:115], v[196:199]
v_mfma_f32_16x16x32_bf16 v[204:207], v[188:191], a[116:119], v[204:207]
s_nop 4
v_cvt_pk_bf16_f32 v192, v192, v193
v_cvt_pk_bf16_f32 v193, v194, v195
v_cvt_pk_bf16_f32 v194, v196, v197
v_cvt_pk_bf16_f32 v195, v198, v199
buffer_store_dwordx4 v[192:195], v238, s[36:39], s64 offen offset:0 sc1
v_cvt_pk_bf16_f32 v200, v200, v201
v_cvt_pk_bf16_f32 v201, v202, v203
v_cvt_pk_bf16_f32 v202, v204, v205
v_cvt_pk_bf16_f32 v203, v206, v207
buffer_store_dwordx4 v[200:203], v238, s[36:39], s64 offen offset:1024 sc1
s_bitcmp1_b32 s40, 0
s_cselect_b64 vcc, -1, 0
v_cndmask_b32 v40, v64, v80, vcc
v_cndmask_b32 v41, v65, v81, vcc
v_cndmask_b32 v42, v66, v82, vcc
v_cndmask_b32 v43, v67, v83, vcc
v_cndmask_b32 v96, v96, v112, vcc
v_cndmask_b32 v97, v97, v113, vcc
v_cndmask_b32 v98, v98, v114, vcc
v_cndmask_b32 v99, v99, v115, vcc
v_mov_b32_dpp v40, v96 row_shr:8 row_mask:0xf bank_mask:0xc
v_mov_b32_dpp v41, v97 row_shr:8 row_mask:0xf bank_mask:0xc
v_mov_b32_dpp v42, v98 row_shr:8 row_mask:0xf bank_mask:0xc
v_mov_b32_dpp v43, v99 row_shr:8 row_mask:0xf bank_mask:0xc
s_lshl_b32 s45, s40, 3
s_mul_i32 s46, s40, -6
s_add_u32 s46, s46, 64
v_bfe_u32 v200, v224, 8, 1
v_bfe_u32 v201, v224, 7, 1
v_bfe_u32 v202, v224, 9, 1
v_add_u32 v200, s45, v200
v_lshl_add_u32 v201, v201, 1, v202
v_lshl_add_u32 v126, v201, 1, v200
v_add_u32 v127, s46, v200
v_and_b32 v200, 0x70, v224
v_mul_u32_u24 v202, 72, v200
v_lshrrev_b32 v203, 2, v126
v_lshl_add_u32 v120, v203, 12, v200
v_lshl_add_u32 v124, v203, 6, v202
v_and_b32 v203, 3, v126
v_lshl_add_u32 v120, v203, 8, v120
v_lshrrev_b32 v203, 1, v203
v_lshl_add_u32 v124, v203, 4, v124
v_and_b32 v203, 1, v126
v_lshl_add_u32 v124, v203, 5, v124
v_lshlrev_b32 v126, 4, v126
v_add_u32 v126, 155648, v126
v_lshrrev_b32 v203, 2, v127
v_lshl_add_u32 v123, v203, 12, v200
v_lshl_add_u32 v125, v203, 6, v202
v_and_b32 v203, 3, v127
v_lshl_add_u32 v123, v203, 8, v123
v_lshrrev_b32 v203, 1, v203
v_lshl_add_u32 v125, v203, 4, v125
v_and_b32 v203, 1, v127
v_lshl_add_u32 v125, v203, 5, v125
v_lshlrev_b32 v127, 4, v127
v_add_u32 v127, 155648, v127
v_add_u32 v121, 32768, v120
s_and_b32 s45, s42, 3
v_xor_b32 v202, s45, v201
v_mul_u32_u24 v202, 73728, v202
v_mul_u32_u24 v200, 640, v201
v_and_b32 v200, 1152, v200
v_add3_u32 v122, v123, v202, v200
v_lshl_add_u32 v123, v201, 29, v123
s_lshr_b32 s45, s42, 1
s_lshl_b32 s45, s45, 10
s_and_b32 s46, s42, 1
s_lshl_b32 s46, s46, 7
s_add_u32 s48, s45, s46
s_lshl_b32 s45, s41, 3
s_add_u32 s45, s45, s42
s_mul_i32 s57, s45, 9216
s_andn2_b32 s46, s45, 3
s_mul_i32 s8, s46, 73728
s_add_u32 s8, s8, 1048576
s_xor_b32 s46, s46, 4
s_mul_i32 s47, s46, 73728
s_add_u32 s47, s47, 1050624
s_xor_b32 s46, s45, 1
s_mul_i32 s46, s46, 73728
s_add_u32 s9, s46, 1048704
s_xor_b32 s46, s45, 2
s_mul_i32 s46, s46, 73728
s_add_u32 s10, s46, 1049600
s_xor_b32 s46, s45, 3
s_mul_i32 s46, s46, 73728
s_add_u32 s11, s46, 1049728
s_xor_b32 s46, s45, 4
s_mul_i32 s46, s46, 73728
s_add_u32 s12, s46, 1050624
s_xor_b32 s46, s45, 5
s_mul_i32 s46, s46, 73728
s_add_u32 s13, s46, 1050752
s_xor_b32 s46, s45, 6
s_mul_i32 s46, s46, 73728
s_add_u32 s14, s46, 1051648
s_xor_b32 s46, s45, 7
s_mul_i32 s46, s46, 73728
s_add_u32 s15, s46, 1051776
ds_read_b128 v[140:143], v126 offset:0
ds_read_b128 v[144:147], v126 offset:512
ds_read_b128 v[148:151], v127 offset:0
ds_read_b128 v[188:191], v126 offset:1152
ds_read_b128 v[192:195], v126 offset:1664
ds_read_b128 v[196:199], v127 offset:1152
ds_read_b128 v[164:167], v126 offset:2304
ds_read_b128 v[168:171], v126 offset:2816
ds_read_b128 v[172:175], v127 offset:2304
s_lshl_b32 s45, s41, 3
s_add_u32 s45, s45, s42
s_mul_i32 s45, s45, 73728
s_add_u32 s45, s45, 41943040
s_lshl_b32 s46, s40, 13
s_add_u32 s60, s45, s46
s_add_u32 s61, s60, 4096
s_add_u32 s62, s60, 32768
s_add_u32 s63, s60, 36864
s_lshr_b32 s46, s40, 1
s_lshl_b32 s46, s46, 12
s_add_u32 s46, s46, s45
s_add_u32 s64, s46, 65536
s_mul_i32 s45, s42, 663552
s_add_u32 s45, s45, 1024
s_mul_i32 s46, s40, 18432
s_add_u32 s68, s45, s46
s_add_u32 s66, s68, s46
s_lshl_b32 s67, s40, 12
s_lshl_b32 s69, s40, 11
s_lshl_b32 s45, s40, 5
v_xor_b32 v244, s45, v225
v_add_u32 v245, 114688, v244
v_add_u32 v244, 73728, v244
s_lshl_b32 s45, s40, 13
v_add_u32 v246, s45, v238
v_add_u32 v247, s45, v239
s_lshr_b32 s45, s40, 1
s_lshl_b32 s45, s45, 12
s_and_b32 s46, s40, 1
s_lshl_b32 s46, s46, 3
s_add_u32 s45, s45, s46
v_add_u32 v220, s45, v240
v_add_u32 v221, s45, v241
s_waitcnt lgkmcnt(0)
s_buffer_load_dwordx8 s[92:99], s[36:39], s54 offset:1664
s_mov_b32 s49, 0x3e803e80
s_mov_b32 s70, 0x3fb8aa3b
v_and_b32 v204, 0x70, v224
v_lshlrev_b32 v204, 1, v204
v_add_u32 v204, 161280, v204
s_lshl_b32 s46, s40, 3
v_add_u32 v205, s46, v204
s_lshl_b32 s46, s40, 10
v_add_u32 v222, s46, v224
v_add_u32 v223, 65536, v222
v_lshlrev_b32 v128, 16, v140
v_and_b32 v129, 0xffff0000, v140
v_lshlrev_b32 v130, 16, v141
v_and_b32 v131, 0xffff0000, v141
v_lshlrev_b32 v132, 16, v142
v_and_b32 v133, 0xffff0000, v142
v_lshlrev_b32 v134, 16, v143
v_and_b32 v135, 0xffff0000, v143
v_lshlrev_b32 v136, 16, v144
v_and_b32 v137, 0xffff0000, v144
v_lshlrev_b32 v138, 16, v145
v_and_b32 v139, 0xffff0000, v145
v_lshlrev_b32 v140, 16, v146
v_and_b32 v141, 0xffff0000, v146
v_lshlrev_b32 v142, 16, v147
v_and_b32 v143, 0xffff0000, v147
v_lshlrev_b32 v144, 16, v148
v_and_b32 v145, 0xffff0000, v148
v_lshlrev_b32 v146, 16, v149
v_and_b32 v147, 0xffff0000, v149
v_lshlrev_b32 v148, 16, v150
v_and_b32 v149, 0xffff0000, v150
v_lshlrev_b32 v150, 16, v151
v_and_b32 v151, 0xffff0000, v151
v_lshlrev_b32 v176, 16, v188
v_and_b32 v177, 0xffff0000, v188
v_lshlrev_b32 v178, 16, v189
v_and_b32 v179, 0xffff0000, v189
v_lshlrev_b32 v180, 16, v190
v_and_b32 v181, 0xffff0000, v190
v_lshlrev_b32 v182, 16, v191
v_and_b32 v183, 0xffff0000, v191
v_lshlrev_b32 v184, 16, v192
v_and_b32 v185, 0xffff0000, v192
v_lshlrev_b32 v186, 16, v193
v_and_b32 v187, 0xffff0000, v193
v_lshlrev_b32 v188, 16, v194
v_and_b32 v189, 0xffff0000, v194
v_lshlrev_b32 v190, 16, v195
v_and_b32 v191, 0xffff0000, v195
v_lshlrev_b32 v192, 16, v196
v_and_b32 v193, 0xffff0000, v196
v_lshlrev_b32 v194, 16, v197
v_and_b32 v195, 0xffff0000, v197
v_lshlrev_b32 v196, 16, v198
v_and_b32 v197, 0xffff0000, v198
v_lshlrev_b32 v198, 16, v199
v_and_b32 v199, 0xffff0000, v199
v_lshlrev_b32 v152, 16, v164
v_and_b32 v153, 0xffff0000, v164
v_lshlrev_b32 v154, 16, v165
v_and_b32 v155, 0xffff0000, v165
v_lshlrev_b32 v156, 16, v166
v_and_b32 v157, 0xffff0000, v166
v_lshlrev_b32 v158, 16, v167
v_and_b32 v159, 0xffff0000, v167
v_lshlrev_b32 v160, 16, v168
v_and_b32 v161, 0xffff0000, v168
v_lshlrev_b32 v162, 16, v169
v_and_b32 v163, 0xffff0000, v169
s_lshl_b32 s45, s41, 2
s_add_u32 s45, s45, s40
s_mul_i32 s45, s45, 9
s_lshr_b32 s45, s45, 1
s_mul_i32 s45, s45, 9216
s_mul_i32 s46, s42, 1152
s_add_u32 s45, s45, s46
v_lshrrev_b32 v206, 7, v224
v_min_u32 v206, 4, v206
v_mul_u32_u24 v206, 9216, v206
v_and_b32 v207, 0x70, v224
v_min_u32 v207, 64, v207
v_lshl_add_u32 v206, v207, 3, v206
v_and_b32 v207, 64, v207
v_lshl_add_u32 v206, v207, 3, v206
v_add_u32 v203, s45, v206
s_waitcnt vmcnt(0)
s_barrier
buffer_store_dword v255, v254, s[36:39], s53 offen offset:0 sc1
s_mov_b32 s55, 1
s_waitcnt lgkmcnt(0)
s_mov_b32 s92, s3
s_mov_b32 s58, s3
s_mov_b32 s59, s3
s_xor_b64 s[92:93], s[92:93], s[58:59]
s_xor_b64 s[94:95], s[94:95], s[58:59]
s_xor_b64 s[96:97], s[96:97], s[58:59]
s_xor_b64 s[98:99], s[98:99], s[58:59]
s_or_b64 s[92:93], s[92:93], s[94:95]
s_or_b64 s[96:97], s[96:97], s[98:99]
s_or_b64 s[92:93], s[92:93], s[96:97]
s_cbranch_scc1 S1_SLOW1
s_buffer_load_dwordx8 s[20:27], s[36:39], s54 offset:128
buffer_load_dwordx4 v[4:7], v120, s[36:39], s9 offen
buffer_load_dwordx4 v[8:11], v120, s[36:39], s10 offen
buffer_load_dwordx4 v[12:15], v120, s[36:39], s11 offen
buffer_load_dwordx4 v[16:19], v120, s[36:39], s12 offen
buffer_load_dwordx4 v[20:23], v120, s[36:39], s13 offen
buffer_load_dwordx4 v[24:27], v120, s[36:39], s14 offen
buffer_load_dwordx4 v[28:31], v120, s[36:39], s15 offen
s_waitcnt lgkmcnt(0)
s_mov_b32 s20, s3
s_mov_b32 s58, s3
s_mov_b32 s59, s3
s_xor_b64 s[20:21], s[20:21], s[58:59]
s_xor_b64 s[22:23], s[22:23], s[58:59]
s_xor_b64 s[24:25], s[24:25], s[58:59]
s_xor_b64 s[26:27], s[26:27], s[58:59]
s_or_b64 s[20:21], s[20:21], s[22:23]
s_or_b64 s[24:25], s[24:25], s[26:27]
s_or_b64 s[20:21], s[20:21], s[24:25]
s_cbranch_scc1 S1_SLOW2
s_barrier
s_barrier
S1_B:
buffer_load_dwordx4 v[32:35], v122, s[36:39], s8 offen
buffer_load_dwordx4 v[36:39], v122, s[36:39], s47 offen
buffer_load_dwordx4 v[44:47], v121, s[36:39], s9 offen
buffer_load_dwordx4 v[48:51], v121, s[36:39], s10 offen
buffer_load_dwordx4 v[52:55], v121, s[36:39], s11 offen
buffer_load_dwordx4 v[56:59], v121, s[36:39], s12 offen
buffer_load_dwordx4 v[60:63], v121, s[36:39], s13 offen
buffer_load_dwordx4 v[64:67], v121, s[36:39], s14 offen
buffer_load_dwordx4 v[68:71], v121, s[36:39], s15 offen
v_lshlrev_b32 v164, 16, v170
v_and_b32 v165, 0xffff0000, v170
v_lshlrev_b32 v166, 16, v171
v_and_b32 v167, 0xffff0000, v171
v_lshlrev_b32 v168, 16, v172
v_and_b32 v169, 0xffff0000, v172
v_lshlrev_b32 v170, 16, v173
v_and_b32 v171, 0xffff0000, v173
v_lshlrev_b32 v172, 16, v174
v_and_b32 v173, 0xffff0000, v174
v_lshlrev_b32 v174, 16, v175
v_and_b32 v175, 0xffff0000, v175
v_mul_f32 v176, s70, v176
v_mul_f32 v177, s70, v177
v_mul_f32 v178, s70, v178
v_mul_f32 v179, s70, v179
v_mul_f32 v180, s70, v180
v_mul_f32 v181, s70, v181
v_mul_f32 v182, s70, v182
v_mul_f32 v183, s70, v183
v_mul_f32 v184, s70, v184
v_mul_f32 v185, s70, v185
v_mul_f32 v186, s70, v186
v_mul_f32 v187, s70, v187
v_mul_f32 v188, s70, v188
v_mul_f32 v189, s70, v189
v_mul_f32 v190, s70, v190
v_mul_f32 v191, s70, v191
v_mul_f32 v192, s70, v192
v_mul_f32 v193, s70, v193
v_mul_f32 v194, s70, v194
v_mul_f32 v195, s70, v195
v_mul_f32 v196, s70, v196
v_mul_f32 v197, s70, v197
v_mul_f32 v198, s70, v198
v_mul_f32 v199, s70, v199
v_fma_f32 v152, v152, s70, s70
v_fma_f32 v153, v153, s70, s70
v_fma_f32 v154, v154, s70, s70
v_fma_f32 v155, v155, s70, s70
v_fma_f32 v156, v156, s70, s70
v_fma_f32 v157, v157, s70, s70
v_fma_f32 v158, v158, s70, s70
v_fma_f32 v159, v159, s70, s70
v_fma_f32 v160, v160, s70, s70
v_fma_f32 v161, v161, s70, s70
v_fma_f32 v162, v162, s70, s70
v_fma_f32 v163, v163, s70, s70
v_fma_f32 v164, v164, s70, s70
v_fma_f32 v165, v165, s70, s70
v_fma_f32 v166, v166, s70, s70
v_fma_f32 v167, v167, s70, s70
v_fma_f32 v168, v168, s70, s70
v_fma_f32 v169, v169, s70, s70
v_fma_f32 v170, v170, s70, s70
v_fma_f32 v171, v171, s70, s70
v_fma_f32 v172, v172, s70, s70
v_fma_f32 v173, v173, s70, s70
v_fma_f32 v174, v174, s70, s70
v_fma_f32 v175, v175, s70, s70
v_permlane16_swap_b32 v208, v210
v_permlane16_swap_b32 v209, v211
v_permlane16_swap_b32 v212, v214
v_permlane16_swap_b32 v213, v215
v_permlane16_swap_b32 v216, v218
v_permlane16_swap_b32 v217, v219
v_lshlrev_b32 v72, 16, v208
v_and_b32 v73, 0xffff0000, v208
v_lshlrev_b32 v74, 16, v209
v_and_b32 v75, 0xffff0000, v209
v_lshlrev_b32 v76, 16, v210
v_and_b32 v77, 0xffff0000, v210
v_lshlrev_b32 v78, 16, v211
v_and_b32 v79, 0xffff0000, v211
v_lshlrev_b32 v80, 16, v212
v_and_b32 v81, 0xffff0000, v212
v_lshlrev_b32 v82, 16, v213
v_and_b32 v83, 0xffff0000, v213
v_lshlrev_b32 v84, 16, v214
v_and_b32 v85, 0xffff0000, v214
v_lshlrev_b32 v86, 16, v215
v_and_b32 v87, 0xffff0000, v215
v_lshlrev_b32 v88, 16, v216
v_and_b32 v89, 0xffff0000, v216
v_lshlrev_b32 v90, 16, v217
v_and_b32 v91, 0xffff0000, v217
v_lshlrev_b32 v92, 16, v218
v_and_b32 v93, 0xffff0000, v218
v_lshlrev_b32 v94, 16, v219
v_and_b32 v95, 0xffff0000, v219
v_dot2_f32_bf16 v96, v0, s101, 0
v_dot2_f32_bf16 v97, v0, s65, 0
v_dot2_f32_bf16 v98, v1, s101, 0
v_dot2_f32_bf16 v99, v1, s65, 0
v_dot2_f32_bf16 v100, v2, s101, 0
v_dot2_f32_bf16 v101, v2, s65, 0
v_dot2_f32_bf16 v102, v3, s101, 0
v_dot2_f32_bf16 v103, v3, s65, 0
s_waitcnt vmcnt(15)
v_dot2_f32_bf16 v96, v4, s101, v96
v_dot2_f32_bf16 v97, v4, s65, v97
v_dot2_f32_bf16 v98, v5, s101, v98
v_dot2_f32_bf16 v99, v5, s65, v99
v_dot2_f32_bf16 v100, v6, s101, v100
v_dot2_f32_bf16 v101, v6, s65, v101
v_dot2_f32_bf16 v102, v7, s101, v102
v_dot2_f32_bf16 v103, v7, s65, v103
s_waitcnt vmcnt(14)
v_dot2_f32_bf16 v96, v8, s101, v96
v_dot2_f32_bf16 v97, v8, s65, v97
v_dot2_f32_bf16 v98, v9, s101, v98
v_dot2_f32_bf16 v99, v9, s65, v99
v_dot2_f32_bf16 v100, v10, s101, v100
v_dot2_f32_bf16 v101, v10, s65, v101
v_dot2_f32_bf16 v102, v11, s101, v102
v_dot2_f32_bf16 v103, v11, s65, v103
s_waitcnt vmcnt(13)
v_dot2_f32_bf16 v96, v12, s101, v96
v_dot2_f32_bf16 v97, v12, s65, v97
v_dot2_f32_bf16 v98, v13, s101, v98
v_dot2_f32_bf16 v99, v13, s65, v99
v_dot2_f32_bf16 v100, v14, s101, v100
v_dot2_f32_bf16 v101, v14, s65, v101
v_dot2_f32_bf16 v102, v15, s101, v102
v_dot2_f32_bf16 v103, v15, s65, v103
s_waitcnt vmcnt(12)
v_dot2_f32_bf16 v96, v16, s101, v96
v_dot2_f32_bf16 v97, v16, s65, v97
v_dot2_f32_bf16 v98, v17, s101, v98
v_dot2_f32_bf16 v99, v17, s65, v99
v_dot2_f32_bf16 v100, v18, s101, v100
v_dot2_f32_bf16 v101, v18, s65, v101
v_dot2_f32_bf16 v102, v19, s101, v102
v_dot2_f32_bf16 v103, v19, s65, v103
s_waitcnt vmcnt(11)
v_dot2_f32_bf16 v96, v20, s101, v96
v_dot2_f32_bf16 v97, v20, s65, v97
v_dot2_f32_bf16 v98, v21, s101, v98
v_dot2_f32_bf16 v99, v21, s65, v99
v_dot2_f32_bf16 v100, v22, s101, v100
v_dot2_f32_bf16 v101, v22, s65, v101
v_dot2_f32_bf16 v102, v23, s101, v102
v_dot2_f32_bf16 v103, v23, s65, v103
s_waitcnt vmcnt(10)
v_dot2_f32_bf16 v96, v24, s101, v96
v_dot2_f32_bf16 v97, v24, s65, v97
v_dot2_f32_bf16 v98, v25, s101, v98
v_dot2_f32_bf16 v99, v25, s65, v99
v_dot2_f32_bf16 v100, v26, s101, v100
v_dot2_f32_bf16 v101, v26, s65, v101
v_dot2_f32_bf16 v102, v27, s101, v102
v_dot2_f32_bf16 v103, v27, s65, v103
s_waitcnt vmcnt(9)
v_dot2_f32_bf16 v96, v28, s101, v96
v_dot2_f32_bf16 v97, v28, s65, v97
v_dot2_f32_bf16 v98, v29, s101, v98
v_dot2_f32_bf16 v99, v29, s65, v99
v_dot2_f32_bf16 v100, v30, s101, v100
v_dot2_f32_bf16 v101, v30, s65, v101
v_dot2_f32_bf16 v102, v31, s101, v102
v_dot2_f32_bf16 v103, v31, s65, v103
v_pk_fma_f32 v[96:97], v[96:97], v[128:129], v[72:73]
v_pk_fma_f32 v[98:99], v[98:99], v[130:131], v[74:75]
v_pk_fma_f32 v[100:101], v[100:101], v[132:133], v[76:77]
v_pk_fma_f32 v[102:103], v[102:103], v[134:135], v[78:79]
s_waitcnt vmcnt(8)
v_dot2_f32_bf16 v112, v32, s101, 0
v_dot2_f32_bf16 v113, v32, s65, 0
v_dot2_f32_bf16 v114, v33, s101, 0
v_dot2_f32_bf16 v115, v33, s65, 0
v_dot2_f32_bf16 v116, v34, s101, 0
v_dot2_f32_bf16 v117, v34, s65, 0
v_dot2_f32_bf16 v118, v35, s101, 0
v_dot2_f32_bf16 v119, v35, s65, 0
s_waitcnt vmcnt(7)
v_dot2_f32_bf16 v112, v36, s101, v112
v_dot2_f32_bf16 v113, v36, s65, v113
v_dot2_f32_bf16 v114, v37, s101, v114
v_dot2_f32_bf16 v115, v37, s65, v115
v_dot2_f32_bf16 v116, v38, s101, v116
v_dot2_f32_bf16 v117, v38, s65, v117
v_dot2_f32_bf16 v118, v39, s101, v118
v_dot2_f32_bf16 v119, v39, s65, v119
v_add_f32_dpp v112, v112, v112 row_ror:8 row_mask:0xf bank_mask:0xf
v_add_f32_dpp v113, v113, v113 row_ror:8 row_mask:0xf bank_mask:0xf
v_add_f32_dpp v114, v114, v114 row_ror:8 row_mask:0xf bank_mask:0xf
v_add_f32_dpp v115, v115, v115 row_ror:8 row_mask:0xf bank_mask:0xf
v_add_f32_dpp v116, v116, v116 row_ror:8 row_mask:0xf bank_mask:0xf
v_add_f32_dpp v117, v117, v117 row_ror:8 row_mask:0xf bank_mask:0xf
v_add_f32_dpp v118, v118, v118 row_ror:8 row_mask:0xf bank_mask:0xf
v_add_f32_dpp v119, v119, v119 row_ror:8 row_mask:0xf bank_mask:0xf
v_mov_b32 v32, v112
v_mov_b32 v33, v113
v_mov_b32 v34, v114
v_mov_b32 v35, v115
v_mov_b32 v36, v116
v_mov_b32 v37, v117
v_mov_b32 v38, v118
v_mov_b32 v39, v119
v_permlane32_swap_b32 v112, v32
v_permlane32_swap_b32 v113, v33
v_permlane32_swap_b32 v114, v34
v_permlane32_swap_b32 v115, v35
v_permlane32_swap_b32 v116, v36
v_permlane32_swap_b32 v117, v37
v_permlane32_swap_b32 v118, v38
v_permlane32_swap_b32 v119, v39
v_add_f32 v112, v112, v32
v_add_f32 v113, v113, v33
v_add_f32 v114, v114, v34
v_add_f32 v115, v115, v35
v_add_f32 v116, v116, v36
v_add_f32 v117, v117, v37
v_add_f32 v118, v118, v38
v_add_f32 v119, v119, v39
v_pk_fma_f32 v[112:113], v[112:113], v[144:145], v[88:89]
v_pk_fma_f32 v[114:115], v[114:115], v[146:147], v[90:91]
v_pk_fma_f32 v[116:117], v[116:117], v[148:149], v[92:93]
v_pk_fma_f32 v[118:119], v[118:119], v[150:151], v[94:95]
v_dot2_f32_bf16 v104, v40, s101, 0
v_dot2_f32_bf16 v105, v40, s65, 0
v_dot2_f32_bf16 v106, v41, s101, 0
v_dot2_f32_bf16 v107, v41, s65, 0
v_dot2_f32_bf16 v108, v42, s101, 0
v_dot2_f32_bf16 v109, v42, s65, 0
v_dot2_f32_bf16 v110, v43, s101, 0
v_dot2_f32_bf16 v111, v43, s65, 0
s_waitcnt vmcnt(6)
v_dot2_f32_bf16 v104, v44, s101, v104
v_dot2_f32_bf16 v105, v44, s65, v105
v_dot2_f32_bf16 v106, v45, s101, v106
v_dot2_f32_bf16 v107, v45, s65, v107
v_dot2_f32_bf16 v108, v46, s101, v108
v_dot2_f32_bf16 v109, v46, s65, v109
v_dot2_f32_bf16 v110, v47, s101, v110
v_dot2_f32_bf16 v111, v47, s65, v111
s_waitcnt vmcnt(5)
v_dot2_f32_bf16 v104, v48, s101, v104
v_dot2_f32_bf16 v105, v48, s65, v105
v_dot2_f32_bf16 v106, v49, s101, v106
v_dot2_f32_bf16 v107, v49, s65, v107
v_dot2_f32_bf16 v108, v50, s101, v108
v_dot2_f32_bf16 v109, v50, s65, v109
v_dot2_f32_bf16 v110, v51, s101, v110
v_dot2_f32_bf16 v111, v51, s65, v111
s_waitcnt vmcnt(4)
v_dot2_f32_bf16 v104, v52, s101, v104
v_dot2_f32_bf16 v105, v52, s65, v105
v_dot2_f32_bf16 v106, v53, s101, v106
v_dot2_f32_bf16 v107, v53, s65, v107
v_dot2_f32_bf16 v108, v54, s101, v108
v_dot2_f32_bf16 v109, v54, s65, v109
v_dot2_f32_bf16 v110, v55, s101, v110
v_dot2_f32_bf16 v111, v55, s65, v111
s_waitcnt vmcnt(3)
v_dot2_f32_bf16 v104, v56, s101, v104
v_dot2_f32_bf16 v105, v56, s65, v105
v_dot2_f32_bf16 v106, v57, s101, v106
v_dot2_f32_bf16 v107, v57, s65, v107
v_dot2_f32_bf16 v108, v58, s101, v108
v_dot2_f32_bf16 v109, v58, s65, v109
v_dot2_f32_bf16 v110, v59, s101, v110
v_dot2_f32_bf16 v111, v59, s65, v111
s_waitcnt vmcnt(2)
v_dot2_f32_bf16 v104, v60, s101, v104
v_dot2_f32_bf16 v105, v60, s65, v105
v_dot2_f32_bf16 v106, v61, s101, v106
v_dot2_f32_bf16 v107, v61, s65, v107
v_dot2_f32_bf16 v108, v62, s101, v108
v_dot2_f32_bf16 v109, v62, s65, v109
v_dot2_f32_bf16 v110, v63, s101, v110
v_dot2_f32_bf16 v111, v63, s65, v111
s_waitcnt vmcnt(1)
v_dot2_f32_bf16 v104, v64, s101, v104
v_dot2_f32_bf16 v105, v64, s65, v105
v_dot2_f32_bf16 v106, v65, s101, v106
v_dot2_f32_bf16 v107, v65, s65, v107
v_dot2_f32_bf16 v108, v66, s101, v108
v_dot2_f32_bf16 v109, v66, s65, v109
v_dot2_f32_bf16 v110, v67, s101, v110
v_dot2_f32_bf16 v111, v67, s65, v111
s_waitcnt vmcnt(0)
v_dot2_f32_bf16 v104, v68, s101, v104
v_dot2_f32_bf16 v105, v68, s65, v105
v_dot2_f32_bf16 v106, v69, s101, v106
v_dot2_f32_bf16 v107, v69, s65, v107
v_dot2_f32_bf16 v108, v70, s101, v108
v_dot2_f32_bf16 v109, v70, s65, v109
v_dot2_f32_bf16 v110, v71, s101, v110
v_dot2_f32_bf16 v111, v71, s65, v111
v_pk_fma_f32 v[104:105], v[104:105], v[136:137], v[80:81]
v_pk_fma_f32 v[106:107], v[106:107], v[138:139], v[82:83]
v_pk_fma_f32 v[108:109], v[108:109], v[140:141], v[84:85]
v_pk_fma_f32 v[110:111], v[110:111], v[142:143], v[86:87]
s_cmp_eq_u32 s55, 0
s_cbranch_scc1 S1_F
s_add_u32 m0, s43, 0
s_add_u32 s44, s52, 0
buffer_load_dwordx4 v234, s[88:91], s44 offen offset:0 lds
buffer_load_dwordx4 v235, s[88:91], s44 offen offset:1024 lds
buffer_load_dwordx4 v236, s[88:91], s44 offen offset:2048 lds
buffer_load_dwordx4 v237, s[88:91], s44 offen offset:3072 lds
s_add_u32 m0, s43, 4096
s_add_u32 s44, s52, 589824
buffer_load_dwordx4 v234, s[88:91], s44 offen offset:0 lds
buffer_load_dwordx4 v235, s[88:91], s44 offen offset:1024 lds
buffer_load_dwordx4 v236, s[88:91], s44 offen offset:2048 lds
buffer_load_dwordx4 v237, s[88:91], s44 offen offset:3072 lds
S1_F:
s_add_u32 m0, s43, 8192
s_add_u32 s44, s52, 1179648
buffer_load_dwordx4 v234, s[88:91], s44 offen offset:0 lds
buffer_load_dwordx4 v235, s[88:91], s44 offen offset:1024 lds
buffer_load_dwordx4 v236, s[88:91], s44 offen offset:2048 lds
buffer_load_dwordx4 v237, s[88:91], s44 offen offset:3072 lds
s_add_u32 m0, s43, 12288
s_add_u32 s44, s52, 1769472
buffer_load_dwordx4 v234, s[88:91], s44 offen offset:0 lds
buffer_load_dwordx4 v235, s[88:91], s44 offen offset:1024 lds
buffer_load_dwordx4 v236, s[88:91], s44 offen offset:2048 lds
buffer_load_dwordx4 v237, s[88:91], s44 offen offset:3072 lds
v_cvt_pk_bf16_f32 v208, v96, v97
v_cvt_pk_bf16_f32 v209, v98, v99
v_cvt_pk_bf16_f32 v210, v100, v101
v_cvt_pk_bf16_f32 v211, v102, v103
v_cvt_pk_bf16_f32 v212, v104, v105
v_cvt_pk_bf16_f32 v213, v106, v107
v_cvt_pk_bf16_f32 v214, v108, v109
v_cvt_pk_bf16_f32 v215, v110, v111
v_cvt_pk_bf16_f32 v216, v112, v113
v_cvt_pk_bf16_f32 v217, v114, v115
v_cvt_pk_bf16_f32 v218, v116, v117
v_cvt_pk_bf16_f32 v219, v118, v119
v_dot2_f32_bf16 v0, v208, s100, 0
v_dot2_f32_bf16 v1, v209, s100, 0
v_dot2_f32_bf16 v2, v210, s100, 0
v_dot2_f32_bf16 v3, v211, s100, 0
v_dot2_f32_bf16 v0, v212, s100, v0
v_dot2_f32_bf16 v1, v213, s100, v1
v_dot2_f32_bf16 v2, v214, s100, v2
v_dot2_f32_bf16 v3, v215, s100, v3
v_dot2_f32_bf16 v0, v216, s49, v0
v_dot2_f32_bf16 v1, v217, s49, v1
v_dot2_f32_bf16 v2, v218, s49, v2
v_dot2_f32_bf16 v3, v219, s49, v3
s_nop 2
v_pk_add_f32 v[0:1], v[0:1], v[2:3]
v_add_f32 v4, v0, v1
s_nop 1
v_add_f32_dpp v4, v4, v4 row_ror:8 row_mask:0xf bank_mask:0xf
v_mov_b32 v0, v4
s_nop 1
v_permlane16_swap_b32 v4, v0
v_add_f32 v4, v4, v0
v_mov_b32 v0, v4
s_nop 1
v_permlane32_swap_b32 v4, v0
v_add_f32 v4, v4, v0
v_mul_f32 v4, 0xbbe38e39, v4
v_dot2_f32_bf16 v96, v208, s101, v4
v_dot2_f32_bf16 v97, v208, s65, v4
v_dot2_f32_bf16 v98, v209, s101, v4
v_dot2_f32_bf16 v99, v209, s65, v4
v_dot2_f32_bf16 v100, v210, s101, v4
v_dot2_f32_bf16 v101, v210, s65, v4
v_dot2_f32_bf16 v102, v211, s101, v4
v_dot2_f32_bf16 v103, v211, s65, v4
v_dot2_f32_bf16 v104, v212, s101, v4
v_dot2_f32_bf16 v105, v212, s65, v4
v_dot2_f32_bf16 v106, v213, s101, v4
v_dot2_f32_bf16 v107, v213, s65, v4
v_dot2_f32_bf16 v108, v214, s101, v4
v_dot2_f32_bf16 v109, v214, s65, v4
v_dot2_f32_bf16 v110, v215, s101, v4
v_dot2_f32_bf16 v111, v215, s65, v4
v_dot2_f32_bf16 v112, v216, s101, v4
v_dot2_f32_bf16 v113, v216, s65, v4
v_dot2_f32_bf16 v114, v217, s101, v4
v_dot2_f32_bf16 v115, v217, s65, v4
v_dot2_f32_bf16 v116, v218, s101, v4
v_dot2_f32_bf16 v117, v218, s65, v4
v_dot2_f32_bf16 v118, v219, s101, v4
v_dot2_f32_bf16 v119, v219, s65, v4
v_pk_fma_f32 v[0:1], v[96:97], v[96:97], 0
v_pk_fma_f32 v[0:1], v[98:99], v[98:99], v[0:1]
v_pk_fma_f32 v[0:1], v[100:101], v[100:101], v[0:1]
v_pk_fma_f32 v[0:1], v[102:103], v[102:103], v[0:1]
v_pk_fma_f32 v[0:1], v[104:105], v[104:105], v[0:1]
v_pk_fma_f32 v[0:1], v[106:107], v[106:107], v[0:1]
v_pk_fma_f32 v[0:1], v[108:109], v[108:109], v[0:1]
v_pk_fma_f32 v[0:1], v[110:111], v[110:111], v[0:1]
v_pk_fma_f32 v[2:3], v[112:113], v[112:113], 0
v_pk_fma_f32 v[2:3], v[114:115], v[114:115], v[2:3]
v_pk_fma_f32 v[2:3], v[116:117], v[116:117], v[2:3]
v_pk_fma_f32 v[2:3], v[118:119], v[118:119], v[2:3]
v_add_f32 v5, v0, v1
v_add_f32 v2, v2, v3
v_fmac_f32 v5, 0x3e800000, v2
s_nop 1
v_add_f32_dpp v5, v5, v5 row_ror:8 row_mask:0xf bank_mask:0xf
v_mov_b32 v0, v5
s_nop 1
v_permlane16_swap_b32 v5, v0
v_add_f32 v5, v5, v0
v_mov_b32 v0, v5
s_nop 1
v_permlane32_swap_b32 v5, v0
v_add_f32 v5, v5, v0
ds_write_b64 v205, v[4:5]
s_waitcnt lgkmcnt(0)
s_barrier
ds_read_b128 v[8:11], v204
ds_read_b128 v[12:15], v204 offset:16
s_mul_i32 s8, s41, 73728
s_add_u32 s8, s8, 33554432
s_add_u32 s9, s8, s48
s_cmp_eq_u32 s40, 0
s_cselect_b32 s10, 0xff00ff00, -1
s_mov_b32 s11, s10
v_xor_b32 v206, s48, v222
v_and_b32 v207, 0x1fffffff, v123
s_waitcnt lgkmcnt(1)
v_pk_add_f32 v[0:1], v[8:9], v[10:11]
s_waitcnt lgkmcnt(0)
v_pk_add_f32 v[2:3], v[12:13], v[14:15]
v_pk_add_f32 v[0:1], v[0:1], v[2:3]
v_mul_f32 v0, 0x3e800000, v0
v_sub_f32 v8, v8, v0
v_sub_f32 v10, v10, v0
v_sub_f32 v12, v12, v0
v_sub_f32 v14, v14, v0
v_mul_f32 v8, v8, v8
v_fmac_f32 v8, v10, v10
v_fmac_f32 v8, v12, v12
v_fmac_f32 v8, v14, v14
v_fmac_f32 v1, 0x43100000, v8
v_mov_b32 v2, 0x3727c5ac
v_fmac_f32 v2, 0x3ae38e39, v1
v_rsq_f32 v2, v2
v_sub_f32 v4, v0, v4
v_mul_f32 v4, v4, v2
v_pk_fma_f32 v[96:97], v[96:97], v[2:3], v[4:5] op_sel_hi:[1,0,0]
v_pk_fma_f32 v[98:99], v[98:99], v[2:3], v[4:5] op_sel_hi:[1,0,0]
v_pk_fma_f32 v[100:101], v[100:101], v[2:3], v[4:5] op_sel_hi:[1,0,0]
v_pk_fma_f32 v[102:103], v[102:103], v[2:3], v[4:5] op_sel_hi:[1,0,0]
v_pk_fma_f32 v[96:97], v[96:97], v[152:153], v[176:177]
v_pk_fma_f32 v[98:99], v[98:99], v[154:155], v[178:179]
v_pk_fma_f32 v[100:101], v[100:101], v[156:157], v[180:181]
v_pk_fma_f32 v[102:103], v[102:103], v[158:159], v[182:183]
v_cvt_pk_bf16_f32 v96, v96, v97
v_cvt_pk_bf16_f32 v97, v98, v99
v_cvt_pk_bf16_f32 v98, v100, v101
v_cvt_pk_bf16_f32 v99, v102, v103
buffer_store_dwordx4 v[96:99], v120, s[36:39], s9 offen sc1
v_pk_fma_f32 v[104:105], v[104:105], v[2:3], v[4:5] op_sel_hi:[1,0,0]
v_pk_fma_f32 v[106:107], v[106:107], v[2:3], v[4:5] op_sel_hi:[1,0,0]
v_pk_fma_f32 v[108:109], v[108:109], v[2:3], v[4:5] op_sel_hi:[1,0,0]
v_pk_fma_f32 v[110:111], v[110:111], v[2:3], v[4:5] op_sel_hi:[1,0,0]
v_pk_fma_f32 v[104:105], v[104:105], v[160:161], v[184:185]
v_pk_fma_f32 v[106:107], v[106:107], v[162:163], v[186:187]
v_pk_fma_f32 v[108:109], v[108:109], v[164:165], v[188:189]
v_pk_fma_f32 v[110:111], v[110:111], v[166:167], v[190:191]
v_cvt_pk_bf16_f32 v104, v104, v105
v_cvt_pk_bf16_f32 v105, v106, v107
v_cvt_pk_bf16_f32 v106, v108, v109
v_cvt_pk_bf16_f32 v107, v110, v111
buffer_store_dwordx4 v[104:107], v121, s[36:39], s9 offen sc1
v_pk_fma_f32 v[112:113], v[112:113], v[2:3], v[4:5] op_sel_hi:[1,0,0]
v_pk_fma_f32 v[114:115], v[114:115], v[2:3], v[4:5] op_sel_hi:[1,0,0]
v_pk_fma_f32 v[116:117], v[116:117], v[2:3], v[4:5] op_sel_hi:[1,0,0]
v_pk_fma_f32 v[118:119], v[118:119], v[2:3], v[4:5] op_sel_hi:[1,0,0]
v_pk_fma_f32 v[112:113], v[112:113], v[168:169], v[192:193]
v_pk_fma_f32 v[114:115], v[114:115], v[170:171], v[194:195]
v_pk_fma_f32 v[116:117], v[116:117], v[172:173], v[196:197]
v_pk_fma_f32 v[118:119], v[118:119], v[174:175], v[198:199]
v_cvt_pk_bf16_f32 v112, v112, v113
v_cvt_pk_bf16_f32 v113, v114, v115
v_cvt_pk_bf16_f32 v114, v116, v117
v_cvt_pk_bf16_f32 v115, v118, v119
buffer_store_dwordx4 v[112:115], v123, s[36:39], s9 offen sc1
ds_write_b128 v120, v[96:99]
ds_write_b128 v121, v[104:107]
ds_write_b128 v207, v[112:115]
s_waitcnt vmcnt(0)
s_barrier
buffer_store_dword v255, v254, s[36:39], s53 offen offset:512 sc1
s_add_u32 m0, s43, 16384
s_add_u32 s44, s52, 2359296
buffer_load_dwordx4 v234, s[88:91], s44 offen offset:0 lds
buffer_load_dwordx4 v235, s[88:91], s44 offen offset:1024 lds
buffer_load_dwordx4 v236, s[88:91], s44 offen offset:2048 lds
buffer_load_dwordx4 v237, s[88:91], s44 offen offset:3072 lds
buffer_load_dword v249, v203, s[72:75], 0 offen
ds_read_b64_tr_b16 a[192:193], v244 offset:0
ds_read_b64_tr_b16 a[194:195], v244 offset:2048
ds_read_b64_tr_b16 a[196:197], v245 offset:0
ds_read_b64_tr_b16 a[198:199], v245 offset:2048
ds_read_b64_tr_b16 a[200:201], v244 offset:20480
ds_read_b64_tr_b16 a[202:203], v244 offset:22528
ds_read_b64_tr_b16 a[204:205], v245 offset:20480
ds_read_b64_tr_b16 a[206:207], v245 offset:22528
ds_read_b64_tr_b16 a[208:209], v244 offset:4096
ds_read_b64_tr_b16 a[210:211], v244 offset:6144
ds_read_b64_tr_b16 a[212:213], v245 offset:4096
ds_read_b64_tr_b16 a[214:215], v245 offset:6144
ds_read_b64_tr_b16 a[216:217], v244 offset:24576
ds_read_b64_tr_b16 a[218:219], v244 offset:26624
ds_read_b64_tr_b16 a[220:221], v245 offset:24576
ds_read_b64_tr_b16 a[222:223], v245 offset:26624
ds_read_b64_tr_b16 a[224:225], v244 offset:8192
ds_read_b64_tr_b16 a[226:227], v244 offset:10240
ds_read_b64_tr_b16 a[228:229], v245 offset:8192
ds_read_b64_tr_b16 a[230:231], v245 offset:10240
ds_read_b64_tr_b16 a[232:233], v244 offset:28672
ds_read_b64_tr_b16 a[234:235], v244 offset:30720
ds_read_b64_tr_b16 a[236:237], v245 offset:28672
ds_read_b64_tr_b16 a[238:239], v245 offset:30720
ds_read_b64_tr_b16 a[240:241], v244 offset:12288
ds_read_b64_tr_b16 a[242:243], v244 offset:14336
ds_read_b64_tr_b16 a[244:245], v245 offset:12288
ds_read_b64_tr_b16 a[246:247], v245 offset:14336
ds_read_b64_tr_b16 a[248:249], v244 offset:32768
ds_read_b64_tr_b16 a[250:251], v244 offset:34816
ds_read_b64_tr_b16 a[252:253], v245 offset:32768
ds_read_b64_tr_b16 a[254:255], v245 offset:34816
s_waitcnt lgkmcnt(0)
s_barrier
s_add_u32 m0, s43, 0
s_add_u32 s44, s52, 2949120
buffer_load_dwordx4 v234, s[88:91], s44 offen offset:0 lds
buffer_load_dwordx4 v235, s[88:91], s44 offen offset:1024 lds
buffer_load_dwordx4 v236, s[88:91], s44 offen offset:2048 lds
buffer_load_dwordx4 v237, s[88:91], s44 offen offset:3072 lds
s_add_u32 m0, s43, 4096
s_add_u32 s44, s52, 3538944
buffer_load_dwordx4 v234, s[88:91], s44 offen offset:0 lds
buffer_load_dwordx4 v235, s[88:91], s44 offen offset:1024 lds
buffer_load_dwordx4 v236, s[88:91], s44 offen offset:2048 lds
buffer_load_dwordx4 v237, s[88:91], s44 offen offset:3072 lds
s_add_u32 m0, s43, 8192
s_add_u32 s44, s52, 4128768
buffer_load_dwordx4 v234, s[88:91], s44 offen offset:0 lds
buffer_load_dwordx4 v235, s[88:91], s44 offen offset:1024 lds
buffer_load_dwordx4 v236, s[88:91], s44 offen offset:2048 lds
buffer_load_dwordx4 v237, s[88:91], s44 offen offset:3072 lds
s_add_u32 m0, s43, 12288
s_add_u32 s44, s52, 4718592
buffer_load_dwordx4 v234, s[88:91], s44 offen offset:0 lds
buffer_load_dwordx4 v235, s[88:91], s44 offen offset:1024 lds
buffer_load_dwordx4 v236, s[88:91], s44 offen offset:2048 lds
buffer_load_dwordx4 v237, s[88:91], s44 offen offset:3072 lds
s_buffer_load_dwordx8 s[20:27], s[36:39], s54 offset:640
s_waitcnt lgkmcnt(0)
s_mov_b32 s20, s3
s_mov_b32 s58, s3
s_mov_b32 s59, s3
s_xor_b64 s[20:21], s[20:21], s[58:59]
s_xor_b64 s[22:23], s[22:23], s[58:59]
s_xor_b64 s[24:25], s[24:25], s[58:59]
s_xor_b64 s[26:27], s[26:27], s[58:59]
s_or_b64 s[20:21], s[20:21], s[22:23]
s_or_b64 s[24:25], s[24:25], s[26:27]
s_or_b64 s[20:21], s[20:21], s[24:25]
s_cbranch_scc0 S2_OK
s_mov_b32 s71, 0
s_cmp_lg_u32 s40, 0
s_cbranch_scc1 S2_OK
S2_LOOP:
buffer_load_dword v253, v252, s[36:39], s54 offen offset:512 sc1
s_add_u32 s71, s71, 1
s_cmp_lt_u32 s71, 40000
s_waitcnt vmcnt(0)
v_cmp_ne_u32 vcc, s3, v253
s_nop 4
s_cbranch_vccz S2_OK
s_cbranch_scc1 S2_LOOP
S2_OK:
s_barrier
s_mov_b64 exec, s[10:11]
buffer_load_dwordx4 v[0:3], v206, s[36:39], s8 offen
s_add_u32 s8, s8, 4096
buffer_load_dwordx4 v[4:7], v206, s[36:39], s8 offen
s_add_u32 s8, s8, 4096
buffer_load_dwordx4 v[8:11], v206, s[36:39], s8 offen
s_add_u32 s8, s8, 4096
buffer_load_dwordx4 v[12:15], v206, s[36:39], s8 offen
s_add_u32 s8, s8, 4096
buffer_load_dwordx4 v[16:19], v206, s[36:39], s8 offen
s_add_u32 s8, s8, 4096
buffer_load_dwordx4 v[20:23], v206, s[36:39], s8 offen
s_add_u32 s8, s8, 4096
buffer_load_dwordx4 v[24:27], v206, s[36:39], s8 offen
s_add_u32 s8, s8, 4096
buffer_load_dwordx4 v[28:31], v206, s[36:39], s8 offen
s_add_u32 s8, s8, 4096
buffer_load_dwordx4 v[32:35], v206, s[36:39], s8 offen
s_add_u32 s8, s8, 4096
buffer_load_dwordx4 v[36:39], v206, s[36:39], s8 offen
s_add_u32 s8, s8, 4096
buffer_load_dwordx4 v[40:43], v206, s[36:39], s8 offen
s_add_u32 s8, s8, 4096
buffer_load_dwordx4 v[44:47], v206, s[36:39], s8 offen
s_add_u32 s8, s8, 4096
buffer_load_dwordx4 v[48:51], v206, s[36:39], s8 offen
s_add_u32 s8, s8, 4096
buffer_load_dwordx4 v[52:55], v206, s[36:39], s8 offen
s_add_u32 s8, s8, 4096
buffer_load_dwordx4 v[56:59], v206, s[36:39], s8 offen
s_add_u32 s8, s8, 4096
buffer_load_dwordx4 v[60:63], v206, s[36:39], s8 offen
s_add_u32 s8, s8, 4096
buffer_load_dwordx4 v[96:99], v206, s[36:39], s8 offen
s_add_u32 s8, s8, 4096
buffer_load_dwordx4 v[100:103], v206, s[36:39], s8 offen
s_mov_b64 exec, -1
s_mov_b64 exec, s[10:11]
s_waitcnt vmcnt(17)
ds_write_b128 v222, v[0:3] offset:0
s_waitcnt vmcnt(16)
ds_write_b128 v222, v[4:7] offset:4096
s_mov_b64 exec, -1
s_waitcnt lgkmcnt(0)
s_barrier
ds_read_b128 a[0:3], v238 offset:0
ds_read_b128 a[4:7], v238 offset:1024
ds_read_b128 a[8:11], v239 offset:0
ds_read_b128 a[12:15], v239 offset:1024
ds_read_b128 a[16:19], v238 offset:4096
ds_read_b128 a[20:23], v238 offset:5120
ds_read_b128 a[24:27], v239 offset:4096
ds_read_b128 a[28:31], v239 offset:5120
s_mov_b64 exec, s[10:11]
s_waitcnt vmcnt(15)
ds_write_b128 v222, v[8:11] offset:8192
s_waitcnt vmcnt(14)
ds_write_b128 v222, v[12:15] offset:12288
s_mov_b64 exec, -1
s_waitcnt lgkmcnt(0)
s_barrier
v_mfma_f32_16x16x32_bf16 v[64:67], a[192:195], a[0:3], 0
ds_read_b128 a[32:35], v238 offset:8192
ds_read_b128 a[36:39], v238 offset:9216
v_mfma_f32_16x16x32_bf16 v[68:71], a[192:195], a[4:7], 0
ds_read_b128 a[40:43], v239 offset:8192
ds_read_b128 a[44:47], v239 offset:9216
v_mfma_f32_16x16x32_bf16 v[72:75], a[192:195], a[8:11], 0
ds_read_b128 a[48:51], v238 offset:12288
ds_read_b128 a[52:55], v238 offset:13312
v_mfma_f32_16x16x32_bf16 v[76:79], a[192:195], a[12:15], 0
ds_read_b128 a[56:59], v239 offset:12288
ds_read_b128 a[60:63], v239 offset:13312
v_mfma_f32_16x16x32_bf16 v[80:83], a[196:199], a[0:3], 0
s_lshl_b32 s45, s41, 2
s_add_u32 s45, s45, s40
v_mfma_f32_16x16x32_bf16 v[84:87], a[196:199], a[4:7], 0
v_mfma_f32_16x16x32_bf16 v[88:91], a[196:199], a[8:11], 0
v_mfma_f32_16x16x32_bf16 v[92:95], a[196:199], a[12:15], 0
s_mul_i32 s45, s45, 9
v_mfma_f32_16x16x32_bf16 v[64:67], a[200:203], a[16:19], v[64:67]
s_lshr_b32 s45, s45, 1
v_mfma_f32_16x16x32_bf16 v[68:71], a[200:203], a[20:23], v[68:71]
s_mul_i32 s46, s45, 9216
v_mfma_f32_16x16x32_bf16 v[72:75], a[200:203], a[24:27], v[72:75]
v_mfma_f32_16x16x32_bf16 v[76:79], a[200:203], a[28:31], v[76:79]
s_mul_i32 s47, s42, 1152
v_mfma_f32_16x16x32_bf16 v[80:83], a[204:207], a[16:19], v[80:83]
v_mfma_f32_16x16x32_bf16 v[84:87], a[204:207], a[20:23], v[84:87]
s_mov_b64 exec, s[10:11]
s_waitcnt vmcnt(13)
ds_write_b128 v222, v[16:19] offset:16384
s_waitcnt vmcnt(12)
ds_write_b128 v222, v[20:23] offset:20480
s_mov_b64 exec, -1
v_mfma_f32_16x16x32_bf16 v[88:91], a[204:207], a[24:27], v[88:91]
s_add_u32 s70, s46, s47
v_mfma_f32_16x16x32_bf16 v[92:95], a[204:207], a[28:31], v[92:95]
s_mul_i32 s47, s47, 576
s_waitcnt lgkmcnt(0)
s_barrier
v_mfma_f32_16x16x32_bf16 v[64:67], a[208:211], a[32:35], v[64:67]
ds_read_b128 a[64:67], v238 offset:16384
ds_read_b128 a[68:71], v238 offset:17408
v_mfma_f32_16x16x32_bf16 v[68:71], a[208:211], a[36:39], v[68:71]
ds_read_b128 a[72:75], v239 offset:16384
ds_read_b128 a[76:79], v239 offset:17408
v_mfma_f32_16x16x32_bf16 v[72:75], a[208:211], a[40:43], v[72:75]
ds_read_b128 a[80:83], v238 offset:20480
ds_read_b128 a[84:87], v238 offset:21504
v_mfma_f32_16x16x32_bf16 v[76:79], a[208:211], a[44:47], v[76:79]
ds_read_b128 a[88:91], v239 offset:20480
ds_read_b128 a[92:95], v239 offset:21504
v_mfma_f32_16x16x32_bf16 v[80:83], a[212:215], a[32:35], v[80:83]
s_mul_i32 s45, s45, 1152
s_add_u32 s9, s45, s47
v_mfma_f32_16x16x32_bf16 v[84:87], a[212:215], a[36:39], v[84:87]
v_mfma_f32_16x16x32_bf16 v[88:91], a[212:215], a[40:43], v[88:91]
v_mfma_f32_16x16x32_bf16 v[92:95], a[212:215], a[44:47], v[92:95]
v_lshrrev_b32 v192, 7, v224
v_mfma_f32_16x16x32_bf16 v[64:67], a[216:219], a[48:51], v[64:67]
v_min_u32 v192, 4, v192
v_mul_u32_u24 v192, 9216, v192
v_mfma_f32_16x16x32_bf16 v[68:71], a[216:219], a[52:55], v[68:71]
v_mfma_f32_16x16x32_bf16 v[72:75], a[216:219], a[56:59], v[72:75]
v_and_b32 v193, 0x70, v224
v_mfma_f32_16x16x32_bf16 v[76:79], a[216:219], a[60:63], v[76:79]
v_mfma_f32_16x16x32_bf16 v[80:83], a[220:223], a[48:51], v[80:83]
v_lshl_add_u32 v192, v193, 2, v192
v_mfma_f32_16x16x32_bf16 v[84:87], a[220:223], a[52:55], v[84:87]
s_mov_b64 exec, s[10:11]
s_waitcnt vmcnt(11)
ds_write_b128 v222, v[24:27] offset:24576
s_waitcnt vmcnt(10)
ds_write_b128 v222, v[28:31] offset:28672
s_mov_b64 exec, -1
v_mfma_f32_16x16x32_bf16 v[88:91], a[220:223], a[56:59], v[88:91]
v_min_u32 v193, 64, v193
v_mfma_f32_16x16x32_bf16 v[92:95], a[220:223], a[60:63], v[92:95]
s_waitcnt lgkmcnt(0)
s_barrier
v_mfma_f32_16x16x32_bf16 v[64:67], a[224:227], a[64:67], v[64:67]
ds_read_b128 a[96:99], v238 offset:24576
ds_read_b128 a[100:103], v238 offset:25600
v_mfma_f32_16x16x32_bf16 v[68:71], a[224:227], a[68:71], v[68:71]
ds_read_b128 a[104:107], v239 offset:24576
ds_read_b128 a[108:111], v239 offset:25600
v_mfma_f32_16x16x32_bf16 v[72:75], a[224:227], a[72:75], v[72:75]
ds_read_b128 a[112:115], v238 offset:28672
ds_read_b128 a[116:119], v238 offset:29696
v_mfma_f32_16x16x32_bf16 v[76:79], a[224:227], a[76:79], v[76:79]
ds_read_b128 a[120:123], v239 offset:28672
ds_read_b128 a[124:127], v239 offset:29696
v_mfma_f32_16x16x32_bf16 v[80:83], a[228:231], a[64:67], v[80:83]
v_lshrrev_b32 v194, 7, v224
v_min_u32 v194, 4, v194
v_mfma_f32_16x16x32_bf16 v[84:87], a[228:231], a[68:71], v[84:87]
v_mul_u32_u24 v194, 1152, v194
v_mfma_f32_16x16x32_bf16 v[88:91], a[228:231], a[72:75], v[88:91]
v_mfma_f32_16x16x32_bf16 v[92:95], a[228:231], a[76:79], v[92:95]
v_lshl_add_u32 v193, v193, 3, v194
v_mfma_f32_16x16x32_bf16 v[64:67], a[232:235], a[80:83], v[64:67]
v_mfma_f32_16x16x32_bf16 v[68:71], a[232:235], a[84:87], v[68:71]
v_mfma_f32_16x16x32_bf16 v[72:75], a[232:235], a[88:91], v[72:75]
v_mfma_f32_16x16x32_bf16 v[76:79], a[232:235], a[92:95], v[76:79]
v_mfma_f32_16x16x32_bf16 v[80:83], a[236:239], a[80:83], v[80:83]
v_mfma_f32_16x16x32_bf16 v[84:87], a[236:239], a[84:87], v[84:87]
s_mov_b64 exec, s[10:11]
s_waitcnt vmcnt(9)
ds_write_b128 v222, v[32:35] offset:32768
s_waitcnt vmcnt(8)
ds_write_b128 v222, v[36:39] offset:36864
s_mov_b64 exec, -1
v_mfma_f32_16x16x32_bf16 v[88:91], a[236:239], a[88:91], v[88:91]
v_mfma_f32_16x16x32_bf16 v[92:95], a[236:239], a[92:95], v[92:95]
s_waitcnt lgkmcnt(0)
s_barrier
v_mfma_f32_16x16x32_bf16 v[64:67], a[240:243], a[96:99], v[64:67]
ds_read_b64_tr_b16 v[160:161], v244 offset:16384
ds_read_b64_tr_b16 v[162:163], v244 offset:18432
v_mfma_f32_16x16x32_bf16 v[68:71], a[240:243], a[100:103], v[68:71]
ds_read_b64_tr_b16 v[164:165], v245 offset:16384
ds_read_b64_tr_b16 v[166:167], v245 offset:18432
v_mfma_f32_16x16x32_bf16 v[72:75], a[240:243], a[104:107], v[72:75]
ds_read_b64_tr_b16 v[168:169], v244 offset:36864
ds_read_b64_tr_b16 v[170:171], v244 offset:38912
v_mfma_f32_16x16x32_bf16 v[76:79], a[240:243], a[108:111], v[76:79]
ds_read_b64_tr_b16 v[172:173], v245 offset:36864
ds_read_b64_tr_b16 v[174:175], v245 offset:38912
v_mfma_f32_16x16x32_bf16 v[80:83], a[244:247], a[96:99], v[80:83]
ds_read_b128 a[128:131], v238 offset:32768
ds_read_b128 a[132:135], v238 offset:33792
v_mfma_f32_16x16x32_bf16 v[84:87], a[244:247], a[100:103], v[84:87]
ds_read_b128 a[136:139], v239 offset:32768
ds_read_b128 a[140:143], v239 offset:33792
v_mfma_f32_16x16x32_bf16 v[88:91], a[244:247], a[104:107], v[88:91]
ds_read_b128 a[144:147], v238 offset:36864
ds_read_b128 a[148:151], v238 offset:37888
v_mfma_f32_16x16x32_bf16 v[92:95], a[244:247], a[108:111], v[92:95]
ds_read_b128 a[152:155], v239 offset:36864
ds_read_b128 a[156:159], v239 offset:37888
v_mfma_f32_16x16x32_bf16 v[64:67], a[248:251], a[112:115], v[64:67]
v_mfma_f32_16x16x32_bf16 v[68:71], a[248:251], a[116:119], v[68:71]
v_mfma_f32_16x16x32_bf16 v[72:75], a[248:251], a[120:123], v[72:75]
v_mfma_f32_16x16x32_bf16 v[76:79], a[248:251], a[124:127], v[76:79]
s_add_u32 m0, s43, 16384
s_add_u32 s44, s50, 0
v_mfma_f32_16x16x32_bf16 v[80:83], a[252:255], a[112:115], v[80:83]
v_mfma_f32_16x16x32_bf16 v[84:87], a[252:255], a[116:119], v[84:87]
s_mov_b64 exec, s[10:11]
s_waitcnt vmcnt(7)
ds_write_b128 v222, v[40:43] offset:40960
s_waitcnt vmcnt(6)
ds_write_b128 v222, v[44:47] offset:45056
s_mov_b64 exec, -1
v_mfma_f32_16x16x32_bf16 v[88:91], a[252:255], a[120:123], v[88:91]
v_mfma_f32_16x16x32_bf16 v[92:95], a[252:255], a[124:127], v[92:95]
s_waitcnt lgkmcnt(0)
s_barrier
v_mfma_f32_16x16x32_bf16 v[64:67], v[160:163], a[128:131], v[64:67]
ds_read_b64_tr_b16 v[176:177], v244 offset:0
ds_read_b64_tr_b16 v[178:179], v244 offset:2048
v_mfma_f32_16x16x32_bf16 v[68:71], v[160:163], a[132:135], v[68:71]
ds_read_b64_tr_b16 v[180:181], v245 offset:0
ds_read_b64_tr_b16 v[182:183], v245 offset:2048
v_mfma_f32_16x16x32_bf16 v[72:75], v[160:163], a[136:139], v[72:75]
ds_read_b64_tr_b16 v[184:185], v244 offset:20480
ds_read_b64_tr_b16 v[186:187], v244 offset:22528
v_mfma_f32_16x16x32_bf16 v[76:79], v[160:163], a[140:143], v[76:79]
ds_read_b64_tr_b16 v[188:189], v245 offset:20480
ds_read_b64_tr_b16 v[190:191], v245 offset:22528
v_mfma_f32_16x16x32_bf16 v[80:83], v[164:167], a[128:131], v[80:83]
ds_read_b128 a[160:163], v238 offset:40960
ds_read_b128 a[164:167], v238 offset:41984
v_mfma_f32_16x16x32_bf16 v[84:87], v[164:167], a[132:135], v[84:87]
ds_read_b128 a[168:171], v239 offset:40960
ds_read_b128 a[172:175], v239 offset:41984
v_mfma_f32_16x16x32_bf16 v[88:91], v[164:167], a[136:139], v[88:91]
ds_read_b128 a[176:179], v238 offset:45056
ds_read_b128 a[180:183], v238 offset:46080
v_mfma_f32_16x16x32_bf16 v[92:95], v[164:167], a[140:143], v[92:95]
ds_read_b128 a[184:187], v239 offset:45056
ds_read_b128 a[188:191], v239 offset:46080
v_mfma_f32_16x16x32_bf16 v[64:67], v[168:171], a[144:147], v[64:67]
buffer_load_dwordx4 v234, s[72:75], s44 offen offset:0 lds
v_mfma_f32_16x16x32_bf16 v[68:71], v[168:171], a[148:151], v[68:71]
v_mfma_f32_16x16x32_bf16 v[72:75], v[168:171], a[152:155], v[72:75]
buffer_load_dwordx4 v235, s[72:75], s44 offen offset:1024 lds
v_mfma_f32_16x16x32_bf16 v[76:79], v[168:171], a[156:159], v[76:79]
v_mfma_f32_16x16x32_bf16 v[80:83], v[172:175], a[144:147], v[80:83]
buffer_load_dwordx4 v236, s[72:75], s44 offen offset:2048 lds
v_mfma_f32_16x16x32_bf16 v[84:87], v[172:175], a[148:151], v[84:87]
s_mov_b64 exec, s[10:11]
s_waitcnt vmcnt(8)
ds_write_b128 v222, v[48:51] offset:49152
s_waitcnt vmcnt(7)
ds_write_b128 v222, v[52:55] offset:53248
s_mov_b64 exec, -1
v_mfma_f32_16x16x32_bf16 v[88:91], v[172:175], a[152:155], v[88:91]
buffer_load_dwordx4 v237, s[72:75], s44 offen offset:3072 lds
v_mfma_f32_16x16x32_bf16 v[92:95], v[172:175], a[156:159], v[92:95]
s_waitcnt lgkmcnt(0)
s_barrier
v_mfma_f32_16x16x32_bf16 v[64:67], v[176:179], a[160:163], v[64:67]
ds_read_b64_tr_b16 v[160:161], v244 offset:4096
ds_read_b64_tr_b16 v[162:163], v244 offset:6144
v_mfma_f32_16x16x32_bf16 v[68:71], v[176:179], a[164:167], v[68:71]
ds_read_b64_tr_b16 v[164:165], v245 offset:4096
ds_read_b64_tr_b16 v[166:167], v245 offset:6144
v_mfma_f32_16x16x32_bf16 v[72:75], v[176:179], a[168:171], v[72:75]
ds_read_b64_tr_b16 v[168:169], v244 offset:24576
ds_read_b64_tr_b16 v[170:171], v244 offset:26624
v_mfma_f32_16x16x32_bf16 v[76:79], v[176:179], a[172:175], v[76:79]
ds_read_b64_tr_b16 v[172:173], v245 offset:24576
ds_read_b64_tr_b16 v[174:175], v245 offset:26624
v_mfma_f32_16x16x32_bf16 v[80:83], v[180:183], a[160:163], v[80:83]
ds_read_b128 a[192:195], v238 offset:49152
ds_read_b128 a[196:199], v238 offset:50176
v_mfma_f32_16x16x32_bf16 v[84:87], v[180:183], a[164:167], v[84:87]
ds_read_b128 a[200:203], v239 offset:49152
ds_read_b128 a[204:207], v239 offset:50176
v_mfma_f32_16x16x32_bf16 v[88:91], v[180:183], a[168:171], v[88:91]
ds_read_b128 a[208:211], v238 offset:53248
ds_read_b128 a[212:215], v238 offset:54272
v_mfma_f32_16x16x32_bf16 v[92:95], v[180:183], a[172:175], v[92:95]
ds_read_b128 a[216:219], v239 offset:53248
ds_read_b128 a[220:223], v239 offset:54272
v_mfma_f32_16x16x32_bf16 v[64:67], v[184:187], a[176:179], v[64:67]
s_add_u32 m0, s43, 0
s_add_u32 s44, s50, 294912
v_mfma_f32_16x16x32_bf16 v[68:71], v[184:187], a[180:183], v[68:71]
buffer_load_dwordx4 v234, s[72:75], s44 offen offset:0 lds
buffer_load_dword v249, v192, s[76:79], s70 offen offset:0
v_mfma_f32_16x16x32_bf16 v[72:75], v[184:187], a[184:187], v[72:75]
v_mfma_f32_16x16x32_bf16 v[76:79], v[184:187], a[188:191], v[76:79]
buffer_load_dwordx4 v235, s[72:75], s44 offen offset:1024 lds
v_mfma_f32_16x16x32_bf16 v[80:83], v[188:191], a[176:179], v[80:83]
v_mfma_f32_16x16x32_bf16 v[84:87], v[188:191], a[180:183], v[84:87]
s_mov_b64 exec, s[10:11]
s_waitcnt vmcnt(10)
ds_write_b128 v222, v[56:59] offset:57344
s_waitcnt vmcnt(9)
ds_write_b128 v222, v[60:63] offset:61440
s_mov_b64 exec, -1
v_mfma_f32_16x16x32_bf16 v[88:91], v[188:191], a[184:187], v[88:91]
buffer_load_dwordx4 v236, s[72:75], s44 offen offset:2048 lds
v_mfma_f32_16x16x32_bf16 v[92:95], v[188:191], a[188:191], v[92:95]
s_waitcnt lgkmcnt(0)
s_barrier
v_mfma_f32_16x16x32_bf16 v[64:67], v[160:163], a[192:195], v[64:67]
ds_read_b64_tr_b16 v[176:177], v244 offset:8192
ds_read_b64_tr_b16 v[178:179], v244 offset:10240
v_mfma_f32_16x16x32_bf16 v[68:71], v[160:163], a[196:199], v[68:71]
ds_read_b64_tr_b16 v[180:181], v245 offset:8192
ds_read_b64_tr_b16 v[182:183], v245 offset:10240
v_mfma_f32_16x16x32_bf16 v[72:75], v[160:163], a[200:203], v[72:75]
ds_read_b64_tr_b16 v[184:185], v244 offset:28672
ds_read_b64_tr_b16 v[186:187], v244 offset:30720
v_mfma_f32_16x16x32_bf16 v[76:79], v[160:163], a[204:207], v[76:79]
ds_read_b64_tr_b16 v[188:189], v245 offset:28672
ds_read_b64_tr_b16 v[190:191], v245 offset:30720
v_mfma_f32_16x16x32_bf16 v[80:83], v[164:167], a[192:195], v[80:83]
ds_read_b128 a[224:227], v238 offset:57344
ds_read_b128 a[228:231], v238 offset:58368
v_mfma_f32_16x16x32_bf16 v[84:87], v[164:167], a[196:199], v[84:87]
ds_read_b128 a[232:235], v239 offset:57344
ds_read_b128 a[236:239], v239 offset:58368
v_mfma_f32_16x16x32_bf16 v[88:91], v[164:167], a[200:203], v[88:91]
ds_read_b128 a[240:243], v238 offset:61440
ds_read_b128 a[244:247], v238 offset:62464
v_mfma_f32_16x16x32_bf16 v[92:95], v[164:167], a[204:207], v[92:95]
ds_read_b128 a[248:251], v239 offset:61440
ds_read_b128 a[252:255], v239 offset:62464
v_mfma_f32_16x16x32_bf16 v[64:67], v[168:171], a[208:211], v[64:67]
buffer_load_dwordx4 v237, s[72:75], s44 offen offset:3072 lds
s_add_u32 m0, s43, 4096
v_mfma_f32_16x16x32_bf16 v[68:71], v[168:171], a[212:215], v[68:71]
s_add_u32 s44, s50, 589824
v_mfma_f32_16x16x32_bf16 v[72:75], v[168:171], a[216:219], v[72:75]
buffer_load_dwordx4 v234, s[72:75], s44 offen offset:0 lds
v_mfma_f32_16x16x32_bf16 v[76:79], v[168:171], a[220:223], v[76:79]
v_mfma_f32_16x16x32_bf16 v[80:83], v[172:175], a[208:211], v[80:83]
buffer_load_dwordx4 v235, s[72:75], s44 offen offset:1024 lds
v_mfma_f32_16x16x32_bf16 v[84:87], v[172:175], a[212:215], v[84:87]
s_mov_b64 exec, s[10:11]
s_waitcnt vmcnt(12)
ds_write_b128 v223, v[96:99] offset:0
s_waitcnt vmcnt(11)
ds_write_b128 v223, v[100:103] offset:4096
s_mov_b64 exec, -1
v_mfma_f32_16x16x32_bf16 v[88:91], v[172:175], a[216:219], v[88:91]
buffer_load_dwordx4 v236, s[72:75], s44 offen offset:2048 lds
v_mfma_f32_16x16x32_bf16 v[92:95], v[172:175], a[220:223], v[92:95]
s_waitcnt lgkmcnt(0)
s_barrier
v_mfma_f32_16x16x32_bf16 v[64:67], v[176:179], a[224:227], v[64:67]
ds_read_b64_tr_b16 v[160:161], v244 offset:12288
ds_read_b64_tr_b16 v[162:163], v244 offset:14336
v_mfma_f32_16x16x32_bf16 v[68:71], v[176:179], a[228:231], v[68:71]
ds_read_b64_tr_b16 v[164:165], v245 offset:12288
ds_read_b64_tr_b16 v[166:167], v245 offset:14336
v_mfma_f32_16x16x32_bf16 v[72:75], v[176:179], a[232:235], v[72:75]
ds_read_b64_tr_b16 v[168:169], v244 offset:32768
ds_read_b64_tr_b16 v[170:171], v244 offset:34816
v_mfma_f32_16x16x32_bf16 v[76:79], v[176:179], a[236:239], v[76:79]
ds_read_b64_tr_b16 v[172:173], v245 offset:32768
ds_read_b64_tr_b16 v[174:175], v245 offset:34816
v_mfma_f32_16x16x32_bf16 v[80:83], v[180:183], a[224:227], v[80:83]
ds_read_b128 v[128:131], v240 offset:0
ds_read_b128 v[132:135], v240 offset:1024
v_mfma_f32_16x16x32_bf16 v[84:87], v[180:183], a[228:231], v[84:87]
ds_read_b128 v[136:139], v241 offset:0
ds_read_b128 v[140:143], v241 offset:1024
v_mfma_f32_16x16x32_bf16 v[88:91], v[180:183], a[232:235], v[88:91]
ds_read_b128 v[144:147], v240 offset:4096
ds_read_b128 v[148:151], v240 offset:5120
v_mfma_f32_16x16x32_bf16 v[92:95], v[180:183], a[236:239], v[92:95]
ds_read_b128 v[152:155], v241 offset:4096
ds_read_b128 v[156:159], v241 offset:5120
v_mfma_f32_16x16x32_bf16 v[64:67], v[184:187], a[240:243], v[64:67]
buffer_load_dwordx4 v237, s[72:75], s44 offen offset:3072 lds
s_add_u32 m0, s43, 8192
v_mfma_f32_16x16x32_bf16 v[68:71], v[184:187], a[244:247], v[68:71]
s_add_u32 s44, s50, 884736
v_mfma_f32_16x16x32_bf16 v[72:75], v[184:187], a[248:251], v[72:75]
buffer_load_dwordx4 v234, s[72:75], s44 offen offset:0 lds
v_mfma_f32_16x16x32_bf16 v[76:79], v[184:187], a[252:255], v[76:79]
v_mfma_f32_16x16x32_bf16 v[80:83], v[188:191], a[240:243], v[80:83]
buffer_load_dwordx4 v235, s[72:75], s44 offen offset:1024 lds
v_mfma_f32_16x16x32_bf16 v[84:87], v[188:191], a[244:247], v[84:87]
v_mfma_f32_16x16x32_bf16 v[88:91], v[188:191], a[248:251], v[88:91]
buffer_load_dwordx4 v236, s[72:75], s44 offen offset:2048 lds
v_mfma_f32_16x16x32_bf16 v[92:95], v[188:191], a[252:255], v[92:95]
s_waitcnt vmcnt(12) lgkmcnt(4)
v_mfma_f32_16x16x32_bf16 v[64:67], v[160:163], v[128:131], v[64:67]
buffer_load_dwordx4 v237, s[72:75], s44 offen offset:3072 lds
v_mfma_f32_16x16x32_bf16 v[68:71], v[160:163], v[132:135], v[68:71]
ds_read_b64_tr_b16 v[176:177], v226 offset:16384
v_mfma_f32_16x16x32_bf16 v[72:75], v[160:163], v[136:139], v[72:75]
v_mfma_f32_16x16x32_bf16 v[76:79], v[160:163], v[140:143], v[76:79]
ds_read_b64_tr_b16 v[178:179], v226 offset:18432
v_mfma_f32_16x16x32_bf16 v[80:83], v[164:167], v[128:131], v[80:83]
v_mfma_f32_16x16x32_bf16 v[84:87], v[164:167], v[132:135], v[84:87]
ds_read_b64_tr_b16 v[180:181], v227 offset:16384
v_mfma_f32_16x16x32_bf16 v[88:91], v[164:167], v[136:139], v[88:91]
v_mfma_f32_16x16x32_bf16 v[92:95], v[164:167], v[140:143], v[92:95]
ds_read_b64_tr_b16 v[182:183], v227 offset:18432
s_waitcnt lgkmcnt(4)
v_mfma_f32_16x16x32_bf16 v[64:67], v[168:171], v[144:147], v[64:67]
v_mfma_f32_16x16x32_bf16 v[68:71], v[168:171], v[148:151], v[68:71]
ds_read_b64_tr_b16 v[184:185], v228 offset:16384
v_mfma_f32_16x16x32_bf16 v[72:75], v[168:171], v[152:155], v[72:75]
v_mfma_f32_16x16x32_bf16 v[76:79], v[168:171], v[156:159], v[76:79]
ds_read_b64_tr_b16 v[186:187], v228 offset:18432
s_add_u32 m0, s43, 12288
v_mfma_f32_16x16x32_bf16 v[80:83], v[172:175], v[144:147], v[80:83]
v_mfma_f32_16x16x32_bf16 v[84:87], v[172:175], v[148:151], v[84:87]
ds_read_b64_tr_b16 v[188:189], v229 offset:16384
s_add_u32 s44, s50, 1179648
v_mfma_f32_16x16x32_bf16 v[88:91], v[172:175], v[152:155], v[88:91]
v_mfma_f32_16x16x32_bf16 v[92:95], v[172:175], v[156:159], v[92:95]
ds_read_b64_tr_b16 v[190:191], v229 offset:18432
s_waitcnt vmcnt(8) lgkmcnt(4)
s_barrier
v_mfma_f32_16x16x32_bf16 v[0:3], v[176:179], a[0:3], 0
v_mfma_f32_16x16x32_bf16 v[8:11], v[176:179], a[4:7], 0
ds_read_b64_tr_b16 v[160:161], v226 offset:0
buffer_load_dwordx4 v234, s[72:75], s44 offen offset:0 lds
v_mfma_f32_16x16x32_bf16 v[16:19], v[176:179], a[8:11], 0
v_mfma_f32_16x16x32_bf16 v[24:27], v[176:179], a[12:15], 0
ds_read_b64_tr_b16 v[162:163], v226 offset:2048
buffer_load_dwordx4 v235, s[72:75], s44 offen offset:1024 lds
v_mfma_f32_16x16x32_bf16 v[4:7], v[180:183], a[0:3], 0
v_exp_f32 v64, -v64
v_mfma_f32_16x16x32_bf16 v[12:15], v[180:183], a[4:7], 0
ds_read_b64_tr_b16 v[164:165], v227 offset:0
buffer_load_dwordx4 v236, s[72:75], s44 offen offset:2048 lds
v_mfma_f32_16x16x32_bf16 v[20:23], v[180:183], a[8:11], 0
v_mfma_f32_16x16x32_bf16 v[28:31], v[180:183], a[12:15], 0
ds_read_b64_tr_b16 v[166:167], v227 offset:2048
s_waitcnt lgkmcnt(4)
v_mfma_f32_16x16x32_bf16 v[32:35], v[184:187], a[0:3], 0
v_exp_f32 v65, -v65
v_mfma_f32_16x16x32_bf16 v[40:43], v[184:187], a[4:7], 0
ds_read_b64_tr_b16 v[168:169], v228 offset:0
buffer_load_dwordx4 v237, s[72:75], s44 offen offset:3072 lds
v_mfma_f32_16x16x32_bf16 v[48:51], v[184:187], a[8:11], 0
s_add_u32 m0, s43, 16384
s_add_u32 s44, s50, 1474560
v_mfma_f32_16x16x32_bf16 v[56:59], v[184:187], a[12:15], 0
ds_read_b64_tr_b16 v[170:171], v228 offset:2048
buffer_load_dwordx4 v234, s[72:75], s44 offen offset:0 lds
v_mfma_f32_16x16x32_bf16 v[36:39], v[188:191], a[0:3], 0
v_add_f32 v64, 1.0, v64
v_mfma_f32_16x16x32_bf16 v[44:47], v[188:191], a[4:7], 0
ds_read_b64_tr_b16 v[172:173], v229 offset:0
buffer_load_dwordx4 v235, s[72:75], s44 offen offset:1024 lds
v_mfma_f32_16x16x32_bf16 v[52:55], v[188:191], a[8:11], 0
v_exp_f32 v66, -v66
v_mfma_f32_16x16x32_bf16 v[60:63], v[188:191], a[12:15], 0
ds_read_b64_tr_b16 v[174:175], v229 offset:2048
s_waitcnt vmcnt(10) lgkmcnt(4)
v_mfma_f32_16x16x32_bf16 v[0:3], v[160:163], a[16:19], v[0:3]
buffer_load_dwordx4 v236, s[72:75], s44 offen offset:2048 lds
v_add_f32 v65, 1.0, v65
v_mfma_f32_16x16x32_bf16 v[8:11], v[160:163], a[20:23], v[8:11]
ds_read_b64_tr_b16 v[176:177], v226 offset:4096
v_mfma_f32_16x16x32_bf16 v[16:19], v[160:163], a[24:27], v[16:19]
v_rcp_f32 v64, v64
v_mfma_f32_16x16x32_bf16 v[24:27], v[160:163], a[28:31], v[24:27]
ds_read_b64_tr_b16 v[178:179], v226 offset:6144
buffer_load_dwordx4 v237, s[72:75], s44 offen offset:3072 lds
v_mfma_f32_16x16x32_bf16 v[4:7], v[164:167], a[16:19], v[4:7]
v_mfma_f32_16x16x32_bf16 v[12:15], v[164:167], a[20:23], v[12:15]
ds_read_b64_tr_b16 v[180:181], v227 offset:4096
s_add_u32 m0, s43, 0
v_mfma_f32_16x16x32_bf16 v[20:23], v[164:167], a[24:27], v[20:23]
v_exp_f32 v67, -v67
v_mfma_f32_16x16x32_bf16 v[28:31], v[164:167], a[28:31], v[28:31]
ds_read_b64_tr_b16 v[182:183], v227 offset:6144
s_waitcnt lgkmcnt(4)
v_mfma_f32_16x16x32_bf16 v[32:35], v[168:171], a[16:19], v[32:35]
s_add_u32 s44, s50, 1769472
v_mfma_f32_16x16x32_bf16 v[40:43], v[168:171], a[20:23], v[40:43]
ds_read_b64_tr_b16 v[184:185], v228 offset:4096
buffer_load_dwordx4 v234, s[72:75], s44 offen offset:0 lds
v_mfma_f32_16x16x32_bf16 v[48:51], v[168:171], a[24:27], v[48:51]
v_add_f32 v66, 1.0, v66
v_mfma_f32_16x16x32_bf16 v[56:59], v[168:171], a[28:31], v[56:59]
ds_read_b64_tr_b16 v[186:187], v228 offset:6144
buffer_load_dwordx4 v235, s[72:75], s44 offen offset:1024 lds
v_mfma_f32_16x16x32_bf16 v[36:39], v[172:175], a[16:19], v[36:39]
v_rcp_f32 v65, v65
v_mfma_f32_16x16x32_bf16 v[44:47], v[172:175], a[20:23], v[44:47]
ds_read_b64_tr_b16 v[188:189], v229 offset:4096
buffer_load_dwordx4 v236, s[72:75], s44 offen offset:2048 lds
v_mfma_f32_16x16x32_bf16 v[52:55], v[172:175], a[24:27], v[52:55]
v_mfma_f32_16x16x32_bf16 v[60:63], v[172:175], a[28:31], v[60:63]
ds_read_b64_tr_b16 v[190:191], v229 offset:6144
s_waitcnt vmcnt(11) lgkmcnt(4)
v_mfma_f32_16x16x32_bf16 v[0:3], v[176:179], a[32:35], v[0:3]
v_exp_f32 v68, -v68
v_mfma_f32_16x16x32_bf16 v[8:11], v[176:179], a[36:39], v[8:11]
ds_read_b64_tr_b16 v[160:161], v226 offset:8192
buffer_load_dwordx4 v237, s[72:75], s44 offen offset:3072 lds
v_mfma_f32_16x16x32_bf16 v[16:19], v[176:179], a[40:43], v[16:19]
v_add_f32 v67, 1.0, v67
v_mfma_f32_16x16x32_bf16 v[24:27], v[176:179], a[44:47], v[24:27]
ds_read_b64_tr_b16 v[162:163], v226 offset:10240
s_add_u32 m0, s43, 4096
v_mfma_f32_16x16x32_bf16 v[4:7], v[180:183], a[32:35], v[4:7]
v_rcp_f32 v66, v66
v_mfma_f32_16x16x32_bf16 v[12:15], v[180:183], a[36:39], v[12:15]
ds_read_b64_tr_b16 v[164:165], v227 offset:8192
s_add_u32 s44, s50, 2064384
v_mfma_f32_16x16x32_bf16 v[20:23], v[180:183], a[40:43], v[20:23]
v_mfma_f32_16x16x32_bf16 v[28:31], v[180:183], a[44:47], v[28:31]
ds_read_b64_tr_b16 v[166:167], v227 offset:10240
s_waitcnt lgkmcnt(4)
v_mfma_f32_16x16x32_bf16 v[32:35], v[184:187], a[32:35], v[32:35]
v_exp_f32 v69, -v69
v_mfma_f32_16x16x32_bf16 v[40:43], v[184:187], a[36:39], v[40:43]
ds_read_b64_tr_b16 v[168:169], v228 offset:8192
buffer_load_dwordx4 v234, s[72:75], s44 offen offset:0 lds
v_mfma_f32_16x16x32_bf16 v[48:51], v[184:187], a[40:43], v[48:51]
buffer_load_dword v249, v192, s[72:75], s70 offen offset:512
v_mfma_f32_16x16x32_bf16 v[56:59], v[184:187], a[44:47], v[56:59]
ds_read_b64_tr_b16 v[170:171], v228 offset:10240
buffer_load_dwordx4 v235, s[72:75], s44 offen offset:1024 lds
v_mfma_f32_16x16x32_bf16 v[36:39], v[188:191], a[32:35], v[36:39]
v_add_f32 v68, 1.0, v68
v_mfma_f32_16x16x32_bf16 v[44:47], v[188:191], a[36:39], v[44:47]
ds_read_b64_tr_b16 v[172:173], v229 offset:8192
buffer_load_dwordx4 v236, s[72:75], s44 offen offset:2048 lds
v_mfma_f32_16x16x32_bf16 v[52:55], v[188:191], a[40:43], v[52:55]
v_rcp_f32 v67, v67
v_mfma_f32_16x16x32_bf16 v[60:63], v[188:191], a[44:47], v[60:63]
ds_read_b64_tr_b16 v[174:175], v229 offset:10240
s_waitcnt vmcnt(12) lgkmcnt(4)
v_mfma_f32_16x16x32_bf16 v[0:3], v[160:163], a[48:51], v[0:3]
v_mfma_f32_16x16x32_bf16 v[8:11], v[160:163], a[52:55], v[8:11]
ds_read_b64_tr_b16 v[176:177], v226 offset:12288
buffer_load_dwordx4 v237, s[72:75], s44 offen offset:3072 lds
v_mfma_f32_16x16x32_bf16 v[16:19], v[160:163], a[56:59], v[16:19]
v_exp_f32 v70, -v70
v_mfma_f32_16x16x32_bf16 v[24:27], v[160:163], a[60:63], v[24:27]
ds_read_b64_tr_b16 v[178:179], v226 offset:14336
s_add_u32 m0, s43, 8192
v_mfma_f32_16x16x32_bf16 v[4:7], v[164:167], a[48:51], v[4:7]
v_mfma_f32_16x16x32_bf16 v[12:15], v[164:167], a[52:55], v[12:15]
ds_read_b64_tr_b16 v[180:181], v227 offset:12288
s_add_u32 s44, s50, 2359296
v_mfma_f32_16x16x32_bf16 v[20:23], v[164:167], a[56:59], v[20:23]
v_add_f32 v69, 1.0, v69
v_mfma_f32_16x16x32_bf16 v[28:31], v[164:167], a[60:63], v[28:31]
ds_read_b64_tr_b16 v[182:183], v227 offset:14336
s_waitcnt lgkmcnt(4)
v_mfma_f32_16x16x32_bf16 v[32:35], v[168:171], a[48:51], v[32:35]
v_rcp_f32 v68, v68
v_mfma_f32_16x16x32_bf16 v[40:43], v[168:171], a[52:55], v[40:43]
ds_read_b64_tr_b16 v[184:185], v228 offset:12288
buffer_load_dwordx4 v234, s[72:75], s44 offen offset:0 lds
v_mfma_f32_16x16x32_bf16 v[48:51], v[168:171], a[56:59], v[48:51]
v_exp_f32 v71, -v71
v_mfma_f32_16x16x32_bf16 v[56:59], v[168:171], a[60:63], v[56:59]
ds_read_b64_tr_b16 v[186:187], v228 offset:14336
buffer_load_dwordx4 v235, s[72:75], s44 offen offset:1024 lds
v_mfma_f32_16x16x32_bf16 v[36:39], v[172:175], a[48:51], v[36:39]
v_mfma_f32_16x16x32_bf16 v[44:47], v[172:175], a[52:55], v[44:47]
ds_read_b64_tr_b16 v[188:189], v229 offset:12288
buffer_load_dwordx4 v236, s[72:75], s44 offen offset:2048 lds
v_mfma_f32_16x16x32_bf16 v[52:55], v[172:175], a[56:59], v[52:55]
v_add_f32 v70, 1.0, v70
v_mfma_f32_16x16x32_bf16 v[60:63], v[172:175], a[60:63], v[60:63]
ds_read_b64_tr_b16 v[190:191], v229 offset:14336
s_waitcnt vmcnt(12) lgkmcnt(4)
v_mfma_f32_16x16x32_bf16 v[0:3], v[176:179], a[64:67], v[0:3]
v_rcp_f32 v69, v69
v_mfma_f32_16x16x32_bf16 v[8:11], v[176:179], a[68:71], v[8:11]
ds_read_b64_tr_b16 v[160:161], v226 offset:16384
buffer_load_dwordx4 v237, s[72:75], s44 offen offset:3072 lds
v_mfma_f32_16x16x32_bf16 v[16:19], v[176:179], a[72:75], v[16:19]
v_mfma_f32_16x16x32_bf16 v[24:27], v[176:179], a[76:79], v[24:27]
ds_read_b64_tr_b16 v[162:163], v226 offset:18432
s_add_u32 m0, s43, 12288
v_mfma_f32_16x16x32_bf16 v[4:7], v[180:183], a[64:67], v[4:7]
v_exp_f32 v72, -v72
v_mfma_f32_16x16x32_bf16 v[12:15], v[180:183], a[68:71], v[12:15]
ds_read_b64_tr_b16 v[164:165], v227 offset:16384
s_add_u32 s44, s50, 2654208
v_mfma_f32_16x16x32_bf16 v[20:23], v[180:183], a[72:75], v[20:23]
v_mfma_f32_16x16x32_bf16 v[28:31], v[180:183], a[76:79], v[28:31]
ds_read_b64_tr_b16 v[166:167], v227 offset:18432
s_waitcnt lgkmcnt(4)
v_mfma_f32_16x16x32_bf16 v[32:35], v[184:187], a[64:67], v[32:35]
v_add_f32 v71, 1.0, v71
v_mfma_f32_16x16x32_bf16 v[40:43], v[184:187], a[68:71], v[40:43]
ds_read_b64_tr_b16 v[168:169], v228 offset:16384
buffer_load_dwordx4 v234, s[72:75], s44 offen offset:0 lds
v_mfma_f32_16x16x32_bf16 v[48:51], v[184:187], a[72:75], v[48:51]
v_rcp_f32 v70, v70
v_mfma_f32_16x16x32_bf16 v[56:59], v[184:187], a[76:79], v[56:59]
ds_read_b64_tr_b16 v[170:171], v228 offset:18432
buffer_load_dwordx4 v235, s[72:75], s44 offen offset:1024 lds
v_mfma_f32_16x16x32_bf16 v[36:39], v[188:191], a[64:67], v[36:39]
v_exp_f32 v73, -v73
v_mfma_f32_16x16x32_bf16 v[44:47], v[188:191], a[68:71], v[44:47]
ds_read_b64_tr_b16 v[172:173], v229 offset:16384
buffer_load_dwordx4 v236, s[72:75], s44 offen offset:2048 lds
v_mfma_f32_16x16x32_bf16 v[52:55], v[188:191], a[72:75], v[52:55]
v_mfma_f32_16x16x32_bf16 v[60:63], v[188:191], a[76:79], v[60:63]
ds_read_b64_tr_b16 v[174:175], v229 offset:18432
s_waitcnt vmcnt(12) lgkmcnt(4)
v_mfma_f32_16x16x32_bf16 v[0:3], v[160:163], a[80:83], v[0:3]
v_add_f32 v72, 1.0, v72
v_mfma_f32_16x16x32_bf16 v[8:11], v[160:163], a[84:87], v[8:11]
ds_read_b64_tr_b16 v[176:177], v226 offset:0
buffer_load_dwordx4 v237, s[72:75], s44 offen offset:3072 lds
v_mfma_f32_16x16x32_bf16 v[16:19], v[160:163], a[88:91], v[16:19]
v_rcp_f32 v71, v71
v_mfma_f32_16x16x32_bf16 v[24:27], v[160:163], a[92:95], v[24:27]
ds_read_b64_tr_b16 v[178:179], v226 offset:2048
s_add_u32 m0, s43, 16384
v_mfma_f32_16x16x32_bf16 v[4:7], v[164:167], a[80:83], v[4:7]
v_mfma_f32_16x16x32_bf16 v[12:15], v[164:167], a[84:87], v[12:15]
ds_read_b64_tr_b16 v[180:181], v227 offset:0
s_add_u32 s44, s50, 2949120
v_mfma_f32_16x16x32_bf16 v[20:23], v[164:167], a[88:91], v[20:23]
v_exp_f32 v74, -v74
v_mfma_f32_16x16x32_bf16 v[28:31], v[164:167], a[92:95], v[28:31]
ds_read_b64_tr_b16 v[182:183], v227 offset:2048
s_waitcnt lgkmcnt(4)
v_mfma_f32_16x16x32_bf16 v[32:35], v[168:171], a[80:83], v[32:35]
v_mfma_f32_16x16x32_bf16 v[40:43], v[168:171], a[84:87], v[40:43]
ds_read_b64_tr_b16 v[184:185], v228 offset:0
buffer_load_dwordx4 v234, s[72:75], s44 offen offset:0 lds
v_mfma_f32_16x16x32_bf16 v[48:51], v[168:171], a[88:91], v[48:51]
v_add_f32 v73, 1.0, v73
v_mfma_f32_16x16x32_bf16 v[56:59], v[168:171], a[92:95], v[56:59]
ds_read_b64_tr_b16 v[186:187], v228 offset:2048
buffer_load_dwordx4 v235, s[72:75], s44 offen offset:1024 lds
v_mfma_f32_16x16x32_bf16 v[36:39], v[172:175], a[80:83], v[36:39]
v_rcp_f32 v72, v72
v_mfma_f32_16x16x32_bf16 v[44:47], v[172:175], a[84:87], v[44:47]
ds_read_b64_tr_b16 v[188:189], v229 offset:0
buffer_load_dwordx4 v236, s[72:75], s44 offen offset:2048 lds
v_mfma_f32_16x16x32_bf16 v[52:55], v[172:175], a[88:91], v[52:55]
v_exp_f32 v75, -v75
v_mfma_f32_16x16x32_bf16 v[60:63], v[172:175], a[92:95], v[60:63]
ds_read_b64_tr_b16 v[190:191], v229 offset:2048
s_waitcnt vmcnt(11) lgkmcnt(4)
v_mfma_f32_16x16x32_bf16 v[0:3], v[176:179], a[96:99], v[0:3]
v_mfma_f32_16x16x32_bf16 v[8:11], v[176:179], a[100:103], v[8:11]
ds_read_b64_tr_b16 v[160:161], v226 offset:4096
buffer_load_dwordx4 v237, s[72:75], s44 offen offset:3072 lds
v_mfma_f32_16x16x32_bf16 v[16:19], v[176:179], a[104:107], v[16:19]
v_add_f32 v74, 1.0, v74
v_mfma_f32_16x16x32_bf16 v[24:27], v[176:179], a[108:111], v[24:27]
ds_read_b64_tr_b16 v[162:163], v226 offset:6144
s_add_u32 m0, s43, 0
v_mfma_f32_16x16x32_bf16 v[4:7], v[180:183], a[96:99], v[4:7]
v_rcp_f32 v73, v73
v_mfma_f32_16x16x32_bf16 v[12:15], v[180:183], a[100:103], v[12:15]
ds_read_b64_tr_b16 v[164:165], v227 offset:4096
s_add_u32 s44, s50, 3244032
v_mfma_f32_16x16x32_bf16 v[20:23], v[180:183], a[104:107], v[20:23]
v_mfma_f32_16x16x32_bf16 v[28:31], v[180:183], a[108:111], v[28:31]
ds_read_b64_tr_b16 v[166:167], v227 offset:6144
s_waitcnt lgkmcnt(4)
v_mfma_f32_16x16x32_bf16 v[32:35], v[184:187], a[96:99], v[32:35]
v_exp_f32 v76, -v76
v_mfma_f32_16x16x32_bf16 v[40:43], v[184:187], a[100:103], v[40:43]
ds_read_b64_tr_b16 v[168:169], v228 offset:4096
buffer_load_dwordx4 v234, s[72:75], s44 offen offset:0 lds
v_mfma_f32_16x16x32_bf16 v[48:51], v[184:187], a[104:107], v[48:51]
v_mfma_f32_16x16x32_bf16 v[56:59], v[184:187], a[108:111], v[56:59]
ds_read_b64_tr_b16 v[170:171], v228 offset:6144
buffer_load_dwordx4 v235, s[72:75], s44 offen offset:1024 lds
v_mfma_f32_16x16x32_bf16 v[36:39], v[188:191], a[96:99], v[36:39]
v_add_f32 v75, 1.0, v75
v_mfma_f32_16x16x32_bf16 v[44:47], v[188:191], a[100:103], v[44:47]
ds_read_b64_tr_b16 v[172:173], v229 offset:4096
buffer_load_dwordx4 v236, s[72:75], s44 offen offset:2048 lds
v_mfma_f32_16x16x32_bf16 v[52:55], v[188:191], a[104:107], v[52:55]
v_rcp_f32 v74, v74
v_mfma_f32_16x16x32_bf16 v[60:63], v[188:191], a[108:111], v[60:63]
ds_read_b64_tr_b16 v[174:175], v229 offset:6144
s_waitcnt vmcnt(11) lgkmcnt(4)
v_mfma_f32_16x16x32_bf16 v[0:3], v[160:163], a[112:115], v[0:3]
v_exp_f32 v77, -v77
v_mfma_f32_16x16x32_bf16 v[8:11], v[160:163], a[116:119], v[8:11]
ds_read_b64_tr_b16 v[176:177], v226 offset:8192
buffer_load_dwordx4 v237, s[72:75], s44 offen offset:3072 lds
v_mfma_f32_16x16x32_bf16 v[16:19], v[160:163], a[120:123], v[16:19]
v_mfma_f32_16x16x32_bf16 v[24:27], v[160:163], a[124:127], v[24:27]
ds_read_b64_tr_b16 v[178:179], v226 offset:10240
s_add_u32 m0, s43, 4096
v_mfma_f32_16x16x32_bf16 v[4:7], v[164:167], a[112:115], v[4:7]
v_add_f32 v76, 1.0, v76
v_mfma_f32_16x16x32_bf16 v[12:15], v[164:167], a[116:119], v[12:15]
ds_read_b64_tr_b16 v[180:181], v227 offset:8192
s_add_u32 s44, s50, 3538944
v_mfma_f32_16x16x32_bf16 v[20:23], v[164:167], a[120:123], v[20:23]
v_rcp_f32 v75, v75
v_mfma_f32_16x16x32_bf16 v[28:31], v[164:167], a[124:127], v[28:31]
ds_read_b64_tr_b16 v[182:183], v227 offset:10240
s_waitcnt lgkmcnt(4)
v_mfma_f32_16x16x32_bf16 v[32:35], v[168:171], a[112:115], v[32:35]
v_mfma_f32_16x16x32_bf16 v[40:43], v[168:171], a[116:119], v[40:43]
ds_read_b64_tr_b16 v[184:185], v228 offset:8192
buffer_load_dwordx4 v234, s[72:75], s44 offen offset:0 lds
v_mfma_f32_16x16x32_bf16 v[48:51], v[168:171], a[120:123], v[48:51]
v_exp_f32 v78, -v78
v_mfma_f32_16x16x32_bf16 v[56:59], v[168:171], a[124:127], v[56:59]
ds_read_b64_tr_b16 v[186:187], v228 offset:10240
buffer_load_dwordx4 v235, s[72:75], s44 offen offset:1024 lds
v_mfma_f32_16x16x32_bf16 v[36:39], v[172:175], a[112:115], v[36:39]
v_mfma_f32_16x16x32_bf16 v[44:47], v[172:175], a[116:119], v[44:47]
ds_read_b64_tr_b16 v[188:189], v229 offset:8192
buffer_load_dwordx4 v236, s[72:75], s44 offen offset:2048 lds
v_mfma_f32_16x16x32_bf16 v[52:55], v[172:175], a[120:123], v[52:55]
v_add_f32 v77, 1.0, v77
v_mfma_f32_16x16x32_bf16 v[60:63], v[172:175], a[124:127], v[60:63]
ds_read_b64_tr_b16 v[190:191], v229 offset:10240
s_waitcnt vmcnt(11) lgkmcnt(4)
v_mfma_f32_16x16x32_bf16 v[0:3], v[176:179], a[128:131], v[0:3]
v_rcp_f32 v76, v76
v_mfma_f32_16x16x32_bf16 v[8:11], v[176:179], a[132:135], v[8:11]
ds_read_b64_tr_b16 v[160:161], v226 offset:12288
buffer_load_dwordx4 v237, s[72:75], s44 offen offset:3072 lds
v_mfma_f32_16x16x32_bf16 v[16:19], v[176:179], a[136:139], v[16:19]
v_mfma_f32_16x16x32_bf16 v[24:27], v[176:179], a[140:143], v[24:27]
ds_read_b64_tr_b16 v[162:163], v226 offset:14336
s_add_u32 m0, s43, 8192
v_mfma_f32_16x16x32_bf16 v[4:7], v[180:183], a[128:131], v[4:7]
v_exp_f32 v79, -v79
v_mfma_f32_16x16x32_bf16 v[12:15], v[180:183], a[132:135], v[12:15]
ds_read_b64_tr_b16 v[164:165], v227 offset:12288
s_add_u32 s44, s50, 3833856
v_mfma_f32_16x16x32_bf16 v[20:23], v[180:183], a[136:139], v[20:23]
v_add_f32 v78, 1.0, v78
v_mfma_f32_16x16x32_bf16 v[28:31], v[180:183], a[140:143], v[28:31]
ds_read_b64_tr_b16 v[166:167], v227 offset:14336
s_waitcnt lgkmcnt(4)
v_mfma_f32_16x16x32_bf16 v[32:35], v[184:187], a[128:131], v[32:35]
v_rcp_f32 v77, v77
v_mfma_f32_16x16x32_bf16 v[40:43], v[184:187], a[132:135], v[40:43]
ds_read_b64_tr_b16 v[168:169], v228 offset:12288
buffer_load_dwordx4 v234, s[72:75], s44 offen offset:0 lds
v_mfma_f32_16x16x32_bf16 v[48:51], v[184:187], a[136:139], v[48:51]
v_mfma_f32_16x16x32_bf16 v[56:59], v[184:187], a[140:143], v[56:59]
ds_read_b64_tr_b16 v[170:171], v228 offset:14336
buffer_load_dwordx4 v235, s[72:75], s44 offen offset:1024 lds
v_mfma_f32_16x16x32_bf16 v[36:39], v[188:191], a[128:131], v[36:39]
v_add_f32 v79, 1.0, v79
v_mfma_f32_16x16x32_bf16 v[44:47], v[188:191], a[132:135], v[44:47]
ds_read_b64_tr_b16 v[172:173], v229 offset:12288
buffer_load_dwordx4 v236, s[72:75], s44 offen offset:2048 lds
v_mfma_f32_16x16x32_bf16 v[52:55], v[188:191], a[136:139], v[52:55]
v_rcp_f32 v78, v78
v_mfma_f32_16x16x32_bf16 v[60:63], v[188:191], a[140:143], v[60:63]
ds_read_b64_tr_b16 v[174:175], v229 offset:14336
s_waitcnt vmcnt(11) lgkmcnt(4)
v_mfma_f32_16x16x32_bf16 v[0:3], v[160:163], a[144:147], v[0:3]
v_mfma_f32_16x16x32_bf16 v[8:11], v[160:163], a[148:151], v[8:11]
ds_read_b64_tr_b16 v[176:177], v226 offset:16384
buffer_load_dwordx4 v237, s[72:75], s44 offen offset:3072 lds
v_mfma_f32_16x16x32_bf16 v[16:19], v[160:163], a[152:155], v[16:19]
v_rcp_f32 v79, v79
v_mfma_f32_16x16x32_bf16 v[24:27], v[160:163], a[156:159], v[24:27]
ds_read_b64_tr_b16 v[178:179], v226 offset:18432
s_add_u32 m0, s43, 12288
v_mfma_f32_16x16x32_bf16 v[4:7], v[164:167], a[144:147], v[4:7]
v_mfma_f32_16x16x32_bf16 v[12:15], v[164:167], a[148:151], v[12:15]
ds_read_b64_tr_b16 v[180:181], v227 offset:16384
s_add_u32 s44, s50, 4128768
v_mfma_f32_16x16x32_bf16 v[20:23], v[164:167], a[152:155], v[20:23]
v_mul_f32 v64, v64, v80
v_mfma_f32_16x16x32_bf16 v[28:31], v[164:167], a[156:159], v[28:31]
ds_read_b64_tr_b16 v[182:183], v227 offset:18432
s_waitcnt lgkmcnt(4)
v_mfma_f32_16x16x32_bf16 v[32:35], v[168:171], a[144:147], v[32:35]
v_mul_f32 v65, v65, v81
v_mul_f32 v66, v66, v82
v_mfma_f32_16x16x32_bf16 v[40:43], v[168:171], a[148:151], v[40:43]
ds_read_b64_tr_b16 v[184:185], v228 offset:16384
buffer_load_dwordx4 v234, s[72:75], s44 offen offset:0 lds
v_mfma_f32_16x16x32_bf16 v[48:51], v[168:171], a[152:155], v[48:51]
v_mul_f32 v67, v67, v83
v_mfma_f32_16x16x32_bf16 v[56:59], v[168:171], a[156:159], v[56:59]
ds_read_b64_tr_b16 v[186:187], v228 offset:18432
buffer_load_dwordx4 v235, s[72:75], s44 offen offset:1024 lds
v_mfma_f32_16x16x32_bf16 v[36:39], v[172:175], a[144:147], v[36:39]
v_mul_f32 v68, v68, v84
v_mfma_f32_16x16x32_bf16 v[44:47], v[172:175], a[148:151], v[44:47]
ds_read_b64_tr_b16 v[188:189], v229 offset:16384
buffer_load_dwordx4 v236, s[72:75], s44 offen offset:2048 lds
v_mfma_f32_16x16x32_bf16 v[52:55], v[172:175], a[152:155], v[52:55]
v_mul_f32 v69, v69, v85
v_mfma_f32_16x16x32_bf16 v[60:63], v[172:175], a[156:159], v[60:63]
ds_read_b64_tr_b16 v[190:191], v229 offset:18432
s_waitcnt vmcnt(11) lgkmcnt(4)
v_mfma_f32_16x16x32_bf16 v[0:3], v[176:179], a[160:163], v[0:3]
v_mul_f32 v70, v70, v86
v_mfma_f32_16x16x32_bf16 v[8:11], v[176:179], a[164:167], v[8:11]
ds_read_b64_tr_b16 v[160:161], v226 offset:0
buffer_load_dwordx4 v237, s[72:75], s44 offen offset:3072 lds
v_mfma_f32_16x16x32_bf16 v[16:19], v[176:179], a[168:171], v[16:19]
v_mul_f32 v71, v71, v87
v_mfma_f32_16x16x32_bf16 v[24:27], v[176:179], a[172:175], v[24:27]
ds_read_b64_tr_b16 v[162:163], v226 offset:2048
s_add_u32 m0, s43, 16384
v_mfma_f32_16x16x32_bf16 v[4:7], v[180:183], a[160:163], v[4:7]
v_mul_f32 v72, v72, v88
v_mfma_f32_16x16x32_bf16 v[12:15], v[180:183], a[164:167], v[12:15]
ds_read_b64_tr_b16 v[164:165], v227 offset:0
s_add_u32 s44, s50, 4423680
v_mfma_f32_16x16x32_bf16 v[20:23], v[180:183], a[168:171], v[20:23]
v_mul_f32 v73, v73, v89
v_mfma_f32_16x16x32_bf16 v[28:31], v[180:183], a[172:175], v[28:31]
ds_read_b64_tr_b16 v[166:167], v227 offset:2048
s_waitcnt lgkmcnt(4)
v_mfma_f32_16x16x32_bf16 v[32:35], v[184:187], a[160:163], v[32:35]
v_mul_f32 v74, v74, v90
v_mfma_f32_16x16x32_bf16 v[40:43], v[184:187], a[164:167], v[40:43]
ds_read_b64_tr_b16 v[168:169], v228 offset:0
buffer_load_dwordx4 v234, s[72:75], s44 offen offset:0 lds
v_mfma_f32_16x16x32_bf16 v[48:51], v[184:187], a[168:171], v[48:51]
v_mul_f32 v75, v75, v91
v_mul_f32 v76, v76, v92
v_mfma_f32_16x16x32_bf16 v[56:59], v[184:187], a[172:175], v[56:59]
ds_read_b64_tr_b16 v[170:171], v228 offset:2048
buffer_load_dwordx4 v235, s[72:75], s44 offen offset:1024 lds
v_mfma_f32_16x16x32_bf16 v[36:39], v[188:191], a[160:163], v[36:39]
v_mul_f32 v77, v77, v93
v_mfma_f32_16x16x32_bf16 v[44:47], v[188:191], a[164:167], v[44:47]
ds_read_b64_tr_b16 v[172:173], v229 offset:0
buffer_load_dwordx4 v236, s[72:75], s44 offen offset:2048 lds
v_mfma_f32_16x16x32_bf16 v[52:55], v[188:191], a[168:171], v[52:55]
v_mul_f32 v78, v78, v94
v_mfma_f32_16x16x32_bf16 v[60:63], v[188:191], a[172:175], v[60:63]
ds_read_b64_tr_b16 v[174:175], v229 offset:2048
s_waitcnt vmcnt(11) lgkmcnt(4)
v_mfma_f32_16x16x32_bf16 v[0:3], v[160:163], a[176:179], v[0:3]
v_mul_f32 v79, v79, v95
v_mfma_f32_16x16x32_bf16 v[8:11], v[160:163], a[180:183], v[8:11]
ds_read_b64_tr_b16 v[176:177], v226 offset:4096
buffer_load_dwordx4 v237, s[72:75], s44 offen offset:3072 lds
v_mfma_f32_16x16x32_bf16 v[16:19], v[160:163], a[184:187], v[16:19]
v_cvt_pk_bf16_f32 v64, v64, v65
v_mfma_f32_16x16x32_bf16 v[24:27], v[160:163], a[188:191], v[24:27]
ds_read_b64_tr_b16 v[178:179], v226 offset:6144
s_add_u32 m0, s43, 0
v_mfma_f32_16x16x32_bf16 v[4:7], v[164:167], a[176:179], v[4:7]
v_cvt_pk_bf16_f32 v65, v66, v67
v_mfma_f32_16x16x32_bf16 v[12:15], v[164:167], a[180:183], v[12:15]
ds_read_b64_tr_b16 v[180:181], v227 offset:4096
s_add_u32 s44, s50, 4718592
v_mfma_f32_16x16x32_bf16 v[20:23], v[164:167], a[184:187], v[20:23]
ds_write_b64 v220, v[64:65] offset:0
v_mfma_f32_16x16x32_bf16 v[28:31], v[164:167], a[188:191], v[28:31]
ds_read_b64_tr_b16 v[182:183], v227 offset:6144
s_waitcnt lgkmcnt(5)
v_mfma_f32_16x16x32_bf16 v[32:35], v[168:171], a[176:179], v[32:35]
v_cvt_pk_bf16_f32 v68, v68, v69
v_mfma_f32_16x16x32_bf16 v[40:43], v[168:171], a[180:183], v[40:43]
ds_read_b64_tr_b16 v[184:185], v228 offset:4096
buffer_load_dwordx4 v234, s[72:75], s44 offen offset:0 lds
v_mfma_f32_16x16x32_bf16 v[48:51], v[168:171], a[184:187], v[48:51]
v_cvt_pk_bf16_f32 v69, v70, v71
v_mfma_f32_16x16x32_bf16 v[56:59], v[168:171], a[188:191], v[56:59]
ds_read_b64_tr_b16 v[186:187], v228 offset:6144
buffer_load_dwordx4 v235, s[72:75], s44 offen offset:1024 lds
v_mfma_f32_16x16x32_bf16 v[36:39], v[172:175], a[176:179], v[36:39]
ds_write_b64 v220, v[68:69] offset:1024
v_mfma_f32_16x16x32_bf16 v[44:47], v[172:175], a[180:183], v[44:47]
ds_read_b64_tr_b16 v[188:189], v229 offset:4096
buffer_load_dwordx4 v236, s[72:75], s44 offen offset:2048 lds
v_mfma_f32_16x16x32_bf16 v[52:55], v[172:175], a[184:187], v[52:55]
v_cvt_pk_bf16_f32 v72, v72, v73
v_cvt_pk_bf16_f32 v73, v74, v75
v_mfma_f32_16x16x32_bf16 v[60:63], v[172:175], a[188:191], v[60:63]
ds_read_b64_tr_b16 v[190:191], v229 offset:6144
s_waitcnt vmcnt(11) lgkmcnt(5)
v_mfma_f32_16x16x32_bf16 v[0:3], v[176:179], a[192:195], v[0:3]
ds_write_b64 v221, v[72:73] offset:0
v_mfma_f32_16x16x32_bf16 v[8:11], v[176:179], a[196:199], v[8:11]
ds_read_b64_tr_b16 v[160:161], v226 offset:8192
buffer_load_dwordx4 v237, s[72:75], s44 offen offset:3072 lds
v_mfma_f32_16x16x32_bf16 v[16:19], v[176:179], a[200:203], v[16:19]
v_cvt_pk_bf16_f32 v76, v76, v77
v_mfma_f32_16x16x32_bf16 v[24:27], v[176:179], a[204:207], v[24:27]
ds_read_b64_tr_b16 v[162:163], v226 offset:10240
s_add_u32 m0, s43, 4096
v_mfma_f32_16x16x32_bf16 v[4:7], v[180:183], a[192:195], v[4:7]
v_cvt_pk_bf16_f32 v77, v78, v79
v_mfma_f32_16x16x32_bf16 v[12:15], v[180:183], a[196:199], v[12:15]
ds_read_b64_tr_b16 v[164:165], v227 offset:8192
s_add_u32 s44, s50, 5013504
v_mfma_f32_16x16x32_bf16 v[20:23], v[180:183], a[200:203], v[20:23]
ds_write_b64 v221, v[76:77] offset:1024
v_mfma_f32_16x16x32_bf16 v[28:31], v[180:183], a[204:207], v[28:31]
ds_read_b64_tr_b16 v[166:167], v227 offset:10240
s_waitcnt lgkmcnt(6)
v_mfma_f32_16x16x32_bf16 v[32:35], v[184:187], a[192:195], v[32:35]
v_mfma_f32_16x16x32_bf16 v[40:43], v[184:187], a[196:199], v[40:43]
ds_read_b64_tr_b16 v[168:169], v228 offset:8192
buffer_load_dwordx4 v234, s[72:75], s44 offen offset:0 lds
v_mfma_f32_16x16x32_bf16 v[48:51], v[184:187], a[200:203], v[48:51]
v_mfma_f32_16x16x32_bf16 v[56:59], v[184:187], a[204:207], v[56:59]
ds_read_b64_tr_b16 v[170:171], v228 offset:10240
buffer_load_dwordx4 v235, s[72:75], s44 offen offset:1024 lds
v_mfma_f32_16x16x32_bf16 v[36:39], v[188:191], a[192:195], v[36:39]
v_mfma_f32_16x16x32_bf16 v[44:47], v[188:191], a[196:199], v[44:47]
ds_read_b64_tr_b16 v[172:173], v229 offset:8192
buffer_load_dwordx4 v236, s[72:75], s44 offen offset:2048 lds
v_mfma_f32_16x16x32_bf16 v[52:55], v[188:191], a[200:203], v[52:55]
v_mfma_f32_16x16x32_bf16 v[60:63], v[188:191], a[204:207], v[60:63]
ds_read_b64_tr_b16 v[174:175], v229 offset:10240
s_waitcnt vmcnt(11) lgkmcnt(4)
v_mfma_f32_16x16x32_bf16 v[0:3], v[160:163], a[208:211], v[0:3]
v_mfma_f32_16x16x32_bf16 v[8:11], v[160:163], a[212:215], v[8:11]
ds_read_b64_tr_b16 v[176:177], v226 offset:12288
buffer_load_dwordx4 v237, s[72:75], s44 offen offset:3072 lds
v_mfma_f32_16x16x32_bf16 v[16:19], v[160:163], a[216:219], v[16:19]
v_mfma_f32_16x16x32_bf16 v[24:27], v[160:163], a[220:223], v[24:27]
ds_read_b64_tr_b16 v[178:179], v226 offset:14336
s_add_u32 m0, s43, 8192
v_mfma_f32_16x16x32_bf16 v[4:7], v[164:167], a[208:211], v[4:7]
v_mfma_f32_16x16x32_bf16 v[12:15], v[164:167], a[212:215], v[12:15]
ds_read_b64_tr_b16 v[180:181], v227 offset:12288
s_add_u32 s44, s50, 0
v_mfma_f32_16x16x32_bf16 v[20:23], v[164:167], a[216:219], v[20:23]
v_mfma_f32_16x16x32_bf16 v[28:31], v[164:167], a[220:223], v[28:31]
ds_read_b64_tr_b16 v[182:183], v227 offset:14336
s_waitcnt lgkmcnt(4)
v_mfma_f32_16x16x32_bf16 v[32:35], v[168:171], a[208:211], v[32:35]
v_mfma_f32_16x16x32_bf16 v[40:43], v[168:171], a[212:215], v[40:43]
ds_read_b64_tr_b16 v[184:185], v228 offset:12288
buffer_load_dwordx4 v234, s[76:79], s44 offen offset:0 lds
v_mfma_f32_16x16x32_bf16 v[48:51], v[168:171], a[216:219], v[48:51]
v_mfma_f32_16x16x32_bf16 v[56:59], v[168:171], a[220:223], v[56:59]
ds_read_b64_tr_b16 v[186:187], v228 offset:14336
buffer_load_dwordx4 v235, s[76:79], s44 offen offset:1024 lds
v_mfma_f32_16x16x32_bf16 v[36:39], v[172:175], a[208:211], v[36:39]
v_mfma_f32_16x16x32_bf16 v[44:47], v[172:175], a[212:215], v[44:47]
ds_read_b64_tr_b16 v[188:189], v229 offset:12288
buffer_load_dwordx4 v236, s[76:79], s44 offen offset:2048 lds
v_mfma_f32_16x16x32_bf16 v[52:55], v[172:175], a[216:219], v[52:55]
v_mfma_f32_16x16x32_bf16 v[60:63], v[172:175], a[220:223], v[60:63]
ds_read_b64_tr_b16 v[190:191], v229 offset:14336
s_waitcnt vmcnt(11) lgkmcnt(4)
v_mfma_f32_16x16x32_bf16 v[0:3], v[176:179], a[224:227], v[0:3]
v_mfma_f32_16x16x32_bf16 v[8:11], v[176:179], a[228:231], v[8:11]
ds_read_b64_tr_b16 v[160:161], v226 offset:16384
buffer_load_dwordx4 v237, s[76:79], s44 offen offset:3072 lds
v_mfma_f32_16x16x32_bf16 v[16:19], v[176:179], a[232:235], v[16:19]
v_mfma_f32_16x16x32_bf16 v[24:27], v[176:179], a[236:239], v[24:27]
ds_read_b64_tr_b16 v[162:163], v226 offset:18432
s_add_u32 m0, s43, 12288
v_mfma_f32_16x16x32_bf16 v[4:7], v[180:183], a[224:227], v[4:7]
v_mfma_f32_16x16x32_bf16 v[12:15], v[180:183], a[228:231], v[12:15]
ds_read_b64_tr_b16 v[164:165], v227 offset:16384
s_add_u32 s44, s50, 294912
v_mfma_f32_16x16x32_bf16 v[20:23], v[180:183], a[232:235], v[20:23]
v_mfma_f32_16x16x32_bf16 v[28:31], v[180:183], a[236:239], v[28:31]
ds_read_b64_tr_b16 v[166:167], v227 offset:18432
s_waitcnt lgkmcnt(4)
v_mfma_f32_16x16x32_bf16 v[32:35], v[184:187], a[224:227], v[32:35]
v_mfma_f32_16x16x32_bf16 v[40:43], v[184:187], a[228:231], v[40:43]
ds_read_b64_tr_b16 v[168:169], v228 offset:16384
buffer_load_dwordx4 v234, s[76:79], s44 offen offset:0 lds
v_mfma_f32_16x16x32_bf16 v[48:51], v[184:187], a[232:235], v[48:51]
v_mfma_f32_16x16x32_bf16 v[56:59], v[184:187], a[236:239], v[56:59]
ds_read_b64_tr_b16 v[170:171], v228 offset:18432
buffer_load_dwordx4 v235, s[76:79], s44 offen offset:1024 lds
v_mfma_f32_16x16x32_bf16 v[36:39], v[188:191], a[224:227], v[36:39]
v_mfma_f32_16x16x32_bf16 v[44:47], v[188:191], a[228:231], v[44:47]
ds_read_b64_tr_b16 v[172:173], v229 offset:16384
buffer_load_dwordx4 v236, s[76:79], s44 offen offset:2048 lds
v_mfma_f32_16x16x32_bf16 v[52:55], v[188:191], a[232:235], v[52:55]
v_mfma_f32_16x16x32_bf16 v[60:63], v[188:191], a[236:239], v[60:63]
ds_read_b64_tr_b16 v[174:175], v229 offset:18432
s_waitcnt vmcnt(11) lgkmcnt(4)
v_mfma_f32_16x16x32_bf16 v[0:3], v[160:163], a[240:243], v[0:3]
v_mfma_f32_16x16x32_bf16 v[8:11], v[160:163], a[244:247], v[8:11]
ds_read_b64_tr_b16 v[176:177], v226 offset:0
buffer_load_dwordx4 v237, s[76:79], s44 offen offset:3072 lds
v_mfma_f32_16x16x32_bf16 v[16:19], v[160:163], a[248:251], v[16:19]
v_mfma_f32_16x16x32_bf16 v[24:27], v[160:163], a[252:255], v[24:27]
ds_read_b64_tr_b16 v[178:179], v226 offset:2048
s_add_u32 m0, s43, 16384
v_mfma_f32_16x16x32_bf16 v[4:7], v[164:167], a[240:243], v[4:7]
v_mfma_f32_16x16x32_bf16 v[12:15], v[164:167], a[244:247], v[12:15]
ds_read_b64_tr_b16 v[180:181], v227 offset:0
s_add_u32 s44, s50, 589824
v_mfma_f32_16x16x32_bf16 v[20:23], v[164:167], a[248:251], v[20:23]
v_mfma_f32_16x16x32_bf16 v[28:31], v[164:167], a[252:255], v[28:31]
ds_read_b64_tr_b16 v[182:183], v227 offset:2048
s_waitcnt lgkmcnt(4)
v_mfma_f32_16x16x32_bf16 v[32:35], v[168:171], a[240:243], v[32:35]
v_mfma_f32_16x16x32_bf16 v[40:43], v[168:171], a[244:247], v[40:43]
ds_read_b64_tr_b16 v[184:185], v228 offset:0
buffer_load_dwordx4 v234, s[76:79], s44 offen offset:0 lds
v_mfma_f32_16x16x32_bf16 v[48:51], v[168:171], a[248:251], v[48:51]
v_mfma_f32_16x16x32_bf16 v[56:59], v[168:171], a[252:255], v[56:59]
ds_read_b64_tr_b16 v[186:187], v228 offset:2048
buffer_load_dwordx4 v235, s[76:79], s44 offen offset:1024 lds
v_mfma_f32_16x16x32_bf16 v[36:39], v[172:175], a[240:243], v[36:39]
v_mfma_f32_16x16x32_bf16 v[44:47], v[172:175], a[244:247], v[44:47]
ds_read_b64_tr_b16 v[188:189], v229 offset:0
buffer_load_dwordx4 v236, s[76:79], s44 offen offset:2048 lds
v_mfma_f32_16x16x32_bf16 v[52:55], v[172:175], a[248:251], v[52:55]
v_mfma_f32_16x16x32_bf16 v[60:63], v[172:175], a[252:255], v[60:63]
ds_read_b64_tr_b16 v[190:191], v229 offset:2048
s_waitcnt vmcnt(11) lgkmcnt(4)
v_mfma_f32_16x16x32_bf16 v[0:3], v[176:179], v[128:131], v[0:3]
v_mfma_f32_16x16x32_bf16 v[8:11], v[176:179], v[132:135], v[8:11]
ds_read_b64_tr_b16 v[160:161], v226 offset:4096
buffer_load_dwordx4 v237, s[76:79], s44 offen offset:3072 lds
v_mfma_f32_16x16x32_bf16 v[16:19], v[176:179], v[136:139], v[16:19]
v_mfma_f32_16x16x32_bf16 v[24:27], v[176:179], v[140:143], v[24:27]
ds_read_b64_tr_b16 v[162:163], v226 offset:6144
s_add_u32 m0, s43, 0
v_mfma_f32_16x16x32_bf16 v[4:7], v[180:183], v[128:131], v[4:7]
v_mfma_f32_16x16x32_bf16 v[12:15], v[180:183], v[132:135], v[12:15]
ds_read_b64_tr_b16 v[164:165], v227 offset:4096
s_add_u32 s44, s50, 884736
v_mfma_f32_16x16x32_bf16 v[20:23], v[180:183], v[136:139], v[20:23]
v_mfma_f32_16x16x32_bf16 v[28:31], v[180:183], v[140:143], v[28:31]
ds_read_b64_tr_b16 v[166:167], v227 offset:6144
s_waitcnt lgkmcnt(4)
v_mfma_f32_16x16x32_bf16 v[32:35], v[184:187], v[128:131], v[32:35]
v_mfma_f32_16x16x32_bf16 v[40:43], v[184:187], v[132:135], v[40:43]
ds_read_b64_tr_b16 v[168:169], v228 offset:4096
buffer_load_dwordx4 v234, s[76:79], s44 offen offset:0 lds
v_mfma_f32_16x16x32_bf16 v[48:51], v[184:187], v[136:139], v[48:51]
v_mfma_f32_16x16x32_bf16 v[56:59], v[184:187], v[140:143], v[56:59]
ds_read_b64_tr_b16 v[170:171], v228 offset:6144
buffer_load_dwordx4 v235, s[76:79], s44 offen offset:1024 lds
v_mfma_f32_16x16x32_bf16 v[36:39], v[188:191], v[128:131], v[36:39]
v_mfma_f32_16x16x32_bf16 v[44:47], v[188:191], v[132:135], v[44:47]
ds_read_b64_tr_b16 v[172:173], v229 offset:4096
buffer_load_dwordx4 v236, s[76:79], s44 offen offset:2048 lds
v_mfma_f32_16x16x32_bf16 v[52:55], v[188:191], v[136:139], v[52:55]
v_mfma_f32_16x16x32_bf16 v[60:63], v[188:191], v[140:143], v[60:63]
ds_read_b64_tr_b16 v[174:175], v229 offset:6144
s_waitcnt vmcnt(11) lgkmcnt(4)
v_mfma_f32_16x16x32_bf16 v[0:3], v[160:163], v[144:147], v[0:3]
v_mfma_f32_16x16x32_bf16 v[8:11], v[160:163], v[148:151], v[8:11]
ds_read_b64_tr_b16 v[176:177], v226 offset:8192
buffer_load_dwordx4 v237, s[76:79], s44 offen offset:3072 lds
v_mfma_f32_16x16x32_bf16 v[16:19], v[160:163], v[152:155], v[16:19]
v_mfma_f32_16x16x32_bf16 v[24:27], v[160:163], v[156:159], v[24:27]
ds_read_b64_tr_b16 v[178:179], v226 offset:10240
s_add_u32 m0, s43, 4096
v_mfma_f32_16x16x32_bf16 v[4:7], v[164:167], v[144:147], v[4:7]
v_mfma_f32_16x16x32_bf16 v[12:15], v[164:167], v[148:151], v[12:15]
ds_read_b64_tr_b16 v[180:181], v227 offset:8192
s_add_u32 s44, s50, 1179648
v_mfma_f32_16x16x32_bf16 v[20:23], v[164:167], v[152:155], v[20:23]
v_mfma_f32_16x16x32_bf16 v[28:31], v[164:167], v[156:159], v[28:31]
ds_read_b64_tr_b16 v[182:183], v227 offset:10240
s_waitcnt lgkmcnt(4)
v_mfma_f32_16x16x32_bf16 v[32:35], v[168:171], v[144:147], v[32:35]
v_mfma_f32_16x16x32_bf16 v[40:43], v[168:171], v[148:151], v[40:43]
ds_read_b64_tr_b16 v[184:185], v228 offset:8192
buffer_load_dwordx4 v234, s[76:79], s44 offen offset:0 lds
v_mfma_f32_16x16x32_bf16 v[48:51], v[168:171], v[152:155], v[48:51]
v_mfma_f32_16x16x32_bf16 v[56:59], v[168:171], v[156:159], v[56:59]
ds_read_b64_tr_b16 v[186:187], v228 offset:10240
buffer_load_dwordx4 v235, s[76:79], s44 offen offset:1024 lds
v_mfma_f32_16x16x32_bf16 v[36:39], v[172:175], v[144:147], v[36:39]
v_mfma_f32_16x16x32_bf16 v[44:47], v[172:175], v[148:151], v[44:47]
ds_read_b64_tr_b16 v[188:189], v229 offset:8192
buffer_load_dwordx4 v236, s[76:79], s44 offen offset:2048 lds
v_mfma_f32_16x16x32_bf16 v[52:55], v[172:175], v[152:155], v[52:55]
v_mfma_f32_16x16x32_bf16 v[60:63], v[172:175], v[156:159], v[60:63]
ds_read_b64_tr_b16 v[190:191], v229 offset:10240
s_waitcnt vmcnt(11) lgkmcnt(4)
v_mfma_f32_16x16x32_bf16 v[64:67], v[176:179], a[0:3], 0
v_mfma_f32_16x16x32_bf16 v[72:75], v[176:179], a[4:7], 0
ds_read_b64_tr_b16 v[160:161], v226 offset:12288
buffer_load_dwordx4 v237, s[76:79], s44 offen offset:3072 lds
v_mfma_f32_16x16x32_bf16 v[80:83], v[176:179], a[8:11], 0
v_mfma_f32_16x16x32_bf16 v[88:91], v[176:179], a[12:15], 0
ds_read_b64_tr_b16 v[162:163], v226 offset:14336
s_add_u32 m0, s43, 8192
v_mfma_f32_16x16x32_bf16 v[68:71], v[180:183], a[0:3], 0
v_exp_f32 v0, -v0
v_mfma_f32_16x16x32_bf16 v[76:79], v[180:183], a[4:7], 0
ds_read_b64_tr_b16 v[164:165], v227 offset:12288
s_add_u32 s44, s50, 1474560
v_mfma_f32_16x16x32_bf16 v[84:87], v[180:183], a[8:11], 0
v_exp_f32 v1, -v1
v_mfma_f32_16x16x32_bf16 v[92:95], v[180:183], a[12:15], 0
ds_read_b64_tr_b16 v[166:167], v227 offset:14336
s_waitcnt lgkmcnt(4)
v_add_f32 v0, 1.0, v0
v_mfma_f32_16x16x32_bf16 v[96:99], v[184:187], a[0:3], 0
v_exp_f32 v2, -v2
v_mfma_f32_16x16x32_bf16 v[104:107], v[184:187], a[4:7], 0
ds_read_b64_tr_b16 v[168:169], v228 offset:12288
buffer_load_dwordx4 v234, s[76:79], s44 offen offset:0 lds
v_mfma_f32_16x16x32_bf16 v[112:115], v[184:187], a[8:11], 0
v_add_f32 v1, 1.0, v1
v_mfma_f32_16x16x32_bf16 v[120:123], v[184:187], a[12:15], 0
ds_read_b64_tr_b16 v[170:171], v228 offset:14336
buffer_load_dwordx4 v235, s[76:79], s44 offen offset:1024 lds
v_mfma_f32_16x16x32_bf16 v[100:103], v[188:191], a[0:3], 0
v_rcp_f32 v0, v0
v_mfma_f32_16x16x32_bf16 v[108:111], v[188:191], a[4:7], 0
ds_read_b64_tr_b16 v[172:173], v229 offset:12288
buffer_load_dwordx4 v236, s[76:79], s44 offen offset:2048 lds
v_mfma_f32_16x16x32_bf16 v[116:119], v[188:191], a[8:11], 0
v_exp_f32 v3, -v3
v_mfma_f32_16x16x32_bf16 v[124:127], v[188:191], a[12:15], 0
ds_read_b64_tr_b16 v[174:175], v229 offset:14336
s_waitcnt vmcnt(11) lgkmcnt(4)
v_add_f32 v2, 1.0, v2
v_mfma_f32_16x16x32_bf16 v[64:67], v[160:163], a[16:19], v[64:67]
v_rcp_f32 v1, v1
v_mfma_f32_16x16x32_bf16 v[72:75], v[160:163], a[20:23], v[72:75]
ds_read_b64_tr_b16 v[176:177], v226 offset:16384
buffer_load_dwordx4 v237, s[76:79], s44 offen offset:3072 lds
v_mfma_f32_16x16x32_bf16 v[80:83], v[160:163], a[24:27], v[80:83]
v_exp_f32 v8, -v8
v_mfma_f32_16x16x32_bf16 v[88:91], v[160:163], a[28:31], v[88:91]
ds_read_b64_tr_b16 v[178:179], v226 offset:18432
s_add_u32 m0, s43, 12288
v_add_f32 v3, 1.0, v3
v_mfma_f32_16x16x32_bf16 v[68:71], v[164:167], a[16:19], v[68:71]
v_rcp_f32 v2, v2
v_mfma_f32_16x16x32_bf16 v[76:79], v[164:167], a[20:23], v[76:79]
ds_read_b64_tr_b16 v[180:181], v227 offset:16384
s_add_u32 s44, s50, 1769472
v_mfma_f32_16x16x32_bf16 v[84:87], v[164:167], a[24:27], v[84:87]
v_exp_f32 v9, -v9
v_mfma_f32_16x16x32_bf16 v[92:95], v[164:167], a[28:31], v[92:95]
ds_read_b64_tr_b16 v[182:183], v227 offset:18432
s_waitcnt lgkmcnt(4)
v_add_f32 v8, 1.0, v8
v_mfma_f32_16x16x32_bf16 v[96:99], v[168:171], a[16:19], v[96:99]
v_rcp_f32 v3, v3
v_mfma_f32_16x16x32_bf16 v[104:107], v[168:171], a[20:23], v[104:107]
ds_read_b64_tr_b16 v[184:185], v228 offset:16384
buffer_load_dwordx4 v234, s[76:79], s44 offen offset:0 lds
v_mfma_f32_16x16x32_bf16 v[112:115], v[168:171], a[24:27], v[112:115]
v_exp_f32 v10, -v10
v_mfma_f32_16x16x32_bf16 v[120:123], v[168:171], a[28:31], v[120:123]
ds_read_b64_tr_b16 v[186:187], v228 offset:18432
buffer_load_dwordx4 v235, s[76:79], s44 offen offset:1024 lds
v_add_f32 v9, 1.0, v9
v_mfma_f32_16x16x32_bf16 v[100:103], v[172:175], a[16:19], v[100:103]
v_rcp_f32 v8, v8
v_mfma_f32_16x16x32_bf16 v[108:111], v[172:175], a[20:23], v[108:111]
ds_read_b64_tr_b16 v[188:189], v229 offset:16384
buffer_load_dwordx4 v236, s[76:79], s44 offen offset:2048 lds
v_mfma_f32_16x16x32_bf16 v[116:119], v[172:175], a[24:27], v[116:119]
v_exp_f32 v11, -v11
v_mfma_f32_16x16x32_bf16 v[124:127], v[172:175], a[28:31], v[124:127]
ds_read_b64_tr_b16 v[190:191], v229 offset:18432
s_waitcnt vmcnt(11) lgkmcnt(4)
v_add_f32 v10, 1.0, v10
v_mfma_f32_16x16x32_bf16 v[64:67], v[176:179], a[32:35], v[64:67]
v_rcp_f32 v9, v9
v_mfma_f32_16x16x32_bf16 v[72:75], v[176:179], a[36:39], v[72:75]
ds_read_b64_tr_b16 v[160:161], v226 offset:0
buffer_load_dwordx4 v237, s[76:79], s44 offen offset:3072 lds
v_mfma_f32_16x16x32_bf16 v[80:83], v[176:179], a[40:43], v[80:83]
v_exp_f32 v16, -v16
v_mfma_f32_16x16x32_bf16 v[88:91], v[176:179], a[44:47], v[88:91]
ds_read_b64_tr_b16 v[162:163], v226 offset:2048
s_add_u32 m0, s43, 16384
v_add_f32 v11, 1.0, v11
v_mfma_f32_16x16x32_bf16 v[68:71], v[180:183], a[32:35], v[68:71]
v_rcp_f32 v10, v10
v_mfma_f32_16x16x32_bf16 v[76:79], v[180:183], a[36:39], v[76:79]
ds_read_b64_tr_b16 v[164:165], v227 offset:0
s_add_u32 s44, s50, 2064384
v_mfma_f32_16x16x32_bf16 v[84:87], v[180:183], a[40:43], v[84:87]
v_exp_f32 v17, -v17
v_mfma_f32_16x16x32_bf16 v[92:95], v[180:183], a[44:47], v[92:95]
ds_read_b64_tr_b16 v[166:167], v227 offset:2048
s_waitcnt lgkmcnt(4)
v_add_f32 v16, 1.0, v16
v_mfma_f32_16x16x32_bf16 v[96:99], v[184:187], a[32:35], v[96:99]
buffer_load_dword v249, v192, s[76:79], s70 offen offset:512
v_rcp_f32 v11, v11
v_mfma_f32_16x16x32_bf16 v[104:107], v[184:187], a[36:39], v[104:107]
ds_read_b64_tr_b16 v[168:169], v228 offset:0
buffer_load_dwordx4 v234, s[76:79], s44 offen offset:0 lds
v_mfma_f32_16x16x32_bf16 v[112:115], v[184:187], a[40:43], v[112:115]
v_exp_f32 v18, -v18
v_mfma_f32_16x16x32_bf16 v[120:123], v[184:187], a[44:47], v[120:123]
ds_read_b64_tr_b16 v[170:171], v228 offset:2048
buffer_load_dwordx4 v235, s[76:79], s44 offen offset:1024 lds
v_add_f32 v17, 1.0, v17
v_mfma_f32_16x16x32_bf16 v[100:103], v[188:191], a[32:35], v[100:103]
v_rcp_f32 v16, v16
v_mfma_f32_16x16x32_bf16 v[108:111], v[188:191], a[36:39], v[108:111]
ds_read_b64_tr_b16 v[172:173], v229 offset:0
buffer_load_dwordx4 v236, s[76:79], s44 offen offset:2048 lds
v_mfma_f32_16x16x32_bf16 v[116:119], v[188:191], a[40:43], v[116:119]
v_exp_f32 v19, -v19
v_mfma_f32_16x16x32_bf16 v[124:127], v[188:191], a[44:47], v[124:127]
ds_read_b64_tr_b16 v[174:175], v229 offset:2048
s_waitcnt vmcnt(12) lgkmcnt(4)
v_add_f32 v18, 1.0, v18
v_mfma_f32_16x16x32_bf16 v[64:67], v[160:163], a[48:51], v[64:67]
v_rcp_f32 v17, v17
v_mfma_f32_16x16x32_bf16 v[72:75], v[160:163], a[52:55], v[72:75]
ds_read_b64_tr_b16 v[176:177], v226 offset:4096
buffer_load_dwordx4 v237, s[76:79], s44 offen offset:3072 lds
v_mfma_f32_16x16x32_bf16 v[80:83], v[160:163], a[56:59], v[80:83]
v_exp_f32 v24, -v24
v_mfma_f32_16x16x32_bf16 v[88:91], v[160:163], a[60:63], v[88:91]
ds_read_b64_tr_b16 v[178:179], v226 offset:6144
s_add_u32 m0, s43, 0
v_add_f32 v19, 1.0, v19
v_mfma_f32_16x16x32_bf16 v[68:71], v[164:167], a[48:51], v[68:71]
v_rcp_f32 v18, v18
v_mfma_f32_16x16x32_bf16 v[76:79], v[164:167], a[52:55], v[76:79]
ds_read_b64_tr_b16 v[180:181], v227 offset:4096
s_add_u32 s44, s50, 2359296
v_mfma_f32_16x16x32_bf16 v[84:87], v[164:167], a[56:59], v[84:87]
v_exp_f32 v25, -v25
v_mfma_f32_16x16x32_bf16 v[92:95], v[164:167], a[60:63], v[92:95]
ds_read_b64_tr_b16 v[182:183], v227 offset:6144
s_waitcnt lgkmcnt(4)
v_add_f32 v24, 1.0, v24
v_mfma_f32_16x16x32_bf16 v[96:99], v[168:171], a[48:51], v[96:99]
v_rcp_f32 v19, v19
v_mfma_f32_16x16x32_bf16 v[104:107], v[168:171], a[52:55], v[104:107]
ds_read_b64_tr_b16 v[184:185], v228 offset:4096
buffer_load_dwordx4 v234, s[76:79], s44 offen offset:0 lds
v_mfma_f32_16x16x32_bf16 v[112:115], v[168:171], a[56:59], v[112:115]
v_exp_f32 v26, -v26
v_mfma_f32_16x16x32_bf16 v[120:123], v[168:171], a[60:63], v[120:123]
ds_read_b64_tr_b16 v[186:187], v228 offset:6144
buffer_load_dwordx4 v235, s[76:79], s44 offen offset:1024 lds
v_add_f32 v25, 1.0, v25
v_mfma_f32_16x16x32_bf16 v[100:103], v[172:175], a[48:51], v[100:103]
v_rcp_f32 v24, v24
v_mfma_f32_16x16x32_bf16 v[108:111], v[172:175], a[52:55], v[108:111]
ds_read_b64_tr_b16 v[188:189], v229 offset:4096
buffer_load_dwordx4 v236, s[76:79], s44 offen offset:2048 lds
v_mfma_f32_16x16x32_bf16 v[116:119], v[172:175], a[56:59], v[116:119]
v_exp_f32 v27, -v27
v_mfma_f32_16x16x32_bf16 v[124:127], v[172:175], a[60:63], v[124:127]
ds_read_b64_tr_b16 v[190:191], v229 offset:6144
s_waitcnt vmcnt(12) lgkmcnt(4)
v_add_f32 v26, 1.0, v26
v_mfma_f32_16x16x32_bf16 v[64:67], v[176:179], a[64:67], v[64:67]
v_rcp_f32 v25, v25
v_mfma_f32_16x16x32_bf16 v[72:75], v[176:179], a[68:71], v[72:75]
ds_read_b64_tr_b16 v[160:161], v226 offset:8192
buffer_load_dwordx4 v237, s[76:79], s44 offen offset:3072 lds
v_mfma_f32_16x16x32_bf16 v[80:83], v[176:179], a[72:75], v[80:83]
v_exp_f32 v4, -v4
v_mfma_f32_16x16x32_bf16 v[88:91], v[176:179], a[76:79], v[88:91]
ds_read_b64_tr_b16 v[162:163], v226 offset:10240
s_add_u32 m0, s43, 4096
v_add_f32 v27, 1.0, v27
v_mfma_f32_16x16x32_bf16 v[68:71], v[180:183], a[64:67], v[68:71]
v_rcp_f32 v26, v26
v_mfma_f32_16x16x32_bf16 v[76:79], v[180:183], a[68:71], v[76:79]
ds_read_b64_tr_b16 v[164:165], v227 offset:8192
s_add_u32 s44, s50, 2654208
v_mfma_f32_16x16x32_bf16 v[84:87], v[180:183], a[72:75], v[84:87]
v_exp_f32 v5, -v5
v_mfma_f32_16x16x32_bf16 v[92:95], v[180:183], a[76:79], v[92:95]
ds_read_b64_tr_b16 v[166:167], v227 offset:10240
s_waitcnt lgkmcnt(4)
v_add_f32 v4, 1.0, v4
v_mfma_f32_16x16x32_bf16 v[96:99], v[184:187], a[64:67], v[96:99]
v_rcp_f32 v27, v27
v_mfma_f32_16x16x32_bf16 v[104:107], v[184:187], a[68:71], v[104:107]
ds_read_b64_tr_b16 v[168:169], v228 offset:8192
buffer_load_dwordx4 v234, s[76:79], s44 offen offset:0 lds
v_mfma_f32_16x16x32_bf16 v[112:115], v[184:187], a[72:75], v[112:115]
v_exp_f32 v6, -v6
v_mfma_f32_16x16x32_bf16 v[120:123], v[184:187], a[76:79], v[120:123]
ds_read_b64_tr_b16 v[170:171], v228 offset:10240
buffer_load_dwordx4 v235, s[76:79], s44 offen offset:1024 lds
v_add_f32 v5, 1.0, v5
v_mfma_f32_16x16x32_bf16 v[100:103], v[188:191], a[64:67], v[100:103]
v_rcp_f32 v4, v4
v_mfma_f32_16x16x32_bf16 v[108:111], v[188:191], a[68:71], v[108:111]
ds_read_b64_tr_b16 v[172:173], v229 offset:8192
buffer_load_dwordx4 v236, s[76:79], s44 offen offset:2048 lds
v_mfma_f32_16x16x32_bf16 v[116:119], v[188:191], a[72:75], v[116:119]
v_exp_f32 v7, -v7
v_mfma_f32_16x16x32_bf16 v[124:127], v[188:191], a[76:79], v[124:127]
ds_read_b64_tr_b16 v[174:175], v229 offset:10240
s_waitcnt vmcnt(12) lgkmcnt(4)
v_add_f32 v6, 1.0, v6
v_mfma_f32_16x16x32_bf16 v[64:67], v[160:163], a[80:83], v[64:67]
v_rcp_f32 v5, v5
v_mfma_f32_16x16x32_bf16 v[72:75], v[160:163], a[84:87], v[72:75]
ds_read_b64_tr_b16 v[176:177], v226 offset:12288
buffer_load_dwordx4 v237, s[76:79], s44 offen offset:3072 lds
v_mfma_f32_16x16x32_bf16 v[80:83], v[160:163], a[88:91], v[80:83]
v_exp_f32 v12, -v12
v_mfma_f32_16x16x32_bf16 v[88:91], v[160:163], a[92:95], v[88:91]
ds_read_b64_tr_b16 v[178:179], v226 offset:14336
s_add_u32 m0, s43, 8192
v_add_f32 v7, 1.0, v7
v_mfma_f32_16x16x32_bf16 v[68:71], v[164:167], a[80:83], v[68:71]
v_rcp_f32 v6, v6
v_mfma_f32_16x16x32_bf16 v[76:79], v[164:167], a[84:87], v[76:79]
ds_read_b64_tr_b16 v[180:181], v227 offset:12288
s_add_u32 s44, s50, 2949120
v_mfma_f32_16x16x32_bf16 v[84:87], v[164:167], a[88:91], v[84:87]
v_exp_f32 v13, -v13
v_mfma_f32_16x16x32_bf16 v[92:95], v[164:167], a[92:95], v[92:95]
ds_read_b64_tr_b16 v[182:183], v227 offset:14336
s_waitcnt lgkmcnt(4)
v_add_f32 v12, 1.0, v12
v_mfma_f32_16x16x32_bf16 v[96:99], v[168:171], a[80:83], v[96:99]
v_rcp_f32 v7, v7
v_mfma_f32_16x16x32_bf16 v[104:107], v[168:171], a[84:87], v[104:107]
ds_read_b64_tr_b16 v[184:185], v228 offset:12288
buffer_load_dwordx4 v234, s[76:79], s44 offen offset:0 lds
v_mfma_f32_16x16x32_bf16 v[112:115], v[168:171], a[88:91], v[112:115]
v_exp_f32 v14, -v14
v_mfma_f32_16x16x32_bf16 v[120:123], v[168:171], a[92:95], v[120:123]
ds_read_b64_tr_b16 v[186:187], v228 offset:14336
buffer_load_dwordx4 v235, s[76:79], s44 offen offset:1024 lds
v_add_f32 v13, 1.0, v13
v_mfma_f32_16x16x32_bf16 v[100:103], v[172:175], a[80:83], v[100:103]
v_rcp_f32 v12, v12
v_mfma_f32_16x16x32_bf16 v[108:111], v[172:175], a[84:87], v[108:111]
ds_read_b64_tr_b16 v[188:189], v229 offset:12288
buffer_load_dwordx4 v236, s[76:79], s44 offen offset:2048 lds
v_mfma_f32_16x16x32_bf16 v[116:119], v[172:175], a[88:91], v[116:119]
v_exp_f32 v15, -v15
v_mfma_f32_16x16x32_bf16 v[124:127], v[172:175], a[92:95], v[124:127]
ds_read_b64_tr_b16 v[190:191], v229 offset:14336
s_waitcnt vmcnt(11) lgkmcnt(4)
v_add_f32 v14, 1.0, v14
v_mfma_f32_16x16x32_bf16 v[64:67], v[176:179], a[96:99], v[64:67]
v_rcp_f32 v13, v13
v_mfma_f32_16x16x32_bf16 v[72:75], v[176:179], a[100:103], v[72:75]
ds_read_b64_tr_b16 v[160:161], v226 offset:16384
buffer_load_dwordx4 v237, s[76:79], s44 offen offset:3072 lds
v_mfma_f32_16x16x32_bf16 v[80:83], v[176:179], a[104:107], v[80:83]
v_exp_f32 v20, -v20
v_mfma_f32_16x16x32_bf16 v[88:91], v[176:179], a[108:111], v[88:91]
ds_read_b64_tr_b16 v[162:163], v226 offset:18432
s_add_u32 m0, s43, 12288
v_add_f32 v15, 1.0, v15
v_mfma_f32_16x16x32_bf16 v[68:71], v[180:183], a[96:99], v[68:71]
v_rcp_f32 v14, v14
v_mfma_f32_16x16x32_bf16 v[76:79], v[180:183], a[100:103], v[76:79]
ds_read_b64_tr_b16 v[164:165], v227 offset:16384
s_add_u32 s44, s50, 3244032
v_mfma_f32_16x16x32_bf16 v[84:87], v[180:183], a[104:107], v[84:87]
v_exp_f32 v21, -v21
v_mfma_f32_16x16x32_bf16 v[92:95], v[180:183], a[108:111], v[92:95]
ds_read_b64_tr_b16 v[166:167], v227 offset:18432
s_waitcnt lgkmcnt(4)
v_add_f32 v20, 1.0, v20
v_mfma_f32_16x16x32_bf16 v[96:99], v[184:187], a[96:99], v[96:99]
v_rcp_f32 v15, v15
v_mfma_f32_16x16x32_bf16 v[104:107], v[184:187], a[100:103], v[104:107]
ds_read_b64_tr_b16 v[168:169], v228 offset:16384
buffer_load_dwordx4 v234, s[76:79], s44 offen offset:0 lds
v_mfma_f32_16x16x32_bf16 v[112:115], v[184:187], a[104:107], v[112:115]
v_exp_f32 v22, -v22
v_mfma_f32_16x16x32_bf16 v[120:123], v[184:187], a[108:111], v[120:123]
ds_read_b64_tr_b16 v[170:171], v228 offset:18432
buffer_load_dwordx4 v235, s[76:79], s44 offen offset:1024 lds
v_add_f32 v21, 1.0, v21
v_mfma_f32_16x16x32_bf16 v[100:103], v[188:191], a[96:99], v[100:103]
v_rcp_f32 v20, v20
v_mfma_f32_16x16x32_bf16 v[108:111], v[188:191], a[100:103], v[108:111]
ds_read_b64_tr_b16 v[172:173], v229 offset:16384
buffer_load_dwordx4 v236, s[76:79], s44 offen offset:2048 lds
v_mfma_f32_16x16x32_bf16 v[116:119], v[188:191], a[104:107], v[116:119]
v_exp_f32 v23, -v23
v_mfma_f32_16x16x32_bf16 v[124:127], v[188:191], a[108:111], v[124:127]
ds_read_b64_tr_b16 v[174:175], v229 offset:18432
s_waitcnt vmcnt(11) lgkmcnt(4)
v_add_f32 v22, 1.0, v22
v_mfma_f32_16x16x32_bf16 v[64:67], v[160:163], a[112:115], v[64:67]
v_rcp_f32 v21, v21
v_mfma_f32_16x16x32_bf16 v[72:75], v[160:163], a[116:119], v[72:75]
ds_read_b64_tr_b16 v[176:177], v226 offset:0
buffer_load_dwordx4 v237, s[76:79], s44 offen offset:3072 lds
v_mfma_f32_16x16x32_bf16 v[80:83], v[160:163], a[120:123], v[80:83]
v_exp_f32 v28, -v28
v_mfma_f32_16x16x32_bf16 v[88:91], v[160:163], a[124:127], v[88:91]
ds_read_b64_tr_b16 v[178:179], v226 offset:2048
s_add_u32 m0, s43, 16384
v_add_f32 v23, 1.0, v23
v_mfma_f32_16x16x32_bf16 v[68:71], v[164:167], a[112:115], v[68:71]
v_rcp_f32 v22, v22
v_mfma_f32_16x16x32_bf16 v[76:79], v[164:167], a[116:119], v[76:79]
ds_read_b64_tr_b16 v[180:181], v227 offset:0
s_add_u32 s44, s50, 3538944
v_mfma_f32_16x16x32_bf16 v[84:87], v[164:167], a[120:123], v[84:87]
v_exp_f32 v29, -v29
v_mfma_f32_16x16x32_bf16 v[92:95], v[164:167], a[124:127], v[92:95]
ds_read_b64_tr_b16 v[182:183], v227 offset:2048
s_waitcnt lgkmcnt(4)
v_add_f32 v28, 1.0, v28
v_mfma_f32_16x16x32_bf16 v[96:99], v[168:171], a[112:115], v[96:99]
v_rcp_f32 v23, v23
v_mfma_f32_16x16x32_bf16 v[104:107], v[168:171], a[116:119], v[104:107]
ds_read_b64_tr_b16 v[184:185], v228 offset:0
buffer_load_dwordx4 v234, s[76:79], s44 offen offset:0 lds
v_mfma_f32_16x16x32_bf16 v[112:115], v[168:171], a[120:123], v[112:115]
v_exp_f32 v30, -v30
v_mfma_f32_16x16x32_bf16 v[120:123], v[168:171], a[124:127], v[120:123]
ds_read_b64_tr_b16 v[186:187], v228 offset:2048
buffer_load_dwordx4 v235, s[76:79], s44 offen offset:1024 lds
v_add_f32 v29, 1.0, v29
v_mfma_f32_16x16x32_bf16 v[100:103], v[172:175], a[112:115], v[100:103]
v_rcp_f32 v28, v28
v_mfma_f32_16x16x32_bf16 v[108:111], v[172:175], a[116:119], v[108:111]
ds_read_b64_tr_b16 v[188:189], v229 offset:0
buffer_load_dwordx4 v236, s[76:79], s44 offen offset:2048 lds
v_mfma_f32_16x16x32_bf16 v[116:119], v[172:175], a[120:123], v[116:119]
v_exp_f32 v31, -v31
v_mfma_f32_16x16x32_bf16 v[124:127], v[172:175], a[124:127], v[124:127]
ds_read_b64_tr_b16 v[190:191], v229 offset:2048
s_waitcnt vmcnt(11) lgkmcnt(4)
v_add_f32 v30, 1.0, v30
v_mfma_f32_16x16x32_bf16 v[64:67], v[176:179], a[128:131], v[64:67]
v_rcp_f32 v29, v29
v_mfma_f32_16x16x32_bf16 v[72:75], v[176:179], a[132:135], v[72:75]
ds_read_b64_tr_b16 v[160:161], v226 offset:4096
buffer_load_dwordx4 v237, s[76:79], s44 offen offset:3072 lds
v_mfma_f32_16x16x32_bf16 v[80:83], v[176:179], a[136:139], v[80:83]
v_exp_f32 v32, -v32
v_mfma_f32_16x16x32_bf16 v[88:91], v[176:179], a[140:143], v[88:91]
ds_read_b64_tr_b16 v[162:163], v226 offset:6144
s_add_u32 m0, s43, 0
v_add_f32 v31, 1.0, v31
v_mfma_f32_16x16x32_bf16 v[68:71], v[180:183], a[128:131], v[68:71]
v_rcp_f32 v30, v30
v_mfma_f32_16x16x32_bf16 v[76:79], v[180:183], a[132:135], v[76:79]
ds_read_b64_tr_b16 v[164:165], v227 offset:4096
s_add_u32 s44, s50, 3833856
v_mfma_f32_16x16x32_bf16 v[84:87], v[180:183], a[136:139], v[84:87]
v_exp_f32 v33, -v33
v_mfma_f32_16x16x32_bf16 v[92:95], v[180:183], a[140:143], v[92:95]
ds_read_b64_tr_b16 v[166:167], v227 offset:6144
s_waitcnt lgkmcnt(4)
v_add_f32 v32, 1.0, v32
v_mfma_f32_16x16x32_bf16 v[96:99], v[184:187], a[128:131], v[96:99]
v_rcp_f32 v31, v31
v_mfma_f32_16x16x32_bf16 v[104:107], v[184:187], a[132:135], v[104:107]
ds_read_b64_tr_b16 v[168:169], v228 offset:4096
buffer_load_dwordx4 v234, s[76:79], s44 offen offset:0 lds
v_mfma_f32_16x16x32_bf16 v[112:115], v[184:187], a[136:139], v[112:115]
v_exp_f32 v34, -v34
v_mfma_f32_16x16x32_bf16 v[120:123], v[184:187], a[140:143], v[120:123]
ds_read_b64_tr_b16 v[170:171], v228 offset:6144
buffer_load_dwordx4 v235, s[76:79], s44 offen offset:1024 lds
v_add_f32 v33, 1.0, v33
v_mfma_f32_16x16x32_bf16 v[100:103], v[188:191], a[128:131], v[100:103]
v_rcp_f32 v32, v32
v_mfma_f32_16x16x32_bf16 v[108:111], v[188:191], a[132:135], v[108:111]
ds_read_b64_tr_b16 v[172:173], v229 offset:4096
buffer_load_dwordx4 v236, s[76:79], s44 offen offset:2048 lds
v_mfma_f32_16x16x32_bf16 v[116:119], v[188:191], a[136:139], v[116:119]
v_exp_f32 v35, -v35
v_mfma_f32_16x16x32_bf16 v[124:127], v[188:191], a[140:143], v[124:127]
ds_read_b64_tr_b16 v[174:175], v229 offset:6144
s_waitcnt vmcnt(11) lgkmcnt(4)
v_add_f32 v34, 1.0, v34
v_mfma_f32_16x16x32_bf16 v[64:67], v[160:163], a[144:147], v[64:67]
v_rcp_f32 v33, v33
v_mfma_f32_16x16x32_bf16 v[72:75], v[160:163], a[148:151], v[72:75]
ds_read_b64_tr_b16 v[176:177], v226 offset:8192
buffer_load_dwordx4 v237, s[76:79], s44 offen offset:3072 lds
v_mfma_f32_16x16x32_bf16 v[80:83], v[160:163], a[152:155], v[80:83]
v_exp_f32 v40, -v40
v_mfma_f32_16x16x32_bf16 v[88:91], v[160:163], a[156:159], v[88:91]
ds_read_b64_tr_b16 v[178:179], v226 offset:10240
s_add_u32 m0, s43, 4096
v_add_f32 v35, 1.0, v35
v_mfma_f32_16x16x32_bf16 v[68:71], v[164:167], a[144:147], v[68:71]
v_rcp_f32 v34, v34
v_mfma_f32_16x16x32_bf16 v[76:79], v[164:167], a[148:151], v[76:79]
ds_read_b64_tr_b16 v[180:181], v227 offset:8192
s_add_u32 s44, s50, 4128768
v_mfma_f32_16x16x32_bf16 v[84:87], v[164:167], a[152:155], v[84:87]
v_exp_f32 v41, -v41
v_mfma_f32_16x16x32_bf16 v[92:95], v[164:167], a[156:159], v[92:95]
ds_read_b64_tr_b16 v[182:183], v227 offset:10240
s_waitcnt lgkmcnt(4)
v_add_f32 v40, 1.0, v40
v_mfma_f32_16x16x32_bf16 v[96:99], v[168:171], a[144:147], v[96:99]
v_rcp_f32 v35, v35
v_mfma_f32_16x16x32_bf16 v[104:107], v[168:171], a[148:151], v[104:107]
ds_read_b64_tr_b16 v[184:185], v228 offset:8192
buffer_load_dwordx4 v234, s[76:79], s44 offen offset:0 lds
v_mfma_f32_16x16x32_bf16 v[112:115], v[168:171], a[152:155], v[112:115]
v_exp_f32 v42, -v42
v_mfma_f32_16x16x32_bf16 v[120:123], v[168:171], a[156:159], v[120:123]
ds_read_b64_tr_b16 v[186:187], v228 offset:10240
buffer_load_dwordx4 v235, s[76:79], s44 offen offset:1024 lds
v_add_f32 v41, 1.0, v41
v_mfma_f32_16x16x32_bf16 v[100:103], v[172:175], a[144:147], v[100:103]
v_rcp_f32 v40, v40
v_mfma_f32_16x16x32_bf16 v[108:111], v[172:175], a[148:151], v[108:111]
ds_read_b64_tr_b16 v[188:189], v229 offset:8192
buffer_load_dwordx4 v236, s[76:79], s44 offen offset:2048 lds
v_mfma_f32_16x16x32_bf16 v[116:119], v[172:175], a[152:155], v[116:119]
v_exp_f32 v43, -v43
v_mfma_f32_16x16x32_bf16 v[124:127], v[172:175], a[156:159], v[124:127]
ds_read_b64_tr_b16 v[190:191], v229 offset:10240
s_waitcnt vmcnt(11) lgkmcnt(4)
v_add_f32 v42, 1.0, v42
v_mfma_f32_16x16x32_bf16 v[64:67], v[176:179], a[160:163], v[64:67]
v_rcp_f32 v41, v41
v_mfma_f32_16x16x32_bf16 v[72:75], v[176:179], a[164:167], v[72:75]
ds_read_b64_tr_b16 v[160:161], v226 offset:12288
buffer_load_dwordx4 v237, s[76:79], s44 offen offset:3072 lds
v_mfma_f32_16x16x32_bf16 v[80:83], v[176:179], a[168:171], v[80:83]
v_exp_f32 v48, -v48
v_mfma_f32_16x16x32_bf16 v[88:91], v[176:179], a[172:175], v[88:91]
ds_read_b64_tr_b16 v[162:163], v226 offset:14336
s_add_u32 m0, s43, 8192
v_add_f32 v43, 1.0, v43
v_mfma_f32_16x16x32_bf16 v[68:71], v[180:183], a[160:163], v[68:71]
v_rcp_f32 v42, v42
v_mfma_f32_16x16x32_bf16 v[76:79], v[180:183], a[164:167], v[76:79]
ds_read_b64_tr_b16 v[164:165], v227 offset:12288
s_add_u32 s44, s50, 4423680
v_mfma_f32_16x16x32_bf16 v[84:87], v[180:183], a[168:171], v[84:87]
v_exp_f32 v49, -v49
v_mfma_f32_16x16x32_bf16 v[92:95], v[180:183], a[172:175], v[92:95]
ds_read_b64_tr_b16 v[166:167], v227 offset:14336
s_waitcnt lgkmcnt(4)
v_add_f32 v48, 1.0, v48
v_mfma_f32_16x16x32_bf16 v[96:99], v[184:187], a[160:163], v[96:99]
v_rcp_f32 v43, v43
v_mfma_f32_16x16x32_bf16 v[104:107], v[184:187], a[164:167], v[104:107]
ds_read_b64_tr_b16 v[168:169], v228 offset:12288
buffer_load_dwordx4 v234, s[76:79], s44 offen offset:0 lds
v_mfma_f32_16x16x32_bf16 v[112:115], v[184:187], a[168:171], v[112:115]
v_exp_f32 v50, -v50
v_mfma_f32_16x16x32_bf16 v[120:123], v[184:187], a[172:175], v[120:123]
ds_read_b64_tr_b16 v[170:171], v228 offset:14336
buffer_load_dwordx4 v235, s[76:79], s44 offen offset:1024 lds
v_add_f32 v49, 1.0, v49
v_mfma_f32_16x16x32_bf16 v[100:103], v[188:191], a[160:163], v[100:103]
v_rcp_f32 v48, v48
v_mfma_f32_16x16x32_bf16 v[108:111], v[188:191], a[164:167], v[108:111]
ds_read_b64_tr_b16 v[172:173], v229 offset:12288
buffer_load_dwordx4 v236, s[76:79], s44 offen offset:2048 lds
v_mfma_f32_16x16x32_bf16 v[116:119], v[188:191], a[168:171], v[116:119]
v_exp_f32 v51, -v51
v_mfma_f32_16x16x32_bf16 v[124:127], v[188:191], a[172:175], v[124:127]
ds_read_b64_tr_b16 v[174:175], v229 offset:14336
s_waitcnt vmcnt(11) lgkmcnt(4)
v_add_f32 v50, 1.0, v50
v_mfma_f32_16x16x32_bf16 v[64:67], v[160:163], a[176:179], v[64:67]
v_rcp_f32 v49, v49
v_mfma_f32_16x16x32_bf16 v[72:75], v[160:163], a[180:183], v[72:75]
ds_read_b64_tr_b16 v[176:177], v226 offset:16384
buffer_load_dwordx4 v237, s[76:79], s44 offen offset:3072 lds
v_mfma_f32_16x16x32_bf16 v[80:83], v[160:163], a[184:187], v[80:83]
v_exp_f32 v56, -v56
v_mfma_f32_16x16x32_bf16 v[88:91], v[160:163], a[188:191], v[88:91]
ds_read_b64_tr_b16 v[178:179], v226 offset:18432
s_add_u32 m0, s43, 12288
v_add_f32 v51, 1.0, v51
v_mfma_f32_16x16x32_bf16 v[68:71], v[164:167], a[176:179], v[68:71]
v_rcp_f32 v50, v50
v_mfma_f32_16x16x32_bf16 v[76:79], v[164:167], a[180:183], v[76:79]
ds_read_b64_tr_b16 v[180:181], v227 offset:16384
s_add_u32 s44, s50, 4718592
v_mfma_f32_16x16x32_bf16 v[84:87], v[164:167], a[184:187], v[84:87]
v_exp_f32 v57, -v57
v_mfma_f32_16x16x32_bf16 v[92:95], v[164:167], a[188:191], v[92:95]
ds_read_b64_tr_b16 v[182:183], v227 offset:18432
s_waitcnt lgkmcnt(4)
v_add_f32 v56, 1.0, v56
v_mfma_f32_16x16x32_bf16 v[96:99], v[168:171], a[176:179], v[96:99]
v_rcp_f32 v51, v51
v_mfma_f32_16x16x32_bf16 v[104:107], v[168:171], a[180:183], v[104:107]
ds_read_b64_tr_b16 v[184:185], v228 offset:16384
buffer_load_dwordx4 v234, s[76:79], s44 offen offset:0 lds
v_mfma_f32_16x16x32_bf16 v[112:115], v[168:171], a[184:187], v[112:115]
v_exp_f32 v58, -v58
v_mfma_f32_16x16x32_bf16 v[120:123], v[168:171], a[188:191], v[120:123]
ds_read_b64_tr_b16 v[186:187], v228 offset:18432
buffer_load_dwordx4 v235, s[76:79], s44 offen offset:1024 lds
v_add_f32 v57, 1.0, v57
v_mfma_f32_16x16x32_bf16 v[100:103], v[172:175], a[176:179], v[100:103]
v_rcp_f32 v56, v56
v_mfma_f32_16x16x32_bf16 v[108:111], v[172:175], a[180:183], v[108:111]
ds_read_b64_tr_b16 v[188:189], v229 offset:16384
buffer_load_dwordx4 v236, s[76:79], s44 offen offset:2048 lds
v_mfma_f32_16x16x32_bf16 v[116:119], v[172:175], a[184:187], v[116:119]
v_exp_f32 v59, -v59
v_mfma_f32_16x16x32_bf16 v[124:127], v[172:175], a[188:191], v[124:127]
ds_read_b64_tr_b16 v[190:191], v229 offset:18432
s_waitcnt vmcnt(11) lgkmcnt(4)
v_add_f32 v58, 1.0, v58
v_mfma_f32_16x16x32_bf16 v[64:67], v[176:179], a[192:195], v[64:67]
v_rcp_f32 v57, v57
v_mfma_f32_16x16x32_bf16 v[72:75], v[176:179], a[196:199], v[72:75]
ds_read_b64_tr_b16 v[160:161], v226 offset:0
buffer_load_dwordx4 v237, s[76:79], s44 offen offset:3072 lds
v_mfma_f32_16x16x32_bf16 v[80:83], v[176:179], a[200:203], v[80:83]
v_exp_f32 v36, -v36
v_mfma_f32_16x16x32_bf16 v[88:91], v[176:179], a[204:207], v[88:91]
ds_read_b64_tr_b16 v[162:163], v226 offset:2048
s_add_u32 m0, s43, 16384
v_add_f32 v59, 1.0, v59
v_mfma_f32_16x16x32_bf16 v[68:71], v[180:183], a[192:195], v[68:71]
v_rcp_f32 v58, v58
v_mfma_f32_16x16x32_bf16 v[76:79], v[180:183], a[196:199], v[76:79]
ds_read_b64_tr_b16 v[164:165], v227 offset:0
s_add_u32 s44, s50, 5013504
v_mfma_f32_16x16x32_bf16 v[84:87], v[180:183], a[200:203], v[84:87]
v_exp_f32 v37, -v37
v_mfma_f32_16x16x32_bf16 v[92:95], v[180:183], a[204:207], v[92:95]
ds_read_b64_tr_b16 v[166:167], v227 offset:2048
s_waitcnt lgkmcnt(4)
v_add_f32 v36, 1.0, v36
v_mfma_f32_16x16x32_bf16 v[96:99], v[184:187], a[192:195], v[96:99]
v_rcp_f32 v59, v59
v_mfma_f32_16x16x32_bf16 v[104:107], v[184:187], a[196:199], v[104:107]
ds_read_b64_tr_b16 v[168:169], v228 offset:0
buffer_load_dwordx4 v234, s[76:79], s44 offen offset:0 lds
v_mfma_f32_16x16x32_bf16 v[112:115], v[184:187], a[200:203], v[112:115]
v_exp_f32 v38, -v38
v_mfma_f32_16x16x32_bf16 v[120:123], v[184:187], a[204:207], v[120:123]
ds_read_b64_tr_b16 v[170:171], v228 offset:2048
buffer_load_dwordx4 v235, s[76:79], s44 offen offset:1024 lds
v_add_f32 v37, 1.0, v37
v_mfma_f32_16x16x32_bf16 v[100:103], v[188:191], a[192:195], v[100:103]
v_rcp_f32 v36, v36
v_mfma_f32_16x16x32_bf16 v[108:111], v[188:191], a[196:199], v[108:111]
ds_read_b64_tr_b16 v[172:173], v229 offset:0
buffer_load_dwordx4 v236, s[76:79], s44 offen offset:2048 lds
v_mfma_f32_16x16x32_bf16 v[116:119], v[188:191], a[200:203], v[116:119]
v_exp_f32 v39, -v39
v_mfma_f32_16x16x32_bf16 v[124:127], v[188:191], a[204:207], v[124:127]
ds_read_b64_tr_b16 v[174:175], v229 offset:2048
s_waitcnt vmcnt(11) lgkmcnt(4)
v_add_f32 v38, 1.0, v38
v_mfma_f32_16x16x32_bf16 v[64:67], v[160:163], a[208:211], v[64:67]
v_rcp_f32 v37, v37
v_mfma_f32_16x16x32_bf16 v[72:75], v[160:163], a[212:215], v[72:75]
ds_read_b64_tr_b16 v[176:177], v226 offset:4096
buffer_load_dwordx4 v237, s[76:79], s44 offen offset:3072 lds
v_mfma_f32_16x16x32_bf16 v[80:83], v[160:163], a[216:219], v[80:83]
v_exp_f32 v44, -v44
v_mfma_f32_16x16x32_bf16 v[88:91], v[160:163], a[220:223], v[88:91]
ds_read_b64_tr_b16 v[178:179], v226 offset:6144
s_add_u32 m0, s43, 0
v_add_f32 v39, 1.0, v39
v_mfma_f32_16x16x32_bf16 v[68:71], v[164:167], a[208:211], v[68:71]
v_rcp_f32 v38, v38
v_mfma_f32_16x16x32_bf16 v[76:79], v[164:167], a[212:215], v[76:79]
ds_read_b64_tr_b16 v[180:181], v227 offset:4096
s_add_u32 s44, s50, 512
v_mfma_f32_16x16x32_bf16 v[84:87], v[164:167], a[216:219], v[84:87]
v_exp_f32 v45, -v45
v_mfma_f32_16x16x32_bf16 v[92:95], v[164:167], a[220:223], v[92:95]
ds_read_b64_tr_b16 v[182:183], v227 offset:6144
s_waitcnt lgkmcnt(4)
v_add_f32 v44, 1.0, v44
v_mfma_f32_16x16x32_bf16 v[96:99], v[168:171], a[208:211], v[96:99]
v_rcp_f32 v39, v39
v_mfma_f32_16x16x32_bf16 v[104:107], v[168:171], a[212:215], v[104:107]
ds_read_b64_tr_b16 v[184:185], v228 offset:4096
buffer_load_dwordx4 v234, s[72:75], s44 offen offset:0 lds
v_mfma_f32_16x16x32_bf16 v[112:115], v[168:171], a[216:219], v[112:115]
v_exp_f32 v46, -v46
v_mfma_f32_16x16x32_bf16 v[120:123], v[168:171], a[220:223], v[120:123]
ds_read_b64_tr_b16 v[186:187], v228 offset:6144
buffer_load_dwordx4 v235, s[72:75], s44 offen offset:1024 lds
v_add_f32 v45, 1.0, v45
v_mfma_f32_16x16x32_bf16 v[100:103], v[172:175], a[208:211], v[100:103]
v_rcp_f32 v44, v44
v_mfma_f32_16x16x32_bf16 v[108:111], v[172:175], a[212:215], v[108:111]
ds_read_b64_tr_b16 v[188:189], v229 offset:4096
buffer_load_dwordx4 v236, s[72:75], s44 offen offset:2048 lds
v_mfma_f32_16x16x32_bf16 v[116:119], v[172:175], a[216:219], v[116:119]
v_exp_f32 v47, -v47
v_mfma_f32_16x16x32_bf16 v[124:127], v[172:175], a[220:223], v[124:127]
ds_read_b64_tr_b16 v[190:191], v229 offset:6144
s_waitcnt vmcnt(11) lgkmcnt(4)
v_add_f32 v46, 1.0, v46
v_mfma_f32_16x16x32_bf16 v[64:67], v[176:179], a[224:227], v[64:67]
v_rcp_f32 v45, v45
v_mfma_f32_16x16x32_bf16 v[72:75], v[176:179], a[228:231], v[72:75]
ds_read_b64_tr_b16 v[160:161], v226 offset:8192
buffer_load_dwordx4 v237, s[72:75], s44 offen offset:3072 lds
v_mfma_f32_16x16x32_bf16 v[80:83], v[176:179], a[232:235], v[80:83]
v_exp_f32 v52, -v52
v_mfma_f32_16x16x32_bf16 v[88:91], v[176:179], a[236:239], v[88:91]
ds_read_b64_tr_b16 v[162:163], v226 offset:10240
s_add_u32 m0, s43, 4096
v_add_f32 v47, 1.0, v47
v_mfma_f32_16x16x32_bf16 v[68:71], v[180:183], a[224:227], v[68:71]
v_rcp_f32 v46, v46
v_mfma_f32_16x16x32_bf16 v[76:79], v[180:183], a[228:231], v[76:79]
ds_read_b64_tr_b16 v[164:165], v227 offset:8192
s_add_u32 s44, s50, 295424
v_mfma_f32_16x16x32_bf16 v[84:87], v[180:183], a[232:235], v[84:87]
v_exp_f32 v53, -v53
v_mfma_f32_16x16x32_bf16 v[92:95], v[180:183], a[236:239], v[92:95]
ds_read_b64_tr_b16 v[166:167], v227 offset:10240
s_waitcnt lgkmcnt(4)
v_add_f32 v52, 1.0, v52
v_mfma_f32_16x16x32_bf16 v[96:99], v[184:187], a[224:227], v[96:99]
v_rcp_f32 v47, v47
v_mfma_f32_16x16x32_bf16 v[104:107], v[184:187], a[228:231], v[104:107]
ds_read_b64_tr_b16 v[168:169], v228 offset:8192
buffer_load_dwordx4 v234, s[72:75], s44 offen offset:0 lds
v_mfma_f32_16x16x32_bf16 v[112:115], v[184:187], a[232:235], v[112:115]
v_exp_f32 v54, -v54
v_mfma_f32_16x16x32_bf16 v[120:123], v[184:187], a[236:239], v[120:123]
ds_read_b64_tr_b16 v[170:171], v228 offset:10240
buffer_load_dwordx4 v235, s[72:75], s44 offen offset:1024 lds
v_add_f32 v53, 1.0, v53
v_mfma_f32_16x16x32_bf16 v[100:103], v[188:191], a[224:227], v[100:103]
v_rcp_f32 v52, v52
v_mfma_f32_16x16x32_bf16 v[108:111], v[188:191], a[228:231], v[108:111]
ds_read_b64_tr_b16 v[172:173], v229 offset:8192
buffer_load_dwordx4 v236, s[72:75], s44 offen offset:2048 lds
v_mfma_f32_16x16x32_bf16 v[116:119], v[188:191], a[232:235], v[116:119]
v_exp_f32 v55, -v55
v_mfma_f32_16x16x32_bf16 v[124:127], v[188:191], a[236:239], v[124:127]
ds_read_b64_tr_b16 v[174:175], v229 offset:10240
s_waitcnt vmcnt(7) lgkmcnt(4)
v_add_f32 v54, 1.0, v54
v_mfma_f32_16x16x32_bf16 v[64:67], v[160:163], a[240:243], v[64:67]
v_rcp_f32 v53, v53
v_mfma_f32_16x16x32_bf16 v[72:75], v[160:163], a[244:247], v[72:75]
ds_read_b64_tr_b16 v[176:177], v226 offset:12288
buffer_load_dwordx4 v237, s[72:75], s44 offen offset:3072 lds
v_mfma_f32_16x16x32_bf16 v[80:83], v[160:163], a[248:251], v[80:83]
v_exp_f32 v60, -v60
v_mfma_f32_16x16x32_bf16 v[88:91], v[160:163], a[252:255], v[88:91]
ds_read_b64_tr_b16 v[178:179], v226 offset:14336
s_add_u32 m0, s43, 8192
v_add_f32 v55, 1.0, v55
v_mfma_f32_16x16x32_bf16 v[68:71], v[164:167], a[240:243], v[68:71]
v_rcp_f32 v54, v54
v_mfma_f32_16x16x32_bf16 v[76:79], v[164:167], a[244:247], v[76:79]
ds_read_b64_tr_b16 v[180:181], v226 offset:16384
s_add_u32 s44, s50, 590336
v_mfma_f32_16x16x32_bf16 v[84:87], v[164:167], a[248:251], v[84:87]
v_exp_f32 v61, -v61
v_mfma_f32_16x16x32_bf16 v[92:95], v[164:167], a[252:255], v[92:95]
ds_read_b64_tr_b16 v[182:183], v226 offset:18432
s_waitcnt lgkmcnt(4)
v_add_f32 v60, 1.0, v60
v_mfma_f32_16x16x32_bf16 v[96:99], v[168:171], a[240:243], v[96:99]
v_rcp_f32 v55, v55
v_mfma_f32_16x16x32_bf16 v[104:107], v[168:171], a[244:247], v[104:107]
ds_read_b64_tr_b16 v[184:185], v227 offset:12288
buffer_load_dwordx4 v234, s[72:75], s44 offen offset:0 lds
v_mfma_f32_16x16x32_bf16 v[112:115], v[168:171], a[248:251], v[112:115]
v_exp_f32 v62, -v62
v_mfma_f32_16x16x32_bf16 v[120:123], v[168:171], a[252:255], v[120:123]
ds_read_b64_tr_b16 v[186:187], v227 offset:14336
buffer_load_dwordx4 v235, s[72:75], s44 offen offset:1024 lds
v_add_f32 v61, 1.0, v61
v_mfma_f32_16x16x32_bf16 v[100:103], v[172:175], a[240:243], v[100:103]
v_rcp_f32 v60, v60
v_mfma_f32_16x16x32_bf16 v[108:111], v[172:175], a[244:247], v[108:111]
ds_read_b64_tr_b16 v[188:189], v227 offset:16384
buffer_load_dwordx4 v236, s[72:75], s44 offen offset:2048 lds
v_mfma_f32_16x16x32_bf16 v[116:119], v[172:175], a[248:251], v[116:119]
v_exp_f32 v63, -v63
v_mfma_f32_16x16x32_bf16 v[124:127], v[172:175], a[252:255], v[124:127]
ds_read_b64_tr_b16 v[190:191], v227 offset:18432
s_waitcnt lgkmcnt(4)
v_add_f32 v62, 1.0, v62
v_mfma_f32_16x16x32_bf16 v[64:67], v[176:179], v[128:131], v[64:67]
v_rcp_f32 v61, v61
v_mfma_f32_16x16x32_bf16 v[72:75], v[176:179], v[132:135], v[72:75]
ds_read_b64_tr_b16 v[160:161], v228 offset:12288
buffer_load_dwordx4 v237, s[72:75], s44 offen offset:3072 lds
v_mfma_f32_16x16x32_bf16 v[80:83], v[176:179], v[136:139], v[80:83]
v_add_f32 v63, 1.0, v63
v_mfma_f32_16x16x32_bf16 v[88:91], v[176:179], v[140:143], v[88:91]
ds_read_b64_tr_b16 v[162:163], v228 offset:14336
v_rcp_f32 v62, v62
v_mfma_f32_16x16x32_bf16 v[64:67], v[180:183], v[144:147], v[64:67]
v_rcp_f32 v63, v63
v_mfma_f32_16x16x32_bf16 v[72:75], v[180:183], v[148:151], v[72:75]
ds_read_b64_tr_b16 v[164:165], v228 offset:16384
v_mfma_f32_16x16x32_bf16 v[80:83], v[180:183], v[152:155], v[80:83]
v_mfma_f32_16x16x32_bf16 v[88:91], v[180:183], v[156:159], v[88:91]
ds_read_b64_tr_b16 v[166:167], v228 offset:18432
s_waitcnt lgkmcnt(4)
v_mfma_f32_16x16x32_bf16 v[68:71], v[184:187], v[128:131], v[68:71]
v_mfma_f32_16x16x32_bf16 v[76:79], v[184:187], v[132:135], v[76:79]
ds_read_b64_tr_b16 v[168:169], v229 offset:12288
v_mfma_f32_16x16x32_bf16 v[84:87], v[184:187], v[136:139], v[84:87]
v_mfma_f32_16x16x32_bf16 v[92:95], v[184:187], v[140:143], v[92:95]
ds_read_b64_tr_b16 v[170:171], v229 offset:14336
v_mfma_f32_16x16x32_bf16 v[68:71], v[188:191], v[144:147], v[68:71]
v_mul_f32 v64, v0, v64
v_mul_f32 v65, v1, v65
v_mfma_f32_16x16x32_bf16 v[76:79], v[188:191], v[148:151], v[76:79]
ds_read_b64_tr_b16 v[172:173], v229 offset:16384
v_mul_f32 v66, v2, v66
v_mfma_f32_16x16x32_bf16 v[84:87], v[188:191], v[152:155], v[84:87]
v_mul_f32 v67, v3, v67
v_mul_f32 v72, v8, v72
v_mfma_f32_16x16x32_bf16 v[92:95], v[188:191], v[156:159], v[92:95]
ds_read_b64_tr_b16 v[174:175], v229 offset:18432
s_waitcnt vmcnt(4) lgkmcnt(4)
v_mul_f32 v73, v9, v73
v_mfma_f32_16x16x32_bf16 v[96:99], v[160:163], v[128:131], v[96:99]
v_mul_f32 v74, v10, v74
v_mul_f32 v75, v11, v75
v_mfma_f32_16x16x32_bf16 v[104:107], v[160:163], v[132:135], v[104:107]
ds_read_b64_tr_b16 v[176:177], v226 offset:0
v_mul_f32 v80, v16, v80
v_mfma_f32_16x16x32_bf16 v[112:115], v[160:163], v[136:139], v[112:115]
v_mul_f32 v81, v17, v81
v_mul_f32 v82, v18, v82
v_mfma_f32_16x16x32_bf16 v[120:123], v[160:163], v[140:143], v[120:123]
ds_read_b64_tr_b16 v[178:179], v226 offset:2048
s_add_u32 m0, s43, 12288
v_mul_f32 v83, v19, v83
v_mfma_f32_16x16x32_bf16 v[96:99], v[164:167], v[144:147], v[96:99]
v_mul_f32 v88, v24, v88
v_mul_f32 v89, v25, v89
v_mfma_f32_16x16x32_bf16 v[104:107], v[164:167], v[148:151], v[104:107]
ds_read_b64_tr_b16 v[180:181], v226 offset:4096
s_add_u32 s44, s50, 885248
v_mfma_f32_16x16x32_bf16 v[112:115], v[164:167], v[152:155], v[112:115]
v_mul_f32 v90, v26, v90
v_mul_f32 v91, v27, v91
v_mfma_f32_16x16x32_bf16 v[120:123], v[164:167], v[156:159], v[120:123]
ds_read_b64_tr_b16 v[182:183], v226 offset:6144
s_waitcnt lgkmcnt(4)
v_mfma_f32_16x16x32_bf16 v[100:103], v[168:171], v[128:131], v[100:103]
v_mul_f32 v68, v4, v68
v_mul_f32 v69, v5, v69
v_mul_f32 v70, v6, v70
v_mfma_f32_16x16x32_bf16 v[108:111], v[168:171], v[132:135], v[108:111]
ds_read_b64_tr_b16 v[184:185], v227 offset:0
buffer_load_dwordx4 v234, s[72:75], s44 offen offset:0 lds
v_mul_f32 v71, v7, v71
v_mfma_f32_16x16x32_bf16 v[116:119], v[168:171], v[136:139], v[116:119]
v_mul_f32 v76, v12, v76
v_mul_f32 v77, v13, v77
v_mul_f32 v78, v14, v78
v_mfma_f32_16x16x32_bf16 v[124:127], v[168:171], v[140:143], v[124:127]
ds_read_b64_tr_b16 v[186:187], v227 offset:2048
buffer_load_dwordx4 v235, s[72:75], s44 offen offset:1024 lds
v_mfma_f32_16x16x32_bf16 v[100:103], v[172:175], v[144:147], v[100:103]
v_mul_f32 v79, v15, v79
v_mul_f32 v84, v20, v84
v_mul_f32 v85, v21, v85
v_mfma_f32_16x16x32_bf16 v[108:111], v[172:175], v[148:151], v[108:111]
ds_read_b64_tr_b16 v[188:189], v227 offset:4096
buffer_load_dwordx4 v236, s[72:75], s44 offen offset:2048 lds
v_mul_f32 v86, v22, v86
v_mfma_f32_16x16x32_bf16 v[116:119], v[172:175], v[152:155], v[116:119]
v_mul_f32 v87, v23, v87
v_mul_f32 v92, v28, v92
v_mul_f32 v93, v29, v93
v_mfma_f32_16x16x32_bf16 v[124:127], v[172:175], v[156:159], v[124:127]
ds_read_b64_tr_b16 v[190:191], v227 offset:6144
s_waitcnt lgkmcnt(4)
v_mfma_f32_16x16x32_bf16 v[0:3], v[176:179], a[0:3], 0
v_mul_f32 v94, v30, v94
v_mul_f32 v95, v31, v95
v_mfma_f32_16x16x32_bf16 v[8:11], v[176:179], a[4:7], 0
ds_read_b64_tr_b16 v[160:161], v228 offset:0
buffer_load_dwordx4 v237, s[72:75], s44 offen offset:3072 lds
v_mfma_f32_16x16x32_bf16 v[16:19], v[176:179], a[8:11], 0
s_add_u32 m0, s43, 16384
s_add_u32 s44, s50, 1180160
v_mfma_f32_16x16x32_bf16 v[24:27], v[176:179], a[12:15], 0
ds_read_b64_tr_b16 v[162:163], v228 offset:2048
buffer_load_dwordx4 v234, s[72:75], s44 offen offset:0 lds
v_mul_f32 v96, v32, v96
v_mfma_f32_16x16x32_bf16 v[0:3], v[180:183], a[16:19], v[0:3]
v_mul_f32 v97, v33, v97
v_mul_f32 v98, v34, v98
v_mul_f32 v99, v35, v99
v_mfma_f32_16x16x32_bf16 v[8:11], v[180:183], a[20:23], v[8:11]
ds_read_b64_tr_b16 v[164:165], v228 offset:4096
buffer_load_dwordx4 v235, s[72:75], s44 offen offset:1024 lds
v_mul_f32 v104, v40, v104
v_mfma_f32_16x16x32_bf16 v[16:19], v[180:183], a[24:27], v[16:19]
v_mul_f32 v105, v41, v105
v_mul_f32 v106, v42, v106
v_mfma_f32_16x16x32_bf16 v[24:27], v[180:183], a[28:31], v[24:27]
ds_read_b64_tr_b16 v[166:167], v228 offset:6144
s_waitcnt lgkmcnt(4)
v_mul_f32 v107, v43, v107
v_mfma_f32_16x16x32_bf16 v[4:7], v[184:187], a[0:3], 0
buffer_load_dwordx4 v236, s[72:75], s44 offen offset:2048 lds
v_mul_f32 v112, v48, v112
v_mul_f32 v113, v49, v113
v_mfma_f32_16x16x32_bf16 v[12:15], v[184:187], a[4:7], 0
ds_read_b64_tr_b16 v[168:169], v229 offset:0
v_mul_f32 v114, v50, v114
v_mul_f32 v115, v51, v115
v_mfma_f32_16x16x32_bf16 v[20:23], v[184:187], a[8:11], 0
buffer_load_dwordx4 v237, s[72:75], s44 offen offset:3072 lds
v_mul_f32 v120, v56, v120
v_mfma_f32_16x16x32_bf16 v[28:31], v[184:187], a[12:15], 0
ds_read_b64_tr_b16 v[170:171], v229 offset:2048
v_mul_f32 v121, v57, v121
v_mul_f32 v122, v58, v122
v_mfma_f32_16x16x32_bf16 v[4:7], v[188:191], a[16:19], v[4:7]
v_mul_f32 v123, v59, v123
v_mfma_f32_16x16x32_bf16 v[12:15], v[188:191], a[20:23], v[12:15]
ds_read_b64_tr_b16 v[172:173], v229 offset:4096
v_mul_f32 v100, v36, v100
v_mfma_f32_16x16x32_bf16 v[20:23], v[188:191], a[24:27], v[20:23]
v_mul_f32 v101, v37, v101
v_mul_f32 v102, v38, v102
v_mul_f32 v103, v39, v103
v_mfma_f32_16x16x32_bf16 v[28:31], v[188:191], a[28:31], v[28:31]
ds_read_b64_tr_b16 v[174:175], v229 offset:6144
s_waitcnt vmcnt(8) lgkmcnt(4)
v_mfma_f32_16x16x32_bf16 v[32:35], v[160:163], a[0:3], 0
v_mul_f32 v108, v44, v108
v_mul_f32 v109, v45, v109
v_mul_f32 v110, v46, v110
v_mfma_f32_16x16x32_bf16 v[40:43], v[160:163], a[4:7], 0
ds_read_b64_tr_b16 v[176:177], v226 offset:8192
v_mul_f32 v111, v47, v111
v_mfma_f32_16x16x32_bf16 v[48:51], v[160:163], a[8:11], 0
v_mul_f32 v116, v52, v116
v_mul_f32 v117, v53, v117
v_mul_f32 v118, v54, v118
v_mfma_f32_16x16x32_bf16 v[56:59], v[160:163], a[12:15], 0
ds_read_b64_tr_b16 v[178:179], v226 offset:10240
s_add_u32 m0, s43, 0
v_mfma_f32_16x16x32_bf16 v[32:35], v[164:167], a[16:19], v[32:35]
v_mul_f32 v119, v55, v119
v_mul_f32 v124, v60, v124
v_mul_f32 v125, v61, v125
v_mfma_f32_16x16x32_bf16 v[40:43], v[164:167], a[20:23], v[40:43]
ds_read_b64_tr_b16 v[180:181], v227 offset:8192
s_add_u32 s44, s50, 1475072
v_mfma_f32_16x16x32_bf16 v[48:51], v[164:167], a[24:27], v[48:51]
v_mul_f32 v126, v62, v126
v_mul_f32 v127, v63, v127
v_mfma_f32_16x16x32_bf16 v[56:59], v[164:167], a[28:31], v[56:59]
ds_read_b64_tr_b16 v[182:183], v227 offset:10240
s_waitcnt lgkmcnt(4)
v_mfma_f32_16x16x32_bf16 v[36:39], v[168:171], a[0:3], 0
v_mfma_f32_16x16x32_bf16 v[44:47], v[168:171], a[4:7], 0
ds_read_b64_tr_b16 v[184:185], v228 offset:8192
buffer_load_dwordx4 v234, s[72:75], s44 offen offset:0 lds
v_mfma_f32_16x16x32_bf16 v[52:55], v[168:171], a[8:11], 0
v_cvt_pk_bf16_f32 v64, v64, v65
v_mfma_f32_16x16x32_bf16 v[60:63], v[168:171], a[12:15], 0
ds_read_b64_tr_b16 v[186:187], v228 offset:10240
buffer_load_dwordx4 v235, s[72:75], s44 offen offset:1024 lds
v_mfma_f32_16x16x32_bf16 v[36:39], v[172:175], a[16:19], v[36:39]
v_cvt_pk_bf16_f32 v65, v66, v67
v_mfma_f32_16x16x32_bf16 v[44:47], v[172:175], a[20:23], v[44:47]
ds_read_b64_tr_b16 v[188:189], v229 offset:8192
buffer_load_dwordx4 v236, s[72:75], s44 offen offset:2048 lds
v_mfma_f32_16x16x32_bf16 v[52:55], v[172:175], a[24:27], v[52:55]
v_cvt_pk_bf16_f32 v66, v68, v69
v_mfma_f32_16x16x32_bf16 v[60:63], v[172:175], a[28:31], v[60:63]
ds_read_b64_tr_b16 v[190:191], v229 offset:10240
s_waitcnt vmcnt(7) lgkmcnt(4)
v_mfma_f32_16x16x32_bf16 v[0:3], v[176:179], a[32:35], v[0:3]
v_mfma_f32_16x16x32_bf16 v[8:11], v[176:179], a[36:39], v[8:11]
ds_read_b64_tr_b16 v[160:161], v226 offset:12288
buffer_load_dwordx4 v237, s[72:75], s44 offen offset:3072 lds
v_mfma_f32_16x16x32_bf16 v[16:19], v[176:179], a[40:43], v[16:19]
s_add_u32 m0, s43, 4096
s_add_u32 s44, s50, 1769984
v_mfma_f32_16x16x32_bf16 v[24:27], v[176:179], a[44:47], v[24:27]
ds_read_b64_tr_b16 v[162:163], v226 offset:14336
buffer_load_dwordx4 v234, s[72:75], s44 offen offset:0 lds
v_mfma_f32_16x16x32_bf16 v[4:7], v[180:183], a[32:35], v[4:7]
v_cvt_pk_bf16_f32 v67, v70, v71
v_mfma_f32_16x16x32_bf16 v[12:15], v[180:183], a[36:39], v[12:15]
ds_read_b64_tr_b16 v[164:165], v227 offset:12288
buffer_load_dwordx4 v235, s[72:75], s44 offen offset:1024 lds
v_mfma_f32_16x16x32_bf16 v[20:23], v[180:183], a[40:43], v[20:23]
ds_write_b128 v246, v[64:67] offset:0
v_cvt_pk_bf16_f32 v72, v72, v73
v_mfma_f32_16x16x32_bf16 v[28:31], v[180:183], a[44:47], v[28:31]
ds_read_b64_tr_b16 v[166:167], v227 offset:14336
s_waitcnt lgkmcnt(5)
v_mfma_f32_16x16x32_bf16 v[32:35], v[184:187], a[32:35], v[32:35]
buffer_load_dwordx4 v236, s[72:75], s44 offen offset:2048 lds
v_cvt_pk_bf16_f32 v73, v74, v75
v_mfma_f32_16x16x32_bf16 v[40:43], v[184:187], a[36:39], v[40:43]
ds_read_b64_tr_b16 v[168:169], v228 offset:12288
buffer_load_dword v249, v193, s[80:83], s9 offen offset:512
v_mfma_f32_16x16x32_bf16 v[48:51], v[184:187], a[40:43], v[48:51]
buffer_load_dwordx4 v237, s[72:75], s44 offen offset:3072 lds
s_add_u32 m0, s43, 8192
v_mfma_f32_16x16x32_bf16 v[56:59], v[184:187], a[44:47], v[56:59]
ds_read_b64_tr_b16 v[170:171], v228 offset:14336
s_add_u32 s44, s50, 2064896
v_mfma_f32_16x16x32_bf16 v[36:39], v[188:191], a[32:35], v[36:39]
buffer_load_dwordx4 v234, s[72:75], s44 offen offset:0 lds
v_cvt_pk_bf16_f32 v74, v76, v77
v_mfma_f32_16x16x32_bf16 v[44:47], v[188:191], a[36:39], v[44:47]
ds_read_b64_tr_b16 v[172:173], v229 offset:12288
v_cvt_pk_bf16_f32 v75, v78, v79
v_mfma_f32_16x16x32_bf16 v[52:55], v[188:191], a[40:43], v[52:55]
buffer_load_dwordx4 v235, s[72:75], s44 offen offset:1024 lds
v_mfma_f32_16x16x32_bf16 v[60:63], v[188:191], a[44:47], v[60:63]
ds_read_b64_tr_b16 v[174:175], v229 offset:14336
s_waitcnt vmcnt(11) lgkmcnt(4)
v_mfma_f32_16x16x32_bf16 v[0:3], v[160:163], a[48:51], v[0:3]
buffer_load_dwordx4 v236, s[72:75], s44 offen offset:2048 lds
ds_write_b128 v246, v[72:75] offset:1024
v_mfma_f32_16x16x32_bf16 v[8:11], v[160:163], a[52:55], v[8:11]
ds_read_b64_tr_b16 v[176:177], v226 offset:16384
v_cvt_pk_bf16_f32 v80, v80, v81
v_mfma_f32_16x16x32_bf16 v[16:19], v[160:163], a[56:59], v[16:19]
v_mfma_f32_16x16x32_bf16 v[24:27], v[160:163], a[60:63], v[24:27]
ds_read_b64_tr_b16 v[178:179], v226 offset:18432
buffer_load_dwordx4 v237, s[72:75], s44 offen offset:3072 lds
v_mfma_f32_16x16x32_bf16 v[4:7], v[164:167], a[48:51], v[4:7]
v_cvt_pk_bf16_f32 v81, v82, v83
v_mfma_f32_16x16x32_bf16 v[12:15], v[164:167], a[52:55], v[12:15]
ds_read_b64_tr_b16 v[180:181], v227 offset:16384
s_add_u32 m0, s43, 12288
v_mfma_f32_16x16x32_bf16 v[20:23], v[164:167], a[56:59], v[20:23]
v_mfma_f32_16x16x32_bf16 v[28:31], v[164:167], a[60:63], v[28:31]
ds_read_b64_tr_b16 v[182:183], v227 offset:18432
s_waitcnt lgkmcnt(5)
v_mfma_f32_16x16x32_bf16 v[32:35], v[168:171], a[48:51], v[32:35]
s_add_u32 s44, s50, 2359808
v_cvt_pk_bf16_f32 v82, v84, v85
v_mfma_f32_16x16x32_bf16 v[40:43], v[168:171], a[52:55], v[40:43]
ds_read_b64_tr_b16 v[184:185], v228 offset:16384
buffer_load_dwordx4 v234, s[72:75], s44 offen offset:0 lds
v_mfma_f32_16x16x32_bf16 v[48:51], v[168:171], a[56:59], v[48:51]
v_cvt_pk_bf16_f32 v83, v86, v87
v_mfma_f32_16x16x32_bf16 v[56:59], v[168:171], a[60:63], v[56:59]
ds_read_b64_tr_b16 v[186:187], v228 offset:18432
buffer_load_dwordx4 v235, s[72:75], s44 offen offset:1024 lds
v_mfma_f32_16x16x32_bf16 v[36:39], v[172:175], a[48:51], v[36:39]
ds_write_b128 v247, v[80:83] offset:0
v_mfma_f32_16x16x32_bf16 v[44:47], v[172:175], a[52:55], v[44:47]
ds_read_b64_tr_b16 v[188:189], v229 offset:16384
buffer_load_dwordx4 v236, s[72:75], s44 offen offset:2048 lds
v_mfma_f32_16x16x32_bf16 v[52:55], v[172:175], a[56:59], v[52:55]
v_cvt_pk_bf16_f32 v88, v88, v89
v_mfma_f32_16x16x32_bf16 v[60:63], v[172:175], a[60:63], v[60:63]
ds_read_b64_tr_b16 v[190:191], v229 offset:18432
s_waitcnt vmcnt(12) lgkmcnt(5)
v_mfma_f32_16x16x32_bf16 v[0:3], v[176:179], a[64:67], v[0:3]
v_cvt_pk_bf16_f32 v89, v90, v91
v_mfma_f32_16x16x32_bf16 v[8:11], v[176:179], a[68:71], v[8:11]
ds_read_b64_tr_b16 v[160:161], v226 offset:0
buffer_load_dwordx4 v237, s[72:75], s44 offen offset:3072 lds
v_mfma_f32_16x16x32_bf16 v[16:19], v[176:179], a[72:75], v[16:19]
v_cvt_pk_bf16_f32 v90, v92, v93
v_mfma_f32_16x16x32_bf16 v[24:27], v[176:179], a[76:79], v[24:27]
ds_read_b64_tr_b16 v[162:163], v226 offset:2048
s_add_u32 m0, s43, 16384
v_mfma_f32_16x16x32_bf16 v[4:7], v[180:183], a[64:67], v[4:7]
v_cvt_pk_bf16_f32 v91, v94, v95
v_mfma_f32_16x16x32_bf16 v[12:15], v[180:183], a[68:71], v[12:15]
ds_read_b64_tr_b16 v[164:165], v227 offset:0
s_add_u32 s44, s50, 2654720
v_mfma_f32_16x16x32_bf16 v[20:23], v[180:183], a[72:75], v[20:23]
ds_write_b128 v247, v[88:91] offset:1024
v_mfma_f32_16x16x32_bf16 v[28:31], v[180:183], a[76:79], v[28:31]
ds_read_b64_tr_b16 v[166:167], v227 offset:2048
s_waitcnt lgkmcnt(5)
v_mfma_f32_16x16x32_bf16 v[32:35], v[184:187], a[64:67], v[32:35]
v_mfma_f32_16x16x32_bf16 v[40:43], v[184:187], a[68:71], v[40:43]
ds_read_b64_tr_b16 v[168:169], v228 offset:0
buffer_load_dwordx4 v234, s[72:75], s44 offen offset:0 lds
v_mfma_f32_16x16x32_bf16 v[48:51], v[184:187], a[72:75], v[48:51]
v_cvt_pk_bf16_f32 v96, v96, v97
v_mfma_f32_16x16x32_bf16 v[56:59], v[184:187], a[76:79], v[56:59]
ds_read_b64_tr_b16 v[170:171], v228 offset:2048
buffer_load_dwordx4 v235, s[72:75], s44 offen offset:1024 lds
v_mfma_f32_16x16x32_bf16 v[36:39], v[188:191], a[64:67], v[36:39]
v_cvt_pk_bf16_f32 v97, v98, v99
v_mfma_f32_16x16x32_bf16 v[44:47], v[188:191], a[68:71], v[44:47]
ds_read_b64_tr_b16 v[172:173], v229 offset:0
buffer_load_dwordx4 v236, s[72:75], s44 offen offset:2048 lds
v_mfma_f32_16x16x32_bf16 v[52:55], v[188:191], a[72:75], v[52:55]
v_cvt_pk_bf16_f32 v98, v100, v101
v_mfma_f32_16x16x32_bf16 v[60:63], v[188:191], a[76:79], v[60:63]
ds_read_b64_tr_b16 v[174:175], v229 offset:2048
s_waitcnt vmcnt(11) lgkmcnt(4)
v_mfma_f32_16x16x32_bf16 v[0:3], v[160:163], a[80:83], v[0:3]
v_cvt_pk_bf16_f32 v99, v102, v103
v_mfma_f32_16x16x32_bf16 v[8:11], v[160:163], a[84:87], v[8:11]
ds_read_b64_tr_b16 v[176:177], v226 offset:4096
buffer_load_dwordx4 v237, s[72:75], s44 offen offset:3072 lds
v_mfma_f32_16x16x32_bf16 v[16:19], v[160:163], a[88:91], v[16:19]
ds_write_b128 v246, v[96:99] offset:4096
v_mfma_f32_16x16x32_bf16 v[24:27], v[160:163], a[92:95], v[24:27]
ds_read_b64_tr_b16 v[178:179], v226 offset:6144
s_add_u32 m0, s43, 0
v_mfma_f32_16x16x32_bf16 v[4:7], v[164:167], a[80:83], v[4:7]
v_cvt_pk_bf16_f32 v104, v104, v105
v_mfma_f32_16x16x32_bf16 v[12:15], v[164:167], a[84:87], v[12:15]
ds_read_b64_tr_b16 v[180:181], v227 offset:4096
s_add_u32 s44, s50, 2949632
v_mfma_f32_16x16x32_bf16 v[20:23], v[164:167], a[88:91], v[20:23]
v_mfma_f32_16x16x32_bf16 v[28:31], v[164:167], a[92:95], v[28:31]
ds_read_b64_tr_b16 v[182:183], v227 offset:6144
s_waitcnt lgkmcnt(5)
v_mfma_f32_16x16x32_bf16 v[32:35], v[168:171], a[80:83], v[32:35]
v_cvt_pk_bf16_f32 v105, v106, v107
v_mfma_f32_16x16x32_bf16 v[40:43], v[168:171], a[84:87], v[40:43]
ds_read_b64_tr_b16 v[184:185], v228 offset:4096
buffer_load_dwordx4 v234, s[72:75], s44 offen offset:0 lds
v_mfma_f32_16x16x32_bf16 v[48:51], v[168:171], a[88:91], v[48:51]
v_cvt_pk_bf16_f32 v106, v108, v109
v_mfma_f32_16x16x32_bf16 v[56:59], v[168:171], a[92:95], v[56:59]
ds_read_b64_tr_b16 v[186:187], v228 offset:6144
buffer_load_dwordx4 v235, s[72:75], s44 offen offset:1024 lds
v_mfma_f32_16x16x32_bf16 v[36:39], v[172:175], a[80:83], v[36:39]
v_cvt_pk_bf16_f32 v107, v110, v111
v_mfma_f32_16x16x32_bf16 v[44:47], v[172:175], a[84:87], v[44:47]
ds_read_b64_tr_b16 v[188:189], v229 offset:4096
buffer_load_dwordx4 v236, s[72:75], s44 offen offset:2048 lds
v_mfma_f32_16x16x32_bf16 v[52:55], v[172:175], a[88:91], v[52:55]
ds_write_b128 v246, v[104:107] offset:5120
v_mfma_f32_16x16x32_bf16 v[60:63], v[172:175], a[92:95], v[60:63]
ds_read_b64_tr_b16 v[190:191], v229 offset:6144
s_waitcnt vmcnt(11) lgkmcnt(5)
v_mfma_f32_16x16x32_bf16 v[0:3], v[176:179], a[96:99], v[0:3]
v_cvt_pk_bf16_f32 v112, v112, v113
v_mfma_f32_16x16x32_bf16 v[8:11], v[176:179], a[100:103], v[8:11]
ds_read_b64_tr_b16 v[160:161], v226 offset:8192
buffer_load_dwordx4 v237, s[72:75], s44 offen offset:3072 lds
v_mfma_f32_16x16x32_bf16 v[16:19], v[176:179], a[104:107], v[16:19]
v_cvt_pk_bf16_f32 v113, v114, v115
v_mfma_f32_16x16x32_bf16 v[24:27], v[176:179], a[108:111], v[24:27]
ds_read_b64_tr_b16 v[162:163], v226 offset:10240
s_add_u32 m0, s43, 4096
v_mfma_f32_16x16x32_bf16 v[4:7], v[180:183], a[96:99], v[4:7]
v_mfma_f32_16x16x32_bf16 v[12:15], v[180:183], a[100:103], v[12:15]
ds_read_b64_tr_b16 v[164:165], v227 offset:8192
s_add_u32 s44, s50, 3244544
v_mfma_f32_16x16x32_bf16 v[20:23], v[180:183], a[104:107], v[20:23]
v_cvt_pk_bf16_f32 v114, v116, v117
v_mfma_f32_16x16x32_bf16 v[28:31], v[180:183], a[108:111], v[28:31]
ds_read_b64_tr_b16 v[166:167], v227 offset:10240
s_waitcnt lgkmcnt(4)
v_mfma_f32_16x16x32_bf16 v[32:35], v[184:187], a[96:99], v[32:35]
v_cvt_pk_bf16_f32 v115, v118, v119
v_mfma_f32_16x16x32_bf16 v[40:43], v[184:187], a[100:103], v[40:43]
ds_read_b64_tr_b16 v[168:169], v228 offset:8192
buffer_load_dwordx4 v234, s[72:75], s44 offen offset:0 lds
v_mfma_f32_16x16x32_bf16 v[48:51], v[184:187], a[104:107], v[48:51]
ds_write_b128 v247, v[112:115] offset:4096
v_mfma_f32_16x16x32_bf16 v[56:59], v[184:187], a[108:111], v[56:59]
ds_read_b64_tr_b16 v[170:171], v228 offset:10240
buffer_load_dwordx4 v235, s[72:75], s44 offen offset:1024 lds
v_mfma_f32_16x16x32_bf16 v[36:39], v[188:191], a[96:99], v[36:39]
v_cvt_pk_bf16_f32 v120, v120, v121
v_mfma_f32_16x16x32_bf16 v[44:47], v[188:191], a[100:103], v[44:47]
ds_read_b64_tr_b16 v[172:173], v229 offset:8192
buffer_load_dwordx4 v236, s[72:75], s44 offen offset:2048 lds
v_mfma_f32_16x16x32_bf16 v[52:55], v[188:191], a[104:107], v[52:55]
v_cvt_pk_bf16_f32 v121, v122, v123
v_mfma_f32_16x16x32_bf16 v[60:63], v[188:191], a[108:111], v[60:63]
ds_read_b64_tr_b16 v[174:175], v229 offset:10240
s_waitcnt vmcnt(11) lgkmcnt(5)
v_mfma_f32_16x16x32_bf16 v[0:3], v[160:163], a[112:115], v[0:3]
v_cvt_pk_bf16_f32 v122, v124, v125
v_mfma_f32_16x16x32_bf16 v[8:11], v[160:163], a[116:119], v[8:11]
ds_read_b64_tr_b16 v[176:177], v226 offset:12288
buffer_load_dwordx4 v237, s[72:75], s44 offen offset:3072 lds
v_mfma_f32_16x16x32_bf16 v[16:19], v[160:163], a[120:123], v[16:19]
v_mfma_f32_16x16x32_bf16 v[24:27], v[160:163], a[124:127], v[24:27]
ds_read_b64_tr_b16 v[178:179], v226 offset:14336
s_add_u32 m0, s43, 8192
v_mfma_f32_16x16x32_bf16 v[4:7], v[164:167], a[112:115], v[4:7]
v_cvt_pk_bf16_f32 v123, v126, v127
v_mfma_f32_16x16x32_bf16 v[12:15], v[164:167], a[116:119], v[12:15]
ds_read_b64_tr_b16 v[180:181], v227 offset:12288
s_add_u32 s44, s50, 3539456
v_mfma_f32_16x16x32_bf16 v[20:23], v[164:167], a[120:123], v[20:23]
ds_write_b128 v247, v[120:123] offset:5120
v_mfma_f32_16x16x32_bf16 v[28:31], v[164:167], a[124:127], v[28:31]
ds_read_b64_tr_b16 v[182:183], v227 offset:14336
s_waitcnt lgkmcnt(5)
v_mfma_f32_16x16x32_bf16 v[32:35], v[168:171], a[112:115], v[32:35]
v_mfma_f32_16x16x32_bf16 v[40:43], v[168:171], a[116:119], v[40:43]
ds_read_b64_tr_b16 v[184:185], v228 offset:12288
buffer_load_dwordx4 v234, s[72:75], s44 offen offset:0 lds
v_mfma_f32_16x16x32_bf16 v[48:51], v[168:171], a[120:123], v[48:51]
v_mfma_f32_16x16x32_bf16 v[56:59], v[168:171], a[124:127], v[56:59]
ds_read_b64_tr_b16 v[186:187], v228 offset:14336
buffer_load_dwordx4 v235, s[72:75], s44 offen offset:1024 lds
v_mfma_f32_16x16x32_bf16 v[36:39], v[172:175], a[112:115], v[36:39]
v_mfma_f32_16x16x32_bf16 v[44:47], v[172:175], a[116:119], v[44:47]
ds_read_b64_tr_b16 v[188:189], v229 offset:12288
buffer_load_dwordx4 v236, s[72:75], s44 offen offset:2048 lds
v_mfma_f32_16x16x32_bf16 v[52:55], v[172:175], a[120:123], v[52:55]
v_mfma_f32_16x16x32_bf16 v[60:63], v[172:175], a[124:127], v[60:63]
ds_read_b64_tr_b16 v[190:191], v229 offset:14336
s_waitcnt vmcnt(11) lgkmcnt(4)
v_mfma_f32_16x16x32_bf16 v[0:3], v[176:179], a[128:131], v[0:3]
v_mfma_f32_16x16x32_bf16 v[8:11], v[176:179], a[132:135], v[8:11]
ds_read_b64_tr_b16 v[160:161], v226 offset:16384
buffer_load_dwordx4 v237, s[72:75], s44 offen offset:3072 lds
v_mfma_f32_16x16x32_bf16 v[16:19], v[176:179], a[136:139], v[16:19]
v_mfma_f32_16x16x32_bf16 v[24:27], v[176:179], a[140:143], v[24:27]
ds_read_b64_tr_b16 v[162:163], v226 offset:18432
s_add_u32 m0, s43, 12288
v_mfma_f32_16x16x32_bf16 v[4:7], v[180:183], a[128:131], v[4:7]
v_mfma_f32_16x16x32_bf16 v[12:15], v[180:183], a[132:135], v[12:15]
ds_read_b64_tr_b16 v[164:165], v227 offset:16384
s_add_u32 s44, s50, 3834368
v_mfma_f32_16x16x32_bf16 v[20:23], v[180:183], a[136:139], v[20:23]
v_mfma_f32_16x16x32_bf16 v[28:31], v[180:183], a[140:143], v[28:31]
ds_read_b64_tr_b16 v[166:167], v227 offset:18432
s_waitcnt lgkmcnt(4)
v_mfma_f32_16x16x32_bf16 v[32:35], v[184:187], a[128:131], v[32:35]
v_mfma_f32_16x16x32_bf16 v[40:43], v[184:187], a[132:135], v[40:43]
ds_read_b64_tr_b16 v[168:169], v228 offset:16384
buffer_load_dwordx4 v234, s[72:75], s44 offen offset:0 lds
v_mfma_f32_16x16x32_bf16 v[48:51], v[184:187], a[136:139], v[48:51]
v_mfma_f32_16x16x32_bf16 v[56:59], v[184:187], a[140:143], v[56:59]
ds_read_b64_tr_b16 v[170:171], v228 offset:18432
buffer_load_dwordx4 v235, s[72:75], s44 offen offset:1024 lds
v_mfma_f32_16x16x32_bf16 v[36:39], v[188:191], a[128:131], v[36:39]
v_mfma_f32_16x16x32_bf16 v[44:47], v[188:191], a[132:135], v[44:47]
ds_read_b64_tr_b16 v[172:173], v229 offset:16384
buffer_load_dwordx4 v236, s[72:75], s44 offen offset:2048 lds
v_mfma_f32_16x16x32_bf16 v[52:55], v[188:191], a[136:139], v[52:55]
v_mfma_f32_16x16x32_bf16 v[60:63], v[188:191], a[140:143], v[60:63]
ds_read_b64_tr_b16 v[174:175], v229 offset:18432
s_waitcnt vmcnt(11) lgkmcnt(4)
v_mfma_f32_16x16x32_bf16 v[0:3], v[160:163], a[144:147], v[0:3]
v_mfma_f32_16x16x32_bf16 v[8:11], v[160:163], a[148:151], v[8:11]
ds_read_b64_tr_b16 v[176:177], v226 offset:0
buffer_load_dwordx4 v237, s[72:75], s44 offen offset:3072 lds
v_mfma_f32_16x16x32_bf16 v[16:19], v[160:163], a[152:155], v[16:19]
v_mfma_f32_16x16x32_bf16 v[24:27], v[160:163], a[156:159], v[24:27]
ds_read_b64_tr_b16 v[178:179], v226 offset:2048
s_add_u32 m0, s43, 16384
v_mfma_f32_16x16x32_bf16 v[4:7], v[164:167], a[144:147], v[4:7]
v_mfma_f32_16x16x32_bf16 v[12:15], v[164:167], a[148:151], v[12:15]
ds_read_b64_tr_b16 v[180:181], v227 offset:0
s_add_u32 s44, s50, 4129280
v_mfma_f32_16x16x32_bf16 v[20:23], v[164:167], a[152:155], v[20:23]
v_mfma_f32_16x16x32_bf16 v[28:31], v[164:167], a[156:159], v[28:31]
ds_read_b64_tr_b16 v[182:183], v227 offset:2048
s_waitcnt lgkmcnt(4)
v_mfma_f32_16x16x32_bf16 v[32:35], v[168:171], a[144:147], v[32:35]
v_mfma_f32_16x16x32_bf16 v[40:43], v[168:171], a[148:151], v[40:43]
ds_read_b64_tr_b16 v[184:185], v228 offset:0
buffer_load_dwordx4 v234, s[72:75], s44 offen offset:0 lds
v_mfma_f32_16x16x32_bf16 v[48:51], v[168:171], a[152:155], v[48:51]
v_mfma_f32_16x16x32_bf16 v[56:59], v[168:171], a[156:159], v[56:59]
ds_read_b64_tr_b16 v[186:187], v228 offset:2048
buffer_load_dwordx4 v235, s[72:75], s44 offen offset:1024 lds
v_mfma_f32_16x16x32_bf16 v[36:39], v[172:175], a[144:147], v[36:39]
v_mfma_f32_16x16x32_bf16 v[44:47], v[172:175], a[148:151], v[44:47]
ds_read_b64_tr_b16 v[188:189], v229 offset:0
buffer_load_dwordx4 v236, s[72:75], s44 offen offset:2048 lds
v_mfma_f32_16x16x32_bf16 v[52:55], v[172:175], a[152:155], v[52:55]
v_mfma_f32_16x16x32_bf16 v[60:63], v[172:175], a[156:159], v[60:63]
ds_read_b64_tr_b16 v[190:191], v229 offset:2048
s_waitcnt vmcnt(11) lgkmcnt(4)
v_mfma_f32_16x16x32_bf16 v[0:3], v[176:179], a[160:163], v[0:3]
v_mfma_f32_16x16x32_bf16 v[8:11], v[176:179], a[164:167], v[8:11]
ds_read_b64_tr_b16 v[160:161], v226 offset:4096
buffer_load_dwordx4 v237, s[72:75], s44 offen offset:3072 lds
v_mfma_f32_16x16x32_bf16 v[16:19], v[176:179], a[168:171], v[16:19]
v_mfma_f32_16x16x32_bf16 v[24:27], v[176:179], a[172:175], v[24:27]
ds_read_b64_tr_b16 v[162:163], v226 offset:6144
s_add_u32 m0, s43, 0
v_mfma_f32_16x16x32_bf16 v[4:7], v[180:183], a[160:163], v[4:7]
v_mfma_f32_16x16x32_bf16 v[12:15], v[180:183], a[164:167], v[12:15]
ds_read_b64_tr_b16 v[164:165], v227 offset:4096
s_add_u32 s44, s50, 4424192
v_mfma_f32_16x16x32_bf16 v[20:23], v[180:183], a[168:171], v[20:23]
v_mfma_f32_16x16x32_bf16 v[28:31], v[180:183], a[172:175], v[28:31]
ds_read_b64_tr_b16 v[166:167], v227 offset:6144
s_waitcnt lgkmcnt(4)
v_mfma_f32_16x16x32_bf16 v[32:35], v[184:187], a[160:163], v[32:35]
v_mfma_f32_16x16x32_bf16 v[40:43], v[184:187], a[164:167], v[40:43]
ds_read_b64_tr_b16 v[168:169], v228 offset:4096
buffer_load_dwordx4 v234, s[72:75], s44 offen offset:0 lds
v_mfma_f32_16x16x32_bf16 v[48:51], v[184:187], a[168:171], v[48:51]
v_mfma_f32_16x16x32_bf16 v[56:59], v[184:187], a[172:175], v[56:59]
ds_read_b64_tr_b16 v[170:171], v228 offset:6144
buffer_load_dwordx4 v235, s[72:75], s44 offen offset:1024 lds
v_mfma_f32_16x16x32_bf16 v[36:39], v[188:191], a[160:163], v[36:39]
v_mfma_f32_16x16x32_bf16 v[44:47], v[188:191], a[164:167], v[44:47]
ds_read_b64_tr_b16 v[172:173], v229 offset:4096
buffer_load_dwordx4 v236, s[72:75], s44 offen offset:2048 lds
v_mfma_f32_16x16x32_bf16 v[52:55], v[188:191], a[168:171], v[52:55]
v_mfma_f32_16x16x32_bf16 v[60:63], v[188:191], a[172:175], v[60:63]
ds_read_b64_tr_b16 v[174:175], v229 offset:6144
s_waitcnt vmcnt(11) lgkmcnt(4)
v_mfma_f32_16x16x32_bf16 v[0:3], v[160:163], a[176:179], v[0:3]
v_mfma_f32_16x16x32_bf16 v[8:11], v[160:163], a[180:183], v[8:11]
ds_read_b64_tr_b16 v[176:177], v226 offset:8192
buffer_load_dwordx4 v237, s[72:75], s44 offen offset:3072 lds
v_mfma_f32_16x16x32_bf16 v[16:19], v[160:163], a[184:187], v[16:19]
v_mfma_f32_16x16x32_bf16 v[24:27], v[160:163], a[188:191], v[24:27]
ds_read_b64_tr_b16 v[178:179], v226 offset:10240
s_add_u32 m0, s43, 4096
v_mfma_f32_16x16x32_bf16 v[4:7], v[164:167], a[176:179], v[4:7]
v_mfma_f32_16x16x32_bf16 v[12:15], v[164:167], a[180:183], v[12:15]
ds_read_b64_tr_b16 v[180:181], v227 offset:8192
s_add_u32 s44, s50, 4719104
v_mfma_f32_16x16x32_bf16 v[20:23], v[164:167], a[184:187], v[20:23]
v_mfma_f32_16x16x32_bf16 v[28:31], v[164:167], a[188:191], v[28:31]
ds_read_b64_tr_b16 v[182:183], v227 offset:10240
s_waitcnt lgkmcnt(4)
v_mfma_f32_16x16x32_bf16 v[32:35], v[168:171], a[176:179], v[32:35]
v_mfma_f32_16x16x32_bf16 v[40:43], v[168:171], a[180:183], v[40:43]
ds_read_b64_tr_b16 v[184:185], v228 offset:8192
buffer_load_dwordx4 v234, s[72:75], s44 offen offset:0 lds
v_mfma_f32_16x16x32_bf16 v[48:51], v[168:171], a[184:187], v[48:51]
v_mfma_f32_16x16x32_bf16 v[56:59], v[168:171], a[188:191], v[56:59]
ds_read_b64_tr_b16 v[186:187], v228 offset:10240
buffer_load_dwordx4 v235, s[72:75], s44 offen offset:1024 lds
v_mfma_f32_16x16x32_bf16 v[36:39], v[172:175], a[176:179], v[36:39]
v_mfma_f32_16x16x32_bf16 v[44:47], v[172:175], a[180:183], v[44:47]
ds_read_b64_tr_b16 v[188:189], v229 offset:8192
buffer_load_dwordx4 v236, s[72:75], s44 offen offset:2048 lds
v_mfma_f32_16x16x32_bf16 v[52:55], v[172:175], a[184:187], v[52:55]
v_mfma_f32_16x16x32_bf16 v[60:63], v[172:175], a[188:191], v[60:63]
ds_read_b64_tr_b16 v[190:191], v229 offset:10240
s_waitcnt vmcnt(11) lgkmcnt(4)
v_mfma_f32_16x16x32_bf16 v[0:3], v[176:179], a[192:195], v[0:3]
v_mfma_f32_16x16x32_bf16 v[8:11], v[176:179], a[196:199], v[8:11]
ds_read_b64_tr_b16 v[160:161], v226 offset:12288
buffer_load_dwordx4 v237, s[72:75], s44 offen offset:3072 lds
v_mfma_f32_16x16x32_bf16 v[16:19], v[176:179], a[200:203], v[16:19]
v_mfma_f32_16x16x32_bf16 v[24:27], v[176:179], a[204:207], v[24:27]
ds_read_b64_tr_b16 v[162:163], v226 offset:14336
s_add_u32 m0, s43, 8192
v_mfma_f32_16x16x32_bf16 v[4:7], v[180:183], a[192:195], v[4:7]
v_mfma_f32_16x16x32_bf16 v[12:15], v[180:183], a[196:199], v[12:15]
ds_read_b64_tr_b16 v[164:165], v227 offset:12288
s_add_u32 s44, s50, 5014016
v_mfma_f32_16x16x32_bf16 v[20:23], v[180:183], a[200:203], v[20:23]
v_mfma_f32_16x16x32_bf16 v[28:31], v[180:183], a[204:207], v[28:31]
ds_read_b64_tr_b16 v[166:167], v227 offset:14336
s_waitcnt lgkmcnt(4)
v_mfma_f32_16x16x32_bf16 v[32:35], v[184:187], a[192:195], v[32:35]
v_mfma_f32_16x16x32_bf16 v[40:43], v[184:187], a[196:199], v[40:43]
ds_read_b64_tr_b16 v[168:169], v228 offset:12288
buffer_load_dwordx4 v234, s[72:75], s44 offen offset:0 lds
v_mfma_f32_16x16x32_bf16 v[48:51], v[184:187], a[200:203], v[48:51]
v_mfma_f32_16x16x32_bf16 v[56:59], v[184:187], a[204:207], v[56:59]
ds_read_b64_tr_b16 v[170:171], v228 offset:14336
buffer_load_dwordx4 v235, s[72:75], s44 offen offset:1024 lds
v_mfma_f32_16x16x32_bf16 v[36:39], v[188:191], a[192:195], v[36:39]
v_mfma_f32_16x16x32_bf16 v[44:47], v[188:191], a[196:199], v[44:47]
ds_read_b64_tr_b16 v[172:173], v229 offset:12288
buffer_load_dwordx4 v236, s[72:75], s44 offen offset:2048 lds
v_mfma_f32_16x16x32_bf16 v[52:55], v[188:191], a[200:203], v[52:55]
v_mfma_f32_16x16x32_bf16 v[60:63], v[188:191], a[204:207], v[60:63]
ds_read_b64_tr_b16 v[174:175], v229 offset:14336
s_waitcnt vmcnt(11) lgkmcnt(4)
v_mfma_f32_16x16x32_bf16 v[0:3], v[160:163], a[208:211], v[0:3]
v_mfma_f32_16x16x32_bf16 v[8:11], v[160:163], a[212:215], v[8:11]
ds_read_b64_tr_b16 v[176:177], v226 offset:16384
buffer_load_dwordx4 v237, s[72:75], s44 offen offset:3072 lds
v_mfma_f32_16x16x32_bf16 v[16:19], v[160:163], a[216:219], v[16:19]
v_mfma_f32_16x16x32_bf16 v[24:27], v[160:163], a[220:223], v[24:27]
ds_read_b64_tr_b16 v[178:179], v226 offset:18432
s_add_u32 m0, s43, 12288
v_mfma_f32_16x16x32_bf16 v[4:7], v[164:167], a[208:211], v[4:7]
v_mfma_f32_16x16x32_bf16 v[12:15], v[164:167], a[212:215], v[12:15]
ds_read_b64_tr_b16 v[180:181], v227 offset:16384
s_add_u32 s44, s50, 512
v_mfma_f32_16x16x32_bf16 v[20:23], v[164:167], a[216:219], v[20:23]
v_mfma_f32_16x16x32_bf16 v[28:31], v[164:167], a[220:223], v[28:31]
ds_read_b64_tr_b16 v[182:183], v227 offset:18432
s_waitcnt lgkmcnt(4)
v_mfma_f32_16x16x32_bf16 v[32:35], v[168:171], a[208:211], v[32:35]
v_mfma_f32_16x16x32_bf16 v[40:43], v[168:171], a[212:215], v[40:43]
ds_read_b64_tr_b16 v[184:185], v228 offset:16384
buffer_load_dwordx4 v234, s[76:79], s44 offen offset:0 lds
v_mfma_f32_16x16x32_bf16 v[48:51], v[168:171], a[216:219], v[48:51]
v_mfma_f32_16x16x32_bf16 v[56:59], v[168:171], a[220:223], v[56:59]
ds_read_b64_tr_b16 v[186:187], v228 offset:18432
buffer_load_dwordx4 v235, s[76:79], s44 offen offset:1024 lds
v_mfma_f32_16x16x32_bf16 v[36:39], v[172:175], a[208:211], v[36:39]
v_mfma_f32_16x16x32_bf16 v[44:47], v[172:175], a[212:215], v[44:47]
ds_read_b64_tr_b16 v[188:189], v229 offset:16384
buffer_load_dwordx4 v236, s[76:79], s44 offen offset:2048 lds
v_mfma_f32_16x16x32_bf16 v[52:55], v[172:175], a[216:219], v[52:55]
v_mfma_f32_16x16x32_bf16 v[60:63], v[172:175], a[220:223], v[60:63]
ds_read_b64_tr_b16 v[190:191], v229 offset:18432
s_waitcnt vmcnt(11) lgkmcnt(4)
v_mfma_f32_16x16x32_bf16 v[0:3], v[176:179], a[224:227], v[0:3]
v_mfma_f32_16x16x32_bf16 v[8:11], v[176:179], a[228:231], v[8:11]
ds_read_b64_tr_b16 v[160:161], v226 offset:0
buffer_load_dwordx4 v237, s[76:79], s44 offen offset:3072 lds
v_mfma_f32_16x16x32_bf16 v[16:19], v[176:179], a[232:235], v[16:19]
v_mfma_f32_16x16x32_bf16 v[24:27], v[176:179], a[236:239], v[24:27]
ds_read_b64_tr_b16 v[162:163], v226 offset:2048
s_add_u32 m0, s43, 16384
v_mfma_f32_16x16x32_bf16 v[4:7], v[180:183], a[224:227], v[4:7]
v_mfma_f32_16x16x32_bf16 v[12:15], v[180:183], a[228:231], v[12:15]
ds_read_b64_tr_b16 v[164:165], v227 offset:0
s_add_u32 s44, s50, 295424
v_mfma_f32_16x16x32_bf16 v[20:23], v[180:183], a[232:235], v[20:23]
v_mfma_f32_16x16x32_bf16 v[28:31], v[180:183], a[236:239], v[28:31]
ds_read_b64_tr_b16 v[166:167], v227 offset:2048
s_waitcnt lgkmcnt(4)
v_mfma_f32_16x16x32_bf16 v[32:35], v[184:187], a[224:227], v[32:35]
v_mfma_f32_16x16x32_bf16 v[40:43], v[184:187], a[228:231], v[40:43]
ds_read_b64_tr_b16 v[168:169], v228 offset:0
buffer_load_dwordx4 v234, s[76:79], s44 offen offset:0 lds
v_mfma_f32_16x16x32_bf16 v[48:51], v[184:187], a[232:235], v[48:51]
v_mfma_f32_16x16x32_bf16 v[56:59], v[184:187], a[236:239], v[56:59]
ds_read_b64_tr_b16 v[170:171], v228 offset:2048
buffer_load_dwordx4 v235, s[76:79], s44 offen offset:1024 lds
v_mfma_f32_16x16x32_bf16 v[36:39], v[188:191], a[224:227], v[36:39]
v_mfma_f32_16x16x32_bf16 v[44:47], v[188:191], a[228:231], v[44:47]
ds_read_b64_tr_b16 v[172:173], v229 offset:0
buffer_load_dwordx4 v236, s[76:79], s44 offen offset:2048 lds
v_mfma_f32_16x16x32_bf16 v[52:55], v[188:191], a[232:235], v[52:55]
v_mfma_f32_16x16x32_bf16 v[60:63], v[188:191], a[236:239], v[60:63]
ds_read_b64_tr_b16 v[174:175], v229 offset:2048
s_waitcnt vmcnt(11) lgkmcnt(4)
v_mfma_f32_16x16x32_bf16 v[0:3], v[160:163], a[240:243], v[0:3]
v_mfma_f32_16x16x32_bf16 v[8:11], v[160:163], a[244:247], v[8:11]
ds_read_b64_tr_b16 v[176:177], v226 offset:4096
buffer_load_dwordx4 v237, s[76:79], s44 offen offset:3072 lds
v_mfma_f32_16x16x32_bf16 v[16:19], v[160:163], a[248:251], v[16:19]
v_mfma_f32_16x16x32_bf16 v[24:27], v[160:163], a[252:255], v[24:27]
ds_read_b64_tr_b16 v[178:179], v226 offset:6144
s_add_u32 m0, s43, 0
v_mfma_f32_16x16x32_bf16 v[4:7], v[164:167], a[240:243], v[4:7]
v_mfma_f32_16x16x32_bf16 v[12:15], v[164:167], a[244:247], v[12:15]
ds_read_b64_tr_b16 v[180:181], v227 offset:4096
s_add_u32 s44, s50, 590336
v_mfma_f32_16x16x32_bf16 v[20:23], v[164:167], a[248:251], v[20:23]
v_mfma_f32_16x16x32_bf16 v[28:31], v[164:167], a[252:255], v[28:31]
ds_read_b64_tr_b16 v[182:183], v227 offset:6144
s_waitcnt lgkmcnt(4)
v_mfma_f32_16x16x32_bf16 v[32:35], v[168:171], a[240:243], v[32:35]
v_mfma_f32_16x16x32_bf16 v[40:43], v[168:171], a[244:247], v[40:43]
ds_read_b64_tr_b16 v[184:185], v228 offset:4096
buffer_load_dwordx4 v234, s[76:79], s44 offen offset:0 lds
v_mfma_f32_16x16x32_bf16 v[48:51], v[168:171], a[248:251], v[48:51]
v_mfma_f32_16x16x32_bf16 v[56:59], v[168:171], a[252:255], v[56:59]
ds_read_b64_tr_b16 v[186:187], v228 offset:6144
buffer_load_dwordx4 v235, s[76:79], s44 offen offset:1024 lds
v_mfma_f32_16x16x32_bf16 v[36:39], v[172:175], a[240:243], v[36:39]
v_mfma_f32_16x16x32_bf16 v[44:47], v[172:175], a[244:247], v[44:47]
ds_read_b64_tr_b16 v[188:189], v229 offset:4096
buffer_load_dwordx4 v236, s[76:79], s44 offen offset:2048 lds
v_mfma_f32_16x16x32_bf16 v[52:55], v[172:175], a[248:251], v[52:55]
v_mfma_f32_16x16x32_bf16 v[60:63], v[172:175], a[252:255], v[60:63]
ds_read_b64_tr_b16 v[190:191], v229 offset:6144
s_waitcnt vmcnt(11) lgkmcnt(4)
v_mfma_f32_16x16x32_bf16 v[0:3], v[176:179], v[128:131], v[0:3]
v_mfma_f32_16x16x32_bf16 v[8:11], v[176:179], v[132:135], v[8:11]
ds_read_b64_tr_b16 v[160:161], v226 offset:8192
buffer_load_dwordx4 v237, s[76:79], s44 offen offset:3072 lds
v_mfma_f32_16x16x32_bf16 v[16:19], v[176:179], v[136:139], v[16:19]
v_mfma_f32_16x16x32_bf16 v[24:27], v[176:179], v[140:143], v[24:27]
ds_read_b64_tr_b16 v[162:163], v226 offset:10240
s_add_u32 m0, s43, 4096
v_mfma_f32_16x16x32_bf16 v[4:7], v[180:183], v[128:131], v[4:7]
v_mfma_f32_16x16x32_bf16 v[12:15], v[180:183], v[132:135], v[12:15]
ds_read_b64_tr_b16 v[164:165], v227 offset:8192
s_add_u32 s44, s50, 885248
v_mfma_f32_16x16x32_bf16 v[20:23], v[180:183], v[136:139], v[20:23]
v_mfma_f32_16x16x32_bf16 v[28:31], v[180:183], v[140:143], v[28:31]
ds_read_b64_tr_b16 v[166:167], v227 offset:10240
s_waitcnt lgkmcnt(4)
v_mfma_f32_16x16x32_bf16 v[32:35], v[184:187], v[128:131], v[32:35]
v_mfma_f32_16x16x32_bf16 v[40:43], v[184:187], v[132:135], v[40:43]
ds_read_b64_tr_b16 v[168:169], v228 offset:8192
buffer_load_dwordx4 v234, s[76:79], s44 offen offset:0 lds
v_mfma_f32_16x16x32_bf16 v[48:51], v[184:187], v[136:139], v[48:51]
v_mfma_f32_16x16x32_bf16 v[56:59], v[184:187], v[140:143], v[56:59]
ds_read_b64_tr_b16 v[170:171], v228 offset:10240
buffer_load_dwordx4 v235, s[76:79], s44 offen offset:1024 lds
v_mfma_f32_16x16x32_bf16 v[36:39], v[188:191], v[128:131], v[36:39]
v_mfma_f32_16x16x32_bf16 v[44:47], v[188:191], v[132:135], v[44:47]
ds_read_b64_tr_b16 v[172:173], v229 offset:8192
buffer_load_dwordx4 v236, s[76:79], s44 offen offset:2048 lds
v_mfma_f32_16x16x32_bf16 v[52:55], v[188:191], v[136:139], v[52:55]
v_mfma_f32_16x16x32_bf16 v[60:63], v[188:191], v[140:143], v[60:63]
ds_read_b64_tr_b16 v[174:175], v229 offset:10240
s_waitcnt vmcnt(11) lgkmcnt(4)
v_mfma_f32_16x16x32_bf16 v[0:3], v[160:163], v[144:147], v[0:3]
v_mfma_f32_16x16x32_bf16 v[8:11], v[160:163], v[148:151], v[8:11]
ds_read_b64_tr_b16 v[176:177], v226 offset:12288
buffer_load_dwordx4 v237, s[76:79], s44 offen offset:3072 lds
v_mfma_f32_16x16x32_bf16 v[16:19], v[160:163], v[152:155], v[16:19]
v_mfma_f32_16x16x32_bf16 v[24:27], v[160:163], v[156:159], v[24:27]
ds_read_b64_tr_b16 v[178:179], v226 offset:14336
s_add_u32 m0, s43, 8192
v_mfma_f32_16x16x32_bf16 v[4:7], v[164:167], v[144:147], v[4:7]
v_mfma_f32_16x16x32_bf16 v[12:15], v[164:167], v[148:151], v[12:15]
ds_read_b64_tr_b16 v[180:181], v227 offset:12288
s_add_u32 s44, s50, 1180160
v_mfma_f32_16x16x32_bf16 v[20:23], v[164:167], v[152:155], v[20:23]
v_mfma_f32_16x16x32_bf16 v[28:31], v[164:167], v[156:159], v[28:31]
ds_read_b64_tr_b16 v[182:183], v227 offset:14336
s_waitcnt lgkmcnt(4)
v_mfma_f32_16x16x32_bf16 v[32:35], v[168:171], v[144:147], v[32:35]
v_mfma_f32_16x16x32_bf16 v[40:43], v[168:171], v[148:151], v[40:43]
ds_read_b64_tr_b16 v[184:185], v228 offset:12288
buffer_load_dwordx4 v234, s[76:79], s44 offen offset:0 lds
v_mfma_f32_16x16x32_bf16 v[48:51], v[168:171], v[152:155], v[48:51]
v_mfma_f32_16x16x32_bf16 v[56:59], v[168:171], v[156:159], v[56:59]
ds_read_b64_tr_b16 v[186:187], v228 offset:14336
buffer_load_dwordx4 v235, s[76:79], s44 offen offset:1024 lds
v_mfma_f32_16x16x32_bf16 v[36:39], v[172:175], v[144:147], v[36:39]
v_mfma_f32_16x16x32_bf16 v[44:47], v[172:175], v[148:151], v[44:47]
ds_read_b64_tr_b16 v[188:189], v229 offset:12288
buffer_load_dwordx4 v236, s[76:79], s44 offen offset:2048 lds
v_mfma_f32_16x16x32_bf16 v[52:55], v[172:175], v[152:155], v[52:55]
v_mfma_f32_16x16x32_bf16 v[60:63], v[172:175], v[156:159], v[60:63]
ds_read_b64_tr_b16 v[190:191], v229 offset:14336
s_waitcnt vmcnt(11) lgkmcnt(4)
s_barrier
v_mfma_f32_16x16x32_bf16 v[64:67], v[176:179], a[0:3], 0
v_mfma_f32_16x16x32_bf16 v[72:75], v[176:179], a[4:7], 0
ds_read_b64_tr_b16 v[160:161], v226 offset:16384
buffer_load_dwordx4 v237, s[76:79], s44 offen offset:3072 lds
v_mfma_f32_16x16x32_bf16 v[80:83], v[176:179], a[8:11], 0
v_mfma_f32_16x16x32_bf16 v[88:91], v[176:179], a[12:15], 0
ds_read_b64_tr_b16 v[162:163], v226 offset:18432
s_add_u32 m0, s43, 12288
v_mfma_f32_16x16x32_bf16 v[68:71], v[180:183], a[0:3], 0
v_exp_f32 v0, -v0
v_mfma_f32_16x16x32_bf16 v[76:79], v[180:183], a[4:7], 0
ds_read_b64_tr_b16 v[164:165], v227 offset:16384
s_add_u32 s44, s50, 1475072
v_mfma_f32_16x16x32_bf16 v[84:87], v[180:183], a[8:11], 0
v_exp_f32 v1, -v1
v_mfma_f32_16x16x32_bf16 v[92:95], v[180:183], a[12:15], 0
ds_read_b64_tr_b16 v[166:167], v227 offset:18432
s_waitcnt lgkmcnt(4)
v_add_f32 v0, 1.0, v0
v_mfma_f32_16x16x32_bf16 v[96:99], v[184:187], a[0:3], 0
v_exp_f32 v2, -v2
v_mfma_f32_16x16x32_bf16 v[104:107], v[184:187], a[4:7], 0
ds_read_b64_tr_b16 v[168:169], v228 offset:16384
buffer_load_dwordx4 v234, s[76:79], s44 offen offset:0 lds
v_mfma_f32_16x16x32_bf16 v[112:115], v[184:187], a[8:11], 0
v_add_f32 v1, 1.0, v1
v_mfma_f32_16x16x32_bf16 v[120:123], v[184:187], a[12:15], 0
ds_read_b64_tr_b16 v[170:171], v228 offset:18432
buffer_load_dwordx4 v235, s[76:79], s44 offen offset:1024 lds
v_mfma_f32_16x16x32_bf16 v[100:103], v[188:191], a[0:3], 0
v_rcp_f32 v0, v0
v_mfma_f32_16x16x32_bf16 v[108:111], v[188:191], a[4:7], 0
ds_read_b64_tr_b16 v[172:173], v229 offset:16384
buffer_load_dwordx4 v236, s[76:79], s44 offen offset:2048 lds
v_mfma_f32_16x16x32_bf16 v[116:119], v[188:191], a[8:11], 0
v_exp_f32 v3, -v3
v_mfma_f32_16x16x32_bf16 v[124:127], v[188:191], a[12:15], 0
ds_read_b64_tr_b16 v[174:175], v229 offset:18432
s_waitcnt vmcnt(11) lgkmcnt(4)
v_add_f32 v2, 1.0, v2
v_mfma_f32_16x16x32_bf16 v[64:67], v[160:163], a[16:19], v[64:67]
v_rcp_f32 v1, v1
v_mfma_f32_16x16x32_bf16 v[72:75], v[160:163], a[20:23], v[72:75]
ds_read_b64_tr_b16 v[176:177], v226 offset:0
buffer_load_dwordx4 v237, s[76:79], s44 offen offset:3072 lds
v_mfma_f32_16x16x32_bf16 v[80:83], v[160:163], a[24:27], v[80:83]
v_exp_f32 v8, -v8
v_mfma_f32_16x16x32_bf16 v[88:91], v[160:163], a[28:31], v[88:91]
ds_read_b64_tr_b16 v[178:179], v226 offset:2048
s_add_u32 m0, s43, 16384
v_add_f32 v3, 1.0, v3
v_mfma_f32_16x16x32_bf16 v[68:71], v[164:167], a[16:19], v[68:71]
v_rcp_f32 v2, v2
v_mfma_f32_16x16x32_bf16 v[76:79], v[164:167], a[20:23], v[76:79]
ds_read_b64_tr_b16 v[180:181], v227 offset:0
s_add_u32 s44, s50, 1769984
v_mfma_f32_16x16x32_bf16 v[84:87], v[164:167], a[24:27], v[84:87]
v_exp_f32 v9, -v9
v_mfma_f32_16x16x32_bf16 v[92:95], v[164:167], a[28:31], v[92:95]
ds_read_b64_tr_b16 v[182:183], v227 offset:2048
s_waitcnt lgkmcnt(4)
v_add_f32 v8, 1.0, v8
v_mfma_f32_16x16x32_bf16 v[96:99], v[168:171], a[16:19], v[96:99]
v_rcp_f32 v3, v3
v_mfma_f32_16x16x32_bf16 v[104:107], v[168:171], a[20:23], v[104:107]
ds_read_b64_tr_b16 v[184:185], v228 offset:0
buffer_load_dwordx4 v234, s[76:79], s44 offen offset:0 lds
v_mfma_f32_16x16x32_bf16 v[112:115], v[168:171], a[24:27], v[112:115]
v_exp_f32 v10, -v10
v_mfma_f32_16x16x32_bf16 v[120:123], v[168:171], a[28:31], v[120:123]
ds_read_b64_tr_b16 v[186:187], v228 offset:2048
buffer_load_dwordx4 v235, s[76:79], s44 offen offset:1024 lds
v_add_f32 v9, 1.0, v9
v_mfma_f32_16x16x32_bf16 v[100:103], v[172:175], a[16:19], v[100:103]
v_rcp_f32 v8, v8
v_mfma_f32_16x16x32_bf16 v[108:111], v[172:175], a[20:23], v[108:111]
ds_read_b64_tr_b16 v[188:189], v229 offset:0
buffer_load_dwordx4 v236, s[76:79], s44 offen offset:2048 lds
v_mfma_f32_16x16x32_bf16 v[116:119], v[172:175], a[24:27], v[116:119]
v_exp_f32 v11, -v11
v_mfma_f32_16x16x32_bf16 v[124:127], v[172:175], a[28:31], v[124:127]
ds_read_b64_tr_b16 v[190:191], v229 offset:2048
s_waitcnt vmcnt(11) lgkmcnt(4)
v_add_f32 v10, 1.0, v10
v_mfma_f32_16x16x32_bf16 v[64:67], v[176:179], a[32:35], v[64:67]
v_rcp_f32 v9, v9
v_mfma_f32_16x16x32_bf16 v[72:75], v[176:179], a[36:39], v[72:75]
ds_read_b64_tr_b16 v[160:161], v226 offset:4096
buffer_load_dwordx4 v237, s[76:79], s44 offen offset:3072 lds
v_mfma_f32_16x16x32_bf16 v[80:83], v[176:179], a[40:43], v[80:83]
v_exp_f32 v16, -v16
v_mfma_f32_16x16x32_bf16 v[88:91], v[176:179], a[44:47], v[88:91]
ds_read_b64_tr_b16 v[162:163], v226 offset:6144
s_add_u32 m0, s43, 0
v_add_f32 v11, 1.0, v11
v_mfma_f32_16x16x32_bf16 v[68:71], v[180:183], a[32:35], v[68:71]
v_rcp_f32 v10, v10
v_mfma_f32_16x16x32_bf16 v[76:79], v[180:183], a[36:39], v[76:79]
ds_read_b64_tr_b16 v[164:165], v227 offset:4096
s_add_u32 s44, s50, 2064896
v_mfma_f32_16x16x32_bf16 v[84:87], v[180:183], a[40:43], v[84:87]
v_exp_f32 v17, -v17
v_mfma_f32_16x16x32_bf16 v[92:95], v[180:183], a[44:47], v[92:95]
ds_read_b64_tr_b16 v[166:167], v227 offset:6144
s_waitcnt lgkmcnt(4)
v_add_f32 v16, 1.0, v16
v_mfma_f32_16x16x32_bf16 v[96:99], v[184:187], a[32:35], v[96:99]
v_rcp_f32 v11, v11
v_mfma_f32_16x16x32_bf16 v[104:107], v[184:187], a[36:39], v[104:107]
ds_read_b64_tr_b16 v[168:169], v228 offset:4096
buffer_load_dwordx4 v234, s[76:79], s44 offen offset:0 lds
v_mfma_f32_16x16x32_bf16 v[112:115], v[184:187], a[40:43], v[112:115]
v_exp_f32 v18, -v18
v_mfma_f32_16x16x32_bf16 v[120:123], v[184:187], a[44:47], v[120:123]
ds_read_b64_tr_b16 v[170:171], v228 offset:6144
buffer_load_dwordx4 v235, s[76:79], s44 offen offset:1024 lds
v_add_f32 v17, 1.0, v17
v_mfma_f32_16x16x32_bf16 v[100:103], v[188:191], a[32:35], v[100:103]
v_rcp_f32 v16, v16
v_mfma_f32_16x16x32_bf16 v[108:111], v[188:191], a[36:39], v[108:111]
ds_read_b64_tr_b16 v[172:173], v229 offset:4096
buffer_load_dwordx4 v236, s[76:79], s44 offen offset:2048 lds
v_mfma_f32_16x16x32_bf16 v[116:119], v[188:191], a[40:43], v[116:119]
v_exp_f32 v19, -v19
v_mfma_f32_16x16x32_bf16 v[124:127], v[188:191], a[44:47], v[124:127]
ds_read_b64_tr_b16 v[174:175], v229 offset:6144
s_waitcnt vmcnt(11) lgkmcnt(4)
v_add_f32 v18, 1.0, v18
v_mfma_f32_16x16x32_bf16 v[64:67], v[160:163], a[48:51], v[64:67]
v_rcp_f32 v17, v17
v_mfma_f32_16x16x32_bf16 v[72:75], v[160:163], a[52:55], v[72:75]
ds_read_b64_tr_b16 v[176:177], v226 offset:8192
buffer_load_dwordx4 v237, s[76:79], s44 offen offset:3072 lds
v_mfma_f32_16x16x32_bf16 v[80:83], v[160:163], a[56:59], v[80:83]
v_exp_f32 v24, -v24
v_mfma_f32_16x16x32_bf16 v[88:91], v[160:163], a[60:63], v[88:91]
ds_read_b64_tr_b16 v[178:179], v226 offset:10240
s_add_u32 m0, s43, 4096
v_add_f32 v19, 1.0, v19
v_mfma_f32_16x16x32_bf16 v[68:71], v[164:167], a[48:51], v[68:71]
v_rcp_f32 v18, v18
v_mfma_f32_16x16x32_bf16 v[76:79], v[164:167], a[52:55], v[76:79]
ds_read_b64_tr_b16 v[180:181], v227 offset:8192
s_add_u32 s44, s50, 2359808
v_mfma_f32_16x16x32_bf16 v[84:87], v[164:167], a[56:59], v[84:87]
v_exp_f32 v25, -v25
v_mfma_f32_16x16x32_bf16 v[92:95], v[164:167], a[60:63], v[92:95]
ds_read_b64_tr_b16 v[182:183], v227 offset:10240
s_waitcnt lgkmcnt(4)
v_add_f32 v24, 1.0, v24
v_mfma_f32_16x16x32_bf16 v[96:99], v[168:171], a[48:51], v[96:99]
v_rcp_f32 v19, v19
v_mfma_f32_16x16x32_bf16 v[104:107], v[168:171], a[52:55], v[104:107]
ds_read_b64_tr_b16 v[184:185], v228 offset:8192
buffer_load_dwordx4 v234, s[76:79], s44 offen offset:0 lds
v_mfma_f32_16x16x32_bf16 v[112:115], v[168:171], a[56:59], v[112:115]
v_exp_f32 v26, -v26
v_mfma_f32_16x16x32_bf16 v[120:123], v[168:171], a[60:63], v[120:123]
ds_read_b64_tr_b16 v[186:187], v228 offset:10240
buffer_load_dwordx4 v235, s[76:79], s44 offen offset:1024 lds
v_add_f32 v25, 1.0, v25
v_mfma_f32_16x16x32_bf16 v[100:103], v[172:175], a[48:51], v[100:103]
v_rcp_f32 v24, v24
v_mfma_f32_16x16x32_bf16 v[108:111], v[172:175], a[52:55], v[108:111]
ds_read_b64_tr_b16 v[188:189], v229 offset:8192
buffer_load_dwordx4 v236, s[76:79], s44 offen offset:2048 lds
v_mfma_f32_16x16x32_bf16 v[116:119], v[172:175], a[56:59], v[116:119]
v_exp_f32 v27, -v27
v_mfma_f32_16x16x32_bf16 v[124:127], v[172:175], a[60:63], v[124:127]
ds_read_b64_tr_b16 v[190:191], v229 offset:10240
s_waitcnt vmcnt(11) lgkmcnt(4)
v_add_f32 v26, 1.0, v26
v_mfma_f32_16x16x32_bf16 v[64:67], v[176:179], a[64:67], v[64:67]
v_rcp_f32 v25, v25
v_mfma_f32_16x16x32_bf16 v[72:75], v[176:179], a[68:71], v[72:75]
ds_read_b64_tr_b16 v[160:161], v226 offset:12288
buffer_load_dwordx4 v237, s[76:79], s44 offen offset:3072 lds
v_mfma_f32_16x16x32_bf16 v[80:83], v[176:179], a[72:75], v[80:83]
v_exp_f32 v4, -v4
v_mfma_f32_16x16x32_bf16 v[88:91], v[176:179], a[76:79], v[88:91]
ds_read_b64_tr_b16 v[162:163], v226 offset:14336
s_add_u32 m0, s43, 8192
v_add_f32 v27, 1.0, v27
v_mfma_f32_16x16x32_bf16 v[68:71], v[180:183], a[64:67], v[68:71]
v_rcp_f32 v26, v26
v_mfma_f32_16x16x32_bf16 v[76:79], v[180:183], a[68:71], v[76:79]
ds_read_b64_tr_b16 v[164:165], v227 offset:12288
s_add_u32 s44, s50, 2654720
v_mfma_f32_16x16x32_bf16 v[84:87], v[180:183], a[72:75], v[84:87]
v_exp_f32 v5, -v5
v_mfma_f32_16x16x32_bf16 v[92:95], v[180:183], a[76:79], v[92:95]
ds_read_b64_tr_b16 v[166:167], v227 offset:14336
s_waitcnt lgkmcnt(4)
v_add_f32 v4, 1.0, v4
v_mfma_f32_16x16x32_bf16 v[96:99], v[184:187], a[64:67], v[96:99]
v_rcp_f32 v27, v27
v_mfma_f32_16x16x32_bf16 v[104:107], v[184:187], a[68:71], v[104:107]
ds_read_b64_tr_b16 v[168:169], v228 offset:12288
buffer_load_dwordx4 v234, s[76:79], s44 offen offset:0 lds
v_mfma_f32_16x16x32_bf16 v[112:115], v[184:187], a[72:75], v[112:115]
v_exp_f32 v6, -v6
v_mfma_f32_16x16x32_bf16 v[120:123], v[184:187], a[76:79], v[120:123]
ds_read_b64_tr_b16 v[170:171], v228 offset:14336
buffer_load_dwordx4 v235, s[76:79], s44 offen offset:1024 lds
v_add_f32 v5, 1.0, v5
v_mfma_f32_16x16x32_bf16 v[100:103], v[188:191], a[64:67], v[100:103]
v_rcp_f32 v4, v4
v_mfma_f32_16x16x32_bf16 v[108:111], v[188:191], a[68:71], v[108:111]
ds_read_b64_tr_b16 v[172:173], v229 offset:12288
buffer_load_dwordx4 v236, s[76:79], s44 offen offset:2048 lds
v_mfma_f32_16x16x32_bf16 v[116:119], v[188:191], a[72:75], v[116:119]
v_exp_f32 v7, -v7
v_mfma_f32_16x16x32_bf16 v[124:127], v[188:191], a[76:79], v[124:127]
ds_read_b64_tr_b16 v[174:175], v229 offset:14336
s_waitcnt vmcnt(11) lgkmcnt(4)
v_add_f32 v6, 1.0, v6
v_mfma_f32_16x16x32_bf16 v[64:67], v[160:163], a[80:83], v[64:67]
v_rcp_f32 v5, v5
v_mfma_f32_16x16x32_bf16 v[72:75], v[160:163], a[84:87], v[72:75]
ds_read_b64_tr_b16 v[176:177], v226 offset:16384
buffer_load_dwordx4 v237, s[76:79], s44 offen offset:3072 lds
v_mfma_f32_16x16x32_bf16 v[80:83], v[160:163], a[88:91], v[80:83]
v_exp_f32 v12, -v12
v_mfma_f32_16x16x32_bf16 v[88:91], v[160:163], a[92:95], v[88:91]
ds_read_b64_tr_b16 v[178:179], v226 offset:18432
s_add_u32 m0, s43, 12288
v_add_f32 v7, 1.0, v7
v_mfma_f32_16x16x32_bf16 v[68:71], v[164:167], a[80:83], v[68:71]
v_rcp_f32 v6, v6
v_mfma_f32_16x16x32_bf16 v[76:79], v[164:167], a[84:87], v[76:79]
ds_read_b64_tr_b16 v[180:181], v227 offset:16384
s_add_u32 s44, s50, 2949632
v_mfma_f32_16x16x32_bf16 v[84:87], v[164:167], a[88:91], v[84:87]
v_exp_f32 v13, -v13
v_mfma_f32_16x16x32_bf16 v[92:95], v[164:167], a[92:95], v[92:95]
ds_read_b64_tr_b16 v[182:183], v227 offset:18432
s_waitcnt lgkmcnt(4)
v_add_f32 v12, 1.0, v12
v_mfma_f32_16x16x32_bf16 v[96:99], v[168:171], a[80:83], v[96:99]
v_rcp_f32 v7, v7
v_mfma_f32_16x16x32_bf16 v[104:107], v[168:171], a[84:87], v[104:107]
ds_read_b64_tr_b16 v[184:185], v228 offset:16384
buffer_load_dwordx4 v234, s[76:79], s44 offen offset:0 lds
v_mfma_f32_16x16x32_bf16 v[112:115], v[168:171], a[88:91], v[112:115]
v_exp_f32 v14, -v14
v_mfma_f32_16x16x32_bf16 v[120:123], v[168:171], a[92:95], v[120:123]
ds_read_b64_tr_b16 v[186:187], v228 offset:18432
buffer_load_dwordx4 v235, s[76:79], s44 offen offset:1024 lds
v_add_f32 v13, 1.0, v13
v_mfma_f32_16x16x32_bf16 v[100:103], v[172:175], a[80:83], v[100:103]
v_rcp_f32 v12, v12
v_mfma_f32_16x16x32_bf16 v[108:111], v[172:175], a[84:87], v[108:111]
ds_read_b64_tr_b16 v[188:189], v229 offset:16384
buffer_load_dwordx4 v236, s[76:79], s44 offen offset:2048 lds
v_mfma_f32_16x16x32_bf16 v[116:119], v[172:175], a[88:91], v[116:119]
v_exp_f32 v15, -v15
v_mfma_f32_16x16x32_bf16 v[124:127], v[172:175], a[92:95], v[124:127]
ds_read_b64_tr_b16 v[190:191], v229 offset:18432
s_waitcnt vmcnt(11) lgkmcnt(4)
v_add_f32 v14, 1.0, v14
v_mfma_f32_16x16x32_bf16 v[64:67], v[176:179], a[96:99], v[64:67]
v_rcp_f32 v13, v13
v_mfma_f32_16x16x32_bf16 v[72:75], v[176:179], a[100:103], v[72:75]
ds_read_b64_tr_b16 v[160:161], v226 offset:0
buffer_load_dwordx4 v237, s[76:79], s44 offen offset:3072 lds
v_mfma_f32_16x16x32_bf16 v[80:83], v[176:179], a[104:107], v[80:83]
v_exp_f32 v20, -v20
v_mfma_f32_16x16x32_bf16 v[88:91], v[176:179], a[108:111], v[88:91]
ds_read_b64_tr_b16 v[162:163], v226 offset:2048
s_add_u32 m0, s43, 16384
v_add_f32 v15, 1.0, v15
v_mfma_f32_16x16x32_bf16 v[68:71], v[180:183], a[96:99], v[68:71]
v_rcp_f32 v14, v14
v_mfma_f32_16x16x32_bf16 v[76:79], v[180:183], a[100:103], v[76:79]
ds_read_b64_tr_b16 v[164:165], v227 offset:0
s_add_u32 s44, s50, 3244544
v_mfma_f32_16x16x32_bf16 v[84:87], v[180:183], a[104:107], v[84:87]
v_exp_f32 v21, -v21
v_mfma_f32_16x16x32_bf16 v[92:95], v[180:183], a[108:111], v[92:95]
ds_read_b64_tr_b16 v[166:167], v227 offset:2048
s_waitcnt lgkmcnt(4)
v_add_f32 v20, 1.0, v20
v_mfma_f32_16x16x32_bf16 v[96:99], v[184:187], a[96:99], v[96:99]
v_rcp_f32 v15, v15
v_mfma_f32_16x16x32_bf16 v[104:107], v[184:187], a[100:103], v[104:107]
ds_read_b64_tr_b16 v[168:169], v228 offset:0
buffer_load_dwordx4 v234, s[76:79], s44 offen offset:0 lds
v_mfma_f32_16x16x32_bf16 v[112:115], v[184:187], a[104:107], v[112:115]
v_exp_f32 v22, -v22
v_mfma_f32_16x16x32_bf16 v[120:123], v[184:187], a[108:111], v[120:123]
ds_read_b64_tr_b16 v[170:171], v228 offset:2048
buffer_load_dwordx4 v235, s[76:79], s44 offen offset:1024 lds
v_add_f32 v21, 1.0, v21
v_mfma_f32_16x16x32_bf16 v[100:103], v[188:191], a[96:99], v[100:103]
v_rcp_f32 v20, v20
v_mfma_f32_16x16x32_bf16 v[108:111], v[188:191], a[100:103], v[108:111]
ds_read_b64_tr_b16 v[172:173], v229 offset:0
buffer_load_dwordx4 v236, s[76:79], s44 offen offset:2048 lds
v_mfma_f32_16x16x32_bf16 v[116:119], v[188:191], a[104:107], v[116:119]
v_exp_f32 v23, -v23
v_mfma_f32_16x16x32_bf16 v[124:127], v[188:191], a[108:111], v[124:127]
ds_read_b64_tr_b16 v[174:175], v229 offset:2048
s_waitcnt vmcnt(11) lgkmcnt(4)
v_add_f32 v22, 1.0, v22
v_mfma_f32_16x16x32_bf16 v[64:67], v[160:163], a[112:115], v[64:67]
v_rcp_f32 v21, v21
v_mfma_f32_16x16x32_bf16 v[72:75], v[160:163], a[116:119], v[72:75]
ds_read_b64_tr_b16 v[176:177], v226 offset:4096
buffer_load_dwordx4 v237, s[76:79], s44 offen offset:3072 lds
v_mfma_f32_16x16x32_bf16 v[80:83], v[160:163], a[120:123], v[80:83]
v_exp_f32 v28, -v28
v_mfma_f32_16x16x32_bf16 v[88:91], v[160:163], a[124:127], v[88:91]
ds_read_b64_tr_b16 v[178:179], v226 offset:6144
s_add_u32 m0, s43, 0
v_add_f32 v23, 1.0, v23
v_mfma_f32_16x16x32_bf16 v[68:71], v[164:167], a[112:115], v[68:71]
v_rcp_f32 v22, v22
v_mfma_f32_16x16x32_bf16 v[76:79], v[164:167], a[116:119], v[76:79]
ds_read_b64_tr_b16 v[180:181], v227 offset:4096
s_add_u32 s44, s50, 3539456
v_mfma_f32_16x16x32_bf16 v[84:87], v[164:167], a[120:123], v[84:87]
v_exp_f32 v29, -v29
v_mfma_f32_16x16x32_bf16 v[92:95], v[164:167], a[124:127], v[92:95]
ds_read_b64_tr_b16 v[182:183], v227 offset:6144
s_waitcnt lgkmcnt(4)
v_add_f32 v28, 1.0, v28
v_mfma_f32_16x16x32_bf16 v[96:99], v[168:171], a[112:115], v[96:99]
v_rcp_f32 v23, v23
v_mfma_f32_16x16x32_bf16 v[104:107], v[168:171], a[116:119], v[104:107]
ds_read_b64_tr_b16 v[184:185], v228 offset:4096
buffer_load_dwordx4 v234, s[76:79], s44 offen offset:0 lds
v_mfma_f32_16x16x32_bf16 v[112:115], v[168:171], a[120:123], v[112:115]
v_exp_f32 v30, -v30
v_mfma_f32_16x16x32_bf16 v[120:123], v[168:171], a[124:127], v[120:123]
ds_read_b64_tr_b16 v[186:187], v228 offset:6144
buffer_load_dwordx4 v235, s[76:79], s44 offen offset:1024 lds
v_add_f32 v29, 1.0, v29
v_mfma_f32_16x16x32_bf16 v[100:103], v[172:175], a[112:115], v[100:103]
v_rcp_f32 v28, v28
v_mfma_f32_16x16x32_bf16 v[108:111], v[172:175], a[116:119], v[108:111]
ds_read_b64_tr_b16 v[188:189], v229 offset:4096
buffer_load_dwordx4 v236, s[76:79], s44 offen offset:2048 lds
v_mfma_f32_16x16x32_bf16 v[116:119], v[172:175], a[120:123], v[116:119]
v_exp_f32 v31, -v31
v_mfma_f32_16x16x32_bf16 v[124:127], v[172:175], a[124:127], v[124:127]
ds_read_b64_tr_b16 v[190:191], v229 offset:6144
s_waitcnt vmcnt(11) lgkmcnt(4)
v_add_f32 v30, 1.0, v30
v_mfma_f32_16x16x32_bf16 v[64:67], v[176:179], a[128:131], v[64:67]
v_rcp_f32 v29, v29
v_mfma_f32_16x16x32_bf16 v[72:75], v[176:179], a[132:135], v[72:75]
ds_read_b64_tr_b16 v[160:161], v226 offset:8192
buffer_load_dwordx4 v237, s[76:79], s44 offen offset:3072 lds
v_mfma_f32_16x16x32_bf16 v[80:83], v[176:179], a[136:139], v[80:83]
v_exp_f32 v32, -v32
v_mfma_f32_16x16x32_bf16 v[88:91], v[176:179], a[140:143], v[88:91]
ds_read_b64_tr_b16 v[162:163], v226 offset:10240
s_add_u32 m0, s43, 4096
v_add_f32 v31, 1.0, v31
v_mfma_f32_16x16x32_bf16 v[68:71], v[180:183], a[128:131], v[68:71]
v_rcp_f32 v30, v30
v_mfma_f32_16x16x32_bf16 v[76:79], v[180:183], a[132:135], v[76:79]
ds_read_b64_tr_b16 v[164:165], v227 offset:8192
s_add_u32 s44, s50, 3834368
v_mfma_f32_16x16x32_bf16 v[84:87], v[180:183], a[136:139], v[84:87]
v_exp_f32 v33, -v33
v_mfma_f32_16x16x32_bf16 v[92:95], v[180:183], a[140:143], v[92:95]
ds_read_b64_tr_b16 v[166:167], v227 offset:10240
s_waitcnt lgkmcnt(4)
v_add_f32 v32, 1.0, v32
v_mfma_f32_16x16x32_bf16 v[96:99], v[184:187], a[128:131], v[96:99]
v_rcp_f32 v31, v31
v_mfma_f32_16x16x32_bf16 v[104:107], v[184:187], a[132:135], v[104:107]
ds_read_b64_tr_b16 v[168:169], v228 offset:8192
buffer_load_dwordx4 v234, s[76:79], s44 offen offset:0 lds
v_mfma_f32_16x16x32_bf16 v[112:115], v[184:187], a[136:139], v[112:115]
v_exp_f32 v34, -v34
v_mfma_f32_16x16x32_bf16 v[120:123], v[184:187], a[140:143], v[120:123]
ds_read_b64_tr_b16 v[170:171], v228 offset:10240
buffer_load_dwordx4 v235, s[76:79], s44 offen offset:1024 lds
v_add_f32 v33, 1.0, v33
v_mfma_f32_16x16x32_bf16 v[100:103], v[188:191], a[128:131], v[100:103]
v_rcp_f32 v32, v32
v_mfma_f32_16x16x32_bf16 v[108:111], v[188:191], a[132:135], v[108:111]
ds_read_b64_tr_b16 v[172:173], v229 offset:8192
buffer_load_dwordx4 v236, s[76:79], s44 offen offset:2048 lds
v_mfma_f32_16x16x32_bf16 v[116:119], v[188:191], a[136:139], v[116:119]
v_exp_f32 v35, -v35
v_mfma_f32_16x16x32_bf16 v[124:127], v[188:191], a[140:143], v[124:127]
ds_read_b64_tr_b16 v[174:175], v229 offset:10240
s_waitcnt vmcnt(11) lgkmcnt(4)
v_add_f32 v34, 1.0, v34
v_mfma_f32_16x16x32_bf16 v[64:67], v[160:163], a[144:147], v[64:67]
v_rcp_f32 v33, v33
v_mfma_f32_16x16x32_bf16 v[72:75], v[160:163], a[148:151], v[72:75]
ds_read_b64_tr_b16 v[176:177], v226 offset:12288
buffer_load_dwordx4 v237, s[76:79], s44 offen offset:3072 lds
v_mfma_f32_16x16x32_bf16 v[80:83], v[160:163], a[152:155], v[80:83]
v_exp_f32 v40, -v40
v_mfma_f32_16x16x32_bf16 v[88:91], v[160:163], a[156:159], v[88:91]
ds_read_b64_tr_b16 v[178:179], v226 offset:14336
s_add_u32 m0, s43, 8192
v_add_f32 v35, 1.0, v35
v_mfma_f32_16x16x32_bf16 v[68:71], v[164:167], a[144:147], v[68:71]
v_rcp_f32 v34, v34
v_mfma_f32_16x16x32_bf16 v[76:79], v[164:167], a[148:151], v[76:79]
ds_read_b64_tr_b16 v[180:181], v227 offset:12288
s_add_u32 s44, s50, 4129280
v_mfma_f32_16x16x32_bf16 v[84:87], v[164:167], a[152:155], v[84:87]
v_exp_f32 v41, -v41
v_mfma_f32_16x16x32_bf16 v[92:95], v[164:167], a[156:159], v[92:95]
ds_read_b64_tr_b16 v[182:183], v227 offset:14336
s_waitcnt lgkmcnt(4)
v_add_f32 v40, 1.0, v40
v_mfma_f32_16x16x32_bf16 v[96:99], v[168:171], a[144:147], v[96:99]
v_rcp_f32 v35, v35
v_mfma_f32_16x16x32_bf16 v[104:107], v[168:171], a[148:151], v[104:107]
ds_read_b64_tr_b16 v[184:185], v228 offset:12288
buffer_load_dwordx4 v234, s[76:79], s44 offen offset:0 lds
v_mfma_f32_16x16x32_bf16 v[112:115], v[168:171], a[152:155], v[112:115]
v_exp_f32 v42, -v42
v_mfma_f32_16x16x32_bf16 v[120:123], v[168:171], a[156:159], v[120:123]
ds_read_b64_tr_b16 v[186:187], v228 offset:14336
buffer_load_dwordx4 v235, s[76:79], s44 offen offset:1024 lds
v_add_f32 v41, 1.0, v41
v_mfma_f32_16x16x32_bf16 v[100:103], v[172:175], a[144:147], v[100:103]
v_rcp_f32 v40, v40
v_mfma_f32_16x16x32_bf16 v[108:111], v[172:175], a[148:151], v[108:111]
ds_read_b64_tr_b16 v[188:189], v229 offset:12288
buffer_load_dwordx4 v236, s[76:79], s44 offen offset:2048 lds
v_mfma_f32_16x16x32_bf16 v[116:119], v[172:175], a[152:155], v[116:119]
v_exp_f32 v43, -v43
v_mfma_f32_16x16x32_bf16 v[124:127], v[172:175], a[156:159], v[124:127]
ds_read_b64_tr_b16 v[190:191], v229 offset:14336
s_waitcnt vmcnt(11) lgkmcnt(4)
v_add_f32 v42, 1.0, v42
v_mfma_f32_16x16x32_bf16 v[64:67], v[176:179], a[160:163], v[64:67]
v_rcp_f32 v41, v41
v_mfma_f32_16x16x32_bf16 v[72:75], v[176:179], a[164:167], v[72:75]
ds_read_b64_tr_b16 v[160:161], v226 offset:16384
buffer_load_dwordx4 v237, s[76:79], s44 offen offset:3072 lds
v_mfma_f32_16x16x32_bf16 v[80:83], v[176:179], a[168:171], v[80:83]
v_exp_f32 v48, -v48
v_mfma_f32_16x16x32_bf16 v[88:91], v[176:179], a[172:175], v[88:91]
ds_read_b64_tr_b16 v[162:163], v226 offset:18432
s_add_u32 m0, s43, 12288
v_add_f32 v43, 1.0, v43
v_mfma_f32_16x16x32_bf16 v[68:71], v[180:183], a[160:163], v[68:71]
v_rcp_f32 v42, v42
v_mfma_f32_16x16x32_bf16 v[76:79], v[180:183], a[164:167], v[76:79]
ds_read_b64_tr_b16 v[164:165], v227 offset:16384
s_add_u32 s44, s50, 4424192
v_mfma_f32_16x16x32_bf16 v[84:87], v[180:183], a[168:171], v[84:87]
v_exp_f32 v49, -v49
v_mfma_f32_16x16x32_bf16 v[92:95], v[180:183], a[172:175], v[92:95]
ds_read_b64_tr_b16 v[166:167], v227 offset:18432
s_waitcnt lgkmcnt(4)
v_add_f32 v48, 1.0, v48
v_mfma_f32_16x16x32_bf16 v[96:99], v[184:187], a[160:163], v[96:99]
v_rcp_f32 v43, v43
v_mfma_f32_16x16x32_bf16 v[104:107], v[184:187], a[164:167], v[104:107]
ds_read_b64_tr_b16 v[168:169], v228 offset:16384
buffer_load_dwordx4 v234, s[76:79], s44 offen offset:0 lds
v_mfma_f32_16x16x32_bf16 v[112:115], v[184:187], a[168:171], v[112:115]
v_exp_f32 v50, -v50
v_mfma_f32_16x16x32_bf16 v[120:123], v[184:187], a[172:175], v[120:123]
ds_read_b64_tr_b16 v[170:171], v228 offset:18432
buffer_load_dwordx4 v235, s[76:79], s44 offen offset:1024 lds
v_add_f32 v49, 1.0, v49
v_mfma_f32_16x16x32_bf16 v[100:103], v[188:191], a[160:163], v[100:103]
v_rcp_f32 v48, v48
v_mfma_f32_16x16x32_bf16 v[108:111], v[188:191], a[164:167], v[108:111]
ds_read_b64_tr_b16 v[172:173], v229 offset:16384
buffer_load_dwordx4 v236, s[76:79], s44 offen offset:2048 lds
v_mfma_f32_16x16x32_bf16 v[116:119], v[188:191], a[168:171], v[116:119]
v_exp_f32 v51, -v51
v_mfma_f32_16x16x32_bf16 v[124:127], v[188:191], a[172:175], v[124:127]
ds_read_b64_tr_b16 v[174:175], v229 offset:18432
s_waitcnt vmcnt(11) lgkmcnt(4)
v_add_f32 v50, 1.0, v50
v_mfma_f32_16x16x32_bf16 v[64:67], v[160:163], a[176:179], v[64:67]
v_rcp_f32 v49, v49
v_mfma_f32_16x16x32_bf16 v[72:75], v[160:163], a[180:183], v[72:75]
ds_read_b64_tr_b16 v[176:177], v226 offset:0
buffer_load_dwordx4 v237, s[76:79], s44 offen offset:3072 lds
v_mfma_f32_16x16x32_bf16 v[80:83], v[160:163], a[184:187], v[80:83]
v_exp_f32 v56, -v56
v_mfma_f32_16x16x32_bf16 v[88:91], v[160:163], a[188:191], v[88:91]
ds_read_b64_tr_b16 v[178:179], v226 offset:2048
s_add_u32 m0, s43, 16384
v_add_f32 v51, 1.0, v51
v_mfma_f32_16x16x32_bf16 v[68:71], v[164:167], a[176:179], v[68:71]
v_rcp_f32 v50, v50
v_mfma_f32_16x16x32_bf16 v[76:79], v[164:167], a[180:183], v[76:79]
ds_read_b64_tr_b16 v[180:181], v227 offset:0
s_add_u32 s44, s50, 4719104
v_mfma_f32_16x16x32_bf16 v[84:87], v[164:167], a[184:187], v[84:87]
v_exp_f32 v57, -v57
v_mfma_f32_16x16x32_bf16 v[92:95], v[164:167], a[188:191], v[92:95]
ds_read_b64_tr_b16 v[182:183], v227 offset:2048
s_waitcnt lgkmcnt(4)
v_add_f32 v56, 1.0, v56
v_mfma_f32_16x16x32_bf16 v[96:99], v[168:171], a[176:179], v[96:99]
v_rcp_f32 v51, v51
v_mfma_f32_16x16x32_bf16 v[104:107], v[168:171], a[180:183], v[104:107]
ds_read_b64_tr_b16 v[184:185], v228 offset:0
buffer_load_dwordx4 v234, s[76:79], s44 offen offset:0 lds
v_mfma_f32_16x16x32_bf16 v[112:115], v[168:171], a[184:187], v[112:115]
v_exp_f32 v58, -v58
v_mfma_f32_16x16x32_bf16 v[120:123], v[168:171], a[188:191], v[120:123]
ds_read_b64_tr_b16 v[186:187], v228 offset:2048
buffer_load_dwordx4 v235, s[76:79], s44 offen offset:1024 lds
v_add_f32 v57, 1.0, v57
v_mfma_f32_16x16x32_bf16 v[100:103], v[172:175], a[176:179], v[100:103]
v_rcp_f32 v56, v56
v_mfma_f32_16x16x32_bf16 v[108:111], v[172:175], a[180:183], v[108:111]
ds_read_b64_tr_b16 v[188:189], v229 offset:0
buffer_load_dwordx4 v236, s[76:79], s44 offen offset:2048 lds
v_mfma_f32_16x16x32_bf16 v[116:119], v[172:175], a[184:187], v[116:119]
v_exp_f32 v59, -v59
v_mfma_f32_16x16x32_bf16 v[124:127], v[172:175], a[188:191], v[124:127]
ds_read_b64_tr_b16 v[190:191], v229 offset:2048
s_waitcnt vmcnt(11) lgkmcnt(4)
v_add_f32 v58, 1.0, v58
v_mfma_f32_16x16x32_bf16 v[64:67], v[176:179], a[192:195], v[64:67]
v_rcp_f32 v57, v57
v_mfma_f32_16x16x32_bf16 v[72:75], v[176:179], a[196:199], v[72:75]
ds_read_b64_tr_b16 v[160:161], v226 offset:4096
buffer_load_dwordx4 v237, s[76:79], s44 offen offset:3072 lds
v_mfma_f32_16x16x32_bf16 v[80:83], v[176:179], a[200:203], v[80:83]
v_exp_f32 v36, -v36
v_mfma_f32_16x16x32_bf16 v[88:91], v[176:179], a[204:207], v[88:91]
ds_read_b64_tr_b16 v[162:163], v226 offset:6144
s_add_u32 m0, s43, 0
v_add_f32 v59, 1.0, v59
v_mfma_f32_16x16x32_bf16 v[68:71], v[180:183], a[192:195], v[68:71]
v_rcp_f32 v58, v58
v_mfma_f32_16x16x32_bf16 v[76:79], v[180:183], a[196:199], v[76:79]
ds_read_b64_tr_b16 v[164:165], v227 offset:4096
s_add_u32 s44, s50, 5014016
v_mfma_f32_16x16x32_bf16 v[84:87], v[180:183], a[200:203], v[84:87]
v_exp_f32 v37, -v37
v_mfma_f32_16x16x32_bf16 v[92:95], v[180:183], a[204:207], v[92:95]
ds_read_b64_tr_b16 v[166:167], v227 offset:6144
s_waitcnt lgkmcnt(4)
v_add_f32 v36, 1.0, v36
v_mfma_f32_16x16x32_bf16 v[96:99], v[184:187], a[192:195], v[96:99]
v_rcp_f32 v59, v59
v_mfma_f32_16x16x32_bf16 v[104:107], v[184:187], a[196:199], v[104:107]
ds_read_b64_tr_b16 v[168:169], v228 offset:4096
buffer_load_dwordx4 v234, s[76:79], s44 offen offset:0 lds
v_mfma_f32_16x16x32_bf16 v[112:115], v[184:187], a[200:203], v[112:115]
v_exp_f32 v38, -v38
v_mfma_f32_16x16x32_bf16 v[120:123], v[184:187], a[204:207], v[120:123]
ds_read_b64_tr_b16 v[170:171], v228 offset:6144
buffer_load_dwordx4 v235, s[76:79], s44 offen offset:1024 lds
v_add_f32 v37, 1.0, v37
v_mfma_f32_16x16x32_bf16 v[100:103], v[188:191], a[192:195], v[100:103]
v_rcp_f32 v36, v36
v_mfma_f32_16x16x32_bf16 v[108:111], v[188:191], a[196:199], v[108:111]
ds_read_b64_tr_b16 v[172:173], v229 offset:4096
buffer_load_dwordx4 v236, s[76:79], s44 offen offset:2048 lds
v_mfma_f32_16x16x32_bf16 v[116:119], v[188:191], a[200:203], v[116:119]
v_exp_f32 v39, -v39
v_mfma_f32_16x16x32_bf16 v[124:127], v[188:191], a[204:207], v[124:127]
ds_read_b64_tr_b16 v[174:175], v229 offset:6144
s_waitcnt vmcnt(11) lgkmcnt(4)
v_add_f32 v38, 1.0, v38
v_mfma_f32_16x16x32_bf16 v[64:67], v[160:163], a[208:211], v[64:67]
v_rcp_f32 v37, v37
v_mfma_f32_16x16x32_bf16 v[72:75], v[160:163], a[212:215], v[72:75]
ds_read_b64_tr_b16 v[176:177], v226 offset:8192
buffer_load_dwordx4 v237, s[76:79], s44 offen offset:3072 lds
v_mfma_f32_16x16x32_bf16 v[80:83], v[160:163], a[216:219], v[80:83]
v_exp_f32 v44, -v44
v_mfma_f32_16x16x32_bf16 v[88:91], v[160:163], a[220:223], v[88:91]
ds_read_b64_tr_b16 v[178:179], v226 offset:10240
s_add_u32 m0, s43, 4096
v_add_f32 v39, 1.0, v39
v_mfma_f32_16x16x32_bf16 v[68:71], v[164:167], a[208:211], v[68:71]
v_rcp_f32 v38, v38
v_mfma_f32_16x16x32_bf16 v[76:79], v[164:167], a[212:215], v[76:79]
ds_read_b64_tr_b16 v[180:181], v227 offset:8192
s_add_u32 s44, s51, 0
v_mfma_f32_16x16x32_bf16 v[84:87], v[164:167], a[216:219], v[84:87]
v_exp_f32 v45, -v45
v_mfma_f32_16x16x32_bf16 v[92:95], v[164:167], a[220:223], v[92:95]
ds_read_b64_tr_b16 v[182:183], v227 offset:10240
s_waitcnt lgkmcnt(4)
v_add_f32 v44, 1.0, v44
v_mfma_f32_16x16x32_bf16 v[96:99], v[168:171], a[208:211], v[96:99]
v_rcp_f32 v39, v39
v_mfma_f32_16x16x32_bf16 v[104:107], v[168:171], a[212:215], v[104:107]
ds_read_b64_tr_b16 v[184:185], v228 offset:8192
buffer_load_dwordx4 v230, s[80:83], s44 offen offset:0 lds
v_mfma_f32_16x16x32_bf16 v[112:115], v[168:171], a[216:219], v[112:115]
v_exp_f32 v46, -v46
v_mfma_f32_16x16x32_bf16 v[120:123], v[168:171], a[220:223], v[120:123]
ds_read_b64_tr_b16 v[186:187], v228 offset:10240
buffer_load_dwordx4 v231, s[80:83], s44 offen offset:1024 lds
v_add_f32 v45, 1.0, v45
v_mfma_f32_16x16x32_bf16 v[100:103], v[172:175], a[208:211], v[100:103]
v_rcp_f32 v44, v44
v_mfma_f32_16x16x32_bf16 v[108:111], v[172:175], a[212:215], v[108:111]
ds_read_b64_tr_b16 v[188:189], v229 offset:8192
buffer_load_dwordx4 v232, s[80:83], s44 offen offset:2048 lds
v_mfma_f32_16x16x32_bf16 v[116:119], v[172:175], a[216:219], v[116:119]
v_exp_f32 v47, -v47
v_mfma_f32_16x16x32_bf16 v[124:127], v[172:175], a[220:223], v[124:127]
ds_read_b64_tr_b16 v[190:191], v229 offset:10240
s_waitcnt vmcnt(11) lgkmcnt(4)
v_add_f32 v46, 1.0, v46
v_mfma_f32_16x16x32_bf16 v[64:67], v[176:179], a[224:227], v[64:67]
v_rcp_f32 v45, v45
v_mfma_f32_16x16x32_bf16 v[72:75], v[176:179], a[228:231], v[72:75]
ds_read_b64_tr_b16 v[160:161], v226 offset:12288
buffer_load_dwordx4 v233, s[80:83], s44 offen offset:3072 lds
v_mfma_f32_16x16x32_bf16 v[80:83], v[176:179], a[232:235], v[80:83]
v_exp_f32 v52, -v52
v_mfma_f32_16x16x32_bf16 v[88:91], v[176:179], a[236:239], v[88:91]
ds_read_b64_tr_b16 v[162:163], v226 offset:14336
s_add_u32 m0, s43, 8192
v_add_f32 v47, 1.0, v47
v_mfma_f32_16x16x32_bf16 v[68:71], v[180:183], a[224:227], v[68:71]
v_rcp_f32 v46, v46
v_mfma_f32_16x16x32_bf16 v[76:79], v[180:183], a[228:231], v[76:79]
ds_read_b64_tr_b16 v[164:165], v227 offset:12288
s_add_u32 s44, s51, 36864
v_mfma_f32_16x16x32_bf16 v[84:87], v[180:183], a[232:235], v[84:87]
v_exp_f32 v53, -v53
v_mfma_f32_16x16x32_bf16 v[92:95], v[180:183], a[236:239], v[92:95]
ds_read_b64_tr_b16 v[166:167], v227 offset:14336
s_waitcnt lgkmcnt(4)
v_add_f32 v52, 1.0, v52
v_mfma_f32_16x16x32_bf16 v[96:99], v[184:187], a[224:227], v[96:99]
v_rcp_f32 v47, v47
v_mfma_f32_16x16x32_bf16 v[104:107], v[184:187], a[228:231], v[104:107]
ds_read_b64_tr_b16 v[168:169], v228 offset:12288
buffer_load_dwordx4 v230, s[80:83], s44 offen offset:0 lds
v_mfma_f32_16x16x32_bf16 v[112:115], v[184:187], a[232:235], v[112:115]
v_exp_f32 v54, -v54
v_mfma_f32_16x16x32_bf16 v[120:123], v[184:187], a[236:239], v[120:123]
ds_read_b64_tr_b16 v[170:171], v228 offset:14336
buffer_load_dwordx4 v231, s[80:83], s44 offen offset:1024 lds
v_add_f32 v53, 1.0, v53
v_mfma_f32_16x16x32_bf16 v[100:103], v[188:191], a[224:227], v[100:103]
v_rcp_f32 v52, v52
v_mfma_f32_16x16x32_bf16 v[108:111], v[188:191], a[228:231], v[108:111]
ds_read_b64_tr_b16 v[172:173], v229 offset:12288
buffer_load_dwordx4 v232, s[80:83], s44 offen offset:2048 lds
v_mfma_f32_16x16x32_bf16 v[116:119], v[188:191], a[232:235], v[116:119]
v_exp_f32 v55, -v55
v_mfma_f32_16x16x32_bf16 v[124:127], v[188:191], a[236:239], v[124:127]
ds_read_b64_tr_b16 v[174:175], v229 offset:14336
s_waitcnt vmcnt(7) lgkmcnt(4)
v_add_f32 v54, 1.0, v54
v_mfma_f32_16x16x32_bf16 v[64:67], v[160:163], a[240:243], v[64:67]
v_rcp_f32 v53, v53
v_mfma_f32_16x16x32_bf16 v[72:75], v[160:163], a[244:247], v[72:75]
ds_read_b64_tr_b16 v[176:177], v226 offset:16384
buffer_load_dwordx4 v233, s[80:83], s44 offen offset:3072 lds
v_mfma_f32_16x16x32_bf16 v[80:83], v[160:163], a[248:251], v[80:83]
v_exp_f32 v60, -v60
v_mfma_f32_16x16x32_bf16 v[88:91], v[160:163], a[252:255], v[88:91]
ds_read_b64_tr_b16 v[178:179], v226 offset:18432
s_add_u32 m0, s43, 12288
v_add_f32 v55, 1.0, v55
v_mfma_f32_16x16x32_bf16 v[68:71], v[164:167], a[240:243], v[68:71]
v_rcp_f32 v54, v54
v_mfma_f32_16x16x32_bf16 v[76:79], v[164:167], a[244:247], v[76:79]
ds_read_b64_tr_b16 v[180:181], v226 offset:0
s_add_u32 s44, s51, 73728
v_mfma_f32_16x16x32_bf16 v[84:87], v[164:167], a[248:251], v[84:87]
v_exp_f32 v61, -v61
v_mfma_f32_16x16x32_bf16 v[92:95], v[164:167], a[252:255], v[92:95]
ds_read_b64_tr_b16 v[182:183], v226 offset:2048
s_waitcnt lgkmcnt(4)
v_add_f32 v60, 1.0, v60
v_mfma_f32_16x16x32_bf16 v[96:99], v[168:171], a[240:243], v[96:99]
v_rcp_f32 v55, v55
v_mfma_f32_16x16x32_bf16 v[104:107], v[168:171], a[244:247], v[104:107]
ds_read_b64_tr_b16 v[184:185], v227 offset:16384
buffer_load_dwordx4 v230, s[80:83], s44 offen offset:0 lds
v_mfma_f32_16x16x32_bf16 v[112:115], v[168:171], a[248:251], v[112:115]
v_exp_f32 v62, -v62
v_mfma_f32_16x16x32_bf16 v[120:123], v[168:171], a[252:255], v[120:123]
ds_read_b64_tr_b16 v[186:187], v227 offset:18432
buffer_load_dwordx4 v231, s[80:83], s44 offen offset:1024 lds
v_add_f32 v61, 1.0, v61
v_mfma_f32_16x16x32_bf16 v[100:103], v[172:175], a[240:243], v[100:103]
v_rcp_f32 v60, v60
v_mfma_f32_16x16x32_bf16 v[108:111], v[172:175], a[244:247], v[108:111]
ds_read_b64_tr_b16 v[188:189], v227 offset:0
buffer_load_dwordx4 v232, s[80:83], s44 offen offset:2048 lds
v_mfma_f32_16x16x32_bf16 v[116:119], v[172:175], a[248:251], v[116:119]
v_exp_f32 v63, -v63
v_mfma_f32_16x16x32_bf16 v[124:127], v[172:175], a[252:255], v[124:127]
ds_read_b64_tr_b16 v[190:191], v227 offset:2048
s_waitcnt lgkmcnt(4)
v_add_f32 v62, 1.0, v62
v_mfma_f32_16x16x32_bf16 v[64:67], v[176:179], v[128:131], v[64:67]
v_rcp_f32 v61, v61
v_mfma_f32_16x16x32_bf16 v[72:75], v[176:179], v[132:135], v[72:75]
ds_read_b64_tr_b16 v[160:161], v228 offset:16384
buffer_load_dwordx4 v233, s[80:83], s44 offen offset:3072 lds
v_mfma_f32_16x16x32_bf16 v[80:83], v[176:179], v[136:139], v[80:83]
v_add_f32 v63, 1.0, v63
v_mfma_f32_16x16x32_bf16 v[88:91], v[176:179], v[140:143], v[88:91]
ds_read_b64_tr_b16 v[162:163], v228 offset:18432
v_rcp_f32 v62, v62
v_mfma_f32_16x16x32_bf16 v[64:67], v[180:183], v[144:147], v[64:67]
v_rcp_f32 v63, v63
v_mfma_f32_16x16x32_bf16 v[72:75], v[180:183], v[148:151], v[72:75]
ds_read_b64_tr_b16 v[164:165], v228 offset:0
v_mfma_f32_16x16x32_bf16 v[80:83], v[180:183], v[152:155], v[80:83]
v_mfma_f32_16x16x32_bf16 v[88:91], v[180:183], v[156:159], v[88:91]
ds_read_b64_tr_b16 v[166:167], v228 offset:2048
s_waitcnt lgkmcnt(4)
v_mfma_f32_16x16x32_bf16 v[68:71], v[184:187], v[128:131], v[68:71]
v_mfma_f32_16x16x32_bf16 v[76:79], v[184:187], v[132:135], v[76:79]
ds_read_b64_tr_b16 v[168:169], v229 offset:16384
v_mfma_f32_16x16x32_bf16 v[84:87], v[184:187], v[136:139], v[84:87]
v_mfma_f32_16x16x32_bf16 v[92:95], v[184:187], v[140:143], v[92:95]
ds_read_b64_tr_b16 v[170:171], v229 offset:18432
v_mfma_f32_16x16x32_bf16 v[68:71], v[188:191], v[144:147], v[68:71]
v_mul_f32 v64, v0, v64
v_mul_f32 v65, v1, v65
v_mul_f32 v66, v2, v66
v_mfma_f32_16x16x32_bf16 v[76:79], v[188:191], v[148:151], v[76:79]
ds_read_b64_tr_b16 v[172:173], v229 offset:0
v_mul_f32 v67, v3, v67
v_mul_f32 v72, v8, v72
v_mfma_f32_16x16x32_bf16 v[84:87], v[188:191], v[152:155], v[84:87]
v_mul_f32 v73, v9, v73
v_mul_f32 v74, v10, v74
v_mul_f32 v75, v11, v75
v_mfma_f32_16x16x32_bf16 v[92:95], v[188:191], v[156:159], v[92:95]
ds_read_b64_tr_b16 v[174:175], v229 offset:2048
s_waitcnt vmcnt(4) lgkmcnt(4)
v_mul_f32 v80, v16, v80
v_mfma_f32_16x16x32_bf16 v[96:99], v[160:163], v[128:131], v[96:99]
ds_read_b128 a[0:3], v238 offset:0
ds_read_b128 a[16:19], v238 offset:4096
v_mul_f32 v81, v17, v81
v_mfma_f32_16x16x32_bf16 v[104:107], v[160:163], v[132:135], v[104:107]
ds_read_b64_tr_b16 v[176:177], v226 offset:4096
v_mul_f32 v82, v18, v82
v_mul_f32 v83, v19, v83
v_mfma_f32_16x16x32_bf16 v[112:115], v[160:163], v[136:139], v[112:115]
ds_read_b128 a[4:7], v238 offset:1024
ds_read_b128 a[20:23], v238 offset:5120
v_mul_f32 v88, v24, v88
v_mfma_f32_16x16x32_bf16 v[120:123], v[160:163], v[140:143], v[120:123]
ds_read_b64_tr_b16 v[178:179], v226 offset:6144
s_add_u32 m0, s43, 16384
v_mul_f32 v89, v25, v89
v_mfma_f32_16x16x32_bf16 v[96:99], v[164:167], v[144:147], v[96:99]
ds_read_b128 a[8:11], v239 offset:0
ds_read_b128 a[24:27], v239 offset:4096
v_mul_f32 v90, v26, v90
v_mfma_f32_16x16x32_bf16 v[104:107], v[164:167], v[148:151], v[104:107]
ds_read_b64_tr_b16 v[180:181], v226 offset:8192
s_add_u32 s44, s51, 110592
v_mul_f32 v91, v27, v91
v_mfma_f32_16x16x32_bf16 v[112:115], v[164:167], v[152:155], v[112:115]
ds_read_b128 a[12:15], v239 offset:1024
ds_read_b128 a[28:31], v239 offset:5120
v_mfma_f32_16x16x32_bf16 v[120:123], v[164:167], v[156:159], v[120:123]
ds_read_b64_tr_b16 v[182:183], v226 offset:10240
s_waitcnt lgkmcnt(12)
v_mfma_f32_16x16x32_bf16 v[100:103], v[168:171], v[128:131], v[100:103]
v_mul_f32 v68, v4, v68
v_mul_f32 v69, v5, v69
v_mul_f32 v70, v6, v70
v_mfma_f32_16x16x32_bf16 v[108:111], v[168:171], v[132:135], v[108:111]
ds_read_b64_tr_b16 v[184:185], v227 offset:4096
buffer_load_dwordx4 v230, s[80:83], s44 offen offset:0 lds
v_mul_f32 v71, v7, v71
v_mfma_f32_16x16x32_bf16 v[116:119], v[168:171], v[136:139], v[116:119]
v_mul_f32 v76, v12, v76
v_mul_f32 v77, v13, v77
v_mul_f32 v78, v14, v78
v_mfma_f32_16x16x32_bf16 v[124:127], v[168:171], v[140:143], v[124:127]
ds_read_b64_tr_b16 v[186:187], v227 offset:6144
buffer_load_dwordx4 v231, s[80:83], s44 offen offset:1024 lds
v_mfma_f32_16x16x32_bf16 v[100:103], v[172:175], v[144:147], v[100:103]
v_mul_f32 v79, v15, v79
v_mul_f32 v84, v20, v84
v_mul_f32 v85, v21, v85
v_mfma_f32_16x16x32_bf16 v[108:111], v[172:175], v[148:151], v[108:111]
ds_read_b64_tr_b16 v[188:189], v227 offset:8192
buffer_load_dwordx4 v232, s[80:83], s44 offen offset:2048 lds
v_mul_f32 v86, v22, v86
v_mfma_f32_16x16x32_bf16 v[116:119], v[172:175], v[152:155], v[116:119]
v_mul_f32 v87, v23, v87
v_mul_f32 v92, v28, v92
v_mul_f32 v93, v29, v93
v_mfma_f32_16x16x32_bf16 v[124:127], v[172:175], v[156:159], v[124:127]
ds_read_b64_tr_b16 v[190:191], v227 offset:10240
s_waitcnt lgkmcnt(4)
v_mfma_f32_16x16x32_bf16 v[0:3], v[176:179], a[0:3], 0
v_mul_f32 v94, v30, v94
v_mul_f32 v95, v31, v95
v_mfma_f32_16x16x32_bf16 v[8:11], v[176:179], a[4:7], 0
ds_read_b64_tr_b16 v[160:161], v228 offset:4096
buffer_load_dwordx4 v233, s[80:83], s44 offen offset:3072 lds
v_mfma_f32_16x16x32_bf16 v[16:19], v[176:179], a[8:11], 0
s_add_u32 m0, s43, 0
s_add_u32 s44, s51, 147456
v_mfma_f32_16x16x32_bf16 v[24:27], v[176:179], a[12:15], 0
ds_read_b64_tr_b16 v[162:163], v228 offset:6144
buffer_load_dwordx4 v230, s[80:83], s44 offen offset:0 lds
v_mul_f32 v96, v32, v96
v_mfma_f32_16x16x32_bf16 v[0:3], v[180:183], a[16:19], v[0:3]
v_mul_f32 v97, v33, v97
v_mul_f32 v98, v34, v98
v_mul_f32 v99, v35, v99
v_mfma_f32_16x16x32_bf16 v[8:11], v[180:183], a[20:23], v[8:11]
ds_read_b64_tr_b16 v[164:165], v228 offset:8192
buffer_load_dwordx4 v231, s[80:83], s44 offen offset:1024 lds
v_mul_f32 v104, v40, v104
v_mfma_f32_16x16x32_bf16 v[16:19], v[180:183], a[24:27], v[16:19]
v_mul_f32 v105, v41, v105
v_mul_f32 v106, v42, v106
v_mfma_f32_16x16x32_bf16 v[24:27], v[180:183], a[28:31], v[24:27]
ds_read_b64_tr_b16 v[166:167], v228 offset:10240
s_waitcnt lgkmcnt(4)
v_mul_f32 v107, v43, v107
v_mfma_f32_16x16x32_bf16 v[4:7], v[184:187], a[0:3], 0
buffer_load_dwordx4 v232, s[80:83], s44 offen offset:2048 lds
v_mul_f32 v112, v48, v112
v_mul_f32 v113, v49, v113
v_mfma_f32_16x16x32_bf16 v[12:15], v[184:187], a[4:7], 0
ds_read_b64_tr_b16 v[168:169], v229 offset:4096
v_mul_f32 v114, v50, v114
v_mul_f32 v115, v51, v115
v_mfma_f32_16x16x32_bf16 v[20:23], v[184:187], a[8:11], 0
buffer_load_dwordx4 v233, s[80:83], s44 offen offset:3072 lds
v_mul_f32 v120, v56, v120
v_mfma_f32_16x16x32_bf16 v[28:31], v[184:187], a[12:15], 0
ds_read_b64_tr_b16 v[170:171], v229 offset:6144
v_mul_f32 v121, v57, v121
v_mul_f32 v122, v58, v122
v_mfma_f32_16x16x32_bf16 v[4:7], v[188:191], a[16:19], v[4:7]
v_mul_f32 v123, v59, v123
v_mfma_f32_16x16x32_bf16 v[12:15], v[188:191], a[20:23], v[12:15]
ds_read_b64_tr_b16 v[172:173], v229 offset:8192
v_mul_f32 v100, v36, v100
v_mfma_f32_16x16x32_bf16 v[20:23], v[188:191], a[24:27], v[20:23]
v_mul_f32 v101, v37, v101
v_mul_f32 v102, v38, v102
v_mul_f32 v103, v39, v103
v_mfma_f32_16x16x32_bf16 v[28:31], v[188:191], a[28:31], v[28:31]
ds_read_b64_tr_b16 v[174:175], v229 offset:10240
s_waitcnt vmcnt(8) lgkmcnt(4)
v_mul_f32 v108, v44, v108
v_mfma_f32_16x16x32_bf16 v[32:35], v[160:163], a[0:3], 0
ds_read_b128 a[32:35], v238 offset:8192
v_mul_f32 v109, v45, v109
v_mul_f32 v110, v46, v110
v_mfma_f32_16x16x32_bf16 v[40:43], v[160:163], a[4:7], 0
ds_read_b64_tr_b16 v[176:177], v226 offset:12288
v_mul_f32 v111, v47, v111
v_mfma_f32_16x16x32_bf16 v[48:51], v[160:163], a[8:11], 0
ds_read_b128 a[36:39], v238 offset:9216
v_mul_f32 v116, v52, v116
v_mul_f32 v117, v53, v117
v_mfma_f32_16x16x32_bf16 v[56:59], v[160:163], a[12:15], 0
ds_read_b64_tr_b16 v[178:179], v226 offset:14336
s_add_u32 m0, s43, 4096
v_mul_f32 v118, v54, v118
v_mfma_f32_16x16x32_bf16 v[32:35], v[164:167], a[16:19], v[32:35]
ds_read_b128 a[40:43], v239 offset:8192
v_mul_f32 v119, v55, v119
v_mul_f32 v124, v60, v124
v_mfma_f32_16x16x32_bf16 v[40:43], v[164:167], a[20:23], v[40:43]
ds_read_b64_tr_b16 v[180:181], v227 offset:12288
s_add_u32 s44, s51, 184320
v_mfma_f32_16x16x32_bf16 v[48:51], v[164:167], a[24:27], v[48:51]
ds_read_b128 a[44:47], v239 offset:9216
v_mul_f32 v125, v61, v125
v_mul_f32 v126, v62, v126
v_mfma_f32_16x16x32_bf16 v[56:59], v[164:167], a[28:31], v[56:59]
ds_read_b64_tr_b16 v[182:183], v227 offset:14336
s_waitcnt lgkmcnt(8)
v_mul_f32 v127, v63, v127
v_mfma_f32_16x16x32_bf16 v[36:39], v[168:171], a[0:3], 0
v_mfma_f32_16x16x32_bf16 v[44:47], v[168:171], a[4:7], 0
ds_read_b64_tr_b16 v[184:185], v228 offset:12288
buffer_load_dwordx4 v230, s[80:83], s44 offen offset:0 lds
v_mfma_f32_16x16x32_bf16 v[52:55], v[168:171], a[8:11], 0
v_cvt_pk_bf16_f32 v64, v64, v65
v_mfma_f32_16x16x32_bf16 v[60:63], v[168:171], a[12:15], 0
ds_read_b64_tr_b16 v[186:187], v228 offset:14336
buffer_load_dwordx4 v231, s[80:83], s44 offen offset:1024 lds
v_mfma_f32_16x16x32_bf16 v[36:39], v[172:175], a[16:19], v[36:39]
v_cvt_pk_bf16_f32 v65, v66, v67
v_mfma_f32_16x16x32_bf16 v[44:47], v[172:175], a[20:23], v[44:47]
ds_read_b64_tr_b16 v[188:189], v229 offset:12288
buffer_load_dwordx4 v232, s[80:83], s44 offen offset:2048 lds
v_mfma_f32_16x16x32_bf16 v[52:55], v[172:175], a[24:27], v[52:55]
v_mfma_f32_16x16x32_bf16 v[60:63], v[172:175], a[28:31], v[60:63]
ds_read_b64_tr_b16 v[190:191], v229 offset:14336
s_waitcnt vmcnt(7) lgkmcnt(4)
v_mfma_f32_16x16x32_bf16 v[0:3], v[176:179], a[32:35], v[0:3]
ds_read_b128 a[48:51], v238 offset:12288
v_cvt_pk_bf16_f32 v66, v68, v69
v_mfma_f32_16x16x32_bf16 v[8:11], v[176:179], a[36:39], v[8:11]
ds_read_b64_tr_b16 v[160:161], v226 offset:16384
buffer_load_dwordx4 v233, s[80:83], s44 offen offset:3072 lds
v_mfma_f32_16x16x32_bf16 v[16:19], v[176:179], a[40:43], v[16:19]
s_add_u32 m0, s43, 8192
ds_read_b128 a[52:55], v238 offset:13312
v_mfma_f32_16x16x32_bf16 v[24:27], v[176:179], a[44:47], v[24:27]
ds_read_b64_tr_b16 v[162:163], v226 offset:18432
s_add_u32 s44, s51, 221184
v_mfma_f32_16x16x32_bf16 v[4:7], v[180:183], a[32:35], v[4:7]
buffer_load_dwordx4 v230, s[80:83], s44 offen offset:0 lds
ds_read_b128 a[56:59], v239 offset:12288
v_mfma_f32_16x16x32_bf16 v[12:15], v[180:183], a[36:39], v[12:15]
ds_read_b64_tr_b16 v[164:165], v227 offset:16384
v_cvt_pk_bf16_f32 v67, v70, v71
v_mfma_f32_16x16x32_bf16 v[20:23], v[180:183], a[40:43], v[20:23]
buffer_load_dwordx4 v231, s[80:83], s44 offen offset:1024 lds
ds_read_b128 a[60:63], v239 offset:13312
v_mfma_f32_16x16x32_bf16 v[28:31], v[180:183], a[44:47], v[28:31]
ds_read_b64_tr_b16 v[166:167], v227 offset:18432
s_waitcnt lgkmcnt(8)
v_mfma_f32_16x16x32_bf16 v[32:35], v[184:187], a[32:35], v[32:35]
buffer_load_dwordx4 v232, s[80:83], s44 offen offset:2048 lds
ds_write_b128 v246, v[64:67] offset:32768
v_mfma_f32_16x16x32_bf16 v[40:43], v[184:187], a[36:39], v[40:43]
ds_read_b64_tr_b16 v[168:169], v228 offset:16384
v_cvt_pk_bf16_f32 v72, v72, v73
v_mfma_f32_16x16x32_bf16 v[48:51], v[184:187], a[40:43], v[48:51]
buffer_load_dwordx4 v233, s[80:83], s44 offen offset:3072 lds
s_add_u32 m0, s43, 12288
v_mfma_f32_16x16x32_bf16 v[56:59], v[184:187], a[44:47], v[56:59]
ds_read_b64_tr_b16 v[170:171], v228 offset:18432
s_add_u32 s44, s51, 258048
v_mfma_f32_16x16x32_bf16 v[36:39], v[188:191], a[32:35], v[36:39]
buffer_load_dwordx4 v230, s[80:83], s44 offen offset:0 lds
v_cvt_pk_bf16_f32 v73, v74, v75
v_mfma_f32_16x16x32_bf16 v[44:47], v[188:191], a[36:39], v[44:47]
ds_read_b64_tr_b16 v[172:173], v229 offset:16384
v_cvt_pk_bf16_f32 v74, v76, v77
v_mfma_f32_16x16x32_bf16 v[52:55], v[188:191], a[40:43], v[52:55]
buffer_load_dwordx4 v231, s[80:83], s44 offen offset:1024 lds
v_cvt_pk_bf16_f32 v75, v78, v79
v_mfma_f32_16x16x32_bf16 v[60:63], v[188:191], a[44:47], v[60:63]
ds_read_b64_tr_b16 v[174:175], v229 offset:18432
s_waitcnt vmcnt(10) lgkmcnt(5)
v_mfma_f32_16x16x32_bf16 v[0:3], v[160:163], a[48:51], v[0:3]
buffer_load_dwordx4 v232, s[80:83], s44 offen offset:2048 lds
ds_read_b128 a[64:67], v238 offset:16384
v_mfma_f32_16x16x32_bf16 v[8:11], v[160:163], a[52:55], v[8:11]
ds_read_b64_tr_b16 v[176:177], v226 offset:0
ds_write_b128 v246, v[72:75] offset:33792
v_mfma_f32_16x16x32_bf16 v[16:19], v[160:163], a[56:59], v[16:19]
ds_read_b128 a[68:71], v238 offset:17408
v_cvt_pk_bf16_f32 v80, v80, v81
v_mfma_f32_16x16x32_bf16 v[24:27], v[160:163], a[60:63], v[24:27]
ds_read_b64_tr_b16 v[178:179], v226 offset:2048
buffer_load_dwordx4 v233, s[80:83], s44 offen offset:3072 lds
v_mfma_f32_16x16x32_bf16 v[4:7], v[164:167], a[48:51], v[4:7]
ds_read_b128 a[72:75], v239 offset:16384
v_cvt_pk_bf16_f32 v81, v82, v83
v_mfma_f32_16x16x32_bf16 v[12:15], v[164:167], a[52:55], v[12:15]
ds_read_b64_tr_b16 v[180:181], v227 offset:0
s_add_u32 m0, s43, 16384
v_mfma_f32_16x16x32_bf16 v[20:23], v[164:167], a[56:59], v[20:23]
ds_read_b128 a[76:79], v239 offset:17408
v_cvt_pk_bf16_f32 v82, v84, v85
v_mfma_f32_16x16x32_bf16 v[28:31], v[164:167], a[60:63], v[28:31]
ds_read_b64_tr_b16 v[182:183], v227 offset:2048
s_waitcnt lgkmcnt(9)
v_mfma_f32_16x16x32_bf16 v[32:35], v[168:171], a[48:51], v[32:35]
s_add_u32 s44, s51, 589824
v_cvt_pk_bf16_f32 v83, v86, v87
v_mfma_f32_16x16x32_bf16 v[40:43], v[168:171], a[52:55], v[40:43]
ds_read_b64_tr_b16 v[184:185], v228 offset:0
buffer_load_dwordx4 v230, s[80:83], s44 offen offset:0 lds
v_mfma_f32_16x16x32_bf16 v[48:51], v[168:171], a[56:59], v[48:51]
ds_write_b128 v247, v[80:83] offset:32768
v_mfma_f32_16x16x32_bf16 v[56:59], v[168:171], a[60:63], v[56:59]
ds_read_b64_tr_b16 v[186:187], v228 offset:2048
buffer_load_dwordx4 v231, s[80:83], s44 offen offset:1024 lds
v_mfma_f32_16x16x32_bf16 v[36:39], v[172:175], a[48:51], v[36:39]
v_mfma_f32_16x16x32_bf16 v[44:47], v[172:175], a[52:55], v[44:47]
ds_read_b64_tr_b16 v[188:189], v229 offset:0
buffer_load_dwordx4 v232, s[80:83], s44 offen offset:2048 lds
v_mfma_f32_16x16x32_bf16 v[52:55], v[172:175], a[56:59], v[52:55]
v_cvt_pk_bf16_f32 v88, v88, v89
v_mfma_f32_16x16x32_bf16 v[60:63], v[172:175], a[60:63], v[60:63]
ds_read_b64_tr_b16 v[190:191], v229 offset:2048
s_waitcnt vmcnt(11) lgkmcnt(5)
v_mfma_f32_16x16x32_bf16 v[0:3], v[176:179], a[64:67], v[0:3]
ds_read_b128 a[80:83], v238 offset:20480
v_cvt_pk_bf16_f32 v89, v90, v91
v_mfma_f32_16x16x32_bf16 v[8:11], v[176:179], a[68:71], v[8:11]
ds_read_b64_tr_b16 v[160:161], v226 offset:4096
buffer_load_dwordx4 v233, s[80:83], s44 offen offset:3072 lds
v_mfma_f32_16x16x32_bf16 v[16:19], v[176:179], a[72:75], v[16:19]
ds_read_b128 a[84:87], v238 offset:21504
v_cvt_pk_bf16_f32 v90, v92, v93
v_mfma_f32_16x16x32_bf16 v[24:27], v[176:179], a[76:79], v[24:27]
ds_read_b64_tr_b16 v[162:163], v226 offset:6144
s_add_u32 m0, s43, 0
v_mfma_f32_16x16x32_bf16 v[4:7], v[180:183], a[64:67], v[4:7]
ds_read_b128 a[88:91], v239 offset:20480
v_cvt_pk_bf16_f32 v91, v94, v95
v_mfma_f32_16x16x32_bf16 v[12:15], v[180:183], a[68:71], v[12:15]
ds_read_b64_tr_b16 v[164:165], v227 offset:4096
s_add_u32 s44, s51, 626688
v_mfma_f32_16x16x32_bf16 v[20:23], v[180:183], a[72:75], v[20:23]
ds_write_b128 v247, v[88:91] offset:33792
ds_read_b128 a[92:95], v239 offset:21504
v_mfma_f32_16x16x32_bf16 v[28:31], v[180:183], a[76:79], v[28:31]
ds_read_b64_tr_b16 v[166:167], v227 offset:6144
s_waitcnt lgkmcnt(9)
v_mfma_f32_16x16x32_bf16 v[32:35], v[184:187], a[64:67], v[32:35]
v_mfma_f32_16x16x32_bf16 v[40:43], v[184:187], a[68:71], v[40:43]
ds_read_b64_tr_b16 v[168:169], v228 offset:4096
buffer_load_dwordx4 v230, s[80:83], s44 offen offset:0 lds
v_mfma_f32_16x16x32_bf16 v[48:51], v[184:187], a[72:75], v[48:51]
v_cvt_pk_bf16_f32 v96, v96, v97
v_mfma_f32_16x16x32_bf16 v[56:59], v[184:187], a[76:79], v[56:59]
ds_read_b64_tr_b16 v[170:171], v228 offset:6144
buffer_load_dwordx4 v231, s[80:83], s44 offen offset:1024 lds
v_mfma_f32_16x16x32_bf16 v[36:39], v[188:191], a[64:67], v[36:39]
v_cvt_pk_bf16_f32 v97, v98, v99
v_mfma_f32_16x16x32_bf16 v[44:47], v[188:191], a[68:71], v[44:47]
ds_read_b64_tr_b16 v[172:173], v229 offset:4096
buffer_load_dwordx4 v232, s[80:83], s44 offen offset:2048 lds
v_mfma_f32_16x16x32_bf16 v[52:55], v[188:191], a[72:75], v[52:55]
v_cvt_pk_bf16_f32 v98, v100, v101
v_mfma_f32_16x16x32_bf16 v[60:63], v[188:191], a[76:79], v[60:63]
ds_read_b64_tr_b16 v[174:175], v229 offset:6144
s_waitcnt vmcnt(11) lgkmcnt(4)
v_mfma_f32_16x16x32_bf16 v[0:3], v[160:163], a[80:83], v[0:3]
ds_read_b128 a[96:99], v238 offset:24576
v_cvt_pk_bf16_f32 v99, v102, v103
v_mfma_f32_16x16x32_bf16 v[8:11], v[160:163], a[84:87], v[8:11]
ds_read_b64_tr_b16 v[176:177], v226 offset:8192
buffer_load_dwordx4 v233, s[80:83], s44 offen offset:3072 lds
v_mfma_f32_16x16x32_bf16 v[16:19], v[160:163], a[88:91], v[16:19]
ds_write_b128 v246, v[96:99] offset:36864
ds_read_b128 a[100:103], v238 offset:25600
v_mfma_f32_16x16x32_bf16 v[24:27], v[160:163], a[92:95], v[24:27]
ds_read_b64_tr_b16 v[178:179], v226 offset:10240
s_add_u32 m0, s43, 4096
v_mfma_f32_16x16x32_bf16 v[4:7], v[164:167], a[80:83], v[4:7]
ds_read_b128 a[104:107], v239 offset:24576
v_cvt_pk_bf16_f32 v104, v104, v105
v_mfma_f32_16x16x32_bf16 v[12:15], v[164:167], a[84:87], v[12:15]
ds_read_b64_tr_b16 v[180:181], v227 offset:8192
s_add_u32 s44, s51, 294912
v_mfma_f32_16x16x32_bf16 v[20:23], v[164:167], a[88:91], v[20:23]
ds_read_b128 a[108:111], v239 offset:25600
v_mfma_f32_16x16x32_bf16 v[28:31], v[164:167], a[92:95], v[28:31]
ds_read_b64_tr_b16 v[182:183], v227 offset:10240
s_waitcnt lgkmcnt(9)
v_mfma_f32_16x16x32_bf16 v[32:35], v[168:171], a[80:83], v[32:35]
v_cvt_pk_bf16_f32 v105, v106, v107
v_mfma_f32_16x16x32_bf16 v[40:43], v[168:171], a[84:87], v[40:43]
ds_read_b64_tr_b16 v[184:185], v228 offset:8192
buffer_load_dwordx4 v230, s[80:83], s44 offen offset:0 lds
v_mfma_f32_16x16x32_bf16 v[48:51], v[168:171], a[88:91], v[48:51]
v_cvt_pk_bf16_f32 v106, v108, v109
v_mfma_f32_16x16x32_bf16 v[56:59], v[168:171], a[92:95], v[56:59]
ds_read_b64_tr_b16 v[186:187], v228 offset:10240
buffer_load_dwordx4 v231, s[80:83], s44 offen offset:1024 lds
v_mfma_f32_16x16x32_bf16 v[36:39], v[172:175], a[80:83], v[36:39]
v_cvt_pk_bf16_f32 v107, v110, v111
v_mfma_f32_16x16x32_bf16 v[44:47], v[172:175], a[84:87], v[44:47]
ds_read_b64_tr_b16 v[188:189], v229 offset:8192
buffer_load_dwordx4 v232, s[80:83], s44 offen offset:2048 lds
v_mfma_f32_16x16x32_bf16 v[52:55], v[172:175], a[88:91], v[52:55]
v_mfma_f32_16x16x32_bf16 v[60:63], v[172:175], a[92:95], v[60:63]
ds_read_b64_tr_b16 v[190:191], v229 offset:10240
s_waitcnt vmcnt(11) lgkmcnt(4)
v_mfma_f32_16x16x32_bf16 v[0:3], v[176:179], a[96:99], v[0:3]
ds_write_b128 v246, v[104:107] offset:37888
ds_read_b128 a[112:115], v238 offset:28672
v_mfma_f32_16x16x32_bf16 v[8:11], v[176:179], a[100:103], v[8:11]
ds_read_b64_tr_b16 v[160:161], v226 offset:12288
buffer_load_dwordx4 v233, s[80:83], s44 offen offset:3072 lds
v_mfma_f32_16x16x32_bf16 v[16:19], v[176:179], a[104:107], v[16:19]
ds_read_b128 a[116:119], v238 offset:29696
v_cvt_pk_bf16_f32 v112, v112, v113
v_mfma_f32_16x16x32_bf16 v[24:27], v[176:179], a[108:111], v[24:27]
ds_read_b64_tr_b16 v[162:163], v226 offset:14336
s_add_u32 m0, s43, 8192
v_mfma_f32_16x16x32_bf16 v[4:7], v[180:183], a[96:99], v[4:7]
ds_read_b128 a[120:123], v239 offset:28672
v_cvt_pk_bf16_f32 v113, v114, v115
v_mfma_f32_16x16x32_bf16 v[12:15], v[180:183], a[100:103], v[12:15]
ds_read_b64_tr_b16 v[164:165], v227 offset:12288
s_add_u32 s44, s51, 331776
v_mfma_f32_16x16x32_bf16 v[20:23], v[180:183], a[104:107], v[20:23]
ds_read_b128 a[124:127], v239 offset:29696
v_cvt_pk_bf16_f32 v114, v116, v117
v_mfma_f32_16x16x32_bf16 v[28:31], v[180:183], a[108:111], v[28:31]
ds_read_b64_tr_b16 v[166:167], v227 offset:14336
s_waitcnt lgkmcnt(9)
v_mfma_f32_16x16x32_bf16 v[32:35], v[184:187], a[96:99], v[32:35]
v_cvt_pk_bf16_f32 v115, v118, v119
v_mfma_f32_16x16x32_bf16 v[40:43], v[184:187], a[100:103], v[40:43]
ds_read_b64_tr_b16 v[168:169], v228 offset:12288
buffer_load_dwordx4 v230, s[80:83], s44 offen offset:0 lds
v_mfma_f32_16x16x32_bf16 v[48:51], v[184:187], a[104:107], v[48:51]
ds_write_b128 v247, v[112:115] offset:36864
v_mfma_f32_16x16x32_bf16 v[56:59], v[184:187], a[108:111], v[56:59]
ds_read_b64_tr_b16 v[170:171], v228 offset:14336
buffer_load_dwordx4 v231, s[80:83], s44 offen offset:1024 lds
v_mfma_f32_16x16x32_bf16 v[36:39], v[188:191], a[96:99], v[36:39]
v_cvt_pk_bf16_f32 v120, v120, v121
v_mfma_f32_16x16x32_bf16 v[44:47], v[188:191], a[100:103], v[44:47]
ds_read_b64_tr_b16 v[172:173], v229 offset:12288
buffer_load_dwordx4 v232, s[80:83], s44 offen offset:2048 lds
v_mfma_f32_16x16x32_bf16 v[52:55], v[188:191], a[104:107], v[52:55]
v_mfma_f32_16x16x32_bf16 v[60:63], v[188:191], a[108:111], v[60:63]
ds_read_b64_tr_b16 v[174:175], v229 offset:14336
s_waitcnt vmcnt(11) lgkmcnt(5)
v_mfma_f32_16x16x32_bf16 v[0:3], v[160:163], a[112:115], v[0:3]
ds_read_b128 a[128:131], v240 offset:0
v_cvt_pk_bf16_f32 v121, v122, v123
v_mfma_f32_16x16x32_bf16 v[8:11], v[160:163], a[116:119], v[8:11]
ds_read_b64_tr_b16 v[176:177], v226 offset:16384
buffer_load_dwordx4 v233, s[80:83], s44 offen offset:3072 lds
v_mfma_f32_16x16x32_bf16 v[16:19], v[160:163], a[120:123], v[16:19]
ds_read_b128 a[132:135], v240 offset:1024
v_cvt_pk_bf16_f32 v122, v124, v125
v_mfma_f32_16x16x32_bf16 v[24:27], v[160:163], a[124:127], v[24:27]
ds_read_b64_tr_b16 v[178:179], v226 offset:18432
s_add_u32 m0, s43, 12288
v_mfma_f32_16x16x32_bf16 v[4:7], v[164:167], a[112:115], v[4:7]
ds_read_b128 a[136:139], v241 offset:0
v_cvt_pk_bf16_f32 v123, v126, v127
v_mfma_f32_16x16x32_bf16 v[12:15], v[164:167], a[116:119], v[12:15]
ds_read_b64_tr_b16 v[180:181], v227 offset:16384
s_add_u32 s44, s51, 368640
v_mfma_f32_16x16x32_bf16 v[20:23], v[164:167], a[120:123], v[20:23]
ds_write_b128 v247, v[120:123] offset:37888
ds_read_b128 a[140:143], v241 offset:1024
v_mfma_f32_16x16x32_bf16 v[28:31], v[164:167], a[124:127], v[28:31]
ds_read_b64_tr_b16 v[182:183], v227 offset:18432
s_waitcnt lgkmcnt(9)
v_mfma_f32_16x16x32_bf16 v[32:35], v[168:171], a[112:115], v[32:35]
v_mfma_f32_16x16x32_bf16 v[40:43], v[168:171], a[116:119], v[40:43]
ds_read_b64_tr_b16 v[184:185], v228 offset:16384
buffer_load_dwordx4 v230, s[80:83], s44 offen offset:0 lds
v_mfma_f32_16x16x32_bf16 v[48:51], v[168:171], a[120:123], v[48:51]
v_mfma_f32_16x16x32_bf16 v[56:59], v[168:171], a[124:127], v[56:59]
ds_read_b64_tr_b16 v[186:187], v228 offset:18432
buffer_load_dwordx4 v231, s[80:83], s44 offen offset:1024 lds
v_mfma_f32_16x16x32_bf16 v[36:39], v[172:175], a[112:115], v[36:39]
v_mfma_f32_16x16x32_bf16 v[44:47], v[172:175], a[116:119], v[44:47]
ds_read_b64_tr_b16 v[188:189], v229 offset:16384
buffer_load_dwordx4 v232, s[80:83], s44 offen offset:2048 lds
v_mfma_f32_16x16x32_bf16 v[52:55], v[172:175], a[120:123], v[52:55]
v_mfma_f32_16x16x32_bf16 v[60:63], v[172:175], a[124:127], v[60:63]
ds_read_b64_tr_b16 v[190:191], v229 offset:18432
s_waitcnt vmcnt(11) lgkmcnt(4)
v_mfma_f32_16x16x32_bf16 v[0:3], v[176:179], a[128:131], v[0:3]
ds_read_b128 a[144:147], v240 offset:4096
v_mfma_f32_16x16x32_bf16 v[8:11], v[176:179], a[132:135], v[8:11]
ds_read_b64_tr_b16 v[160:161], v226 offset:0
buffer_load_dwordx4 v233, s[80:83], s44 offen offset:3072 lds
v_mfma_f32_16x16x32_bf16 v[16:19], v[176:179], a[136:139], v[16:19]
ds_read_b128 a[148:151], v240 offset:5120
v_mfma_f32_16x16x32_bf16 v[24:27], v[176:179], a[140:143], v[24:27]
ds_read_b64_tr_b16 v[162:163], v226 offset:2048
s_add_u32 m0, s43, 16384
v_mfma_f32_16x16x32_bf16 v[4:7], v[180:183], a[128:131], v[4:7]
ds_read_b128 a[152:155], v241 offset:4096
v_mfma_f32_16x16x32_bf16 v[12:15], v[180:183], a[132:135], v[12:15]
ds_read_b64_tr_b16 v[164:165], v227 offset:0
s_add_u32 s44, s51, 405504
v_mfma_f32_16x16x32_bf16 v[20:23], v[180:183], a[136:139], v[20:23]
ds_read_b128 a[156:159], v241 offset:5120
v_mfma_f32_16x16x32_bf16 v[28:31], v[180:183], a[140:143], v[28:31]
ds_read_b64_tr_b16 v[166:167], v227 offset:2048
s_waitcnt lgkmcnt(8)
v_mfma_f32_16x16x32_bf16 v[32:35], v[184:187], a[128:131], v[32:35]
v_mfma_f32_16x16x32_bf16 v[40:43], v[184:187], a[132:135], v[40:43]
ds_read_b64_tr_b16 v[168:169], v228 offset:0
buffer_load_dwordx4 v230, s[80:83], s44 offen offset:0 lds
v_mfma_f32_16x16x32_bf16 v[48:51], v[184:187], a[136:139], v[48:51]
v_mfma_f32_16x16x32_bf16 v[56:59], v[184:187], a[140:143], v[56:59]
ds_read_b64_tr_b16 v[170:171], v228 offset:2048
buffer_load_dwordx4 v231, s[80:83], s44 offen offset:1024 lds
v_mfma_f32_16x16x32_bf16 v[36:39], v[188:191], a[128:131], v[36:39]
v_mfma_f32_16x16x32_bf16 v[44:47], v[188:191], a[132:135], v[44:47]
ds_read_b64_tr_b16 v[172:173], v229 offset:0
buffer_load_dwordx4 v232, s[80:83], s44 offen offset:2048 lds
v_mfma_f32_16x16x32_bf16 v[52:55], v[188:191], a[136:139], v[52:55]
v_mfma_f32_16x16x32_bf16 v[60:63], v[188:191], a[140:143], v[60:63]
ds_read_b64_tr_b16 v[174:175], v229 offset:2048
s_waitcnt vmcnt(11) lgkmcnt(4)
s_barrier
v_mfma_f32_16x16x32_bf16 v[0:3], v[160:163], a[144:147], v[0:3]
ds_read_b128 a[160:163], v238 offset:32768
v_mfma_f32_16x16x32_bf16 v[8:11], v[160:163], a[148:151], v[8:11]
ds_read_b64_tr_b16 v[176:177], v226 offset:4096
buffer_load_dwordx4 v233, s[80:83], s44 offen offset:3072 lds
v_mfma_f32_16x16x32_bf16 v[16:19], v[160:163], a[152:155], v[16:19]
ds_read_b128 a[164:167], v238 offset:33792
v_mfma_f32_16x16x32_bf16 v[24:27], v[160:163], a[156:159], v[24:27]
ds_read_b64_tr_b16 v[178:179], v226 offset:6144
s_add_u32 m0, s43, 0
v_mfma_f32_16x16x32_bf16 v[4:7], v[164:167], a[144:147], v[4:7]
ds_read_b128 a[168:171], v239 offset:32768
v_mfma_f32_16x16x32_bf16 v[12:15], v[164:167], a[148:151], v[12:15]
ds_read_b64_tr_b16 v[180:181], v227 offset:4096
s_add_u32 s44, s51, 442368
v_mfma_f32_16x16x32_bf16 v[20:23], v[164:167], a[152:155], v[20:23]
ds_read_b128 a[172:175], v239 offset:33792
v_mfma_f32_16x16x32_bf16 v[28:31], v[164:167], a[156:159], v[28:31]
ds_read_b64_tr_b16 v[182:183], v227 offset:6144
s_waitcnt lgkmcnt(8)
v_mfma_f32_16x16x32_bf16 v[32:35], v[168:171], a[144:147], v[32:35]
v_mfma_f32_16x16x32_bf16 v[40:43], v[168:171], a[148:151], v[40:43]
ds_read_b64_tr_b16 v[184:185], v228 offset:4096
buffer_load_dwordx4 v230, s[80:83], s44 offen offset:0 lds
v_mfma_f32_16x16x32_bf16 v[48:51], v[168:171], a[152:155], v[48:51]
v_mfma_f32_16x16x32_bf16 v[56:59], v[168:171], a[156:159], v[56:59]
ds_read_b64_tr_b16 v[186:187], v228 offset:6144
buffer_load_dwordx4 v231, s[80:83], s44 offen offset:1024 lds
v_mfma_f32_16x16x32_bf16 v[36:39], v[172:175], a[144:147], v[36:39]
v_mfma_f32_16x16x32_bf16 v[44:47], v[172:175], a[148:151], v[44:47]
ds_read_b64_tr_b16 v[188:189], v229 offset:4096
buffer_load_dwordx4 v232, s[80:83], s44 offen offset:2048 lds
v_mfma_f32_16x16x32_bf16 v[52:55], v[172:175], a[152:155], v[52:55]
v_mfma_f32_16x16x32_bf16 v[60:63], v[172:175], a[156:159], v[60:63]
ds_read_b64_tr_b16 v[190:191], v229 offset:6144
s_waitcnt vmcnt(11) lgkmcnt(4)
v_mfma_f32_16x16x32_bf16 v[0:3], v[176:179], a[160:163], v[0:3]
ds_read_b128 a[176:179], v238 offset:36864
v_mfma_f32_16x16x32_bf16 v[8:11], v[176:179], a[164:167], v[8:11]
ds_read_b64_tr_b16 v[160:161], v226 offset:8192
buffer_load_dwordx4 v233, s[80:83], s44 offen offset:3072 lds
v_mfma_f32_16x16x32_bf16 v[16:19], v[176:179], a[168:171], v[16:19]
ds_read_b128 a[180:183], v238 offset:37888
v_mfma_f32_16x16x32_bf16 v[24:27], v[176:179], a[172:175], v[24:27]
ds_read_b64_tr_b16 v[162:163], v226 offset:10240
s_add_u32 m0, s43, 4096
v_mfma_f32_16x16x32_bf16 v[4:7], v[180:183], a[160:163], v[4:7]
ds_read_b128 a[184:187], v239 offset:36864
v_mfma_f32_16x16x32_bf16 v[12:15], v[180:183], a[164:167], v[12:15]
ds_read_b64_tr_b16 v[164:165], v227 offset:8192
s_add_u32 s44, s51, 479232
v_mfma_f32_16x16x32_bf16 v[20:23], v[180:183], a[168:171], v[20:23]
ds_read_b128 a[188:191], v239 offset:37888
v_mfma_f32_16x16x32_bf16 v[28:31], v[180:183], a[172:175], v[28:31]
ds_read_b64_tr_b16 v[166:167], v227 offset:10240
s_waitcnt lgkmcnt(8)
v_mfma_f32_16x16x32_bf16 v[32:35], v[184:187], a[160:163], v[32:35]
v_mfma_f32_16x16x32_bf16 v[40:43], v[184:187], a[164:167], v[40:43]
ds_read_b64_tr_b16 v[168:169], v228 offset:8192
buffer_load_dwordx4 v230, s[80:83], s44 offen offset:0 lds
v_mfma_f32_16x16x32_bf16 v[48:51], v[184:187], a[168:171], v[48:51]
v_mfma_f32_16x16x32_bf16 v[56:59], v[184:187], a[172:175], v[56:59]
ds_read_b64_tr_b16 v[170:171], v228 offset:10240
buffer_load_dwordx4 v231, s[80:83], s44 offen offset:1024 lds
v_mfma_f32_16x16x32_bf16 v[36:39], v[188:191], a[160:163], v[36:39]
v_mfma_f32_16x16x32_bf16 v[44:47], v[188:191], a[164:167], v[44:47]
ds_read_b64_tr_b16 v[172:173], v229 offset:8192
buffer_load_dwordx4 v232, s[80:83], s44 offen offset:2048 lds
v_mfma_f32_16x16x32_bf16 v[52:55], v[188:191], a[168:171], v[52:55]
v_mfma_f32_16x16x32_bf16 v[60:63], v[188:191], a[172:175], v[60:63]
ds_read_b64_tr_b16 v[174:175], v229 offset:10240
s_waitcnt vmcnt(11) lgkmcnt(4)
v_mfma_f32_16x16x32_bf16 v[0:3], v[160:163], a[176:179], v[0:3]
ds_read_b128 a[192:195], v238 offset:40960
v_mfma_f32_16x16x32_bf16 v[8:11], v[160:163], a[180:183], v[8:11]
ds_read_b64_tr_b16 v[176:177], v226 offset:12288
buffer_load_dwordx4 v233, s[80:83], s44 offen offset:3072 lds
v_mfma_f32_16x16x32_bf16 v[16:19], v[160:163], a[184:187], v[16:19]
ds_read_b128 a[196:199], v238 offset:41984
v_mfma_f32_16x16x32_bf16 v[24:27], v[160:163], a[188:191], v[24:27]
ds_read_b64_tr_b16 v[178:179], v226 offset:14336
s_add_u32 m0, s43, 8192
v_mfma_f32_16x16x32_bf16 v[4:7], v[164:167], a[176:179], v[4:7]
ds_read_b128 a[200:203], v239 offset:40960
v_mfma_f32_16x16x32_bf16 v[12:15], v[164:167], a[180:183], v[12:15]
ds_read_b64_tr_b16 v[180:181], v227 offset:12288
s_add_u32 s44, s51, 516096
v_mfma_f32_16x16x32_bf16 v[20:23], v[164:167], a[184:187], v[20:23]
ds_read_b128 a[204:207], v239 offset:41984
v_mfma_f32_16x16x32_bf16 v[28:31], v[164:167], a[188:191], v[28:31]
ds_read_b64_tr_b16 v[182:183], v227 offset:14336
s_waitcnt lgkmcnt(8)
v_mfma_f32_16x16x32_bf16 v[32:35], v[168:171], a[176:179], v[32:35]
v_mfma_f32_16x16x32_bf16 v[40:43], v[168:171], a[180:183], v[40:43]
ds_read_b64_tr_b16 v[184:185], v228 offset:12288
buffer_load_dwordx4 v230, s[80:83], s44 offen offset:0 lds
v_mfma_f32_16x16x32_bf16 v[48:51], v[168:171], a[184:187], v[48:51]
v_mfma_f32_16x16x32_bf16 v[56:59], v[168:171], a[188:191], v[56:59]
ds_read_b64_tr_b16 v[186:187], v228 offset:14336
buffer_load_dwordx4 v231, s[80:83], s44 offen offset:1024 lds
v_mfma_f32_16x16x32_bf16 v[36:39], v[172:175], a[176:179], v[36:39]
v_mfma_f32_16x16x32_bf16 v[44:47], v[172:175], a[180:183], v[44:47]
ds_read_b64_tr_b16 v[188:189], v229 offset:12288
buffer_load_dwordx4 v232, s[80:83], s44 offen offset:2048 lds
v_mfma_f32_16x16x32_bf16 v[52:55], v[172:175], a[184:187], v[52:55]
v_mfma_f32_16x16x32_bf16 v[60:63], v[172:175], a[188:191], v[60:63]
ds_read_b64_tr_b16 v[190:191], v229 offset:14336
s_waitcnt vmcnt(11) lgkmcnt(4)
v_mfma_f32_16x16x32_bf16 v[0:3], v[176:179], a[192:195], v[0:3]
ds_read_b128 a[208:211], v238 offset:45056
v_mfma_f32_16x16x32_bf16 v[8:11], v[176:179], a[196:199], v[8:11]
ds_read_b64_tr_b16 v[160:161], v226 offset:16384
buffer_load_dwordx4 v233, s[80:83], s44 offen offset:3072 lds
v_mfma_f32_16x16x32_bf16 v[16:19], v[176:179], a[200:203], v[16:19]
ds_read_b128 a[212:215], v238 offset:46080
v_mfma_f32_16x16x32_bf16 v[24:27], v[176:179], a[204:207], v[24:27]
ds_read_b64_tr_b16 v[162:163], v226 offset:18432
s_add_u32 m0, s43, 12288
v_mfma_f32_16x16x32_bf16 v[4:7], v[180:183], a[192:195], v[4:7]
ds_read_b128 a[216:219], v239 offset:45056
v_mfma_f32_16x16x32_bf16 v[12:15], v[180:183], a[196:199], v[12:15]
ds_read_b64_tr_b16 v[164:165], v227 offset:16384
s_add_u32 s44, s51, 552960
v_mfma_f32_16x16x32_bf16 v[20:23], v[180:183], a[200:203], v[20:23]
ds_read_b128 a[220:223], v239 offset:46080
v_mfma_f32_16x16x32_bf16 v[28:31], v[180:183], a[204:207], v[28:31]
ds_read_b64_tr_b16 v[166:167], v227 offset:18432
s_waitcnt lgkmcnt(8)
v_mfma_f32_16x16x32_bf16 v[32:35], v[184:187], a[192:195], v[32:35]
v_mfma_f32_16x16x32_bf16 v[40:43], v[184:187], a[196:199], v[40:43]
ds_read_b64_tr_b16 v[168:169], v228 offset:16384
buffer_load_dwordx4 v230, s[80:83], s44 offen offset:0 lds
v_mfma_f32_16x16x32_bf16 v[48:51], v[184:187], a[200:203], v[48:51]
v_mfma_f32_16x16x32_bf16 v[56:59], v[184:187], a[204:207], v[56:59]
ds_read_b64_tr_b16 v[170:171], v228 offset:18432
buffer_load_dwordx4 v231, s[80:83], s44 offen offset:1024 lds
v_mfma_f32_16x16x32_bf16 v[36:39], v[188:191], a[192:195], v[36:39]
v_mfma_f32_16x16x32_bf16 v[44:47], v[188:191], a[196:199], v[44:47]
ds_read_b64_tr_b16 v[172:173], v229 offset:16384
buffer_load_dwordx4 v232, s[80:83], s44 offen offset:2048 lds
v_mfma_f32_16x16x32_bf16 v[52:55], v[188:191], a[200:203], v[52:55]
v_mfma_f32_16x16x32_bf16 v[60:63], v[188:191], a[204:207], v[60:63]
ds_read_b64_tr_b16 v[174:175], v229 offset:18432
s_waitcnt vmcnt(11) lgkmcnt(4)
v_mfma_f32_16x16x32_bf16 v[0:3], v[160:163], a[208:211], v[0:3]
ds_read_b128 a[224:227], v238 offset:49152
v_mfma_f32_16x16x32_bf16 v[8:11], v[160:163], a[212:215], v[8:11]
ds_read_b64_tr_b16 v[176:177], v226 offset:0
buffer_load_dwordx4 v233, s[80:83], s44 offen offset:3072 lds
v_mfma_f32_16x16x32_bf16 v[16:19], v[160:163], a[216:219], v[16:19]
ds_read_b128 a[228:231], v238 offset:50176
v_mfma_f32_16x16x32_bf16 v[24:27], v[160:163], a[220:223], v[24:27]
ds_read_b64_tr_b16 v[178:179], v226 offset:2048
s_add_u32 m0, s43, 16384
v_mfma_f32_16x16x32_bf16 v[4:7], v[164:167], a[208:211], v[4:7]
ds_read_b128 a[232:235], v239 offset:49152
v_mfma_f32_16x16x32_bf16 v[12:15], v[164:167], a[212:215], v[12:15]
ds_read_b64_tr_b16 v[180:181], v227 offset:0
s_add_u32 s44, s51, 512
v_mfma_f32_16x16x32_bf16 v[20:23], v[164:167], a[216:219], v[20:23]
ds_read_b128 a[236:239], v239 offset:50176
v_mfma_f32_16x16x32_bf16 v[28:31], v[164:167], a[220:223], v[28:31]
ds_read_b64_tr_b16 v[182:183], v227 offset:2048
s_waitcnt lgkmcnt(8)
v_mfma_f32_16x16x32_bf16 v[32:35], v[168:171], a[208:211], v[32:35]
v_mfma_f32_16x16x32_bf16 v[40:43], v[168:171], a[212:215], v[40:43]
ds_read_b64_tr_b16 v[184:185], v228 offset:0
buffer_load_dwordx4 v230, s[80:83], s44 offen offset:0 lds
v_mfma_f32_16x16x32_bf16 v[48:51], v[168:171], a[216:219], v[48:51]
v_mfma_f32_16x16x32_bf16 v[56:59], v[168:171], a[220:223], v[56:59]
ds_read_b64_tr_b16 v[186:187], v228 offset:2048
buffer_load_dwordx4 v231, s[80:83], s44 offen offset:1024 lds
v_mfma_f32_16x16x32_bf16 v[36:39], v[172:175], a[208:211], v[36:39]
v_mfma_f32_16x16x32_bf16 v[44:47], v[172:175], a[212:215], v[44:47]
ds_read_b64_tr_b16 v[188:189], v229 offset:0
buffer_load_dwordx4 v232, s[80:83], s44 offen offset:2048 lds
v_mfma_f32_16x16x32_bf16 v[52:55], v[172:175], a[216:219], v[52:55]
v_mfma_f32_16x16x32_bf16 v[60:63], v[172:175], a[220:223], v[60:63]
ds_read_b64_tr_b16 v[190:191], v229 offset:2048
s_waitcnt vmcnt(11) lgkmcnt(4)
v_mfma_f32_16x16x32_bf16 v[0:3], v[176:179], a[224:227], v[0:3]
ds_read_b128 a[240:243], v238 offset:53248
v_mfma_f32_16x16x32_bf16 v[8:11], v[176:179], a[228:231], v[8:11]
ds_read_b64_tr_b16 v[160:161], v226 offset:4096
buffer_load_dwordx4 v233, s[80:83], s44 offen offset:3072 lds
v_mfma_f32_16x16x32_bf16 v[16:19], v[176:179], a[232:235], v[16:19]
ds_read_b128 a[244:247], v238 offset:54272
v_mfma_f32_16x16x32_bf16 v[24:27], v[176:179], a[236:239], v[24:27]
ds_read_b64_tr_b16 v[162:163], v226 offset:6144
s_add_u32 m0, s43, 0
v_mfma_f32_16x16x32_bf16 v[4:7], v[180:183], a[224:227], v[4:7]
ds_read_b128 a[248:251], v239 offset:53248
v_mfma_f32_16x16x32_bf16 v[12:15], v[180:183], a[228:231], v[12:15]
ds_read_b64_tr_b16 v[164:165], v227 offset:4096
s_add_u32 s44, s51, 37376
v_mfma_f32_16x16x32_bf16 v[20:23], v[180:183], a[232:235], v[20:23]
ds_read_b128 a[252:255], v239 offset:54272
v_mfma_f32_16x16x32_bf16 v[28:31], v[180:183], a[236:239], v[28:31]
ds_read_b64_tr_b16 v[166:167], v227 offset:6144
s_waitcnt lgkmcnt(8)
v_mfma_f32_16x16x32_bf16 v[32:35], v[184:187], a[224:227], v[32:35]
v_mfma_f32_16x16x32_bf16 v[40:43], v[184:187], a[228:231], v[40:43]
ds_read_b64_tr_b16 v[168:169], v228 offset:4096
buffer_load_dwordx4 v230, s[80:83], s44 offen offset:0 lds
v_mfma_f32_16x16x32_bf16 v[48:51], v[184:187], a[232:235], v[48:51]
v_mfma_f32_16x16x32_bf16 v[56:59], v[184:187], a[236:239], v[56:59]
ds_read_b64_tr_b16 v[170:171], v228 offset:6144
buffer_load_dwordx4 v231, s[80:83], s44 offen offset:1024 lds
v_mfma_f32_16x16x32_bf16 v[36:39], v[188:191], a[224:227], v[36:39]
v_mfma_f32_16x16x32_bf16 v[44:47], v[188:191], a[228:231], v[44:47]
ds_read_b64_tr_b16 v[172:173], v229 offset:4096
buffer_load_dwordx4 v232, s[80:83], s44 offen offset:2048 lds
v_mfma_f32_16x16x32_bf16 v[52:55], v[188:191], a[232:235], v[52:55]
v_mfma_f32_16x16x32_bf16 v[60:63], v[188:191], a[236:239], v[60:63]
ds_read_b64_tr_b16 v[174:175], v229 offset:6144
s_waitcnt vmcnt(11) lgkmcnt(4)
v_mfma_f32_16x16x32_bf16 v[0:3], v[160:163], a[240:243], v[0:3]
ds_read_b128 v[128:131], v238 offset:57344
v_mfma_f32_16x16x32_bf16 v[8:11], v[160:163], a[244:247], v[8:11]
ds_read_b64_tr_b16 v[176:177], v226 offset:8192
buffer_load_dwordx4 v233, s[80:83], s44 offen offset:3072 lds
v_mfma_f32_16x16x32_bf16 v[16:19], v[160:163], a[248:251], v[16:19]
ds_read_b128 v[132:135], v238 offset:58368
v_mfma_f32_16x16x32_bf16 v[24:27], v[160:163], a[252:255], v[24:27]
ds_read_b64_tr_b16 v[178:179], v226 offset:10240
s_add_u32 m0, s43, 4096
v_mfma_f32_16x16x32_bf16 v[4:7], v[164:167], a[240:243], v[4:7]
ds_read_b128 v[136:139], v239 offset:57344
v_mfma_f32_16x16x32_bf16 v[12:15], v[164:167], a[244:247], v[12:15]
ds_read_b64_tr_b16 v[180:181], v227 offset:8192
s_add_u32 s44, s51, 74240
v_mfma_f32_16x16x32_bf16 v[20:23], v[164:167], a[248:251], v[20:23]
ds_read_b128 v[140:143], v239 offset:58368
v_mfma_f32_16x16x32_bf16 v[28:31], v[164:167], a[252:255], v[28:31]
ds_read_b64_tr_b16 v[182:183], v227 offset:10240
s_waitcnt lgkmcnt(8)
v_mfma_f32_16x16x32_bf16 v[32:35], v[168:171], a[240:243], v[32:35]
v_and_b32 v244, 0x880, v238
v_mfma_f32_16x16x32_bf16 v[40:43], v[168:171], a[244:247], v[40:43]
ds_read_b64_tr_b16 v[184:185], v228 offset:8192
buffer_load_dwordx4 v230, s[80:83], s44 offen offset:0 lds
v_mfma_f32_16x16x32_bf16 v[48:51], v[168:171], a[248:251], v[48:51]
v_mfma_f32_16x16x32_bf16 v[56:59], v[168:171], a[252:255], v[56:59]
ds_read_b64_tr_b16 v[186:187], v228 offset:10240
buffer_load_dwordx4 v231, s[80:83], s44 offen offset:1024 lds
v_mfma_f32_16x16x32_bf16 v[36:39], v[172:175], a[240:243], v[36:39]
v_min_u32 v244, 1, v244
v_mfma_f32_16x16x32_bf16 v[44:47], v[172:175], a[244:247], v[44:47]
ds_read_b64_tr_b16 v[188:189], v229 offset:8192
buffer_load_dwordx4 v232, s[80:83], s44 offen offset:2048 lds
v_mfma_f32_16x16x32_bf16 v[52:55], v[172:175], a[248:251], v[52:55]
v_mfma_f32_16x16x32_bf16 v[60:63], v[172:175], a[252:255], v[60:63]
ds_read_b64_tr_b16 v[190:191], v229 offset:10240
s_waitcnt vmcnt(11) lgkmcnt(4)
v_mfma_f32_16x16x32_bf16 v[0:3], v[176:179], v[128:131], v[0:3]
ds_read_b128 v[144:147], v238 offset:61440
v_xor_b32 v244, 1, v244
v_mfma_f32_16x16x32_bf16 v[8:11], v[176:179], v[132:135], v[8:11]
ds_read_b64_tr_b16 v[160:161], v226 offset:12288
buffer_load_dwordx4 v233, s[80:83], s44 offen offset:3072 lds
v_mfma_f32_16x16x32_bf16 v[16:19], v[176:179], v[136:139], v[16:19]
ds_read_b128 v[148:151], v238 offset:62464
v_mfma_f32_16x16x32_bf16 v[24:27], v[176:179], v[140:143], v[24:27]
ds_read_b64_tr_b16 v[162:163], v226 offset:14336
s_add_u32 m0, s43, 8192
v_mfma_f32_16x16x32_bf16 v[4:7], v[180:183], v[128:131], v[4:7]
ds_read_b128 v[152:155], v239 offset:61440
v_lshl_add_u32 v244, v244, 30, v238
v_mfma_f32_16x16x32_bf16 v[12:15], v[180:183], v[132:135], v[12:15]
ds_read_b64_tr_b16 v[164:165], v227 offset:12288
s_add_u32 s44, s51, 111104
v_mfma_f32_16x16x32_bf16 v[20:23], v[180:183], v[136:139], v[20:23]
ds_read_b128 v[156:159], v239 offset:62464
v_mfma_f32_16x16x32_bf16 v[28:31], v[180:183], v[140:143], v[28:31]
ds_read_b64_tr_b16 v[166:167], v227 offset:14336
s_waitcnt lgkmcnt(8)
v_mfma_f32_16x16x32_bf16 v[32:35], v[184:187], v[128:131], v[32:35]
v_and_b32 v245, 0x880, v239
v_mfma_f32_16x16x32_bf16 v[40:43], v[184:187], v[132:135], v[40:43]
ds_read_b64_tr_b16 v[168:169], v228 offset:12288
buffer_load_dwordx4 v230, s[80:83], s44 offen offset:0 lds
v_mfma_f32_16x16x32_bf16 v[48:51], v[184:187], v[136:139], v[48:51]
v_min_u32 v245, 1, v245
v_mfma_f32_16x16x32_bf16 v[56:59], v[184:187], v[140:143], v[56:59]
ds_read_b64_tr_b16 v[170:171], v228 offset:14336
buffer_load_dwordx4 v231, s[80:83], s44 offen offset:1024 lds
v_mfma_f32_16x16x32_bf16 v[36:39], v[188:191], v[128:131], v[36:39]
v_mfma_f32_16x16x32_bf16 v[44:47], v[188:191], v[132:135], v[44:47]
ds_read_b64_tr_b16 v[172:173], v229 offset:12288
buffer_load_dwordx4 v232, s[80:83], s44 offen offset:2048 lds
v_mfma_f32_16x16x32_bf16 v[52:55], v[188:191], v[136:139], v[52:55]
v_xor_b32 v245, 1, v245
v_mfma_f32_16x16x32_bf16 v[60:63], v[188:191], v[140:143], v[60:63]
ds_read_b64_tr_b16 v[174:175], v229 offset:14336
s_waitcnt vmcnt(11) lgkmcnt(4)
v_mfma_f32_16x16x32_bf16 v[0:3], v[160:163], v[144:147], v[0:3]
v_mfma_f32_16x16x32_bf16 v[8:11], v[160:163], v[148:151], v[8:11]
ds_read_b64_tr_b16 v[176:177], v226 offset:16384
buffer_load_dwordx4 v233, s[80:83], s44 offen offset:3072 lds
v_mfma_f32_16x16x32_bf16 v[16:19], v[160:163], v[152:155], v[16:19]
v_lshl_add_u32 v245, v245, 30, v239
v_mfma_f32_16x16x32_bf16 v[24:27], v[160:163], v[156:159], v[24:27]
ds_read_b64_tr_b16 v[178:179], v226 offset:18432
s_add_u32 m0, s43, 12288
v_mfma_f32_16x16x32_bf16 v[4:7], v[164:167], v[144:147], v[4:7]
v_mfma_f32_16x16x32_bf16 v[12:15], v[164:167], v[148:151], v[12:15]
ds_read_b64_tr_b16 v[180:181], v227 offset:16384
s_add_u32 s44, s51, 147968
v_mfma_f32_16x16x32_bf16 v[20:23], v[164:167], v[152:155], v[20:23]
v_mfma_f32_16x16x32_bf16 v[28:31], v[164:167], v[156:159], v[28:31]
ds_read_b64_tr_b16 v[182:183], v227 offset:18432
s_waitcnt lgkmcnt(4)
v_mfma_f32_16x16x32_bf16 v[32:35], v[168:171], v[144:147], v[32:35]
v_mfma_f32_16x16x32_bf16 v[40:43], v[168:171], v[148:151], v[40:43]
ds_read_b64_tr_b16 v[184:185], v228 offset:16384
buffer_load_dwordx4 v230, s[80:83], s44 offen offset:0 lds
v_mfma_f32_16x16x32_bf16 v[48:51], v[168:171], v[152:155], v[48:51]
v_mfma_f32_16x16x32_bf16 v[56:59], v[168:171], v[156:159], v[56:59]
ds_read_b64_tr_b16 v[186:187], v228 offset:18432
buffer_load_dwordx4 v231, s[80:83], s44 offen offset:1024 lds
v_mfma_f32_16x16x32_bf16 v[36:39], v[172:175], v[144:147], v[36:39]
v_mfma_f32_16x16x32_bf16 v[44:47], v[172:175], v[148:151], v[44:47]
ds_read_b64_tr_b16 v[188:189], v229 offset:16384
buffer_load_dwordx4 v232, s[80:83], s44 offen offset:2048 lds
v_mfma_f32_16x16x32_bf16 v[52:55], v[172:175], v[152:155], v[52:55]
v_mfma_f32_16x16x32_bf16 v[60:63], v[172:175], v[156:159], v[60:63]
ds_read_b64_tr_b16 v[190:191], v229 offset:18432
s_waitcnt vmcnt(11) lgkmcnt(4)
v_mfma_f32_16x16x32_bf16 v[64:67], v[176:179], a[0:3], 0
s_barrier
v_mfma_f32_16x16x32_bf16 v[72:75], v[176:179], a[4:7], 0
ds_read_b64_tr_b16 v[160:161], v226 offset:0
buffer_load_dwordx4 v233, s[80:83], s44 offen offset:3072 lds
v_mfma_f32_16x16x32_bf16 v[80:83], v[176:179], a[8:11], 0
v_mfma_f32_16x16x32_bf16 v[88:91], v[176:179], a[12:15], 0
ds_read_b64_tr_b16 v[162:163], v226 offset:2048
s_add_u32 m0, s43, 16384
v_mfma_f32_16x16x32_bf16 v[68:71], v[180:183], a[0:3], 0
v_mfma_f32_16x16x32_bf16 v[76:79], v[180:183], a[4:7], 0
ds_read_b64_tr_b16 v[164:165], v227 offset:0
s_add_u32 s44, s51, 184832
v_mfma_f32_16x16x32_bf16 v[84:87], v[180:183], a[8:11], 0
v_mfma_f32_16x16x32_bf16 v[92:95], v[180:183], a[12:15], 0
ds_read_b64_tr_b16 v[166:167], v227 offset:2048
s_waitcnt lgkmcnt(4)
v_mfma_f32_16x16x32_bf16 v[96:99], v[184:187], a[0:3], 0
v_cvt_pk_bf16_f32 v0, v0, v1
v_mfma_f32_16x16x32_bf16 v[104:107], v[184:187], a[4:7], 0
ds_read_b64_tr_b16 v[168:169], v228 offset:0
buffer_load_dwordx4 v230, s[80:83], s44 offen offset:0 lds
v_mfma_f32_16x16x32_bf16 v[112:115], v[184:187], a[8:11], 0
v_cvt_pk_bf16_f32 v1, v2, v3
v_mfma_f32_16x16x32_bf16 v[120:123], v[184:187], a[12:15], 0
ds_read_b64_tr_b16 v[170:171], v228 offset:2048
buffer_load_dwordx4 v231, s[80:83], s44 offen offset:1024 lds
v_mfma_f32_16x16x32_bf16 v[100:103], v[188:191], a[0:3], 0
v_cvt_pk_bf16_f32 v2, v4, v5
v_cvt_pk_bf16_f32 v3, v6, v7
v_mfma_f32_16x16x32_bf16 v[108:111], v[188:191], a[4:7], 0
ds_read_b64_tr_b16 v[172:173], v229 offset:0
buffer_load_dwordx4 v232, s[80:83], s44 offen offset:2048 lds
v_mfma_f32_16x16x32_bf16 v[116:119], v[188:191], a[8:11], 0
buffer_store_dwordx4 v[0:3], v244, s[36:39], s60 offen offset:0 sc1
v_mfma_f32_16x16x32_bf16 v[124:127], v[188:191], a[12:15], 0
ds_read_b64_tr_b16 v[174:175], v229 offset:2048
s_waitcnt vmcnt(12) lgkmcnt(4)
v_mfma_f32_16x16x32_bf16 v[64:67], v[160:163], a[16:19], v[64:67]
v_mfma_f32_16x16x32_bf16 v[72:75], v[160:163], a[20:23], v[72:75]
ds_read_b64_tr_b16 v[176:177], v226 offset:4096
buffer_load_dwordx4 v233, s[80:83], s44 offen offset:3072 lds
v_mfma_f32_16x16x32_bf16 v[80:83], v[160:163], a[24:27], v[80:83]
v_mfma_f32_16x16x32_bf16 v[88:91], v[160:163], a[28:31], v[88:91]
ds_read_b64_tr_b16 v[178:179], v226 offset:6144
s_add_u32 m0, s43, 0
v_mfma_f32_16x16x32_bf16 v[68:71], v[164:167], a[16:19], v[68:71]
v_cvt_pk_bf16_f32 v8, v8, v9
v_cvt_pk_bf16_f32 v9, v10, v11
v_mfma_f32_16x16x32_bf16 v[76:79], v[164:167], a[20:23], v[76:79]
ds_read_b64_tr_b16 v[180:181], v227 offset:4096
s_add_u32 s44, s51, 221696
v_mfma_f32_16x16x32_bf16 v[84:87], v[164:167], a[24:27], v[84:87]
v_cvt_pk_bf16_f32 v10, v12, v13
v_mfma_f32_16x16x32_bf16 v[92:95], v[164:167], a[28:31], v[92:95]
ds_read_b64_tr_b16 v[182:183], v227 offset:6144
s_waitcnt lgkmcnt(4)
v_mfma_f32_16x16x32_bf16 v[96:99], v[168:171], a[16:19], v[96:99]
v_cvt_pk_bf16_f32 v11, v14, v15
v_mfma_f32_16x16x32_bf16 v[104:107], v[168:171], a[20:23], v[104:107]
ds_read_b64_tr_b16 v[184:185], v228 offset:4096
buffer_load_dwordx4 v230, s[80:83], s44 offen offset:0 lds
v_mfma_f32_16x16x32_bf16 v[112:115], v[168:171], a[24:27], v[112:115]
buffer_store_dwordx4 v[8:11], v238, s[36:39], s60 offen offset:1024 sc1
v_mfma_f32_16x16x32_bf16 v[120:123], v[168:171], a[28:31], v[120:123]
ds_read_b64_tr_b16 v[186:187], v228 offset:6144
buffer_load_dwordx4 v231, s[80:83], s44 offen offset:1024 lds
v_mfma_f32_16x16x32_bf16 v[100:103], v[172:175], a[16:19], v[100:103]
v_mfma_f32_16x16x32_bf16 v[108:111], v[172:175], a[20:23], v[108:111]
ds_read_b64_tr_b16 v[188:189], v229 offset:4096
buffer_load_dwordx4 v232, s[80:83], s44 offen offset:2048 lds
v_mfma_f32_16x16x32_bf16 v[116:119], v[172:175], a[24:27], v[116:119]
v_cvt_pk_bf16_f32 v16, v16, v17
v_mfma_f32_16x16x32_bf16 v[124:127], v[172:175], a[28:31], v[124:127]
ds_read_b64_tr_b16 v[190:191], v229 offset:6144
s_waitcnt vmcnt(13) lgkmcnt(4)
v_mfma_f32_16x16x32_bf16 v[64:67], v[176:179], a[32:35], v[64:67]
v_cvt_pk_bf16_f32 v17, v18, v19
v_mfma_f32_16x16x32_bf16 v[72:75], v[176:179], a[36:39], v[72:75]
ds_read_b64_tr_b16 v[160:161], v226 offset:8192
buffer_load_dwordx4 v233, s[80:83], s44 offen offset:3072 lds
v_mfma_f32_16x16x32_bf16 v[80:83], v[176:179], a[40:43], v[80:83]
v_cvt_pk_bf16_f32 v18, v20, v21
v_cvt_pk_bf16_f32 v19, v22, v23
v_mfma_f32_16x16x32_bf16 v[88:91], v[176:179], a[44:47], v[88:91]
ds_read_b64_tr_b16 v[162:163], v226 offset:10240
s_add_u32 m0, s43, 4096
v_mfma_f32_16x16x32_bf16 v[68:71], v[180:183], a[32:35], v[68:71]
buffer_store_dwordx4 v[16:19], v245, s[36:39], s60 offen offset:0 sc1
v_mfma_f32_16x16x32_bf16 v[76:79], v[180:183], a[36:39], v[76:79]
ds_read_b64_tr_b16 v[164:165], v227 offset:8192
s_add_u32 s44, s51, 258560
v_mfma_f32_16x16x32_bf16 v[84:87], v[180:183], a[40:43], v[84:87]
v_mfma_f32_16x16x32_bf16 v[92:95], v[180:183], a[44:47], v[92:95]
ds_read_b64_tr_b16 v[166:167], v227 offset:10240
s_waitcnt lgkmcnt(4)
v_mfma_f32_16x16x32_bf16 v[96:99], v[184:187], a[32:35], v[96:99]
v_mfma_f32_16x16x32_bf16 v[104:107], v[184:187], a[36:39], v[104:107]
ds_read_b64_tr_b16 v[168:169], v228 offset:8192
buffer_load_dwordx4 v230, s[80:83], s44 offen offset:0 lds
v_mfma_f32_16x16x32_bf16 v[112:115], v[184:187], a[40:43], v[112:115]
v_cvt_pk_bf16_f32 v24, v24, v25
v_cvt_pk_bf16_f32 v25, v26, v27
v_mfma_f32_16x16x32_bf16 v[120:123], v[184:187], a[44:47], v[120:123]
ds_read_b64_tr_b16 v[170:171], v228 offset:10240
buffer_load_dwordx4 v231, s[80:83], s44 offen offset:1024 lds
v_mfma_f32_16x16x32_bf16 v[100:103], v[188:191], a[32:35], v[100:103]
v_cvt_pk_bf16_f32 v26, v28, v29
v_mfma_f32_16x16x32_bf16 v[108:111], v[188:191], a[36:39], v[108:111]
ds_read_b64_tr_b16 v[172:173], v229 offset:8192
buffer_load_dwordx4 v232, s[80:83], s44 offen offset:2048 lds
v_mfma_f32_16x16x32_bf16 v[116:119], v[188:191], a[40:43], v[116:119]
v_cvt_pk_bf16_f32 v27, v30, v31
v_mfma_f32_16x16x32_bf16 v[124:127], v[188:191], a[44:47], v[124:127]
ds_read_b64_tr_b16 v[174:175], v229 offset:10240
s_waitcnt vmcnt(14) lgkmcnt(4)
v_mfma_f32_16x16x32_bf16 v[64:67], v[160:163], a[48:51], v[64:67]
buffer_store_dwordx4 v[24:27], v239, s[36:39], s60 offen offset:1024 sc1
v_mfma_f32_16x16x32_bf16 v[72:75], v[160:163], a[52:55], v[72:75]
ds_read_b64_tr_b16 v[176:177], v226 offset:12288
buffer_load_dwordx4 v233, s[80:83], s44 offen offset:3072 lds
v_mfma_f32_16x16x32_bf16 v[80:83], v[160:163], a[56:59], v[80:83]
v_mfma_f32_16x16x32_bf16 v[88:91], v[160:163], a[60:63], v[88:91]
ds_read_b64_tr_b16 v[178:179], v226 offset:14336
s_add_u32 m0, s43, 8192
v_mfma_f32_16x16x32_bf16 v[68:71], v[164:167], a[48:51], v[68:71]
v_cvt_pk_bf16_f32 v32, v32, v33
v_mfma_f32_16x16x32_bf16 v[76:79], v[164:167], a[52:55], v[76:79]
ds_read_b64_tr_b16 v[180:181], v227 offset:12288
s_add_u32 s44, s51, 590336
v_mfma_f32_16x16x32_bf16 v[84:87], v[164:167], a[56:59], v[84:87]
v_cvt_pk_bf16_f32 v33, v34, v35
v_mfma_f32_16x16x32_bf16 v[92:95], v[164:167], a[60:63], v[92:95]
ds_read_b64_tr_b16 v[182:183], v227 offset:14336
s_waitcnt lgkmcnt(4)
v_mfma_f32_16x16x32_bf16 v[96:99], v[168:171], a[48:51], v[96:99]
v_cvt_pk_bf16_f32 v34, v36, v37
v_cvt_pk_bf16_f32 v35, v38, v39
v_mfma_f32_16x16x32_bf16 v[104:107], v[168:171], a[52:55], v[104:107]
ds_read_b64_tr_b16 v[184:185], v228 offset:12288
buffer_load_dwordx4 v230, s[80:83], s44 offen offset:0 lds
v_mfma_f32_16x16x32_bf16 v[112:115], v[168:171], a[56:59], v[112:115]
buffer_store_dwordx4 v[32:35], v244, s[36:39], s61 offen offset:0 sc1
v_mfma_f32_16x16x32_bf16 v[120:123], v[168:171], a[60:63], v[120:123]
ds_read_b64_tr_b16 v[186:187], v228 offset:14336
buffer_load_dwordx4 v231, s[80:83], s44 offen offset:1024 lds
v_mfma_f32_16x16x32_bf16 v[100:103], v[172:175], a[48:51], v[100:103]
v_mfma_f32_16x16x32_bf16 v[108:111], v[172:175], a[52:55], v[108:111]
ds_read_b64_tr_b16 v[188:189], v229 offset:12288
buffer_load_dwordx4 v232, s[80:83], s44 offen offset:2048 lds
v_mfma_f32_16x16x32_bf16 v[116:119], v[172:175], a[56:59], v[116:119]
v_mfma_f32_16x16x32_bf16 v[124:127], v[172:175], a[60:63], v[124:127]
ds_read_b64_tr_b16 v[190:191], v229 offset:14336
s_waitcnt vmcnt(15) lgkmcnt(4)
v_mfma_f32_16x16x32_bf16 v[64:67], v[176:179], a[64:67], v[64:67]
v_cvt_pk_bf16_f32 v40, v40, v41
v_cvt_pk_bf16_f32 v41, v42, v43
v_mfma_f32_16x16x32_bf16 v[72:75], v[176:179], a[68:71], v[72:75]
ds_read_b64_tr_b16 v[160:161], v226 offset:16384
buffer_load_dwordx4 v233, s[80:83], s44 offen offset:3072 lds
v_mfma_f32_16x16x32_bf16 v[80:83], v[176:179], a[72:75], v[80:83]
v_cvt_pk_bf16_f32 v42, v44, v45
v_mfma_f32_16x16x32_bf16 v[88:91], v[176:179], a[76:79], v[88:91]
ds_read_b64_tr_b16 v[162:163], v226 offset:18432
s_add_u32 m0, s43, 12288
v_mfma_f32_16x16x32_bf16 v[68:71], v[180:183], a[64:67], v[68:71]
v_cvt_pk_bf16_f32 v43, v46, v47
v_mfma_f32_16x16x32_bf16 v[76:79], v[180:183], a[68:71], v[76:79]
ds_read_b64_tr_b16 v[164:165], v227 offset:16384
s_add_u32 s44, s51, 627200
v_mfma_f32_16x16x32_bf16 v[84:87], v[180:183], a[72:75], v[84:87]
buffer_store_dwordx4 v[40:43], v238, s[36:39], s61 offen offset:1024 sc1
v_mfma_f32_16x16x32_bf16 v[92:95], v[180:183], a[76:79], v[92:95]
ds_read_b64_tr_b16 v[166:167], v227 offset:18432
s_waitcnt lgkmcnt(4)
v_mfma_f32_16x16x32_bf16 v[96:99], v[184:187], a[64:67], v[96:99]
v_mfma_f32_16x16x32_bf16 v[104:107], v[184:187], a[68:71], v[104:107]
ds_read_b64_tr_b16 v[168:169], v228 offset:16384
buffer_load_dwordx4 v230, s[80:83], s44 offen offset:0 lds
v_mfma_f32_16x16x32_bf16 v[112:115], v[184:187], a[72:75], v[112:115]
v_cvt_pk_bf16_f32 v48, v48, v49
v_mfma_f32_16x16x32_bf16 v[120:123], v[184:187], a[76:79], v[120:123]
ds_read_b64_tr_b16 v[170:171], v228 offset:18432
buffer_load_dwordx4 v231, s[80:83], s44 offen offset:1024 lds
v_mfma_f32_16x16x32_bf16 v[100:103], v[188:191], a[64:67], v[100:103]
v_cvt_pk_bf16_f32 v49, v50, v51
v_mfma_f32_16x16x32_bf16 v[108:111], v[188:191], a[68:71], v[108:111]
ds_read_b64_tr_b16 v[172:173], v229 offset:16384
buffer_load_dwordx4 v232, s[80:83], s44 offen offset:2048 lds
v_mfma_f32_16x16x32_bf16 v[116:119], v[188:191], a[72:75], v[116:119]
v_cvt_pk_bf16_f32 v50, v52, v53
v_cvt_pk_bf16_f32 v51, v54, v55
v_mfma_f32_16x16x32_bf16 v[124:127], v[188:191], a[76:79], v[124:127]
ds_read_b64_tr_b16 v[174:175], v229 offset:18432
s_waitcnt vmcnt(15) lgkmcnt(4)
v_mfma_f32_16x16x32_bf16 v[64:67], v[160:163], a[80:83], v[64:67]
buffer_store_dwordx4 v[48:51], v245, s[36:39], s61 offen offset:0 sc1
v_mfma_f32_16x16x32_bf16 v[72:75], v[160:163], a[84:87], v[72:75]
ds_read_b64_tr_b16 v[176:177], v226 offset:0
buffer_load_dwordx4 v233, s[80:83], s44 offen offset:3072 lds
v_mfma_f32_16x16x32_bf16 v[80:83], v[160:163], a[88:91], v[80:83]
v_mfma_f32_16x16x32_bf16 v[88:91], v[160:163], a[92:95], v[88:91]
ds_read_b64_tr_b16 v[178:179], v226 offset:2048
s_add_u32 m0, s43, 16384
v_mfma_f32_16x16x32_bf16 v[68:71], v[164:167], a[80:83], v[68:71]
v_mfma_f32_16x16x32_bf16 v[76:79], v[164:167], a[84:87], v[76:79]
ds_read_b64_tr_b16 v[180:181], v227 offset:0
s_add_u32 s44, s51, 295424
v_mfma_f32_16x16x32_bf16 v[84:87], v[164:167], a[88:91], v[84:87]
v_cvt_pk_bf16_f32 v56, v56, v57
v_cvt_pk_bf16_f32 v57, v58, v59
v_mfma_f32_16x16x32_bf16 v[92:95], v[164:167], a[92:95], v[92:95]
ds_read_b64_tr_b16 v[182:183], v227 offset:2048
s_waitcnt lgkmcnt(4)
v_mfma_f32_16x16x32_bf16 v[96:99], v[168:171], a[80:83], v[96:99]
v_cvt_pk_bf16_f32 v58, v60, v61
v_mfma_f32_16x16x32_bf16 v[104:107], v[168:171], a[84:87], v[104:107]
ds_read_b64_tr_b16 v[184:185], v228 offset:0
buffer_load_dwordx4 v230, s[80:83], s44 offen offset:0 lds
v_mfma_f32_16x16x32_bf16 v[112:115], v[168:171], a[88:91], v[112:115]
v_cvt_pk_bf16_f32 v59, v62, v63
v_mfma_f32_16x16x32_bf16 v[120:123], v[168:171], a[92:95], v[120:123]
ds_read_b64_tr_b16 v[186:187], v228 offset:2048
buffer_load_dwordx4 v231, s[80:83], s44 offen offset:1024 lds
v_mfma_f32_16x16x32_bf16 v[100:103], v[172:175], a[80:83], v[100:103]
buffer_store_dwordx4 v[56:59], v239, s[36:39], s61 offen offset:1024 sc1
v_mfma_f32_16x16x32_bf16 v[108:111], v[172:175], a[84:87], v[108:111]
ds_read_b64_tr_b16 v[188:189], v229 offset:0
buffer_load_dwordx4 v232, s[80:83], s44 offen offset:2048 lds
v_mfma_f32_16x16x32_bf16 v[116:119], v[172:175], a[88:91], v[116:119]
v_mfma_f32_16x16x32_bf16 v[124:127], v[172:175], a[92:95], v[124:127]
ds_read_b64_tr_b16 v[190:191], v229 offset:2048
s_waitcnt vmcnt(15) lgkmcnt(4)
v_mfma_f32_16x16x32_bf16 v[64:67], v[176:179], a[96:99], v[64:67]
v_mfma_f32_16x16x32_bf16 v[72:75], v[176:179], a[100:103], v[72:75]
ds_read_b64_tr_b16 v[160:161], v226 offset:4096
buffer_load_dwordx4 v233, s[80:83], s44 offen offset:3072 lds
v_mfma_f32_16x16x32_bf16 v[80:83], v[176:179], a[104:107], v[80:83]
v_mfma_f32_16x16x32_bf16 v[88:91], v[176:179], a[108:111], v[88:91]
ds_read_b64_tr_b16 v[162:163], v226 offset:6144
s_add_u32 m0, s43, 0
v_mfma_f32_16x16x32_bf16 v[68:71], v[180:183], a[96:99], v[68:71]
v_mfma_f32_16x16x32_bf16 v[76:79], v[180:183], a[100:103], v[76:79]
ds_read_b64_tr_b16 v[164:165], v227 offset:4096
s_add_u32 s44, s51, 332288
v_mfma_f32_16x16x32_bf16 v[84:87], v[180:183], a[104:107], v[84:87]
v_mfma_f32_16x16x32_bf16 v[92:95], v[180:183], a[108:111], v[92:95]
ds_read_b64_tr_b16 v[166:167], v227 offset:6144
s_waitcnt lgkmcnt(4)
v_mfma_f32_16x16x32_bf16 v[96:99], v[184:187], a[96:99], v[96:99]
v_mfma_f32_16x16x32_bf16 v[104:107], v[184:187], a[100:103], v[104:107]
ds_read_b64_tr_b16 v[168:169], v228 offset:4096
buffer_load_dwordx4 v230, s[80:83], s44 offen offset:0 lds
v_mfma_f32_16x16x32_bf16 v[112:115], v[184:187], a[104:107], v[112:115]
v_mfma_f32_16x16x32_bf16 v[120:123], v[184:187], a[108:111], v[120:123]
ds_read_b64_tr_b16 v[170:171], v228 offset:6144
buffer_load_dwordx4 v231, s[80:83], s44 offen offset:1024 lds
v_mfma_f32_16x16x32_bf16 v[100:103], v[188:191], a[96:99], v[100:103]
v_mfma_f32_16x16x32_bf16 v[108:111], v[188:191], a[100:103], v[108:111]
ds_read_b64_tr_b16 v[172:173], v229 offset:4096
buffer_load_dwordx4 v232, s[80:83], s44 offen offset:2048 lds
v_mfma_f32_16x16x32_bf16 v[116:119], v[188:191], a[104:107], v[116:119]
v_mfma_f32_16x16x32_bf16 v[124:127], v[188:191], a[108:111], v[124:127]
ds_read_b64_tr_b16 v[174:175], v229 offset:6144
s_waitcnt vmcnt(14) lgkmcnt(4)
v_mfma_f32_16x16x32_bf16 v[64:67], v[160:163], a[112:115], v[64:67]
v_mfma_f32_16x16x32_bf16 v[72:75], v[160:163], a[116:119], v[72:75]
ds_read_b64_tr_b16 v[176:177], v226 offset:8192
buffer_load_dwordx4 v233, s[80:83], s44 offen offset:3072 lds
v_mfma_f32_16x16x32_bf16 v[80:83], v[160:163], a[120:123], v[80:83]
v_mfma_f32_16x16x32_bf16 v[88:91], v[160:163], a[124:127], v[88:91]
ds_read_b64_tr_b16 v[178:179], v226 offset:10240
s_add_u32 m0, s43, 4096
v_mfma_f32_16x16x32_bf16 v[68:71], v[164:167], a[112:115], v[68:71]
v_mfma_f32_16x16x32_bf16 v[76:79], v[164:167], a[116:119], v[76:79]
ds_read_b64_tr_b16 v[180:181], v227 offset:8192
s_add_u32 s44, s51, 369152
v_mfma_f32_16x16x32_bf16 v[84:87], v[164:167], a[120:123], v[84:87]
v_mfma_f32_16x16x32_bf16 v[92:95], v[164:167], a[124:127], v[92:95]
ds_read_b64_tr_b16 v[182:183], v227 offset:10240
s_waitcnt lgkmcnt(4)
v_mfma_f32_16x16x32_bf16 v[96:99], v[168:171], a[112:115], v[96:99]
v_mfma_f32_16x16x32_bf16 v[104:107], v[168:171], a[116:119], v[104:107]
ds_read_b64_tr_b16 v[184:185], v228 offset:8192
buffer_load_dwordx4 v230, s[80:83], s44 offen offset:0 lds
v_mfma_f32_16x16x32_bf16 v[112:115], v[168:171], a[120:123], v[112:115]
v_mfma_f32_16x16x32_bf16 v[120:123], v[168:171], a[124:127], v[120:123]
ds_read_b64_tr_b16 v[186:187], v228 offset:10240
buffer_load_dwordx4 v231, s[80:83], s44 offen offset:1024 lds
v_mfma_f32_16x16x32_bf16 v[100:103], v[172:175], a[112:115], v[100:103]
v_mfma_f32_16x16x32_bf16 v[108:111], v[172:175], a[116:119], v[108:111]
ds_read_b64_tr_b16 v[188:189], v229 offset:8192
buffer_load_dwordx4 v232, s[80:83], s44 offen offset:2048 lds
v_mfma_f32_16x16x32_bf16 v[116:119], v[172:175], a[120:123], v[116:119]
v_mfma_f32_16x16x32_bf16 v[124:127], v[172:175], a[124:127], v[124:127]
ds_read_b64_tr_b16 v[190:191], v229 offset:10240
s_waitcnt vmcnt(12) lgkmcnt(4)
v_mfma_f32_16x16x32_bf16 v[64:67], v[176:179], a[128:131], v[64:67]
v_mfma_f32_16x16x32_bf16 v[72:75], v[176:179], a[132:135], v[72:75]
ds_read_b64_tr_b16 v[160:161], v226 offset:12288
buffer_load_dwordx4 v233, s[80:83], s44 offen offset:3072 lds
v_mfma_f32_16x16x32_bf16 v[80:83], v[176:179], a[136:139], v[80:83]
v_mfma_f32_16x16x32_bf16 v[88:91], v[176:179], a[140:143], v[88:91]
ds_read_b64_tr_b16 v[162:163], v226 offset:14336
s_add_u32 m0, s43, 8192
v_mfma_f32_16x16x32_bf16 v[68:71], v[180:183], a[128:131], v[68:71]
v_mfma_f32_16x16x32_bf16 v[76:79], v[180:183], a[132:135], v[76:79]
ds_read_b64_tr_b16 v[164:165], v227 offset:12288
s_add_u32 s44, s51, 406016
v_mfma_f32_16x16x32_bf16 v[84:87], v[180:183], a[136:139], v[84:87]
v_mfma_f32_16x16x32_bf16 v[92:95], v[180:183], a[140:143], v[92:95]
ds_read_b64_tr_b16 v[166:167], v227 offset:14336
s_waitcnt lgkmcnt(4)
v_mfma_f32_16x16x32_bf16 v[96:99], v[184:187], a[128:131], v[96:99]
v_mfma_f32_16x16x32_bf16 v[104:107], v[184:187], a[132:135], v[104:107]
ds_read_b64_tr_b16 v[168:169], v228 offset:12288
buffer_load_dwordx4 v230, s[80:83], s44 offen offset:0 lds
v_mfma_f32_16x16x32_bf16 v[112:115], v[184:187], a[136:139], v[112:115]
v_mfma_f32_16x16x32_bf16 v[120:123], v[184:187], a[140:143], v[120:123]
ds_read_b64_tr_b16 v[170:171], v228 offset:14336
buffer_load_dwordx4 v231, s[80:83], s44 offen offset:1024 lds
v_mfma_f32_16x16x32_bf16 v[100:103], v[188:191], a[128:131], v[100:103]
v_mfma_f32_16x16x32_bf16 v[108:111], v[188:191], a[132:135], v[108:111]
ds_read_b64_tr_b16 v[172:173], v229 offset:12288
buffer_load_dwordx4 v232, s[80:83], s44 offen offset:2048 lds
v_mfma_f32_16x16x32_bf16 v[116:119], v[188:191], a[136:139], v[116:119]
v_mfma_f32_16x16x32_bf16 v[124:127], v[188:191], a[140:143], v[124:127]
ds_read_b64_tr_b16 v[174:175], v229 offset:14336
s_waitcnt vmcnt(11) lgkmcnt(4)
v_mfma_f32_16x16x32_bf16 v[64:67], v[160:163], a[144:147], v[64:67]
v_mfma_f32_16x16x32_bf16 v[72:75], v[160:163], a[148:151], v[72:75]
ds_read_b64_tr_b16 v[176:177], v226 offset:16384
buffer_load_dwordx4 v233, s[80:83], s44 offen offset:3072 lds
v_mfma_f32_16x16x32_bf16 v[80:83], v[160:163], a[152:155], v[80:83]
v_mfma_f32_16x16x32_bf16 v[88:91], v[160:163], a[156:159], v[88:91]
ds_read_b64_tr_b16 v[178:179], v226 offset:18432
s_add_u32 m0, s43, 12288
v_mfma_f32_16x16x32_bf16 v[68:71], v[164:167], a[144:147], v[68:71]
v_mfma_f32_16x16x32_bf16 v[76:79], v[164:167], a[148:151], v[76:79]
ds_read_b64_tr_b16 v[180:181], v227 offset:16384
s_add_u32 s44, s51, 442880
v_mfma_f32_16x16x32_bf16 v[84:87], v[164:167], a[152:155], v[84:87]
v_mfma_f32_16x16x32_bf16 v[92:95], v[164:167], a[156:159], v[92:95]
ds_read_b64_tr_b16 v[182:183], v227 offset:18432
s_waitcnt lgkmcnt(4)
v_mfma_f32_16x16x32_bf16 v[96:99], v[168:171], a[144:147], v[96:99]
v_mfma_f32_16x16x32_bf16 v[104:107], v[168:171], a[148:151], v[104:107]
ds_read_b64_tr_b16 v[184:185], v228 offset:16384
buffer_load_dwordx4 v230, s[80:83], s44 offen offset:0 lds
v_mfma_f32_16x16x32_bf16 v[112:115], v[168:171], a[152:155], v[112:115]
v_mfma_f32_16x16x32_bf16 v[120:123], v[168:171], a[156:159], v[120:123]
ds_read_b64_tr_b16 v[186:187], v228 offset:18432
buffer_load_dwordx4 v231, s[80:83], s44 offen offset:1024 lds
v_mfma_f32_16x16x32_bf16 v[100:103], v[172:175], a[144:147], v[100:103]
v_mfma_f32_16x16x32_bf16 v[108:111], v[172:175], a[148:151], v[108:111]
ds_read_b64_tr_b16 v[188:189], v229 offset:16384
buffer_load_dwordx4 v232, s[80:83], s44 offen offset:2048 lds
v_mfma_f32_16x16x32_bf16 v[116:119], v[172:175], a[152:155], v[116:119]
v_mfma_f32_16x16x32_bf16 v[124:127], v[172:175], a[156:159], v[124:127]
ds_read_b64_tr_b16 v[190:191], v229 offset:18432
s_waitcnt vmcnt(11) lgkmcnt(4)
v_mfma_f32_16x16x32_bf16 v[64:67], v[176:179], a[160:163], v[64:67]
v_mfma_f32_16x16x32_bf16 v[72:75], v[176:179], a[164:167], v[72:75]
ds_read_b64_tr_b16 v[160:161], v226 offset:0
buffer_load_dwordx4 v233, s[80:83], s44 offen offset:3072 lds
v_mfma_f32_16x16x32_bf16 v[80:83], v[176:179], a[168:171], v[80:83]
v_mfma_f32_16x16x32_bf16 v[88:91], v[176:179], a[172:175], v[88:91]
ds_read_b64_tr_b16 v[162:163], v226 offset:2048
s_add_u32 m0, s43, 16384
v_mfma_f32_16x16x32_bf16 v[68:71], v[180:183], a[160:163], v[68:71]
v_mfma_f32_16x16x32_bf16 v[76:79], v[180:183], a[164:167], v[76:79]
ds_read_b64_tr_b16 v[164:165], v227 offset:0
s_add_u32 s44, s51, 479744
v_mfma_f32_16x16x32_bf16 v[84:87], v[180:183], a[168:171], v[84:87]
v_mfma_f32_16x16x32_bf16 v[92:95], v[180:183], a[172:175], v[92:95]
ds_read_b64_tr_b16 v[166:167], v227 offset:2048
s_waitcnt lgkmcnt(4)
v_mfma_f32_16x16x32_bf16 v[96:99], v[184:187], a[160:163], v[96:99]
v_mfma_f32_16x16x32_bf16 v[104:107], v[184:187], a[164:167], v[104:107]
ds_read_b64_tr_b16 v[168:169], v228 offset:0
buffer_load_dwordx4 v230, s[80:83], s44 offen offset:0 lds
v_mfma_f32_16x16x32_bf16 v[112:115], v[184:187], a[168:171], v[112:115]
v_mfma_f32_16x16x32_bf16 v[120:123], v[184:187], a[172:175], v[120:123]
ds_read_b64_tr_b16 v[170:171], v228 offset:2048
buffer_load_dwordx4 v231, s[80:83], s44 offen offset:1024 lds
v_mfma_f32_16x16x32_bf16 v[100:103], v[188:191], a[160:163], v[100:103]
v_mfma_f32_16x16x32_bf16 v[108:111], v[188:191], a[164:167], v[108:111]
ds_read_b64_tr_b16 v[172:173], v229 offset:0
buffer_load_dwordx4 v232, s[80:83], s44 offen offset:2048 lds
v_mfma_f32_16x16x32_bf16 v[116:119], v[188:191], a[168:171], v[116:119]
v_mfma_f32_16x16x32_bf16 v[124:127], v[188:191], a[172:175], v[124:127]
ds_read_b64_tr_b16 v[174:175], v229 offset:2048
s_waitcnt vmcnt(11) lgkmcnt(4)
v_mfma_f32_16x16x32_bf16 v[64:67], v[160:163], a[176:179], v[64:67]
v_mfma_f32_16x16x32_bf16 v[72:75], v[160:163], a[180:183], v[72:75]
ds_read_b64_tr_b16 v[176:177], v226 offset:4096
buffer_load_dwordx4 v233, s[80:83], s44 offen offset:3072 lds
v_mfma_f32_16x16x32_bf16 v[80:83], v[160:163], a[184:187], v[80:83]
v_mfma_f32_16x16x32_bf16 v[88:91], v[160:163], a[188:191], v[88:91]
ds_read_b64_tr_b16 v[178:179], v226 offset:6144
s_add_u32 m0, s43, 0
v_mfma_f32_16x16x32_bf16 v[68:71], v[164:167], a[176:179], v[68:71]
v_mfma_f32_16x16x32_bf16 v[76:79], v[164:167], a[180:183], v[76:79]
ds_read_b64_tr_b16 v[180:181], v227 offset:4096
s_add_u32 s44, s51, 516608
v_mfma_f32_16x16x32_bf16 v[84:87], v[164:167], a[184:187], v[84:87]
v_mfma_f32_16x16x32_bf16 v[92:95], v[164:167], a[188:191], v[92:95]
ds_read_b64_tr_b16 v[182:183], v227 offset:6144
s_waitcnt lgkmcnt(4)
v_mfma_f32_16x16x32_bf16 v[96:99], v[168:171], a[176:179], v[96:99]
v_mfma_f32_16x16x32_bf16 v[104:107], v[168:171], a[180:183], v[104:107]
ds_read_b64_tr_b16 v[184:185], v228 offset:4096
buffer_load_dwordx4 v230, s[80:83], s44 offen offset:0 lds
v_mfma_f32_16x16x32_bf16 v[112:115], v[168:171], a[184:187], v[112:115]
v_mfma_f32_16x16x32_bf16 v[120:123], v[168:171], a[188:191], v[120:123]
ds_read_b64_tr_b16 v[186:187], v228 offset:6144
buffer_load_dwordx4 v231, s[80:83], s44 offen offset:1024 lds
v_mfma_f32_16x16x32_bf16 v[100:103], v[172:175], a[176:179], v[100:103]
v_mfma_f32_16x16x32_bf16 v[108:111], v[172:175], a[180:183], v[108:111]
ds_read_b64_tr_b16 v[188:189], v229 offset:4096
buffer_load_dwordx4 v232, s[80:83], s44 offen offset:2048 lds
v_mfma_f32_16x16x32_bf16 v[116:119], v[172:175], a[184:187], v[116:119]
v_mfma_f32_16x16x32_bf16 v[124:127], v[172:175], a[188:191], v[124:127]
ds_read_b64_tr_b16 v[190:191], v229 offset:6144
s_waitcnt vmcnt(11) lgkmcnt(4)
v_mfma_f32_16x16x32_bf16 v[64:67], v[176:179], a[192:195], v[64:67]
v_mfma_f32_16x16x32_bf16 v[72:75], v[176:179], a[196:199], v[72:75]
ds_read_b64_tr_b16 v[160:161], v226 offset:8192
buffer_load_dwordx4 v233, s[80:83], s44 offen offset:3072 lds
v_mfma_f32_16x16x32_bf16 v[80:83], v[176:179], a[200:203], v[80:83]
v_mfma_f32_16x16x32_bf16 v[88:91], v[176:179], a[204:207], v[88:91]
ds_read_b64_tr_b16 v[162:163], v226 offset:10240
s_add_u32 m0, s43, 4096
v_mfma_f32_16x16x32_bf16 v[68:71], v[180:183], a[192:195], v[68:71]
v_mfma_f32_16x16x32_bf16 v[76:79], v[180:183], a[196:199], v[76:79]
ds_read_b64_tr_b16 v[164:165], v227 offset:8192
s_add_u32 s44, s51, 553472
v_mfma_f32_16x16x32_bf16 v[84:87], v[180:183], a[200:203], v[84:87]
v_mfma_f32_16x16x32_bf16 v[92:95], v[180:183], a[204:207], v[92:95]
ds_read_b64_tr_b16 v[166:167], v227 offset:10240
s_waitcnt lgkmcnt(4)
v_mfma_f32_16x16x32_bf16 v[96:99], v[184:187], a[192:195], v[96:99]
v_mfma_f32_16x16x32_bf16 v[104:107], v[184:187], a[196:199], v[104:107]
ds_read_b64_tr_b16 v[168:169], v228 offset:8192
buffer_load_dwordx4 v230, s[80:83], s44 offen offset:0 lds
v_mfma_f32_16x16x32_bf16 v[112:115], v[184:187], a[200:203], v[112:115]
v_mfma_f32_16x16x32_bf16 v[120:123], v[184:187], a[204:207], v[120:123]
ds_read_b64_tr_b16 v[170:171], v228 offset:10240
buffer_load_dwordx4 v231, s[80:83], s44 offen offset:1024 lds
v_mfma_f32_16x16x32_bf16 v[100:103], v[188:191], a[192:195], v[100:103]
v_mfma_f32_16x16x32_bf16 v[108:111], v[188:191], a[196:199], v[108:111]
ds_read_b64_tr_b16 v[172:173], v229 offset:8192
buffer_load_dwordx4 v232, s[80:83], s44 offen offset:2048 lds
v_mfma_f32_16x16x32_bf16 v[116:119], v[188:191], a[200:203], v[116:119]
v_mfma_f32_16x16x32_bf16 v[124:127], v[188:191], a[204:207], v[124:127]
ds_read_b64_tr_b16 v[174:175], v229 offset:10240
s_waitcnt vmcnt(11) lgkmcnt(4)
v_mfma_f32_16x16x32_bf16 v[64:67], v[160:163], a[208:211], v[64:67]
v_mfma_f32_16x16x32_bf16 v[72:75], v[160:163], a[212:215], v[72:75]
ds_read_b64_tr_b16 v[176:177], v226 offset:12288
buffer_load_dwordx4 v233, s[80:83], s44 offen offset:3072 lds
v_mfma_f32_16x16x32_bf16 v[80:83], v[160:163], a[216:219], v[80:83]
s_add_u32 m0, s67, 0
s_add_u32 s44, s66, 0
v_mfma_f32_16x16x32_bf16 v[88:91], v[160:163], a[220:223], v[88:91]
ds_read_b64_tr_b16 v[178:179], v226 offset:14336
buffer_load_dwordx4 v230, s[80:83], s44 offen offset:0 lds
v_mfma_f32_16x16x32_bf16 v[68:71], v[164:167], a[208:211], v[68:71]
v_mfma_f32_16x16x32_bf16 v[76:79], v[164:167], a[212:215], v[76:79]
ds_read_b64_tr_b16 v[180:181], v227 offset:12288
buffer_load_dwordx4 v231, s[80:83], s44 offen offset:1024 lds
v_mfma_f32_16x16x32_bf16 v[84:87], v[164:167], a[216:219], v[84:87]
v_mfma_f32_16x16x32_bf16 v[92:95], v[164:167], a[220:223], v[92:95]
ds_read_b64_tr_b16 v[182:183], v227 offset:14336
s_waitcnt lgkmcnt(4)
v_mfma_f32_16x16x32_bf16 v[96:99], v[168:171], a[208:211], v[96:99]
buffer_load_dwordx4 v232, s[80:83], s44 offen offset:2048 lds
v_mfma_f32_16x16x32_bf16 v[104:107], v[168:171], a[212:215], v[104:107]
ds_read_b64_tr_b16 v[184:185], v228 offset:12288
v_mfma_f32_16x16x32_bf16 v[112:115], v[168:171], a[216:219], v[112:115]
buffer_load_dwordx4 v233, s[80:83], s44 offen offset:3072 lds
s_add_u32 m0, s67, 16384
v_mfma_f32_16x16x32_bf16 v[120:123], v[168:171], a[220:223], v[120:123]
ds_read_b64_tr_b16 v[186:187], v228 offset:14336
s_add_u32 s44, s66, 147456
v_mfma_f32_16x16x32_bf16 v[100:103], v[172:175], a[208:211], v[100:103]
buffer_load_dwordx4 v230, s[80:83], s44 offen offset:0 lds
v_mfma_f32_16x16x32_bf16 v[108:111], v[172:175], a[212:215], v[108:111]
ds_read_b64_tr_b16 v[188:189], v229 offset:12288
v_mfma_f32_16x16x32_bf16 v[116:119], v[172:175], a[216:219], v[116:119]
buffer_load_dwordx4 v231, s[80:83], s44 offen offset:1024 lds
v_mfma_f32_16x16x32_bf16 v[124:127], v[172:175], a[220:223], v[124:127]
ds_read_b64_tr_b16 v[190:191], v229 offset:14336
s_waitcnt vmcnt(14) lgkmcnt(4)
v_mfma_f32_16x16x32_bf16 v[64:67], v[176:179], a[224:227], v[64:67]
buffer_load_dwordx4 v232, s[80:83], s44 offen offset:2048 lds
v_mfma_f32_16x16x32_bf16 v[72:75], v[176:179], a[228:231], v[72:75]
ds_read_b64_tr_b16 v[160:161], v226 offset:16384
v_mfma_f32_16x16x32_bf16 v[80:83], v[176:179], a[232:235], v[80:83]
buffer_load_dwordx4 v233, s[80:83], s44 offen offset:3072 lds
s_add_u32 m0, s67, 32768
v_mfma_f32_16x16x32_bf16 v[88:91], v[176:179], a[236:239], v[88:91]
ds_read_b64_tr_b16 v[162:163], v226 offset:18432
s_barrier
v_mfma_f32_16x16x32_bf16 v[68:71], v[180:183], a[224:227], v[68:71]
buffer_store_dword v255, v254, s[36:39], s53 offen offset:2048 sc1
s_add_u32 s44, s66, 294912
v_mfma_f32_16x16x32_bf16 v[76:79], v[180:183], a[228:231], v[76:79]
ds_read_b64_tr_b16 v[164:165], v227 offset:16384
buffer_load_dwordx4 v230, s[80:83], s44 offen offset:0 lds
v_mfma_f32_16x16x32_bf16 v[84:87], v[180:183], a[232:235], v[84:87]
v_mfma_f32_16x16x32_bf16 v[92:95], v[180:183], a[236:239], v[92:95]
ds_read_b64_tr_b16 v[166:167], v227 offset:18432
s_waitcnt lgkmcnt(4)
v_mfma_f32_16x16x32_bf16 v[96:99], v[184:187], a[224:227], v[96:99]
buffer_load_dwordx4 v231, s[80:83], s44 offen offset:1024 lds
s_bitcmp1_b32 s40, 0
s_cselect_b64 vcc, -1, 0
v_mfma_f32_16x16x32_bf16 v[104:107], v[184:187], a[228:231], v[104:107]
ds_read_b64_tr_b16 v[168:169], v228 offset:16384
v_cndmask_b32 v0, v0, v16, vcc
v_mfma_f32_16x16x32_bf16 v[112:115], v[184:187], a[232:235], v[112:115]
buffer_load_dwordx4 v232, s[80:83], s44 offen offset:2048 lds
v_mfma_f32_16x16x32_bf16 v[120:123], v[184:187], a[236:239], v[120:123]
ds_read_b64_tr_b16 v[170:171], v228 offset:18432
v_cndmask_b32 v1, v1, v17, vcc
v_mfma_f32_16x16x32_bf16 v[100:103], v[188:191], a[224:227], v[100:103]
buffer_load_dwordx4 v233, s[80:83], s44 offen offset:3072 lds
s_add_u32 m0, s67, 49152
v_mfma_f32_16x16x32_bf16 v[108:111], v[188:191], a[228:231], v[108:111]
ds_read_b64_tr_b16 v[172:173], v229 offset:16384
s_add_u32 s44, s66, 442368
v_mfma_f32_16x16x32_bf16 v[116:119], v[188:191], a[232:235], v[116:119]
buffer_load_dwordx4 v230, s[80:83], s44 offen offset:0 lds
v_cndmask_b32 v2, v2, v18, vcc
v_mfma_f32_16x16x32_bf16 v[124:127], v[188:191], a[236:239], v[124:127]
ds_read_b64_tr_b16 v[174:175], v229 offset:18432
s_waitcnt vmcnt(18) lgkmcnt(4)
v_mfma_f32_16x16x32_bf16 v[64:67], v[160:163], a[240:243], v[64:67]
buffer_load_dwordx4 v231, s[80:83], s44 offen offset:1024 lds
v_mfma_f32_16x16x32_bf16 v[72:75], v[160:163], a[244:247], v[72:75]
ds_read_b64_tr_b16 v[176:177], v226 offset:0
v_cndmask_b32 v3, v3, v19, vcc
v_mfma_f32_16x16x32_bf16 v[80:83], v[160:163], a[248:251], v[80:83]
buffer_load_dwordx4 v232, s[80:83], s44 offen offset:2048 lds
v_mfma_f32_16x16x32_bf16 v[88:91], v[160:163], a[252:255], v[88:91]
ds_read_b64_tr_b16 v[178:179], v226 offset:2048
v_mfma_f32_16x16x32_bf16 v[68:71], v[164:167], a[240:243], v[68:71]
buffer_load_dwordx4 v233, s[80:83], s44 offen offset:3072 lds
s_add_u32 m0, s69, 65536
v_mfma_f32_16x16x32_bf16 v[76:79], v[164:167], a[244:247], v[76:79]
ds_read_b64_tr_b16 v[180:181], v227 offset:0
s_add_u32 s44, s68, 589824
v_mfma_f32_16x16x32_bf16 v[84:87], v[164:167], a[248:251], v[84:87]
buffer_load_dwordx4 v230, s[80:83], s44 offen offset:0 lds
v_cndmask_b32 v32, v32, v48, vcc
v_mfma_f32_16x16x32_bf16 v[92:95], v[164:167], a[252:255], v[92:95]
ds_read_b64_tr_b16 v[182:183], v227 offset:2048
s_waitcnt lgkmcnt(4)
v_mfma_f32_16x16x32_bf16 v[96:99], v[168:171], a[240:243], v[96:99]
buffer_load_dwordx4 v231, s[80:83], s44 offen offset:1024 lds
v_cndmask_b32 v33, v33, v49, vcc
v_mfma_f32_16x16x32_bf16 v[104:107], v[168:171], a[244:247], v[104:107]
ds_read_b64_tr_b16 v[184:185], v228 offset:0
v_mfma_f32_16x16x32_bf16 v[112:115], v[168:171], a[248:251], v[112:115]
v_mfma_f32_16x16x32_bf16 v[120:123], v[168:171], a[252:255], v[120:123]
ds_read_b64_tr_b16 v[186:187], v228 offset:2048
v_cndmask_b32 v34, v34, v50, vcc
v_mfma_f32_16x16x32_bf16 v[100:103], v[172:175], a[240:243], v[100:103]
v_mfma_f32_16x16x32_bf16 v[108:111], v[172:175], a[244:247], v[108:111]
ds_read_b64_tr_b16 v[188:189], v229 offset:0
v_cndmask_b32 v35, v35, v51, vcc
v_mfma_f32_16x16x32_bf16 v[116:119], v[172:175], a[248:251], v[116:119]
v_mfma_f32_16x16x32_bf16 v[124:127], v[172:175], a[252:255], v[124:127]
ds_read_b64_tr_b16 v[190:191], v229 offset:2048
s_waitcnt vmcnt(19) lgkmcnt(4)
v_mfma_f32_16x16x32_bf16 v[64:67], v[176:179], v[128:131], v[64:67]
v_mfma_f32_16x16x32_bf16 v[72:75], v[176:179], v[132:135], v[72:75]
ds_read_b64_tr_b16 v[160:161], v226 offset:4096
v_mov_b32_dpp v0, v32 row_shr:8 row_mask:0xf bank_mask:0xc
v_mfma_f32_16x16x32_bf16 v[80:83], v[176:179], v[136:139], v[80:83]
v_mfma_f32_16x16x32_bf16 v[88:91], v[176:179], v[140:143], v[88:91]
ds_read_b64_tr_b16 v[162:163], v226 offset:6144
v_mov_b32_dpp v1, v33 row_shr:8 row_mask:0xf bank_mask:0xc
v_mfma_f32_16x16x32_bf16 v[68:71], v[180:183], v[128:131], v[68:71]
v_mfma_f32_16x16x32_bf16 v[76:79], v[180:183], v[132:135], v[76:79]
ds_read_b64_tr_b16 v[164:165], v227 offset:4096
v_mfma_f32_16x16x32_bf16 v[84:87], v[180:183], v[136:139], v[84:87]
v_mov_b32_dpp v2, v34 row_shr:8 row_mask:0xf bank_mask:0xc
v_mfma_f32_16x16x32_bf16 v[92:95], v[180:183], v[140:143], v[92:95]
ds_read_b64_tr_b16 v[166:167], v227 offset:6144
s_waitcnt lgkmcnt(4)
v_mfma_f32_16x16x32_bf16 v[96:99], v[184:187], v[128:131], v[96:99]
v_mfma_f32_16x16x32_bf16 v[104:107], v[184:187], v[132:135], v[104:107]
ds_read_b64_tr_b16 v[168:169], v228 offset:4096
v_mov_b32_dpp v3, v35 row_shr:8 row_mask:0xf bank_mask:0xc
v_mfma_f32_16x16x32_bf16 v[112:115], v[184:187], v[136:139], v[112:115]
v_mfma_f32_16x16x32_bf16 v[120:123], v[184:187], v[140:143], v[120:123]
ds_read_b64_tr_b16 v[170:171], v228 offset:6144
v_mfma_f32_16x16x32_bf16 v[100:103], v[188:191], v[128:131], v[100:103]
v_mfma_f32_16x16x32_bf16 v[108:111], v[188:191], v[132:135], v[108:111]
ds_read_b64_tr_b16 v[172:173], v229 offset:4096
v_mfma_f32_16x16x32_bf16 v[116:119], v[188:191], v[136:139], v[116:119]
v_mfma_f32_16x16x32_bf16 v[124:127], v[188:191], v[140:143], v[124:127]
ds_read_b64_tr_b16 v[174:175], v229 offset:6144
s_waitcnt lgkmcnt(4)
v_mfma_f32_16x16x32_bf16 v[64:67], v[160:163], v[144:147], v[64:67]
v_mfma_f32_16x16x32_bf16 v[72:75], v[160:163], v[148:151], v[72:75]
v_mfma_f32_16x16x32_bf16 v[80:83], v[160:163], v[152:155], v[80:83]
v_add_u32 v250, 65536, v242
v_add_u32 v251, 65536, v243
v_mfma_f32_16x16x32_bf16 v[88:91], v[160:163], v[156:159], v[88:91]
s_waitcnt vmcnt(11)
s_barrier
v_mfma_f32_16x16x32_bf16 v[68:71], v[164:167], v[144:147], v[68:71]
ds_read_b64_tr_b16 v[176:177], v242 offset:0
v_mfma_f32_16x16x32_bf16 v[76:79], v[164:167], v[148:151], v[76:79]
ds_read_b64_tr_b16 v[178:179], v242 offset:2048
v_mfma_f32_16x16x32_bf16 v[84:87], v[164:167], v[152:155], v[84:87]
ds_read_b64_tr_b16 v[180:181], v243 offset:0
v_mfma_f32_16x16x32_bf16 v[92:95], v[164:167], v[156:159], v[92:95]
ds_read_b64_tr_b16 v[182:183], v243 offset:2048
s_waitcnt lgkmcnt(4)
v_mfma_f32_16x16x32_bf16 v[96:99], v[168:171], v[144:147], v[96:99]
ds_read_b64_tr_b16 v[184:185], v242 offset:4096
v_mfma_f32_16x16x32_bf16 v[104:107], v[168:171], v[148:151], v[104:107]
ds_read_b64_tr_b16 v[186:187], v242 offset:6144
v_mfma_f32_16x16x32_bf16 v[112:115], v[168:171], v[152:155], v[112:115]
ds_read_b64_tr_b16 v[188:189], v243 offset:4096
v_mfma_f32_16x16x32_bf16 v[120:123], v[168:171], v[156:159], v[120:123]
ds_read_b64_tr_b16 v[190:191], v243 offset:6144
v_mfma_f32_16x16x32_bf16 v[100:103], v[172:175], v[144:147], v[100:103]
ds_read_b64_tr_b16 v[160:161], v242 offset:8192
v_mfma_f32_16x16x32_bf16 v[108:111], v[172:175], v[148:151], v[108:111]
ds_read_b64_tr_b16 v[162:163], v242 offset:10240
v_mfma_f32_16x16x32_bf16 v[116:119], v[172:175], v[152:155], v[116:119]
ds_read_b64_tr_b16 v[164:165], v243 offset:8192
v_mfma_f32_16x16x32_bf16 v[124:127], v[172:175], v[156:159], v[124:127]
ds_read_b64_tr_b16 v[166:167], v243 offset:10240
s_waitcnt lgkmcnt(8)
v_mfma_f32_16x16x32_bf16 v[192:195], v[176:179], a[0:3], 0
ds_read_b64_tr_b16 v[168:169], v242 offset:12288
v_mfma_f32_16x16x32_bf16 v[200:203], v[176:179], a[4:7], 0
ds_read_b64_tr_b16 v[170:171], v242 offset:14336
v_cvt_pk_bf16_f32 v64, v64, v65
v_mfma_f32_16x16x32_bf16 v[196:199], v[180:183], a[0:3], 0
ds_read_b64_tr_b16 v[172:173], v243 offset:12288
v_cvt_pk_bf16_f32 v65, v66, v67
v_mfma_f32_16x16x32_bf16 v[204:207], v[180:183], a[4:7], 0
ds_read_b64_tr_b16 v[174:175], v243 offset:14336
s_waitcnt lgkmcnt(8)
v_mfma_f32_16x16x32_bf16 v[192:195], v[184:187], a[16:19], v[192:195]
ds_read_b64_tr_b16 v[176:177], v242 offset:16384
v_cvt_pk_bf16_f32 v66, v68, v69
v_mfma_f32_16x16x32_bf16 v[200:203], v[184:187], a[20:23], v[200:203]
ds_read_b64_tr_b16 v[178:179], v242 offset:18432
v_cvt_pk_bf16_f32 v67, v70, v71
v_mfma_f32_16x16x32_bf16 v[196:199], v[188:191], a[16:19], v[196:199]
ds_read_b64_tr_b16 v[180:181], v243 offset:16384
buffer_store_dwordx4 v[64:67], v244, s[36:39], s62 offen offset:0 sc1
v_mfma_f32_16x16x32_bf16 v[204:207], v[188:191], a[20:23], v[204:207]
ds_read_b64_tr_b16 v[182:183], v243 offset:18432
s_waitcnt lgkmcnt(8)
v_mfma_f32_16x16x32_bf16 v[192:195], v[160:163], a[32:35], v[192:195]
ds_read_b64_tr_b16 v[184:185], v242 offset:20480
v_cvt_pk_bf16_f32 v72, v72, v73
v_mfma_f32_16x16x32_bf16 v[200:203], v[160:163], a[36:39], v[200:203]
ds_read_b64_tr_b16 v[186:187], v242 offset:22528
v_cvt_pk_bf16_f32 v73, v74, v75
v_mfma_f32_16x16x32_bf16 v[196:199], v[164:167], a[32:35], v[196:199]
ds_read_b64_tr_b16 v[188:189], v243 offset:20480
v_cvt_pk_bf16_f32 v74, v76, v77
v_mfma_f32_16x16x32_bf16 v[204:207], v[164:167], a[36:39], v[204:207]
ds_read_b64_tr_b16 v[190:191], v243 offset:22528
s_waitcnt lgkmcnt(8)
v_mfma_f32_16x16x32_bf16 v[192:195], v[168:171], a[48:51], v[192:195]
ds_read_b64_tr_b16 v[160:161], v242 offset:24576
v_cvt_pk_bf16_f32 v75, v78, v79
v_mfma_f32_16x16x32_bf16 v[200:203], v[168:171], a[52:55], v[200:203]
ds_read_b64_tr_b16 v[162:163], v242 offset:26624
buffer_store_dwordx4 v[72:75], v238, s[36:39], s62 offen offset:1024 sc1
v_mfma_f32_16x16x32_bf16 v[196:199], v[172:175], a[48:51], v[196:199]
ds_read_b64_tr_b16 v[164:165], v243 offset:24576
v_cvt_pk_bf16_f32 v80, v80, v81
v_mfma_f32_16x16x32_bf16 v[204:207], v[172:175], a[52:55], v[204:207]
ds_read_b64_tr_b16 v[166:167], v243 offset:26624
s_waitcnt lgkmcnt(8)
v_mfma_f32_16x16x32_bf16 v[192:195], v[176:179], a[64:67], v[192:195]
ds_read_b64_tr_b16 v[168:169], v242 offset:28672
v_cvt_pk_bf16_f32 v81, v82, v83
v_mfma_f32_16x16x32_bf16 v[200:203], v[176:179], a[68:71], v[200:203]
ds_read_b64_tr_b16 v[170:171], v242 offset:30720
v_cvt_pk_bf16_f32 v82, v84, v85
v_mfma_f32_16x16x32_bf16 v[196:199], v[180:183], a[64:67], v[196:199]
ds_read_b64_tr_b16 v[172:173], v243 offset:28672
v_cvt_pk_bf16_f32 v83, v86, v87
v_mfma_f32_16x16x32_bf16 v[204:207], v[180:183], a[68:71], v[204:207]
ds_read_b64_tr_b16 v[174:175], v243 offset:30720
s_waitcnt lgkmcnt(8)
s_waitcnt vmcnt(2)
s_barrier
v_mfma_f32_16x16x32_bf16 v[192:195], v[184:187], a[80:83], v[192:195]
ds_read_b64_tr_b16 v[176:177], v242 offset:32768
buffer_store_dwordx4 v[80:83], v245, s[36:39], s62 offen offset:0 sc1
v_mfma_f32_16x16x32_bf16 v[200:203], v[184:187], a[84:87], v[200:203]
ds_read_b64_tr_b16 v[178:179], v242 offset:34816
v_cvt_pk_bf16_f32 v88, v88, v89
v_mfma_f32_16x16x32_bf16 v[196:199], v[188:191], a[80:83], v[196:199]
ds_read_b64_tr_b16 v[180:181], v243 offset:32768
v_cvt_pk_bf16_f32 v89, v90, v91
v_mfma_f32_16x16x32_bf16 v[204:207], v[188:191], a[84:87], v[204:207]
ds_read_b64_tr_b16 v[182:183], v243 offset:34816
s_waitcnt lgkmcnt(8)
v_mfma_f32_16x16x32_bf16 v[192:195], v[160:163], a[96:99], v[192:195]
ds_read_b64_tr_b16 v[184:185], v242 offset:36864
v_cvt_pk_bf16_f32 v90, v92, v93
v_mfma_f32_16x16x32_bf16 v[200:203], v[160:163], a[100:103], v[200:203]
ds_read_b64_tr_b16 v[186:187], v242 offset:38912
v_cvt_pk_bf16_f32 v91, v94, v95
v_mfma_f32_16x16x32_bf16 v[196:199], v[164:167], a[96:99], v[196:199]
ds_read_b64_tr_b16 v[188:189], v243 offset:36864
buffer_store_dwordx4 v[88:91], v239, s[36:39], s62 offen offset:1024 sc1
v_mfma_f32_16x16x32_bf16 v[204:207], v[164:167], a[100:103], v[204:207]
ds_read_b64_tr_b16 v[190:191], v243 offset:38912
s_waitcnt lgkmcnt(8)
v_mfma_f32_16x16x32_bf16 v[192:195], v[168:171], a[112:115], v[192:195]
ds_read_b64_tr_b16 v[160:161], v242 offset:40960
v_cvt_pk_bf16_f32 v96, v96, v97
v_mfma_f32_16x16x32_bf16 v[200:203], v[168:171], a[116:119], v[200:203]
ds_read_b64_tr_b16 v[162:163], v242 offset:43008
v_cvt_pk_bf16_f32 v97, v98, v99
v_mfma_f32_16x16x32_bf16 v[196:199], v[172:175], a[112:115], v[196:199]
ds_read_b64_tr_b16 v[164:165], v243 offset:40960
v_cvt_pk_bf16_f32 v98, v100, v101
v_mfma_f32_16x16x32_bf16 v[204:207], v[172:175], a[116:119], v[204:207]
ds_read_b64_tr_b16 v[166:167], v243 offset:43008
s_waitcnt lgkmcnt(8)
v_mfma_f32_16x16x32_bf16 v[192:195], v[176:179], a[160:163], v[192:195]
ds_read_b64_tr_b16 v[168:169], v242 offset:45056
v_cvt_pk_bf16_f32 v99, v102, v103
v_mfma_f32_16x16x32_bf16 v[200:203], v[176:179], a[164:167], v[200:203]
ds_read_b64_tr_b16 v[170:171], v242 offset:47104
buffer_store_dwordx4 v[96:99], v244, s[36:39], s63 offen offset:0 sc1
v_mfma_f32_16x16x32_bf16 v[196:199], v[180:183], a[160:163], v[196:199]
ds_read_b64_tr_b16 v[172:173], v243 offset:45056
v_cvt_pk_bf16_f32 v104, v104, v105
v_mfma_f32_16x16x32_bf16 v[204:207], v[180:183], a[164:167], v[204:207]
ds_read_b64_tr_b16 v[174:175], v243 offset:47104
s_waitcnt lgkmcnt(8)
v_mfma_f32_16x16x32_bf16 v[192:195], v[184:187], a[176:179], v[192:195]
ds_read_b64_tr_b16 v[176:177], v242 offset:49152
v_cvt_pk_bf16_f32 v105, v106, v107
v_mfma_f32_16x16x32_bf16 v[200:203], v[184:187], a[180:183], v[200:203]
ds_read_b64_tr_b16 v[178:179], v242 offset:51200
v_cvt_pk_bf16_f32 v106, v108, v109
v_mfma_f32_16x16x32_bf16 v[196:199], v[188:191], a[176:179], v[196:199]
ds_read_b64_tr_b16 v[180:181], v243 offset:49152
v_cvt_pk_bf16_f32 v107, v110, v111
v_mfma_f32_16x16x32_bf16 v[204:207], v[188:191], a[180:183], v[204:207]
ds_read_b64_tr_b16 v[182:183], v243 offset:51200
s_waitcnt lgkmcnt(8)
v_mfma_f32_16x16x32_bf16 v[192:195], v[160:163], a[192:195], v[192:195]
ds_read_b64_tr_b16 v[184:185], v242 offset:53248
buffer_store_dwordx4 v[104:107], v238, s[36:39], s63 offen offset:1024 sc1
v_mfma_f32_16x16x32_bf16 v[200:203], v[160:163], a[196:199], v[200:203]
ds_read_b64_tr_b16 v[186:187], v242 offset:55296
v_cvt_pk_bf16_f32 v112, v112, v113
v_mfma_f32_16x16x32_bf16 v[196:199], v[164:167], a[192:195], v[196:199]
ds_read_b64_tr_b16 v[188:189], v243 offset:53248
v_cvt_pk_bf16_f32 v113, v114, v115
v_mfma_f32_16x16x32_bf16 v[204:207], v[164:167], a[196:199], v[204:207]
ds_read_b64_tr_b16 v[190:191], v243 offset:55296
s_waitcnt lgkmcnt(8)
v_mfma_f32_16x16x32_bf16 v[192:195], v[168:171], a[208:211], v[192:195]
ds_read_b64_tr_b16 v[160:161], v242 offset:57344
v_cvt_pk_bf16_f32 v114, v116, v117
v_mfma_f32_16x16x32_bf16 v[200:203], v[168:171], a[212:215], v[200:203]
ds_read_b64_tr_b16 v[162:163], v242 offset:59392
v_cvt_pk_bf16_f32 v115, v118, v119
v_mfma_f32_16x16x32_bf16 v[196:199], v[172:175], a[208:211], v[196:199]
ds_read_b64_tr_b16 v[164:165], v243 offset:57344
buffer_store_dwordx4 v[112:115], v245, s[36:39], s63 offen offset:0 sc1
v_mfma_f32_16x16x32_bf16 v[204:207], v[172:175], a[212:215], v[204:207]
ds_read_b64_tr_b16 v[166:167], v243 offset:59392
s_waitcnt lgkmcnt(8)
v_mfma_f32_16x16x32_bf16 v[192:195], v[176:179], a[224:227], v[192:195]
ds_read_b64_tr_b16 v[168:169], v242 offset:61440
v_cvt_pk_bf16_f32 v120, v120, v121
v_mfma_f32_16x16x32_bf16 v[200:203], v[176:179], a[228:231], v[200:203]
ds_read_b64_tr_b16 v[170:171], v242 offset:63488
v_cvt_pk_bf16_f32 v121, v122, v123
v_mfma_f32_16x16x32_bf16 v[196:199], v[180:183], a[224:227], v[196:199]
ds_read_b64_tr_b16 v[172:173], v243 offset:61440
v_cvt_pk_bf16_f32 v122, v124, v125
v_mfma_f32_16x16x32_bf16 v[204:207], v[180:183], a[228:231], v[204:207]
ds_read_b64_tr_b16 v[174:175], v243 offset:63488
s_waitcnt lgkmcnt(8)
v_mfma_f32_16x16x32_bf16 v[192:195], v[184:187], a[240:243], v[192:195]
ds_read_b64_tr_b16 v[176:177], v250 offset:0
v_cvt_pk_bf16_f32 v123, v126, v127
v_mfma_f32_16x16x32_bf16 v[200:203], v[184:187], a[244:247], v[200:203]
ds_read_b64_tr_b16 v[178:179], v250 offset:2048
buffer_store_dwordx4 v[120:123], v239, s[36:39], s63 offen offset:1024 sc1
v_mfma_f32_16x16x32_bf16 v[196:199], v[188:191], a[240:243], v[196:199]
ds_read_b64_tr_b16 v[180:181], v251 offset:0
v_mfma_f32_16x16x32_bf16 v[204:207], v[188:191], a[244:247], v[204:207]
ds_read_b64_tr_b16 v[182:183], v251 offset:2048
s_waitcnt lgkmcnt(8)
v_mfma_f32_16x16x32_bf16 v[192:195], v[160:163], v[128:131], v[192:195]
ds_read_b64_tr_b16 v[184:185], v250 offset:4096
v_mfma_f32_16x16x32_bf16 v[200:203], v[160:163], v[132:135], v[200:203]
ds_read_b64_tr_b16 v[186:187], v250 offset:6144
v_mfma_f32_16x16x32_bf16 v[196:199], v[164:167], v[128:131], v[196:199]
ds_read_b64_tr_b16 v[188:189], v251 offset:4096
v_mfma_f32_16x16x32_bf16 v[204:207], v[164:167], v[132:135], v[204:207]
ds_read_b64_tr_b16 v[190:191], v251 offset:6144
s_waitcnt lgkmcnt(8)
v_mfma_f32_16x16x32_bf16 v[192:195], v[168:171], v[144:147], v[192:195]
v_mfma_f32_16x16x32_bf16 v[200:203], v[168:171], v[148:151], v[200:203]
v_mfma_f32_16x16x32_bf16 v[196:199], v[172:175], v[144:147], v[196:199]
v_mfma_f32_16x16x32_bf16 v[204:207], v[172:175], v[148:151], v[204:207]
s_waitcnt lgkmcnt(4)
v_mfma_f32_16x16x32_bf16 v[192:195], v[176:179], a[128:131], v[192:195]
v_mfma_f32_16x16x32_bf16 v[200:203], v[176:179], a[132:135], v[200:203]
v_mfma_f32_16x16x32_bf16 v[196:199], v[180:183], a[128:131], v[196:199]
v_mfma_f32_16x16x32_bf16 v[204:207], v[180:183], a[132:135], v[204:207]
s_waitcnt lgkmcnt(0)
v_mfma_f32_16x16x32_bf16 v[192:195], v[184:187], a[144:147], v[192:195]
v_mfma_f32_16x16x32_bf16 v[200:203], v[184:187], a[148:151], v[200:203]
v_mfma_f32_16x16x32_bf16 v[196:199], v[188:191], a[144:147], v[196:199]
v_mfma_f32_16x16x32_bf16 v[204:207], v[188:191], a[148:151], v[204:207]
s_nop 4
v_cvt_pk_bf16_f32 v192, v192, v193
v_cvt_pk_bf16_f32 v193, v194, v195
v_cvt_pk_bf16_f32 v194, v196, v197
v_cvt_pk_bf16_f32 v195, v198, v199
buffer_store_dwordx4 v[192:195], v238, s[36:39], s64 offen offset:0 sc1
v_cvt_pk_bf16_f32 v200, v200, v201
v_cvt_pk_bf16_f32 v201, v202, v203
v_cvt_pk_bf16_f32 v202, v204, v205
v_cvt_pk_bf16_f32 v203, v206, v207
buffer_store_dwordx4 v[200:203], v238, s[36:39], s64 offen offset:1024 sc1
s_bitcmp1_b32 s40, 0
s_cselect_b64 vcc, -1, 0
v_cndmask_b32 v40, v64, v80, vcc
v_cndmask_b32 v41, v65, v81, vcc
v_cndmask_b32 v42, v66, v82, vcc
v_cndmask_b32 v43, v67, v83, vcc
v_cndmask_b32 v96, v96, v112, vcc
v_cndmask_b32 v97, v97, v113, vcc
v_cndmask_b32 v98, v98, v114, vcc
v_cndmask_b32 v99, v99, v115, vcc
v_mov_b32_dpp v40, v96 row_shr:8 row_mask:0xf bank_mask:0xc
v_mov_b32_dpp v41, v97 row_shr:8 row_mask:0xf bank_mask:0xc
v_mov_b32_dpp v42, v98 row_shr:8 row_mask:0xf bank_mask:0xc
v_mov_b32_dpp v43, v99 row_shr:8 row_mask:0xf bank_mask:0xc
s_lshl_b32 s45, s40, 3
s_mul_i32 s46, s40, -6
s_add_u32 s46, s46, 64
v_bfe_u32 v200, v224, 8, 1
v_bfe_u32 v201, v224, 7, 1
v_bfe_u32 v202, v224, 9, 1
v_add_u32 v200, s45, v200
v_lshl_add_u32 v201, v201, 1, v202
v_lshl_add_u32 v126, v201, 1, v200
v_add_u32 v127, s46, v200
v_and_b32 v200, 0x70, v224
v_mul_u32_u24 v202, 72, v200
v_lshrrev_b32 v203, 2, v126
v_lshl_add_u32 v120, v203, 12, v200
v_lshl_add_u32 v124, v203, 6, v202
v_and_b32 v203, 3, v126
v_lshl_add_u32 v120, v203, 8, v120
v_lshrrev_b32 v203, 1, v203
v_lshl_add_u32 v124, v203, 4, v124
v_and_b32 v203, 1, v126
v_lshl_add_u32 v124, v203, 5, v124
v_lshlrev_b32 v126, 4, v126
v_add_u32 v126, 155648, v126
v_lshrrev_b32 v203, 2, v127
v_lshl_add_u32 v123, v203, 12, v200
v_lshl_add_u32 v125, v203, 6, v202
v_and_b32 v203, 3, v127
v_lshl_add_u32 v123, v203, 8, v123
v_lshrrev_b32 v203, 1, v203
v_lshl_add_u32 v125, v203, 4, v125
v_and_b32 v203, 1, v127
v_lshl_add_u32 v125, v203, 5, v125
v_lshlrev_b32 v127, 4, v127
v_add_u32 v127, 155648, v127
v_add_u32 v121, 32768, v120
s_and_b32 s45, s42, 3
v_xor_b32 v202, s45, v201
v_mul_u32_u24 v202, 73728, v202
v_mul_u32_u24 v200, 640, v201
v_and_b32 v200, 1152, v200
v_add3_u32 v122, v123, v202, v200
v_lshl_add_u32 v125, v201, 29, v125
s_lshr_b32 s45, s42, 1
s_lshl_b32 s45, s45, 10
s_and_b32 s46, s42, 1
s_lshl_b32 s46, s46, 7
s_add_u32 s48, s45, s46
s_lshl_b32 s45, s41, 3
s_add_u32 s45, s45, s42
s_mul_i32 s57, s45, 9216
s_andn2_b32 s46, s45, 3
s_mul_i32 s8, s46, 73728
s_add_u32 s8, s8, 41943040
s_xor_b32 s46, s46, 4
s_mul_i32 s47, s46, 73728
s_add_u32 s47, s47, 41945088
s_xor_b32 s46, s45, 1
s_mul_i32 s46, s46, 73728
s_add_u32 s9, s46, 41943168
s_xor_b32 s46, s45, 2
s_mul_i32 s46, s46, 73728
s_add_u32 s10, s46, 41944064
s_xor_b32 s46, s45, 3
s_mul_i32 s46, s46, 73728
s_add_u32 s11, s46, 41944192
s_xor_b32 s46, s45, 4
s_mul_i32 s46, s46, 73728
s_add_u32 s12, s46, 41945088
s_xor_b32 s46, s45, 5
s_mul_i32 s46, s46, 73728
s_add_u32 s13, s46, 41945216
s_xor_b32 s46, s45, 6
s_mul_i32 s46, s46, 73728
s_add_u32 s14, s46, 41946112
s_xor_b32 s46, s45, 7
s_mul_i32 s46, s46, 73728
s_add_u32 s15, s46, 41946240
ds_read_b128 v[140:143], v126 offset:3456
ds_read_b128 v[144:147], v126 offset:3968
ds_read_b128 v[148:151], v127 offset:3456
v_lshlrev_b32 v72, 16, v208
v_and_b32 v73, 0xffff0000, v208
v_lshlrev_b32 v74, 16, v209
v_and_b32 v75, 0xffff0000, v209
v_lshlrev_b32 v76, 16, v210
v_and_b32 v77, 0xffff0000, v210
v_lshlrev_b32 v78, 16, v211
v_and_b32 v79, 0xffff0000, v211
v_lshlrev_b32 v80, 16, v212
v_and_b32 v81, 0xffff0000, v212
v_lshlrev_b32 v82, 16, v213
v_and_b32 v83, 0xffff0000, v213
v_lshlrev_b32 v84, 16, v214
v_and_b32 v85, 0xffff0000, v214
v_lshlrev_b32 v86, 16, v215
v_and_b32 v87, 0xffff0000, v215
v_lshlrev_b32 v88, 16, v216
v_and_b32 v89, 0xffff0000, v216
v_lshlrev_b32 v90, 16, v217
v_and_b32 v91, 0xffff0000, v217
v_lshlrev_b32 v92, 16, v218
v_and_b32 v93, 0xffff0000, v218
v_lshlrev_b32 v94, 16, v219
v_and_b32 v95, 0xffff0000, v219
s_waitcnt lgkmcnt(0)
s_buffer_load_dwordx8 s[92:99], s[36:39], s54 offset:2176
v_lshlrev_b32 v128, 16, v140
v_and_b32 v129, 0xffff0000, v140
v_lshlrev_b32 v130, 16, v141
v_and_b32 v131, 0xffff0000, v141
v_lshlrev_b32 v132, 16, v142
v_and_b32 v133, 0xffff0000, v142
v_lshlrev_b32 v134, 16, v143
v_and_b32 v135, 0xffff0000, v143
v_lshlrev_b32 v136, 16, v144
v_and_b32 v137, 0xffff0000, v144
v_lshlrev_b32 v138, 16, v145
v_and_b32 v139, 0xffff0000, v145
v_lshlrev_b32 v140, 16, v146
v_and_b32 v141, 0xffff0000, v146
v_lshlrev_b32 v142, 16, v147
v_and_b32 v143, 0xffff0000, v147
v_lshlrev_b32 v144, 16, v148
v_and_b32 v145, 0xffff0000, v148
v_lshlrev_b32 v146, 16, v149
v_and_b32 v147, 0xffff0000, v149
v_lshlrev_b32 v148, 16, v150
v_and_b32 v149, 0xffff0000, v150
v_lshlrev_b32 v150, 16, v151
v_and_b32 v151, 0xffff0000, v151
v_mul_f32 v128, 0x3f317218, v128
v_mul_f32 v129, 0x3f317218, v129
v_mul_f32 v130, 0x3f317218, v130
v_mul_f32 v131, 0x3f317218, v131
v_mul_f32 v132, 0x3f317218, v132
v_mul_f32 v133, 0x3f317218, v133
v_mul_f32 v134, 0x3f317218, v134
v_mul_f32 v135, 0x3f317218, v135
v_mul_f32 v136, 0x3f317218, v136
v_mul_f32 v137, 0x3f317218, v137
v_mul_f32 v138, 0x3f317218, v138
v_mul_f32 v139, 0x3f317218, v139
v_mul_f32 v140, 0x3f317218, v140
v_mul_f32 v141, 0x3f317218, v141
v_mul_f32 v142, 0x3f317218, v142
v_mul_f32 v143, 0x3f317218, v143
v_mul_f32 v144, 0x3f317218, v144
v_mul_f32 v145, 0x3f317218, v145
v_mul_f32 v146, 0x3f317218, v146
v_mul_f32 v147, 0x3f317218, v147
v_mul_f32 v148, 0x3f317218, v148
v_mul_f32 v149, 0x3f317218, v149
v_mul_f32 v150, 0x3f317218, v150
v_mul_f32 v151, 0x3f317218, v151
s_waitcnt vmcnt(0)
s_barrier
buffer_store_dword v255, v254, s[36:39], s53 offen offset:1024 sc1
s_mov_b32 s55, 1
s_waitcnt lgkmcnt(0)
s_mov_b32 s92, s3
s_mov_b32 s58, s3
s_mov_b32 s59, s3
s_xor_b64 s[92:93], s[92:93], s[58:59]
s_xor_b64 s[94:95], s[94:95], s[58:59]
s_xor_b64 s[96:97], s[96:97], s[58:59]
s_xor_b64 s[98:99], s[98:99], s[58:59]
s_or_b64 s[92:93], s[92:93], s[94:95]
s_or_b64 s[96:97], s[96:97], s[98:99]
s_or_b64 s[92:93], s[92:93], s[96:97]
s_cbranch_scc1 S3_SLOW1
s_buffer_load_dwordx8 s[20:27], s[36:39], s54 offset:1152
buffer_load_dwordx4 v[4:7], v120, s[36:39], s9 offen
buffer_load_dwordx4 v[8:11], v120, s[36:39], s10 offen
buffer_load_dwordx4 v[12:15], v120, s[36:39], s11 offen
buffer_load_dwordx4 v[16:19], v120, s[36:39], s12 offen
buffer_load_dwordx4 v[20:23], v120, s[36:39], s13 offen
buffer_load_dwordx4 v[24:27], v120, s[36:39], s14 offen
buffer_load_dwordx4 v[28:31], v120, s[36:39], s15 offen
s_waitcnt lgkmcnt(0)
s_mov_b32 s20, s3
s_mov_b32 s58, s3
s_mov_b32 s59, s3
s_xor_b64 s[20:21], s[20:21], s[58:59]
s_xor_b64 s[22:23], s[22:23], s[58:59]
s_xor_b64 s[24:25], s[24:25], s[58:59]
s_xor_b64 s[26:27], s[26:27], s[58:59]
s_or_b64 s[20:21], s[20:21], s[22:23]
s_or_b64 s[24:25], s[24:25], s[26:27]
s_or_b64 s[20:21], s[20:21], s[24:25]
s_cbranch_scc1 S3_SLOW2
s_barrier
s_barrier
S3_B:
buffer_load_dwordx4 v[32:35], v122, s[36:39], s8 offen
buffer_load_dwordx4 v[36:39], v122, s[36:39], s47 offen
buffer_load_dwordx4 v[44:47], v121, s[36:39], s9 offen
buffer_load_dwordx4 v[48:51], v121, s[36:39], s10 offen
buffer_load_dwordx4 v[52:55], v121, s[36:39], s11 offen
buffer_load_dwordx4 v[56:59], v121, s[36:39], s12 offen
buffer_load_dwordx4 v[60:63], v121, s[36:39], s13 offen
buffer_load_dwordx4 v[64:67], v121, s[36:39], s14 offen
buffer_load_dwordx4 v[68:71], v121, s[36:39], s15 offen
v_dot2_f32_bf16 v96, v0, s101, 0
v_dot2_f32_bf16 v97, v0, s65, 0
v_dot2_f32_bf16 v98, v1, s101, 0
v_dot2_f32_bf16 v99, v1, s65, 0
v_dot2_f32_bf16 v100, v2, s101, 0
v_dot2_f32_bf16 v101, v2, s65, 0
v_dot2_f32_bf16 v102, v3, s101, 0
v_dot2_f32_bf16 v103, v3, s65, 0
s_waitcnt vmcnt(15)
v_dot2_f32_bf16 v96, v4, s101, v96
v_dot2_f32_bf16 v97, v4, s65, v97
v_dot2_f32_bf16 v98, v5, s101, v98
v_dot2_f32_bf16 v99, v5, s65, v99
v_dot2_f32_bf16 v100, v6, s101, v100
v_dot2_f32_bf16 v101, v6, s65, v101
v_dot2_f32_bf16 v102, v7, s101, v102
v_dot2_f32_bf16 v103, v7, s65, v103
s_waitcnt vmcnt(14)
v_dot2_f32_bf16 v96, v8, s101, v96
v_dot2_f32_bf16 v97, v8, s65, v97
v_dot2_f32_bf16 v98, v9, s101, v98
v_dot2_f32_bf16 v99, v9, s65, v99
v_dot2_f32_bf16 v100, v10, s101, v100
v_dot2_f32_bf16 v101, v10, s65, v101
v_dot2_f32_bf16 v102, v11, s101, v102
v_dot2_f32_bf16 v103, v11, s65, v103
s_waitcnt vmcnt(13)
v_dot2_f32_bf16 v96, v12, s101, v96
v_dot2_f32_bf16 v97, v12, s65, v97
v_dot2_f32_bf16 v98, v13, s101, v98
v_dot2_f32_bf16 v99, v13, s65, v99
v_dot2_f32_bf16 v100, v14, s101, v100
v_dot2_f32_bf16 v101, v14, s65, v101
v_dot2_f32_bf16 v102, v15, s101, v102
v_dot2_f32_bf16 v103, v15, s65, v103
s_waitcnt vmcnt(12)
v_dot2_f32_bf16 v96, v16, s101, v96
v_dot2_f32_bf16 v97, v16, s65, v97
v_dot2_f32_bf16 v98, v17, s101, v98
v_dot2_f32_bf16 v99, v17, s65, v99
v_dot2_f32_bf16 v100, v18, s101, v100
v_dot2_f32_bf16 v101, v18, s65, v101
v_dot2_f32_bf16 v102, v19, s101, v102
v_dot2_f32_bf16 v103, v19, s65, v103
s_waitcnt vmcnt(11)
v_dot2_f32_bf16 v96, v20, s101, v96
v_dot2_f32_bf16 v97, v20, s65, v97
v_dot2_f32_bf16 v98, v21, s101, v98
v_dot2_f32_bf16 v99, v21, s65, v99
v_dot2_f32_bf16 v100, v22, s101, v100
v_dot2_f32_bf16 v101, v22, s65, v101
v_dot2_f32_bf16 v102, v23, s101, v102
v_dot2_f32_bf16 v103, v23, s65, v103
s_waitcnt vmcnt(10)
v_dot2_f32_bf16 v96, v24, s101, v96
v_dot2_f32_bf16 v97, v24, s65, v97
v_dot2_f32_bf16 v98, v25, s101, v98
v_dot2_f32_bf16 v99, v25, s65, v99
v_dot2_f32_bf16 v100, v26, s101, v100
v_dot2_f32_bf16 v101, v26, s65, v101
v_dot2_f32_bf16 v102, v27, s101, v102
v_dot2_f32_bf16 v103, v27, s65, v103
s_waitcnt vmcnt(9)
v_dot2_f32_bf16 v96, v28, s101, v96
v_dot2_f32_bf16 v97, v28, s65, v97
v_dot2_f32_bf16 v98, v29, s101, v98
v_dot2_f32_bf16 v99, v29, s65, v99
v_dot2_f32_bf16 v100, v30, s101, v100
v_dot2_f32_bf16 v101, v30, s65, v101
v_dot2_f32_bf16 v102, v31, s101, v102
v_dot2_f32_bf16 v103, v31, s65, v103
v_pk_fma_f32 v[96:97], v[96:97], v[128:129], v[72:73]
v_pk_fma_f32 v[98:99], v[98:99], v[130:131], v[74:75]
v_pk_fma_f32 v[100:101], v[100:101], v[132:133], v[76:77]
v_pk_fma_f32 v[102:103], v[102:103], v[134:135], v[78:79]
s_waitcnt vmcnt(8)
v_dot2_f32_bf16 v112, v32, s101, 0
v_dot2_f32_bf16 v113, v32, s65, 0
v_dot2_f32_bf16 v114, v33, s101, 0
v_dot2_f32_bf16 v115, v33, s65, 0
v_dot2_f32_bf16 v116, v34, s101, 0
v_dot2_f32_bf16 v117, v34, s65, 0
v_dot2_f32_bf16 v118, v35, s101, 0
v_dot2_f32_bf16 v119, v35, s65, 0
s_waitcnt vmcnt(7)
v_dot2_f32_bf16 v112, v36, s101, v112
v_dot2_f32_bf16 v113, v36, s65, v113
v_dot2_f32_bf16 v114, v37, s101, v114
v_dot2_f32_bf16 v115, v37, s65, v115
v_dot2_f32_bf16 v116, v38, s101, v116
v_dot2_f32_bf16 v117, v38, s65, v117
v_dot2_f32_bf16 v118, v39, s101, v118
v_dot2_f32_bf16 v119, v39, s65, v119
v_add_f32_dpp v112, v112, v112 row_ror:8 row_mask:0xf bank_mask:0xf
v_add_f32_dpp v113, v113, v113 row_ror:8 row_mask:0xf bank_mask:0xf
v_add_f32_dpp v114, v114, v114 row_ror:8 row_mask:0xf bank_mask:0xf
v_add_f32_dpp v115, v115, v115 row_ror:8 row_mask:0xf bank_mask:0xf
v_add_f32_dpp v116, v116, v116 row_ror:8 row_mask:0xf bank_mask:0xf
v_add_f32_dpp v117, v117, v117 row_ror:8 row_mask:0xf bank_mask:0xf
v_add_f32_dpp v118, v118, v118 row_ror:8 row_mask:0xf bank_mask:0xf
v_add_f32_dpp v119, v119, v119 row_ror:8 row_mask:0xf bank_mask:0xf
v_mov_b32 v32, v112
v_mov_b32 v33, v113
v_mov_b32 v34, v114
v_mov_b32 v35, v115
v_mov_b32 v36, v116
v_mov_b32 v37, v117
v_mov_b32 v38, v118
v_mov_b32 v39, v119
v_permlane32_swap_b32 v112, v32
v_permlane32_swap_b32 v113, v33
v_permlane32_swap_b32 v114, v34
v_permlane32_swap_b32 v115, v35
v_permlane32_swap_b32 v116, v36
v_permlane32_swap_b32 v117, v37
v_permlane32_swap_b32 v118, v38
v_permlane32_swap_b32 v119, v39
v_add_f32 v112, v112, v32
v_add_f32 v113, v113, v33
v_add_f32 v114, v114, v34
v_add_f32 v115, v115, v35
v_add_f32 v116, v116, v36
v_add_f32 v117, v117, v37
v_add_f32 v118, v118, v38
v_add_f32 v119, v119, v39
v_pk_fma_f32 v[112:113], v[112:113], v[144:145], v[88:89]
v_pk_fma_f32 v[114:115], v[114:115], v[146:147], v[90:91]
v_pk_fma_f32 v[116:117], v[116:117], v[148:149], v[92:93]
v_pk_fma_f32 v[118:119], v[118:119], v[150:151], v[94:95]
v_dot2_f32_bf16 v104, v40, s101, 0
v_dot2_f32_bf16 v105, v40, s65, 0
v_dot2_f32_bf16 v106, v41, s101, 0
v_dot2_f32_bf16 v107, v41, s65, 0
v_dot2_f32_bf16 v108, v42, s101, 0
v_dot2_f32_bf16 v109, v42, s65, 0
v_dot2_f32_bf16 v110, v43, s101, 0
v_dot2_f32_bf16 v111, v43, s65, 0
s_waitcnt vmcnt(6)
v_dot2_f32_bf16 v104, v44, s101, v104
v_dot2_f32_bf16 v105, v44, s65, v105
v_dot2_f32_bf16 v106, v45, s101, v106
v_dot2_f32_bf16 v107, v45, s65, v107
v_dot2_f32_bf16 v108, v46, s101, v108
v_dot2_f32_bf16 v109, v46, s65, v109
v_dot2_f32_bf16 v110, v47, s101, v110
v_dot2_f32_bf16 v111, v47, s65, v111
s_waitcnt vmcnt(5)
v_dot2_f32_bf16 v104, v48, s101, v104
v_dot2_f32_bf16 v105, v48, s65, v105
v_dot2_f32_bf16 v106, v49, s101, v106
v_dot2_f32_bf16 v107, v49, s65, v107
v_dot2_f32_bf16 v108, v50, s101, v108
v_dot2_f32_bf16 v109, v50, s65, v109
v_dot2_f32_bf16 v110, v51, s101, v110
v_dot2_f32_bf16 v111, v51, s65, v111
s_waitcnt vmcnt(4)
v_dot2_f32_bf16 v104, v52, s101, v104
v_dot2_f32_bf16 v105, v52, s65, v105
v_dot2_f32_bf16 v106, v53, s101, v106
v_dot2_f32_bf16 v107, v53, s65, v107
v_dot2_f32_bf16 v108, v54, s101, v108
v_dot2_f32_bf16 v109, v54, s65, v109
v_dot2_f32_bf16 v110, v55, s101, v110
v_dot2_f32_bf16 v111, v55, s65, v111
s_waitcnt vmcnt(3)
v_dot2_f32_bf16 v104, v56, s101, v104
v_dot2_f32_bf16 v105, v56, s65, v105
v_dot2_f32_bf16 v106, v57, s101, v106
v_dot2_f32_bf16 v107, v57, s65, v107
v_dot2_f32_bf16 v108, v58, s101, v108
v_dot2_f32_bf16 v109, v58, s65, v109
v_dot2_f32_bf16 v110, v59, s101, v110
v_dot2_f32_bf16 v111, v59, s65, v111
s_waitcnt vmcnt(2)
v_dot2_f32_bf16 v104, v60, s101, v104
v_dot2_f32_bf16 v105, v60, s65, v105
v_dot2_f32_bf16 v106, v61, s101, v106
v_dot2_f32_bf16 v107, v61, s65, v107
v_dot2_f32_bf16 v108, v62, s101, v108
v_dot2_f32_bf16 v109, v62, s65, v109
v_dot2_f32_bf16 v110, v63, s101, v110
v_dot2_f32_bf16 v111, v63, s65, v111
s_waitcnt vmcnt(1)
v_dot2_f32_bf16 v104, v64, s101, v104
v_dot2_f32_bf16 v105, v64, s65, v105
v_dot2_f32_bf16 v106, v65, s101, v106
v_dot2_f32_bf16 v107, v65, s65, v107
v_dot2_f32_bf16 v108, v66, s101, v108
v_dot2_f32_bf16 v109, v66, s65, v109
v_dot2_f32_bf16 v110, v67, s101, v110
v_dot2_f32_bf16 v111, v67, s65, v111
s_waitcnt vmcnt(0)
v_dot2_f32_bf16 v104, v68, s101, v104
v_dot2_f32_bf16 v105, v68, s65, v105
v_dot2_f32_bf16 v106, v69, s101, v106
v_dot2_f32_bf16 v107, v69, s65, v107
v_dot2_f32_bf16 v108, v70, s101, v108
v_dot2_f32_bf16 v109, v70, s65, v109
v_dot2_f32_bf16 v110, v71, s101, v110
v_dot2_f32_bf16 v111, v71, s65, v111
v_pk_fma_f32 v[104:105], v[104:105], v[136:137], v[80:81]
v_pk_fma_f32 v[106:107], v[106:107], v[138:139], v[82:83]
v_pk_fma_f32 v[108:109], v[108:109], v[140:141], v[84:85]
v_pk_fma_f32 v[110:111], v[110:111], v[142:143], v[86:87]
v_cvt_pk_bf16_f32 v0, v96, v97
v_cvt_pk_bf16_f32 v1, v98, v99
v_cvt_pk_bf16_f32 v2, v100, v101
v_cvt_pk_bf16_f32 v3, v102, v103
v_cvt_pk_bf16_f32 v4, v104, v105
v_cvt_pk_bf16_f32 v5, v106, v107
v_cvt_pk_bf16_f32 v6, v108, v109
v_cvt_pk_bf16_f32 v7, v110, v111
v_cvt_pk_bf16_f32 v8, v112, v113
v_cvt_pk_bf16_f32 v9, v114, v115
v_cvt_pk_bf16_f32 v10, v116, v117
v_cvt_pk_bf16_f32 v11, v118, v119
v_permlane16_swap_b32 v0, v2
v_permlane16_swap_b32 v1, v3
v_permlane16_swap_b32 v4, v6
v_permlane16_swap_b32 v5, v7
v_permlane16_swap_b32 v8, v10
v_permlane16_swap_b32 v9, v11
buffer_store_dwordx4 v[0:3], v124, s[84:87], s57 offen offset:0
buffer_store_dwordx4 v[4:7], v124, s[84:87], s57 offen offset:512
buffer_store_dwordx4 v[8:11], v125, s[84:87], s57 offen offset:0
END:
s_endpgm
ATT_LOOP1:
s_waitcnt lgkmcnt(0)
s_barrier
v_mfma_f32_16x16x32_bf16 v[160:163], a[64:67], a[0:3], v[192:195]
v_exp_f32 v149, v149
v_mfma_f32_16x16x32_bf16 v[168:171], a[64:67], a[4:7], v[196:199]
ds_read_b64_tr_b16 a[96:97], v226 offset:16384
v_cvt_pk_bf16_f32 v146, v148, v149
v_mfma_f32_16x16x32_bf16 v[176:179], a[64:67], a[8:11], v[200:203]
v_exp_f32 v150, v150
v_mfma_f32_16x16x32_bf16 v[184:187], a[64:67], a[12:15], v[204:207]
ds_read_b64_tr_b16 a[98:99], v226 offset:18432
buffer_load_dword v249, v247, s[92:95], s9 offen
v_mfma_f32_16x16x32_bf16 v[160:163], a[68:71], a[16:19], v[160:163]
v_exp_f32 v151, v151
v_mfma_f32_16x16x32_bf16 v[168:171], a[68:71], a[20:23], v[168:171]
ds_read_b64_tr_b16 a[100:101], v227 offset:16384
v_cvt_pk_bf16_f32 v147, v150, v151
v_mfma_f32_16x16x32_bf16 v[176:179], a[68:71], a[24:27], v[176:179]
v_exp_f32 v156, v156
v_mfma_f32_16x16x32_bf16 v[184:187], a[68:71], a[28:31], v[184:187]
ds_read_b64_tr_b16 a[102:103], v227 offset:18432
s_add_u32 s9, s9, s57
v_mfma_f32_16x16x32_bf16 v[160:163], a[72:75], a[32:35], v[160:163]
v_exp_f32 v157, v157
v_mfma_f32_16x16x32_bf16 v[168:171], a[72:75], a[36:39], v[168:171]
ds_read_b64_tr_b16 a[104:105], v228 offset:16384
v_cvt_pk_bf16_f32 v154, v156, v157
v_mfma_f32_16x16x32_bf16 v[176:179], a[72:75], a[40:43], v[176:179]
v_exp_f32 v158, v158
v_mfma_f32_16x16x32_bf16 v[184:187], a[72:75], a[44:47], v[184:187]
ds_read_b64_tr_b16 a[106:107], v228 offset:18432
buffer_load_dword v249, v247, s[88:91], s70 offen
v_mfma_f32_16x16x32_bf16 v[160:163], a[76:79], a[48:51], v[160:163]
v_exp_f32 v159, v159
v_mfma_f32_16x16x32_bf16 v[168:171], a[76:79], a[52:55], v[168:171]
ds_read_b64_tr_b16 a[108:109], v229 offset:16384
v_cvt_pk_bf16_f32 v155, v158, v159
v_mfma_f32_16x16x32_bf16 v[176:179], a[76:79], a[56:59], v[176:179]
ds_read_b64_tr_b16 a[110:111], v229 offset:18432
ds_read_b64_tr_b16 a[112:113], v226 offset:20480
v_mfma_f32_16x16x32_bf16 v[184:187], a[76:79], a[60:63], v[184:187]
ds_read_b64_tr_b16 a[114:115], v226 offset:22528
s_add_u32 s70, s70, s57
v_mfma_f32_16x16x32_bf16 v[164:167], a[80:83], a[0:3], v[192:195]
ds_read_b64_tr_b16 a[116:117], v227 offset:20480
v_mfma_f32_16x16x32_bf16 v[172:175], a[80:83], a[4:7], v[196:199]
ds_read_b64_tr_b16 a[118:119], v227 offset:22528
ds_read_b64_tr_b16 a[120:121], v228 offset:20480
v_mfma_f32_16x16x32_bf16 v[180:183], a[80:83], a[8:11], v[200:203]
v_exp_f32 v160, v160
v_mfma_f32_16x16x32_bf16 v[188:191], a[80:83], a[12:15], v[204:207]
ds_read_b64_tr_b16 a[122:123], v228 offset:22528
v_mfma_f32_16x16x32_bf16 v[164:167], a[84:87], a[16:19], v[164:167]
v_exp_f32 v161, v161
v_mfma_f32_16x16x32_bf16 v[172:175], a[84:87], a[20:23], v[172:175]
ds_read_b64_tr_b16 a[124:125], v229 offset:20480
v_cvt_pk_bf16_f32 v160, v160, v161
v_mfma_f32_16x16x32_bf16 v[180:183], a[84:87], a[24:27], v[180:183]
v_exp_f32 v162, v162
v_mfma_f32_16x16x32_bf16 v[188:191], a[84:87], a[28:31], v[188:191]
ds_read_b64_tr_b16 a[126:127], v229 offset:22528
v_mfma_f32_16x16x32_bf16 v[164:167], a[88:91], a[32:35], v[164:167]
v_exp_f32 v163, v163
v_mfma_f32_16x16x32_bf16 v[172:175], a[88:91], a[36:39], v[172:175]
v_cvt_pk_bf16_f32 v161, v162, v163
v_mfma_f32_16x16x32_bf16 v[180:183], a[88:91], a[40:43], v[180:183]
v_exp_f32 v168, v168
v_mfma_f32_16x16x32_bf16 v[188:191], a[88:91], a[44:47], v[188:191]
v_mfma_f32_16x16x32_bf16 v[164:167], a[92:95], a[48:51], v[164:167]
v_exp_f32 v169, v169
v_mfma_f32_16x16x32_bf16 v[172:175], a[92:95], a[52:55], v[172:175]
s_add_u32 s51, s51, 8192
v_cvt_pk_bf16_f32 v168, v168, v169
v_mfma_f32_16x16x32_bf16 v[180:183], a[92:95], a[56:59], v[180:183]
v_exp_f32 v170, v170
v_mfma_f32_16x16x32_bf16 v[188:191], a[92:95], a[60:63], v[188:191]
s_waitcnt vmcnt(6) lgkmcnt(0)
s_barrier
v_mfma_f32_16x16x32_bf16 v[208:211], a[128:131], v[128:131], v[208:211]
v_exp_f32 v171, v171
v_mfma_f32_16x16x32_bf16 v[212:215], a[128:131], v[136:139], v[212:215]
v_cvt_pk_bf16_f32 v169, v170, v171
v_mfma_f32_16x16x32_bf16 v[216:219], a[128:131], v[144:147], v[216:219]
v_exp_f32 v176, v176
v_mfma_f32_16x16x32_bf16 v[220:223], a[128:131], v[152:155], v[220:223]
ds_read_b128 a[64:67], v244 offset:16384
ds_read_b128 a[68:71], v245 offset:16384
v_mfma_f32_16x16x32_bf16 v[0:3], a[96:99], v[128:131], v[0:3]
v_exp_f32 v177, v177
v_mfma_f32_16x16x32_bf16 v[8:11], a[96:99], v[136:139], v[8:11]
v_cvt_pk_bf16_f32 v176, v176, v177
v_mfma_f32_16x16x32_bf16 v[16:19], a[96:99], v[144:147], v[16:19]
v_exp_f32 v178, v178
v_mfma_f32_16x16x32_bf16 v[24:27], a[96:99], v[152:155], v[24:27]
ds_read_b128 a[72:75], v244 offset:20480
v_mfma_f32_16x16x32_bf16 v[4:7], a[100:103], v[128:131], v[4:7]
v_exp_f32 v179, v179
v_mfma_f32_16x16x32_bf16 v[12:15], a[100:103], v[136:139], v[12:15]
ds_read_b128 a[76:79], v245 offset:20480
v_cvt_pk_bf16_f32 v177, v178, v179
v_mfma_f32_16x16x32_bf16 v[20:23], a[100:103], v[144:147], v[20:23]
v_exp_f32 v184, v184
v_mfma_f32_16x16x32_bf16 v[28:31], a[100:103], v[152:155], v[28:31]
v_mfma_f32_16x16x32_bf16 v[32:35], a[104:107], v[128:131], v[32:35]
v_exp_f32 v185, v185
v_mfma_f32_16x16x32_bf16 v[40:43], a[104:107], v[136:139], v[40:43]
ds_read_b128 a[80:83], v244 offset:18432
v_cvt_pk_bf16_f32 v184, v184, v185
v_mfma_f32_16x16x32_bf16 v[48:51], a[104:107], v[144:147], v[48:51]
v_exp_f32 v186, v186
v_mfma_f32_16x16x32_bf16 v[56:59], a[104:107], v[152:155], v[56:59]
ds_read_b128 a[84:87], v245 offset:18432
v_mfma_f32_16x16x32_bf16 v[36:39], a[108:111], v[128:131], v[36:39]
v_exp_f32 v187, v187
v_mfma_f32_16x16x32_bf16 v[44:47], a[108:111], v[136:139], v[44:47]
ds_read_b128 a[88:91], v244 offset:22528
v_cvt_pk_bf16_f32 v185, v186, v187
v_mfma_f32_16x16x32_bf16 v[52:55], a[108:111], v[144:147], v[52:55]
v_exp_f32 v164, v164
v_mfma_f32_16x16x32_bf16 v[60:63], a[108:111], v[152:155], v[60:63]
ds_read_b128 a[92:95], v245 offset:22528
v_mfma_f32_16x16x32_bf16 v[64:67], a[112:115], v[128:131], v[64:67]
v_exp_f32 v165, v165
v_mfma_f32_16x16x32_bf16 v[72:75], a[112:115], v[136:139], v[72:75]
v_cvt_pk_bf16_f32 v162, v164, v165
v_mfma_f32_16x16x32_bf16 v[80:83], a[112:115], v[144:147], v[80:83]
v_exp_f32 v166, v166
v_mfma_f32_16x16x32_bf16 v[88:91], a[112:115], v[152:155], v[88:91]
v_mfma_f32_16x16x32_bf16 v[68:71], a[116:119], v[128:131], v[68:71]
v_exp_f32 v167, v167
v_mfma_f32_16x16x32_bf16 v[76:79], a[116:119], v[136:139], v[76:79]
v_cvt_pk_bf16_f32 v163, v166, v167
v_mfma_f32_16x16x32_bf16 v[84:87], a[116:119], v[144:147], v[84:87]
v_exp_f32 v172, v172
v_mfma_f32_16x16x32_bf16 v[92:95], a[116:119], v[152:155], v[92:95]
v_mfma_f32_16x16x32_bf16 v[96:99], a[120:123], v[128:131], v[96:99]
v_exp_f32 v173, v173
v_mfma_f32_16x16x32_bf16 v[104:107], a[120:123], v[136:139], v[104:107]
s_add_u32 s8, s8, 8192
v_cvt_pk_bf16_f32 v170, v172, v173
v_mfma_f32_16x16x32_bf16 v[112:115], a[120:123], v[144:147], v[112:115]
v_exp_f32 v174, v174
v_mfma_f32_16x16x32_bf16 v[120:123], a[120:123], v[152:155], v[120:123]
v_mfma_f32_16x16x32_bf16 v[100:103], a[124:127], v[128:131], v[100:103]
v_exp_f32 v175, v175
v_mfma_f32_16x16x32_bf16 v[108:111], a[124:127], v[136:139], v[108:111]
v_cvt_pk_bf16_f32 v171, v174, v175
v_mfma_f32_16x16x32_bf16 v[116:119], a[124:127], v[144:147], v[116:119]
v_exp_f32 v180, v180
v_mfma_f32_16x16x32_bf16 v[124:127], a[124:127], v[152:155], v[124:127]
s_waitcnt vmcnt(2) lgkmcnt(0)
s_barrier
v_mfma_f32_16x16x32_bf16 v[128:131], a[64:67], a[0:3], v[192:195]
v_exp_f32 v181, v181
v_mfma_f32_16x16x32_bf16 v[136:139], a[64:67], a[4:7], v[196:199]
ds_read_b64_tr_b16 a[96:97], v226 offset:0
v_cvt_pk_bf16_f32 v178, v180, v181
v_mfma_f32_16x16x32_bf16 v[144:147], a[64:67], a[8:11], v[200:203]
v_exp_f32 v182, v182
v_mfma_f32_16x16x32_bf16 v[152:155], a[64:67], a[12:15], v[204:207]
ds_read_b64_tr_b16 a[98:99], v226 offset:2048
v_mfma_f32_16x16x32_bf16 v[128:131], a[68:71], a[16:19], v[128:131]
v_exp_f32 v183, v183
v_mfma_f32_16x16x32_bf16 v[136:139], a[68:71], a[20:23], v[136:139]
ds_read_b64_tr_b16 a[100:101], v227 offset:0
v_cvt_pk_bf16_f32 v179, v182, v183
v_mfma_f32_16x16x32_bf16 v[144:147], a[68:71], a[24:27], v[144:147]
v_exp_f32 v188, v188
v_mfma_f32_16x16x32_bf16 v[152:155], a[68:71], a[28:31], v[152:155]
ds_read_b64_tr_b16 a[102:103], v227 offset:2048
v_mfma_f32_16x16x32_bf16 v[128:131], a[72:75], a[32:35], v[128:131]
v_exp_f32 v189, v189
v_mfma_f32_16x16x32_bf16 v[136:139], a[72:75], a[36:39], v[136:139]
ds_read_b64_tr_b16 a[104:105], v228 offset:0
v_cvt_pk_bf16_f32 v186, v188, v189
v_mfma_f32_16x16x32_bf16 v[144:147], a[72:75], a[40:43], v[144:147]
v_exp_f32 v190, v190
v_mfma_f32_16x16x32_bf16 v[152:155], a[72:75], a[44:47], v[152:155]
ds_read_b64_tr_b16 a[106:107], v228 offset:2048
v_mfma_f32_16x16x32_bf16 v[128:131], a[76:79], a[48:51], v[128:131]
v_exp_f32 v191, v191
v_mfma_f32_16x16x32_bf16 v[136:139], a[76:79], a[52:55], v[136:139]
ds_read_b64_tr_b16 a[108:109], v229 offset:0
v_cvt_pk_bf16_f32 v187, v190, v191
v_mfma_f32_16x16x32_bf16 v[144:147], a[76:79], a[56:59], v[144:147]
ds_read_b64_tr_b16 a[110:111], v229 offset:2048
ds_read_b64_tr_b16 a[112:113], v226 offset:4096
v_mfma_f32_16x16x32_bf16 v[152:155], a[76:79], a[60:63], v[152:155]
ds_read_b64_tr_b16 a[114:115], v226 offset:6144
v_mfma_f32_16x16x32_bf16 v[132:135], a[80:83], a[0:3], v[192:195]
ds_read_b64_tr_b16 a[116:117], v227 offset:4096
v_mfma_f32_16x16x32_bf16 v[140:143], a[80:83], a[4:7], v[196:199]
ds_read_b64_tr_b16 a[118:119], v227 offset:6144
ds_read_b64_tr_b16 a[120:121], v228 offset:4096
v_mfma_f32_16x16x32_bf16 v[148:151], a[80:83], a[8:11], v[200:203]
v_exp_f32 v128, v128
v_mfma_f32_16x16x32_bf16 v[156:159], a[80:83], a[12:15], v[204:207]
ds_read_b64_tr_b16 a[122:123], v228 offset:6144
v_mfma_f32_16x16x32_bf16 v[132:135], a[84:87], a[16:19], v[132:135]
v_exp_f32 v129, v129
v_mfma_f32_16x16x32_bf16 v[140:143], a[84:87], a[20:23], v[140:143]
ds_read_b64_tr_b16 a[124:125], v229 offset:4096
v_cvt_pk_bf16_f32 v128, v128, v129
v_mfma_f32_16x16x32_bf16 v[148:151], a[84:87], a[24:27], v[148:151]
v_exp_f32 v130, v130
v_mfma_f32_16x16x32_bf16 v[156:159], a[84:87], a[28:31], v[156:159]
ds_read_b64_tr_b16 a[126:127], v229 offset:6144
v_mfma_f32_16x16x32_bf16 v[132:135], a[88:91], a[32:35], v[132:135]
v_exp_f32 v131, v131
v_mfma_f32_16x16x32_bf16 v[140:143], a[88:91], a[36:39], v[140:143]
v_cvt_pk_bf16_f32 v129, v130, v131
v_mfma_f32_16x16x32_bf16 v[148:151], a[88:91], a[40:43], v[148:151]
v_exp_f32 v136, v136
v_mfma_f32_16x16x32_bf16 v[156:159], a[88:91], a[44:47], v[156:159]
v_mfma_f32_16x16x32_bf16 v[132:135], a[92:95], a[48:51], v[132:135]
v_exp_f32 v137, v137
v_mfma_f32_16x16x32_bf16 v[140:143], a[92:95], a[52:55], v[140:143]
s_add_u32 s51, s51, 8192
v_cvt_pk_bf16_f32 v136, v136, v137
v_mfma_f32_16x16x32_bf16 v[148:151], a[92:95], a[56:59], v[148:151]
v_exp_f32 v138, v138
v_mfma_f32_16x16x32_bf16 v[156:159], a[92:95], a[60:63], v[156:159]
s_waitcnt lgkmcnt(0)
s_barrier
v_mfma_f32_16x16x32_bf16 v[208:211], a[128:131], v[160:163], v[208:211]
v_exp_f32 v139, v139
v_mfma_f32_16x16x32_bf16 v[212:215], a[128:131], v[168:171], v[212:215]
v_cvt_pk_bf16_f32 v137, v138, v139
v_mfma_f32_16x16x32_bf16 v[216:219], a[128:131], v[176:179], v[216:219]
v_exp_f32 v144, v144
v_mfma_f32_16x16x32_bf16 v[220:223], a[128:131], v[184:187], v[220:223]
ds_read_b128 a[64:67], v244 offset:0
ds_read_b128 a[68:71], v245 offset:0
v_mfma_f32_16x16x32_bf16 v[0:3], a[96:99], v[160:163], v[0:3]
v_exp_f32 v145, v145
v_mfma_f32_16x16x32_bf16 v[8:11], a[96:99], v[168:171], v[8:11]
v_cvt_pk_bf16_f32 v144, v144, v145
v_mfma_f32_16x16x32_bf16 v[16:19], a[96:99], v[176:179], v[16:19]
v_exp_f32 v146, v146
v_mfma_f32_16x16x32_bf16 v[24:27], a[96:99], v[184:187], v[24:27]
ds_read_b128 a[72:75], v244 offset:4096
v_mfma_f32_16x16x32_bf16 v[4:7], a[100:103], v[160:163], v[4:7]
v_exp_f32 v147, v147
v_mfma_f32_16x16x32_bf16 v[12:15], a[100:103], v[168:171], v[12:15]
ds_read_b128 a[76:79], v245 offset:4096
v_cvt_pk_bf16_f32 v145, v146, v147
v_mfma_f32_16x16x32_bf16 v[20:23], a[100:103], v[176:179], v[20:23]
v_exp_f32 v152, v152
v_mfma_f32_16x16x32_bf16 v[28:31], a[100:103], v[184:187], v[28:31]
v_mfma_f32_16x16x32_bf16 v[32:35], a[104:107], v[160:163], v[32:35]
v_exp_f32 v153, v153
v_mfma_f32_16x16x32_bf16 v[40:43], a[104:107], v[168:171], v[40:43]
ds_read_b128 a[80:83], v244 offset:2048
v_cvt_pk_bf16_f32 v152, v152, v153
v_mfma_f32_16x16x32_bf16 v[48:51], a[104:107], v[176:179], v[48:51]
v_exp_f32 v154, v154
v_mfma_f32_16x16x32_bf16 v[56:59], a[104:107], v[184:187], v[56:59]
ds_read_b128 a[84:87], v245 offset:2048
v_mfma_f32_16x16x32_bf16 v[36:39], a[108:111], v[160:163], v[36:39]
v_exp_f32 v155, v155
v_mfma_f32_16x16x32_bf16 v[44:47], a[108:111], v[168:171], v[44:47]
ds_read_b128 a[88:91], v244 offset:6144
v_cvt_pk_bf16_f32 v153, v154, v155
v_mfma_f32_16x16x32_bf16 v[52:55], a[108:111], v[176:179], v[52:55]
v_exp_f32 v132, v132
v_mfma_f32_16x16x32_bf16 v[60:63], a[108:111], v[184:187], v[60:63]
ds_read_b128 a[92:95], v245 offset:6144
v_mfma_f32_16x16x32_bf16 v[64:67], a[112:115], v[160:163], v[64:67]
v_exp_f32 v133, v133
v_mfma_f32_16x16x32_bf16 v[72:75], a[112:115], v[168:171], v[72:75]
v_cvt_pk_bf16_f32 v130, v132, v133
v_mfma_f32_16x16x32_bf16 v[80:83], a[112:115], v[176:179], v[80:83]
v_exp_f32 v134, v134
v_mfma_f32_16x16x32_bf16 v[88:91], a[112:115], v[184:187], v[88:91]
v_mfma_f32_16x16x32_bf16 v[68:71], a[116:119], v[160:163], v[68:71]
v_exp_f32 v135, v135
v_mfma_f32_16x16x32_bf16 v[76:79], a[116:119], v[168:171], v[76:79]
v_cvt_pk_bf16_f32 v131, v134, v135
v_mfma_f32_16x16x32_bf16 v[84:87], a[116:119], v[176:179], v[84:87]
v_exp_f32 v140, v140
v_mfma_f32_16x16x32_bf16 v[92:95], a[116:119], v[184:187], v[92:95]
v_mfma_f32_16x16x32_bf16 v[96:99], a[120:123], v[160:163], v[96:99]
v_exp_f32 v141, v141
v_mfma_f32_16x16x32_bf16 v[104:107], a[120:123], v[168:171], v[104:107]
s_add_u32 s8, s8, 8192
v_cvt_pk_bf16_f32 v138, v140, v141
v_mfma_f32_16x16x32_bf16 v[112:115], a[120:123], v[176:179], v[112:115]
v_exp_f32 v142, v142
v_mfma_f32_16x16x32_bf16 v[120:123], a[120:123], v[184:187], v[120:123]
s_cmp_lt_u32 s8, s52
v_mfma_f32_16x16x32_bf16 v[100:103], a[124:127], v[160:163], v[100:103]
v_exp_f32 v143, v143
v_mfma_f32_16x16x32_bf16 v[108:111], a[124:127], v[168:171], v[108:111]
v_cvt_pk_bf16_f32 v139, v142, v143
v_mfma_f32_16x16x32_bf16 v[116:119], a[124:127], v[176:179], v[116:119]
v_exp_f32 v148, v148
v_mfma_f32_16x16x32_bf16 v[124:127], a[124:127], v[184:187], v[124:127]
s_cbranch_scc1 ATT_LOOP1
s_branch ATT_DONE
FALLBACK:
s_waitcnt vmcnt(0) lgkmcnt(0)
s_mov_b32 s53, 0
s_mov_b32 s54, 0
s_mov_b32 s51, s52
v_add_u32 v226, s56, v225
v_xor_b32 v227, 32, v226
v_xor_b32 v228, 64, v226
v_xor_b32 v229, 96, v226
v_mov_b32 v212, 0xff800000
v_mov_b32 v213, 0xff800000
v_mov_b32 v214, 0xff800000
v_mov_b32 v215, 0xff800000
v_accvgpr_write_b32 a128, s100
v_accvgpr_write_b32 a129, s100
v_accvgpr_write_b32 a130, s100
v_accvgpr_write_b32 a131, s100
FB_LOOP:
s_barrier
s_add_u32 m0, s50, 0
s_nop 0
buffer_load_dwordx4 v234, s[20:23], s51 offen offset:0 lds
buffer_load_dwordx4 v235, s[20:23], s51 offen offset:1024 lds
buffer_load_dwordx4 v236, s[20:23], s51 offen offset:2048 lds
buffer_load_dwordx4 v237, s[20:23], s51 offen offset:3072 lds
s_sub_u32 s51, s51, 8192
s_waitcnt vmcnt(0)
s_barrier
ds_read_b128 a[64:67], v244 offset:0
ds_read_b128 a[68:71], v245 offset:0
ds_read_b128 a[72:75], v244 offset:4096
ds_read_b128 a[76:79], v245 offset:4096
ds_read_b128 a[80:83], v244 offset:2048
ds_read_b128 a[84:87], v245 offset:2048
ds_read_b128 a[88:91], v244 offset:6144
ds_read_b128 a[92:95], v245 offset:6144
s_waitcnt lgkmcnt(7)
v_mfma_f32_16x16x32_bf16 v[160:163], a[64:67], a[0:3], 0
v_mfma_f32_16x16x32_bf16 v[168:171], a[64:67], a[4:7], 0
v_mfma_f32_16x16x32_bf16 v[176:179], a[64:67], a[8:11], 0
v_mfma_f32_16x16x32_bf16 v[184:187], a[64:67], a[12:15], 0
s_waitcnt lgkmcnt(6)
v_mfma_f32_16x16x32_bf16 v[160:163], a[68:71], a[16:19], v[160:163]
v_mfma_f32_16x16x32_bf16 v[168:171], a[68:71], a[20:23], v[168:171]
v_mfma_f32_16x16x32_bf16 v[176:179], a[68:71], a[24:27], v[176:179]
v_mfma_f32_16x16x32_bf16 v[184:187], a[68:71], a[28:31], v[184:187]
s_waitcnt lgkmcnt(5)
v_mfma_f32_16x16x32_bf16 v[160:163], a[72:75], a[32:35], v[160:163]
v_mfma_f32_16x16x32_bf16 v[168:171], a[72:75], a[36:39], v[168:171]
v_mfma_f32_16x16x32_bf16 v[176:179], a[72:75], a[40:43], v[176:179]
v_mfma_f32_16x16x32_bf16 v[184:187], a[72:75], a[44:47], v[184:187]
s_waitcnt lgkmcnt(4)
v_mfma_f32_16x16x32_bf16 v[160:163], a[76:79], a[48:51], v[160:163]
v_mfma_f32_16x16x32_bf16 v[168:171], a[76:79], a[52:55], v[168:171]
v_mfma_f32_16x16x32_bf16 v[176:179], a[76:79], a[56:59], v[176:179]
v_mfma_f32_16x16x32_bf16 v[184:187], a[76:79], a[60:63], v[184:187]
s_waitcnt lgkmcnt(3)
v_mfma_f32_16x16x32_bf16 v[164:167], a[80:83], a[0:3], 0
v_mfma_f32_16x16x32_bf16 v[172:175], a[80:83], a[4:7], 0
v_mfma_f32_16x16x32_bf16 v[180:183], a[80:83], a[8:11], 0
v_mfma_f32_16x16x32_bf16 v[188:191], a[80:83], a[12:15], 0
s_waitcnt lgkmcnt(2)
v_mfma_f32_16x16x32_bf16 v[164:167], a[84:87], a[16:19], v[164:167]
v_mfma_f32_16x16x32_bf16 v[172:175], a[84:87], a[20:23], v[172:175]
v_mfma_f32_16x16x32_bf16 v[180:183], a[84:87], a[24:27], v[180:183]
v_mfma_f32_16x16x32_bf16 v[188:191], a[84:87], a[28:31], v[188:191]
s_waitcnt lgkmcnt(1)
v_mfma_f32_16x16x32_bf16 v[164:167], a[88:91], a[32:35], v[164:167]
v_mfma_f32_16x16x32_bf16 v[172:175], a[88:91], a[36:39], v[172:175]
v_mfma_f32_16x16x32_bf16 v[180:183], a[88:91], a[40:43], v[180:183]
v_mfma_f32_16x16x32_bf16 v[188:191], a[88:91], a[44:47], v[188:191]
s_waitcnt lgkmcnt(0)
v_mfma_f32_16x16x32_bf16 v[164:167], a[92:95], a[48:51], v[164:167]
v_mfma_f32_16x16x32_bf16 v[172:175], a[92:95], a[52:55], v[172:175]
v_mfma_f32_16x16x32_bf16 v[180:183], a[92:95], a[56:59], v[180:183]
v_mfma_f32_16x16x32_bf16 v[188:191], a[92:95], a[60:63], v[188:191]
v_max3_f32 v212, v160, v161, v212
v_max3_f32 v212, v162, v163, v212
v_max3_f32 v213, v168, v169, v213
v_max3_f32 v213, v170, v171, v213
v_max3_f32 v214, v176, v177, v214
v_max3_f32 v214, v178, v179, v214
v_max3_f32 v215, v184, v185, v215
v_max3_f32 v215, v186, v187, v215
v_max3_f32 v212, v164, v165, v212
v_max3_f32 v212, v166, v167, v212
v_max3_f32 v213, v172, v173, v213
v_max3_f32 v213, v174, v175, v213
v_max3_f32 v214, v180, v181, v214
v_max3_f32 v214, v182, v183, v214
v_max3_f32 v215, v188, v189, v215
v_max3_f32 v215, v190, v191, v215
s_cmp_ge_u32 s51, s55
s_cbranch_scc1 FB_LOOP
s_add_u32 m0, s50, 16384
s_add_u32 s44, s55, 8192
buffer_load_dwordx4 v234, s[20:23], s44 offen offset:0 lds
buffer_load_dwordx4 v235, s[20:23], s44 offen offset:1024 lds
buffer_load_dwordx4 v236, s[20:23], s44 offen offset:2048 lds
buffer_load_dwordx4 v237, s[20:23], s44 offen offset:3072 lds
s_add_u32 m0, s50, 32768
s_add_u32 s44, s55, 0
buffer_load_dwordx4 v234, s[24:27], s44 offen offset:0 lds
buffer_load_dwordx4 v235, s[24:27], s44 offen offset:1024 lds
buffer_load_dwordx4 v236, s[24:27], s44 offen offset:2048 lds
buffer_load_dwordx4 v237, s[24:27], s44 offen offset:3072 lds
s_add_u32 m0, s50, 49152
s_add_u32 s44, s55, 8192
buffer_load_dwordx4 v234, s[24:27], s44 offen offset:0 lds
buffer_load_dwordx4 v235, s[24:27], s44 offen offset:1024 lds
buffer_load_dwordx4 v236, s[24:27], s44 offen offset:2048 lds
buffer_load_dwordx4 v237, s[24:27], s44 offen offset:3072 lds
buffer_load_dword v249, off, s[20:23], 0
s_branch HAVE_MAX
P1_RETRY:
s_mov_b32 s71, 0
P1_LOOP:
buffer_load_dwordx4 v[150:153], v252, s[36:39], s12 offen sc1
buffer_load_dwordx4 v[154:157], v252, s[36:39], s12 offen offset:2304 sc1
s_waitcnt vmcnt(0)
v_xor_b32 v158, s3, v151
v_xor_b32 v159, s3, v153
v_or_b32 v158, v158, v159
v_xor_b32 v159, s3, v155
v_or_b32 v158, v158, v159
v_xor_b32 v159, s3, v157
v_or_b32 v158, v158, v159
v_cmp_ne_u32 vcc, 0, v158
s_nop 4
s_cbranch_vccz P1_OK
s_add_u32 s71, s71, 1
s_cmp_lt_u32 s71, 40000
s_cbranch_scc1 P1_LOOP
s_branch P1_OK
P2_RETRY:
s_mov_b32 s71, 0
P2_LOOP:
buffer_load_dwordx4 v[192:195], v252, s[36:39], s13 offen offset:0 sc1
buffer_load_dwordx4 v[196:199], v252, s[36:39], s13 offen offset:2304 sc1
buffer_load_dwordx4 v[200:203], v252, s[36:39], s14 offen offset:0 sc1
buffer_load_dwordx4 v[204:207], v252, s[36:39], s14 offen offset:2304 sc1
buffer_load_dword v208, v254, s[36:39], s12 offen sc1
s_waitcnt vmcnt(0)
v_xor_b32 v210, s3, v193
v_xor_b32 v211, s3, v195
v_or_b32 v210, v210, v211
v_xor_b32 v211, s3, v197
v_or_b32 v210, v210, v211
v_xor_b32 v211, s3, v199
v_or_b32 v210, v210, v211
v_xor_b32 v211, s3, v201
v_or_b32 v210, v210, v211
v_xor_b32 v211, s3, v203
v_or_b32 v210, v210, v211
v_xor_b32 v211, s3, v205
v_or_b32 v210, v210, v211
v_xor_b32 v211, s3, v207
v_or_b32 v210, v210, v211
v_xor_b32 v211, s3, v208
v_or_b32 v210, v210, v211
v_cmp_ne_u32 vcc, 0, v210
s_nop 4
s_cbranch_vccz P2_OK
s_add_u32 s71, s71, 1
s_cmp_lt_u32 s71, 40000
s_cbranch_scc1 P2_LOOP
s_branch P2_OK
S1_SLOW2:
s_add_u32 m0, s43, 0
s_add_u32 s44, s52, 0
buffer_load_dwordx4 v234, s[88:91], s44 offen offset:0 lds
buffer_load_dwordx4 v235, s[88:91], s44 offen offset:1024 lds
buffer_load_dwordx4 v236, s[88:91], s44 offen offset:2048 lds
buffer_load_dwordx4 v237, s[88:91], s44 offen offset:3072 lds
s_add_u32 m0, s43, 4096
s_add_u32 s44, s52, 589824
buffer_load_dwordx4 v234, s[88:91], s44 offen offset:0 lds
buffer_load_dwordx4 v235, s[88:91], s44 offen offset:1024 lds
buffer_load_dwordx4 v236, s[88:91], s44 offen offset:2048 lds
buffer_load_dwordx4 v237, s[88:91], s44 offen offset:3072 lds
s_barrier
s_mov_b32 s55, 0
s_branch S1_J
S1_SLOW1:
s_mov_b32 s55, 0
s_add_u32 m0, s43, 0
s_add_u32 s44, s52, 0
buffer_load_dwordx4 v234, s[88:91], s44 offen offset:0 lds
buffer_load_dwordx4 v235, s[88:91], s44 offen offset:1024 lds
buffer_load_dwordx4 v236, s[88:91], s44 offen offset:2048 lds
buffer_load_dwordx4 v237, s[88:91], s44 offen offset:3072 lds
s_add_u32 m0, s43, 4096
s_add_u32 s44, s52, 589824
buffer_load_dwordx4 v234, s[88:91], s44 offen offset:0 lds
buffer_load_dwordx4 v235, s[88:91], s44 offen offset:1024 lds
buffer_load_dwordx4 v236, s[88:91], s44 offen offset:2048 lds
buffer_load_dwordx4 v237, s[88:91], s44 offen offset:3072 lds
s_mov_b32 s71, 0
s_cmp_lg_u32 s40, 0
s_cbranch_scc1 S1A_OK
S1A_LOOP:
buffer_load_dword v253, v252, s[36:39], s54 offen offset:1536 sc1
s_add_u32 s71, s71, 1
s_cmp_lt_u32 s71, 40000
s_waitcnt vmcnt(0)
v_cmp_ne_u32 vcc, s3, v253
s_nop 4
s_cbranch_vccz S1A_OK
s_cbranch_scc1 S1A_LOOP
S1A_OK:
s_barrier
s_buffer_load_dwordx8 s[20:27], s[36:39], s54 offset:128
buffer_load_dwordx4 v[4:7], v120, s[36:39], s9 offen
buffer_load_dwordx4 v[8:11], v120, s[36:39], s10 offen
buffer_load_dwordx4 v[12:15], v120, s[36:39], s11 offen
buffer_load_dwordx4 v[16:19], v120, s[36:39], s12 offen
buffer_load_dwordx4 v[20:23], v120, s[36:39], s13 offen
buffer_load_dwordx4 v[24:27], v120, s[36:39], s14 offen
buffer_load_dwordx4 v[28:31], v120, s[36:39], s15 offen
s_waitcnt lgkmcnt(0)
s_mov_b32 s20, s3
s_mov_b32 s58, s3
s_mov_b32 s59, s3
s_xor_b64 s[20:21], s[20:21], s[58:59]
s_xor_b64 s[22:23], s[22:23], s[58:59]
s_xor_b64 s[24:25], s[24:25], s[58:59]
s_xor_b64 s[26:27], s[26:27], s[58:59]
s_or_b64 s[20:21], s[20:21], s[22:23]
s_or_b64 s[24:25], s[24:25], s[26:27]
s_or_b64 s[20:21], s[20:21], s[24:25]
s_cbranch_scc0 S1_OK
S1_J:
s_mov_b32 s71, 0
s_cmp_lg_u32 s40, 0
s_cbranch_scc1 S1_OK
S1_LOOP:
buffer_load_dword v253, v252, s[36:39], s54 offen offset:0 sc1
s_add_u32 s71, s71, 1
s_cmp_lt_u32 s71, 40000
s_waitcnt vmcnt(0)
v_cmp_ne_u32 vcc, s3, v253
s_nop 4
s_cbranch_vccz S1_OK
s_cbranch_scc1 S1_LOOP
S1_OK:
s_barrier
s_branch S1_B
S3_SLOW2:
s_barrier
s_mov_b32 s55, 0
s_branch S3_J
S3_SLOW1:
s_mov_b32 s55, 0
s_mov_b32 s71, 0
s_cmp_lg_u32 s40, 0
s_cbranch_scc1 S3A_OK
S3A_LOOP:
buffer_load_dword v253, v252, s[36:39], s54 offen offset:2048 sc1
s_add_u32 s71, s71, 1
s_cmp_lt_u32 s71, 40000
s_waitcnt vmcnt(0)
v_cmp_ne_u32 vcc, s3, v253
s_nop 4
s_cbranch_vccz S3A_OK
s_cbranch_scc1 S3A_LOOP
S3A_OK:
s_barrier
s_buffer_load_dwordx8 s[20:27], s[36:39], s54 offset:1152
buffer_load_dwordx4 v[4:7], v120, s[36:39], s9 offen
buffer_load_dwordx4 v[8:11], v120, s[36:39], s10 offen
buffer_load_dwordx4 v[12:15], v120, s[36:39], s11 offen
buffer_load_dwordx4 v[16:19], v120, s[36:39], s12 offen
buffer_load_dwordx4 v[20:23], v120, s[36:39], s13 offen
buffer_load_dwordx4 v[24:27], v120, s[36:39], s14 offen
buffer_load_dwordx4 v[28:31], v120, s[36:39], s15 offen
s_waitcnt lgkmcnt(0)
s_mov_b32 s20, s3
s_mov_b32 s58, s3
s_mov_b32 s59, s3
s_xor_b64 s[20:21], s[20:21], s[58:59]
s_xor_b64 s[22:23], s[22:23], s[58:59]
s_xor_b64 s[24:25], s[24:25], s[58:59]
s_xor_b64 s[26:27], s[26:27], s[58:59]
s_or_b64 s[20:21], s[20:21], s[22:23]
s_or_b64 s[24:25], s[24:25], s[26:27]
s_or_b64 s[20:21], s[20:21], s[24:25]
s_cbranch_scc0 S3_OK
S3_J:
s_mov_b32 s71, 0
s_cmp_lg_u32 s40, 0
s_cbranch_scc1 S3_OK
S3_LOOP:
buffer_load_dword v253, v252, s[36:39], s54 offen offset:1024 sc1
s_add_u32 s71, s71, 1
s_cmp_lt_u32 s71, 40000
s_waitcnt vmcnt(0)
v_cmp_ne_u32 vcc, s3, v253
s_nop 4
s_cbranch_vccz S3_OK
s_cbranch_scc1 S3_LOOP
S3_OK:
s_barrier
s_branch S3_B
s_endpgm
CODE_END:
.section .rodata,"a"
.p2align 6
.amdhsa_kernel adaLN_cond__sliding_block_cached__glu_gated_glu__prompt_kernel
  .amdhsa_next_free_vgpr 512
  .amdhsa_next_free_sgpr 102
  .amdhsa_accum_offset 256
  .amdhsa_group_segment_fixed_size 0
  .amdhsa_kernarg_size 112
  .amdhsa_user_sgpr_count 2
  .amdhsa_user_sgpr_kernarg_segment_ptr 1
  .amdhsa_system_sgpr_workgroup_id_x 1
.end_amdhsa_kernel
```
